```python
import torch

def _softmax(x, axis=-1):
    return torch.softmax(x, dim=axis)

def _gelu(x):
    return torch.nn.functional.gelu(x, approximate='tanh')

def _silu(x):
    return torch.nn.functional.silu(x)

def _sigmoid(x):
    return torch.sigmoid(x)

def _layernorm(x, axis=-1, eps=1e-05):
    m = x.mean(dim=axis, keepdim=True)
    v = x.var(dim=axis, keepdim=True, unbiased=False)
    return (x - m) / torch.sqrt(v + eps)

def _scatter_add(tgt, idx, src, axis=0):
    return tgt.clone().index_add_(axis, idx, src)

def _segment_sum(src, seg, n):
    out = torch.zeros((n,) + src.shape[1:], dtype=src.dtype)
    return out.index_add_(0, seg, src)

def _pad(x, pw):
    flat = tuple((v for pair in reversed(pw) for v in pair))
    return torch.nn.functional.pad(x, flat)
kernel_name = 'recurrent_scan__memory_aug_recurrent_mem_tr__glu_gated_swiglu__prompt'

def setup_inputs():

    _w = lambda a: (lambda t: t.to(torch.bfloat16) if t.is_floating_point() else t)(torch.as_tensor(a))

    def _A_setup():
        B, S, Dm = (1, 2048, 448)
        H, Dh = (16, 256)
        M, seg = (8, 32)
        seg = min(seg, S)
        S = S // seg * seg
        return {'x': _w((lambda *s: torch.randn(*s, dtype=torch.bfloat16) * 0.1)(B, S, Dm)), 'mem0': _w((lambda *s: torch.randn(*s, dtype=torch.bfloat16) * 1.6)(B, M, Dm)), 'Wq': _w((lambda *s: torch.randn(*s, dtype=torch.bfloat16) * 0.8)(Dm, H, Dh) * Dm ** (-0.5)), 'Wk': _w((lambda *s: torch.randn(*s, dtype=torch.bfloat16) * 0.8)(Dm, H, Dh) * Dm ** (-0.5)), 'Wv': _w((lambda *s: torch.randn(*s, dtype=torch.bfloat16) * 1.6)(Dm, H, Dh) * Dm ** (-0.5)), 'Wo': _w((lambda *s: torch.randn(*s, dtype=torch.bfloat16) * 1.6)(H, Dh, Dm) * (H * Dh) ** (-0.5)), 'seg_len': seg}
    _A_in = _A_setup()

    def _B_setup():
        B, S, D, F = (1, 2048, 448, 1792)
        return {'x': _w((lambda *s: torch.randn(*s, dtype=torch.bfloat16) * 0.1)(B, S, D)), 'w1': _w((lambda *s: torch.randn(*s, dtype=torch.bfloat16) * 0.4)(D, F) * (2.0 / D) ** 0.5), 'w3': _w((lambda *s: torch.randn(*s, dtype=torch.bfloat16) * 0.4)(D, F) * (2.0 / D) ** 0.5), 'w2': _w((lambda *s: torch.randn(*s, dtype=torch.bfloat16) * 0.4)(F, D) * (2.0 / F) ** 0.5)}
    _B_in = _B_setup()
    return {'A_x': _A_in['x'], 'A_mem0': _A_in['mem0'], 'A_Wq': _A_in['Wq'], 'A_Wk': _A_in['Wk'], 'A_Wv': _A_in['Wv'], 'A_Wo': _A_in['Wo'], 'A_seg_len': _A_in['seg_len'], 'B_x': _B_in['x'], 'B_w1': _B_in['w1'], 'B_w3': _B_in['w3'], 'B_w2': _B_in['w2']}

def reference(A_x, A_mem0, A_Wq, A_Wk, A_Wv, A_Wo, A_seg_len, B_x, B_w1, B_w3, B_w2):

    def _A_ref(x, mem0, Wq, Wk, Wv, Wo, seg_len):
        B, S, Dm = x.shape
        H, Dh = (Wq.shape[1], Wq.shape[2])
        M = mem0.shape[1]
        scale = Dh ** (-0.5)
        n_seg = S // seg_len
        L = M + seg_len
        idx = torch.arange(L)
        mask = (idx[:, None] < M) | (idx[:, None] >= idx[None, :])
        mem = mem0
        outs = []
        for s in range(n_seg):
            xs = x[:, s * seg_len:(s + 1) * seg_len, :].clone()
            h = torch.concatenate([mem, xs], axis=1)
            q = torch.einsum('btd,dhe->bhte', h, Wq)
            k = torch.einsum('btd,dhe->bhte', h, Wk)
            v = torch.einsum('btd,dhe->bhte', h, Wv)
            scores = torch.einsum('bhqe,bhke->bhqk', q, k) * scale
            scores = torch.where(mask[None, None], scores, -1000000000.0)
            p = _softmax(scores, axis=-1)
            o = torch.einsum('bhqk,bhke->bhqe', p, v)
            o = torch.einsum('bhte,hed->btd', o, Wo)
            mem = o[:, :M, :].clone()
            outs.append(o[:, M:, :])
        return torch.concatenate(outs, axis=1)

    def _B_ref(x, w1, w3, w2):
        gate = torch.einsum('bsd,df->bsf', x, w1)
        up = torch.einsum('bsd,df->bsf', x, w3)
        h = _silu(gate) * up
        out = torch.einsum('bsf,fd->bsd', h, w2)
        return out
    x = A_x
    xn = _layernorm(x, axis=-1)
    s = _A_ref(xn, A_mem0, A_Wq, A_Wk, A_Wv, A_Wo, A_seg_len)
    g = _silu(_B_ref(xn, B_w1, B_w3, B_w2))
    return x + s * g
```

```asm
; @launch kernel=recurrent_scan__memory_aug_recurrent_mem_tr__glu_gated_swiglu__prompt_kernel grid=(256,1,1) block=(256,1,1) lds=161856
.amdgcn_target "amdgcn-amd-amdhsa--gfx950"
.text
.globl recurrent_scan__memory_aug_recurrent_mem_tr__glu_gated_swiglu__prompt_kernel
.p2align 8
.type recurrent_scan__memory_aug_recurrent_mem_tr__glu_gated_swiglu__prompt_kernel,@function
recurrent_scan__memory_aug_recurrent_mem_tr__glu_gated_swiglu__prompt_kernel:
    s_cmp_ge_u32 s2, 256
    s_cbranch_scc1 Lexit0_2
    s_load_dwordx2 s[4:5], s[0:1], 104
    s_load_dwordx2 s[6:7], s[0:1], 96
    s_load_dwordx2 s[44:45], s[0:1], 0
    s_load_dwordx2 s[46:47], s[0:1], 16
    s_load_dwordx2 s[48:49], s[0:1], 24
    s_load_dwordx2 s[50:51], s[0:1], 32
    s_load_dwordx2 s[52:53], s[0:1], 40
    s_load_dwordx2 s[54:55], s[0:1], 64
    s_load_dwordx2 s[56:57], s[0:1], 72
    s_load_dwordx2 s[58:59], s[0:1], 80
    s_load_dwordx2 s[60:61], s[0:1], 8
    s_load_dwordx2 s[62:63], s[0:1], 88
    v_lshrrev_b32 v1, 6, v0
    s_nop 0
    v_readfirstlane_b32 s23, v1
    s_waitcnt lgkmcnt(0)
    s_getreg_b32 s70, hwreg(HW_REG_XCC_ID)
    s_and_b32 s70, s70, 7
    s_lshl_b32 s25, s70, 2
    v_mov_b32 v251, s25
    v_mov_b32 v252, 1
    s_lshl_b32 s20, s2, 3
    s_cmp_lg_u32 s2, 2
    s_cbranch_scc1 Lpz_3
    v_lshlrev_b32 v11, 4, v0
    v_mov_b32 v12, 0
    v_mov_b32 v13, 0
    v_mov_b32 v14, 0
    v_mov_b32 v15, 0
    s_add_u32 s68, s4, 0x7900000
    s_addc_u32 s69, s5, 0
    global_store_dwordx4 v11, v[12:15], s[68:69] sc1
    s_add_u32 s68, s68, 0x1000
    s_addc_u32 s69, s69, 0
    global_store_dwordx4 v11, v[12:15], s[68:69] sc1
    s_add_u32 s68, s68, 0x1000
    s_addc_u32 s69, s69, 0
    global_store_dwordx4 v11, v[12:15], s[68:69] sc1
    s_add_u32 s68, s68, 0x1000
    s_addc_u32 s69, s69, 0
    global_store_dwordx4 v11, v[12:15], s[68:69] sc1
    s_add_u32 s68, s68, 0x1000
    s_addc_u32 s69, s69, 0
    global_store_dwordx4 v11, v[12:15], s[68:69] sc1
    s_add_u32 s68, s68, 0x1000
    s_addc_u32 s69, s69, 0
    global_store_dwordx4 v11, v[12:15], s[68:69] sc1
    s_add_u32 s68, s68, 0x1000
    s_addc_u32 s69, s69, 0
    global_store_dwordx4 v11, v[12:15], s[68:69] sc1
    s_add_u32 s68, s68, 0x1000
    s_addc_u32 s69, s69, 0
    global_store_dwordx4 v11, v[12:15], s[68:69] sc1
    s_add_u32 s68, s68, 0x1000
    s_addc_u32 s69, s69, 0
Lpz_3:
    v_add_u32 v2, 0, v0
    v_min_u32 v2, 447, v2
    v_and_b32 v3, 7, v2
    v_mul_u32_u24 v3, 896, v3
    v_lshrrev_b32 v8, 3, v2
    v_lshl_add_u32 v248, v8, 4, v3
    v_lshlrev_b32 v253, 4, v2
    v_add_u32 v2, 256, v0
    v_min_u32 v2, 447, v2
    v_and_b32 v3, 7, v2
    v_mul_u32_u24 v3, 896, v3
    v_lshrrev_b32 v8, 3, v2
    v_lshl_add_u32 v249, v8, 4, v3
    v_lshlrev_b32 v254, 4, v2
    s_cmp_lg_u32 s2, 0
    s_cbranch_scc1 Lm0_4
    global_load_dwordx4 a[240:243], v248, s[60:61]
    global_load_dwordx4 a[244:247], v249, s[60:61]
Lm0_4:
    v_and_b32 v1, 63, v0
    s_lshl_b32 s25, s23, 1
    s_add_u32 s25, s25, s20
    s_mul_i32 s26, s25, 896
    v_lshl_add_u32 v2, v1, 4, s26
    v_cmp_gt_u32 s[64:65], 56, v1
    v_mov_b32 v240, 0
    v_mov_b32 v241, 0
    v_mov_b32 v242, 0
    v_mov_b32 v243, 0
    v_mov_b32 v244, 0
    v_mov_b32 v245, 0
    v_mov_b32 v246, 0
    v_mov_b32 v247, 0
    s_mov_b64 exec, s[64:65]
    global_load_dwordx4 v[240:243], v2, s[44:45] offset:0
    global_load_dwordx4 v[244:247], v2, s[44:45] offset:896
    s_mov_b64 exec, -1
    s_cmp_lg_u32 s23, 0
    s_cbranch_scc1 Ltk_5
    s_mov_b64 exec, 1
    global_atomic_add v250, v251, v252, s[6:7] sc0
    s_mov_b64 exec, -1
Ltk_5:
    s_and_b32 s25, s2, 1
    s_lshl_b32 s25, s25, 4
    s_bfe_u32 s26, s2, 0x20001
    s_lshl_b32 s26, s26, 2
    s_add_u32 s25, s25, s26
    s_bfe_u32 s26, s2, 0x20003
    s_add_u32 s25, s25, s26
    s_and_b32 s27, s25, 15
    s_bfe_u32 s26, s2, 0x10005
    s_mul_i32 s26, s26, 7
    s_lshl_b32 s35, s23, 1
    s_min_u32 s35, s35, 5
    s_add_u32 s26, s26, s35
    s_lshr_b32 s35, s2, 6
    v_and_b32 v1, 63, v0
    v_and_b32 v6, 15, v1
    v_lshrrev_b32 v7, 4, v1
    s_cmp_ge_u32 s25, 16
    s_cselect_b32 s28, s50, s46
    s_cselect_b32 s29, s51, s47
    s_lshl_b32 s30, s26, 18
    s_lshl_b32 s31, s27, 9
    s_add_u32 s30, s30, s31
    s_add_u32 s28, s28, s30
    s_addc_u32 s29, s29, 0
    s_lshl_b32 s34, s23, 14
    s_add_u32 s34, s34, 57344
    v_and_b32 v2, 1, v7
    v_lshrrev_b32 v3, 1, v7
    v_lshl_add_u32 v2, v3, 3, v2
    v_lshlrev_b32 v4, 2, v7
    v_xor_b32 v4, v4, v6
    v_lshlrev_b32 v4, 4, v4
    v_lshl_add_u32 v4, v2, 13, v4
    v_lshlrev_b32 v18, 8, v6
    v_lshl_add_u32 v18, v7, 4, v18
    v_add_u32 v18, s34, v18
    v_and_b32 v5, 3, v1
    v_xor_b32 v19, 0, v5
    v_lshl_add_u32 v20, v19, 6, v18
    v_xor_b32 v19, 1, v5
    v_lshl_add_u32 v21, v19, 6, v18
    v_xor_b32 v19, 2, v5
    v_lshl_add_u32 v22, v19, 6, v18
    v_xor_b32 v19, 3, v5
    v_lshl_add_u32 v23, v19, 6, v18
    v_add_u32 v5, 0, v4
    s_add_u32 m0, s34, 0
    s_nop 0
    global_load_lds_dwordx4 v5, s[28:29]
    v_add_u32 v5, 32768, v4
    s_add_u32 m0, s34, 1024
    s_nop 0
    global_load_lds_dwordx4 v5, s[28:29]
    v_add_u32 v5, 131072, v4
    s_add_u32 m0, s34, 2048
    s_nop 0
    global_load_lds_dwordx4 v5, s[28:29]
    v_add_u32 v5, 163840, v4
    s_add_u32 m0, s34, 3072
    s_nop 0
    global_load_lds_dwordx4 v5, s[28:29]
    v_add_u32 v5, 16384, v4
    s_add_u32 m0, s34, 4096
    s_nop 0
    global_load_lds_dwordx4 v5, s[28:29]
    v_add_u32 v5, 49152, v4
    s_add_u32 m0, s34, 5120
    s_nop 0
    global_load_lds_dwordx4 v5, s[28:29]
    v_add_u32 v5, 147456, v4
    s_add_u32 m0, s34, 6144
    s_nop 0
    global_load_lds_dwordx4 v5, s[28:29]
    v_add_u32 v5, 180224, v4
    s_add_u32 m0, s34, 7168
    s_nop 0
    global_load_lds_dwordx4 v5, s[28:29]
    v_add_u32 v5, 262144, v4
    s_add_u32 m0, s34, 8192
    s_nop 0
    global_load_lds_dwordx4 v5, s[28:29]
    v_add_u32 v5, 294912, v4
    s_add_u32 m0, s34, 9216
    s_nop 0
    global_load_lds_dwordx4 v5, s[28:29]
    v_add_u32 v5, 393216, v4
    s_add_u32 m0, s34, 10240
    s_nop 0
    global_load_lds_dwordx4 v5, s[28:29]
    v_add_u32 v5, 425984, v4
    s_add_u32 m0, s34, 11264
    s_nop 0
    global_load_lds_dwordx4 v5, s[28:29]
    v_add_u32 v5, 278528, v4
    s_add_u32 m0, s34, 12288
    s_nop 0
    global_load_lds_dwordx4 v5, s[28:29]
    v_add_u32 v5, 311296, v4
    s_add_u32 m0, s34, 13312
    s_nop 0
    global_load_lds_dwordx4 v5, s[28:29]
    v_add_u32 v5, 409600, v4
    s_add_u32 m0, s34, 14336
    s_nop 0
    global_load_lds_dwordx4 v5, s[28:29]
    v_add_u32 v5, 442368, v4
    s_add_u32 m0, s34, 15360
    s_nop 0
    global_load_lds_dwordx4 v5, s[28:29]
    s_cmp_ge_u32 s25, 16
    s_cbranch_scc1 Lgu_u_6
    s_mul_i32 s30, s35, 917504
    s_mul_i32 s31, s23, 229376
    s_add_u32 s30, s30, s31
    s_lshl_b32 s31, s27, 9
    s_add_u32 s30, s30, s31
    s_add_u32 s32, s48, s30
    s_addc_u32 s33, s49, 0
    v_lshlrev_b32 v8, 2, v7
    v_xor_b32 v8, v8, v6
    v_lshlrev_b32 v8, 4, v8
    v_lshl_add_u32 v8, v7, 13, v8
    s_mul_i32 s36, s23, 7168
    v_add_u32 v5, 0, v8
    s_add_u32 m0, s36, 0
    s_nop 0
    global_load_lds_dwordx4 v5, s[32:33]
    v_add_u32 v5, 32768, v8
    s_add_u32 m0, s36, 1024
    s_nop 0
    global_load_lds_dwordx4 v5, s[32:33]
    v_add_u32 v5, 65536, v8
    s_add_u32 m0, s36, 2048
    s_nop 0
    global_load_lds_dwordx4 v5, s[32:33]
    v_add_u32 v5, 98304, v8
    s_add_u32 m0, s36, 3072
    s_nop 0
    global_load_lds_dwordx4 v5, s[32:33]
    v_add_u32 v5, 131072, v8
    s_add_u32 m0, s36, 4096
    s_nop 0
    global_load_lds_dwordx4 v5, s[32:33]
    v_add_u32 v5, 163840, v8
    s_add_u32 m0, s36, 5120
    s_nop 0
    global_load_lds_dwordx4 v5, s[32:33]
    v_add_u32 v5, 196608, v8
    s_add_u32 m0, s36, 6144
    s_nop 0
    global_load_lds_dwordx4 v5, s[32:33]
    v_add_u32 v5, 256, v8
    s_add_u32 m0, s36, 28672
    s_nop 0
    global_load_lds_dwordx4 v5, s[32:33]
    v_add_u32 v5, 33024, v8
    s_add_u32 m0, s36, 29696
    s_nop 0
    global_load_lds_dwordx4 v5, s[32:33]
    v_add_u32 v5, 65792, v8
    s_add_u32 m0, s36, 30720
    s_nop 0
    global_load_lds_dwordx4 v5, s[32:33]
    v_add_u32 v5, 98560, v8
    s_add_u32 m0, s36, 31744
    s_nop 0
    global_load_lds_dwordx4 v5, s[32:33]
    v_add_u32 v5, 131328, v8
    s_add_u32 m0, s36, 32768
    s_nop 0
    global_load_lds_dwordx4 v5, s[32:33]
    v_add_u32 v5, 164096, v8
    s_add_u32 m0, s36, 33792
    s_nop 0
    global_load_lds_dwordx4 v5, s[32:33]
    v_add_u32 v5, 196864, v8
    s_add_u32 m0, s36, 34816
    s_nop 0
    global_load_lds_dwordx4 v5, s[32:33]
    v_subrev_u32 v24, s34, v20
    v_subrev_u32 v25, s34, v21
    v_subrev_u32 v26, s34, v22
    v_subrev_u32 v27, s34, v23
    s_waitcnt vmcnt(30)
    v_lshlrev_b32 v32, 16, v240
    v_and_b32 v33, 0xffff0000, v240
    v_lshlrev_b32 v34, 16, v241
    v_and_b32 v35, 0xffff0000, v241
    v_lshlrev_b32 v36, 16, v242
    v_and_b32 v37, 0xffff0000, v242
    v_lshlrev_b32 v38, 16, v243
    v_and_b32 v39, 0xffff0000, v243
    v_lshlrev_b32 v40, 16, v244
    v_and_b32 v41, 0xffff0000, v244
    v_lshlrev_b32 v42, 16, v245
    v_and_b32 v43, 0xffff0000, v245
    v_lshlrev_b32 v44, 16, v246
    v_and_b32 v45, 0xffff0000, v246
    v_lshlrev_b32 v46, 16, v247
    v_and_b32 v47, 0xffff0000, v247
    v_add_f32 v56, v32, v33
    v_add_f32 v56, v56, v34
    v_add_f32 v56, v56, v35
    v_add_f32 v56, v56, v36
    v_add_f32 v56, v56, v37
    v_add_f32 v56, v56, v38
    v_add_f32 v56, v56, v39
    v_add_f32 v57, v40, v41
    v_add_f32 v57, v57, v42
    v_add_f32 v57, v57, v43
    v_add_f32 v57, v57, v44
    v_add_f32 v57, v57, v45
    v_add_f32 v57, v57, v46
    v_add_f32 v57, v57, v47
    s_nop 1
    v_add_f32_dpp v56, v56, v56 quad_perm:[1,0,3,2] row_mask:0xf bank_mask:0xf
    v_add_f32_dpp v57, v57, v57 quad_perm:[1,0,3,2] row_mask:0xf bank_mask:0xf
    s_nop 1
    v_add_f32_dpp v56, v56, v56 quad_perm:[2,3,0,1] row_mask:0xf bank_mask:0xf
    v_add_f32_dpp v57, v57, v57 quad_perm:[2,3,0,1] row_mask:0xf bank_mask:0xf
    s_nop 1
    v_add_f32_dpp v56, v56, v56 row_half_mirror row_mask:0xf bank_mask:0xf
    v_add_f32_dpp v57, v57, v57 row_half_mirror row_mask:0xf bank_mask:0xf
    s_nop 1
    v_add_f32_dpp v56, v56, v56 row_mirror row_mask:0xf bank_mask:0xf
    v_add_f32_dpp v57, v57, v57 row_mirror row_mask:0xf bank_mask:0xf
    v_mov_b32 v58, v56
    v_mov_b32 v59, v57
    s_nop 1
    v_permlane16_swap_b32 v56, v58
    v_permlane16_swap_b32 v57, v59
    v_add_f32 v56, v56, v58
    v_add_f32 v57, v57, v59
    v_mov_b32 v58, v56
    v_mov_b32 v59, v57
    s_nop 1
    v_permlane32_swap_b32 v56, v58
    v_permlane32_swap_b32 v57, v59
    v_add_f32 v56, v56, v58
    v_add_f32 v57, v57, v59
    s_mov_b32 s66, 0x3b124925
    v_mul_f32 v60, s66, v56
    v_mul_f32 v61, s66, v57
    v_mov_b32 v56, 0
    v_sub_f32 v58, v32, v60
    v_fmac_f32 v56, v58, v58
    v_sub_f32 v58, v33, v60
    v_fmac_f32 v56, v58, v58
    v_sub_f32 v58, v34, v60
    v_fmac_f32 v56, v58, v58
    v_sub_f32 v58, v35, v60
    v_fmac_f32 v56, v58, v58
    v_sub_f32 v58, v36, v60
    v_fmac_f32 v56, v58, v58
    v_sub_f32 v58, v37, v60
    v_fmac_f32 v56, v58, v58
    v_sub_f32 v58, v38, v60
    v_fmac_f32 v56, v58, v58
    v_sub_f32 v58, v39, v60
    v_fmac_f32 v56, v58, v58
    v_cndmask_b32 v56, 0, v56, s[64:65]
    v_mov_b32 v57, 0
    v_sub_f32 v59, v40, v61
    v_fmac_f32 v57, v59, v59
    v_sub_f32 v59, v41, v61
    v_fmac_f32 v57, v59, v59
    v_sub_f32 v59, v42, v61
    v_fmac_f32 v57, v59, v59
    v_sub_f32 v59, v43, v61
    v_fmac_f32 v57, v59, v59
    v_sub_f32 v59, v44, v61
    v_fmac_f32 v57, v59, v59
    v_sub_f32 v59, v45, v61
    v_fmac_f32 v57, v59, v59
    v_sub_f32 v59, v46, v61
    v_fmac_f32 v57, v59, v59
    v_sub_f32 v59, v47, v61
    v_fmac_f32 v57, v59, v59
    v_cndmask_b32 v57, 0, v57, s[64:65]
    s_nop 1
    v_add_f32_dpp v56, v56, v56 quad_perm:[1,0,3,2] row_mask:0xf bank_mask:0xf
    v_add_f32_dpp v57, v57, v57 quad_perm:[1,0,3,2] row_mask:0xf bank_mask:0xf
    s_nop 1
    v_add_f32_dpp v56, v56, v56 quad_perm:[2,3,0,1] row_mask:0xf bank_mask:0xf
    v_add_f32_dpp v57, v57, v57 quad_perm:[2,3,0,1] row_mask:0xf bank_mask:0xf
    s_nop 1
    v_add_f32_dpp v56, v56, v56 row_half_mirror row_mask:0xf bank_mask:0xf
    v_add_f32_dpp v57, v57, v57 row_half_mirror row_mask:0xf bank_mask:0xf
    s_nop 1
    v_add_f32_dpp v56, v56, v56 row_mirror row_mask:0xf bank_mask:0xf
    v_add_f32_dpp v57, v57, v57 row_mirror row_mask:0xf bank_mask:0xf
    v_mov_b32 v58, v56
    v_mov_b32 v59, v57
    s_nop 1
    v_permlane16_swap_b32 v56, v58
    v_permlane16_swap_b32 v57, v59
    v_add_f32 v56, v56, v58
    v_add_f32 v57, v57, v59
    v_mov_b32 v58, v56
    v_mov_b32 v59, v57
    s_nop 1
    v_permlane32_swap_b32 v56, v58
    v_permlane32_swap_b32 v57, v59
    v_add_f32 v56, v56, v58
    v_add_f32 v57, v57, v59
    v_mul_f32 v56, s66, v56
    v_cvt_pk_bf16_f32 v56, v56, v56
    v_lshlrev_b32 v56, 16, v56
    v_cvt_pk_bf16_f32 v60, v60, v60
    v_lshlrev_b32 v60, 16, v60
    v_add_f32 v56, 0x3727c5ac, v56
    v_cvt_pk_bf16_f32 v56, v56, v56
    v_lshlrev_b32 v56, 16, v56
    v_sqrt_f32 v56, v56
    s_nop 0
    v_cvt_pk_bf16_f32 v56, v56, v56
    v_lshlrev_b32 v56, 16, v56
    v_rcp_f32 v58, v56
    s_nop 0
    v_mul_f32 v57, s66, v57
    v_cvt_pk_bf16_f32 v57, v57, v57
    v_lshlrev_b32 v57, 16, v57
    v_cvt_pk_bf16_f32 v61, v61, v61
    v_lshlrev_b32 v61, 16, v61
    v_add_f32 v57, 0x3727c5ac, v57
    v_cvt_pk_bf16_f32 v57, v57, v57
    v_lshlrev_b32 v57, 16, v57
    v_sqrt_f32 v57, v57
    s_nop 0
    v_cvt_pk_bf16_f32 v57, v57, v57
    v_lshlrev_b32 v57, 16, v57
    v_rcp_f32 v59, v57
    s_nop 0
    v_sub_f32 v32, v32, v60
    v_sub_f32 v33, v33, v60
    v_cvt_pk_bf16_f32 v240, v32, v33
    v_lshlrev_b32 v32, 16, v240
    v_and_b32 v33, 0xffff0000, v240
    v_mul_f32 v62, v32, v58
    v_fma_f32 v32, -v62, v56, v32
    v_fma_f32 v32, v32, v58, v62
    v_mul_f32 v63, v33, v58
    v_fma_f32 v33, -v63, v56, v33
    v_fma_f32 v33, v33, v58, v63
    v_cvt_pk_bf16_f32 v240, v32, v33
    v_sub_f32 v34, v34, v60
    v_sub_f32 v35, v35, v60
    v_cvt_pk_bf16_f32 v241, v34, v35
    v_lshlrev_b32 v34, 16, v241
    v_and_b32 v35, 0xffff0000, v241
    v_mul_f32 v62, v34, v58
    v_fma_f32 v34, -v62, v56, v34
    v_fma_f32 v34, v34, v58, v62
    v_mul_f32 v63, v35, v58
    v_fma_f32 v35, -v63, v56, v35
    v_fma_f32 v35, v35, v58, v63
    v_cvt_pk_bf16_f32 v241, v34, v35
    v_sub_f32 v36, v36, v60
    v_sub_f32 v37, v37, v60
    v_cvt_pk_bf16_f32 v242, v36, v37
    v_lshlrev_b32 v36, 16, v242
    v_and_b32 v37, 0xffff0000, v242
    v_mul_f32 v62, v36, v58
    v_fma_f32 v36, -v62, v56, v36
    v_fma_f32 v36, v36, v58, v62
    v_mul_f32 v63, v37, v58
    v_fma_f32 v37, -v63, v56, v37
    v_fma_f32 v37, v37, v58, v63
    v_cvt_pk_bf16_f32 v242, v36, v37
    v_sub_f32 v38, v38, v60
    v_sub_f32 v39, v39, v60
    v_cvt_pk_bf16_f32 v243, v38, v39
    v_lshlrev_b32 v38, 16, v243
    v_and_b32 v39, 0xffff0000, v243
    v_mul_f32 v62, v38, v58
    v_fma_f32 v38, -v62, v56, v38
    v_fma_f32 v38, v38, v58, v62
    v_mul_f32 v63, v39, v58
    v_fma_f32 v39, -v63, v56, v39
    v_fma_f32 v39, v39, v58, v63
    v_cvt_pk_bf16_f32 v243, v38, v39
    v_sub_f32 v40, v40, v61
    v_sub_f32 v41, v41, v61
    v_cvt_pk_bf16_f32 v244, v40, v41
    v_lshlrev_b32 v40, 16, v244
    v_and_b32 v41, 0xffff0000, v244
    v_mul_f32 v62, v40, v59
    v_fma_f32 v40, -v62, v57, v40
    v_fma_f32 v40, v40, v59, v62
    v_mul_f32 v63, v41, v59
    v_fma_f32 v41, -v63, v57, v41
    v_fma_f32 v41, v41, v59, v63
    v_cvt_pk_bf16_f32 v244, v40, v41
    v_sub_f32 v42, v42, v61
    v_sub_f32 v43, v43, v61
    v_cvt_pk_bf16_f32 v245, v42, v43
    v_lshlrev_b32 v42, 16, v245
    v_and_b32 v43, 0xffff0000, v245
    v_mul_f32 v62, v42, v59
    v_fma_f32 v42, -v62, v57, v42
    v_fma_f32 v42, v42, v59, v62
    v_mul_f32 v63, v43, v59
    v_fma_f32 v43, -v63, v57, v43
    v_fma_f32 v43, v43, v59, v63
    v_cvt_pk_bf16_f32 v245, v42, v43
    v_sub_f32 v44, v44, v61
    v_sub_f32 v45, v45, v61
    v_cvt_pk_bf16_f32 v246, v44, v45
    v_lshlrev_b32 v44, 16, v246
    v_and_b32 v45, 0xffff0000, v246
    v_mul_f32 v62, v44, v59
    v_fma_f32 v44, -v62, v57, v44
    v_fma_f32 v44, v44, v59, v62
    v_mul_f32 v63, v45, v59
    v_fma_f32 v45, -v63, v57, v45
    v_fma_f32 v45, v45, v59, v63
    v_cvt_pk_bf16_f32 v246, v44, v45
    v_sub_f32 v46, v46, v61
    v_sub_f32 v47, v47, v61
    v_cvt_pk_bf16_f32 v247, v46, v47
    v_lshlrev_b32 v46, 16, v247
    v_and_b32 v47, 0xffff0000, v247
    v_mul_f32 v62, v46, v59
    v_fma_f32 v46, -v62, v57, v46
    v_fma_f32 v46, v46, v59, v62
    v_mul_f32 v63, v47, v59
    v_fma_f32 v47, -v63, v57, v47
    v_fma_f32 v47, v47, v59, v63
    v_cvt_pk_bf16_f32 v247, v46, v47
    s_mov_b32 s66, 0xaaaaaaaa
    s_mov_b32 s67, 0xaaaaaaaa
    v_mov_b32_dpp v32, v240 quad_perm:[1,0,3,2] row_mask:0xf bank_mask:0xf
    v_mov_b32_dpp v33, v241 quad_perm:[1,0,3,2] row_mask:0xf bank_mask:0xf
    v_mov_b32_dpp v34, v242 quad_perm:[1,0,3,2] row_mask:0xf bank_mask:0xf
    v_mov_b32_dpp v35, v243 quad_perm:[1,0,3,2] row_mask:0xf bank_mask:0xf
    v_cndmask_b32 v64, v240, v34, s[66:67]
    v_cndmask_b32 v65, v32, v242, s[66:67]
    v_cndmask_b32 v66, v241, v35, s[66:67]
    v_cndmask_b32 v67, v33, v243, s[66:67]
    v_mov_b32_dpp v40, v244 quad_perm:[1,0,3,2] row_mask:0xf bank_mask:0xf
    v_mov_b32_dpp v41, v245 quad_perm:[1,0,3,2] row_mask:0xf bank_mask:0xf
    v_mov_b32_dpp v42, v246 quad_perm:[1,0,3,2] row_mask:0xf bank_mask:0xf
    v_mov_b32_dpp v43, v247 quad_perm:[1,0,3,2] row_mask:0xf bank_mask:0xf
    v_cndmask_b32 v68, v244, v42, s[66:67]
    v_cndmask_b32 v69, v40, v246, s[66:67]
    v_cndmask_b32 v70, v245, v43, s[66:67]
    v_cndmask_b32 v71, v41, v247, s[66:67]
    v_and_b32 v72, 63, v0
    s_lshl_b32 s68, s23, 5
    s_add_u32 s68, s68, 147456
    v_lshl_add_u32 v72, v72, 7, s68
    s_mov_b64 exec, s[64:65]
    ds_write_b128 v72, v[240:243] offset:0
    ds_write_b128 v72, v[64:67] offset:7168
    ds_write_b128 v72, v[244:247] offset:16
    ds_write_b128 v72, v[68:71] offset:7184
    s_mov_b64 exec, -1
    v_lshlrev_b32 v74, 4, v0
    v_mov_b32 v76, -1
    v_mov_b32 v77, -1
    v_mov_b32 v78, -1
    v_mov_b32 v79, -1
    s_lshl_b32 s66, s2, 1
    s_add_u32 s66, s66, 0
    s_min_u32 s66, s66, 507
    s_lshl_b32 s67, s66, 12
    s_add_u32 s68, s67, 0x6002000
    s_add_u32 s69, s67, 0x6184000
    s_add_u32 s67, s67, 0x6082000
    s_cmp_lt_u32 s66, 126
    s_cselect_b32 s67, s68, s67
    s_cmp_ge_u32 s66, 382
    s_cselect_b32 s67, s69, s67
    s_add_u32 s68, s4, s67
    s_addc_u32 s69, s5, 0
    global_store_dwordx4 v74, v[76:79], s[68:69] sc1
    s_lshl_b32 s66, s2, 1
    s_add_u32 s66, s66, 1
    s_min_u32 s66, s66, 507
    s_lshl_b32 s67, s66, 12
    s_add_u32 s68, s67, 0x6002000
    s_add_u32 s69, s67, 0x6184000
    s_add_u32 s67, s67, 0x6082000
    s_cmp_lt_u32 s66, 126
    s_cselect_b32 s67, s68, s67
    s_cmp_ge_u32 s66, 382
    s_cselect_b32 s67, s69, s67
    s_add_u32 s68, s4, s67
    s_addc_u32 s69, s5, 0
    global_store_dwordx4 v74, v[76:79], s[68:69] sc1
    s_waitcnt vmcnt(9) lgkmcnt(0)
    s_barrier
    ds_read_b128 v[144:147], v20 offset:0
    ds_read_b128 v[148:151], v20 offset:4096
    ds_read_b128 v[152:155], v20 offset:8192
    ds_read_b128 v[156:159], v20 offset:12288
    ds_read_b128 v[160:163], v21 offset:0
    ds_read_b128 v[164:167], v21 offset:4096
    ds_read_b128 v[168:171], v21 offset:8192
    ds_read_b128 v[172:175], v21 offset:12288
    ds_read_b128 v[176:179], v22 offset:0
    ds_read_b128 v[180:183], v22 offset:4096
    ds_read_b128 v[184:187], v22 offset:8192
    ds_read_b128 v[188:191], v22 offset:12288
    s_waitcnt lgkmcnt(4)
    ds_read_b128 v[192:195], v23 offset:0
    ds_read_b128 v[196:199], v23 offset:4096
    ds_read_b128 v[200:203], v23 offset:8192
    ds_read_b128 v[204:207], v23 offset:12288
    s_waitcnt lgkmcnt(0)
    v_add_u32 v5, 256, v4
    s_add_u32 m0, s34, 0
    s_nop 0
    global_load_lds_dwordx4 v5, s[28:29]
    v_add_u32 v5, 33024, v4
    s_add_u32 m0, s34, 1024
    s_nop 0
    global_load_lds_dwordx4 v5, s[28:29]
    v_add_u32 v5, 131328, v4
    s_add_u32 m0, s34, 2048
    s_nop 0
    global_load_lds_dwordx4 v5, s[28:29]
    v_add_u32 v5, 164096, v4
    s_add_u32 m0, s34, 3072
    s_nop 0
    global_load_lds_dwordx4 v5, s[28:29]
    v_add_u32 v5, 16640, v4
    s_add_u32 m0, s34, 4096
    s_nop 0
    global_load_lds_dwordx4 v5, s[28:29]
    v_add_u32 v5, 49408, v4
    s_add_u32 m0, s34, 5120
    s_nop 0
    global_load_lds_dwordx4 v5, s[28:29]
    v_add_u32 v5, 147712, v4
    s_add_u32 m0, s34, 6144
    s_nop 0
    global_load_lds_dwordx4 v5, s[28:29]
    v_add_u32 v5, 180480, v4
    s_add_u32 m0, s34, 7168
    s_nop 0
    global_load_lds_dwordx4 v5, s[28:29]
    v_add_u32 v5, 262400, v4
    s_add_u32 m0, s34, 8192
    s_nop 0
    global_load_lds_dwordx4 v5, s[28:29]
    v_add_u32 v5, 295168, v4
    s_add_u32 m0, s34, 9216
    s_nop 0
    global_load_lds_dwordx4 v5, s[28:29]
    v_add_u32 v5, 393472, v4
    s_add_u32 m0, s34, 10240
    s_nop 0
    global_load_lds_dwordx4 v5, s[28:29]
    v_add_u32 v5, 426240, v4
    s_add_u32 m0, s34, 11264
    s_nop 0
    global_load_lds_dwordx4 v5, s[28:29]
    v_add_u32 v5, 278784, v4
    s_add_u32 m0, s34, 12288
    s_nop 0
    global_load_lds_dwordx4 v5, s[28:29]
    v_add_u32 v5, 311552, v4
    s_add_u32 m0, s34, 13312
    s_nop 0
    global_load_lds_dwordx4 v5, s[28:29]
    v_add_u32 v5, 409856, v4
    s_add_u32 m0, s34, 14336
    s_nop 0
    global_load_lds_dwordx4 v5, s[28:29]
    v_add_u32 v5, 442624, v4
    s_add_u32 m0, s34, 15360
    s_nop 0
    global_load_lds_dwordx4 v5, s[28:29]
    v_mov_b32 v255, 0
    s_lshl_b32 s64, s23, 8
    s_add_u32 s64, s64, s2
    s_cmp_lg_u32 s64, 2
    s_cbranch_scc1 Lec_8
    s_mov_b64 exec, 1
    s_add_u32 s64, s70, 1
    v_mov_b32 v249, s64
    global_store_dword v255, v249, s[6:7] offset:128 sc1
    s_mov_b64 exec, -1
Lec_8:
    s_lshr_b32 s66, s20, 4
    s_mul_i32 s66, s66, 14336
    s_and_b32 s64, s20, 15
    s_lshl_b32 s64, s64, 4
    s_add_u32 s66, s66, s64
    s_add_u32 s64, s66, 0x200000
    s_add_u32 s68, s4, s64
    s_addc_u32 s69, s5, 0
    s_add_u32 s66, s4, s66
    s_addc_u32 s67, s5, 0
    v_add_u32 v216, 0, v0
    v_min_u32 v216, 447, v216
    v_lshlrev_b32 v217, 4, v216
    v_add_u32 v217, 147456, v217
    ds_read_b128 v[220:223], v217
    ds_read_b128 v[224:227], v217 offset:7168
    v_lshrrev_b32 v218, 3, v216
    v_and_b32 v216, 7, v216
    v_lshlrev_b32 v216, 4, v216
    v_lshl_add_u32 v216, v218, 8, v216
    v_add_u32 v228, 256, v0
    v_min_u32 v228, 447, v228
    v_lshlrev_b32 v229, 4, v228
    v_add_u32 v229, 147456, v229
    ds_read_b128 v[232:235], v229
    ds_read_b128 v[236:239], v229 offset:7168
    v_lshrrev_b32 v230, 3, v228
    v_and_b32 v228, 7, v228
    v_lshlrev_b32 v228, 4, v228
    v_lshl_add_u32 v228, v230, 8, v228
    s_waitcnt lgkmcnt(0)
    global_store_dwordx4 v216, v[220:223], s[66:67] sc1
    global_store_dwordx4 v216, v[224:227], s[68:69] sc1
    global_store_dwordx4 v228, v[232:235], s[66:67] sc1
    global_store_dwordx4 v228, v[236:239], s[68:69] sc1
    s_cmp_lg_u32 s2, 0
    s_cbranch_scc1 Lpz_9
    s_add_u32 s68, s4, 0x6000000
    s_addc_u32 s69, s5, 0
    s_add_u32 s66, s4, 0x6300000
    s_addc_u32 s67, s5, 0
    v_accvgpr_read_b32 v240, a240
    v_min_u32 v240, -2, v240
    v_accvgpr_read_b32 v241, a241
    v_min_u32 v241, -2, v241
    v_accvgpr_read_b32 v242, a242
    v_min_u32 v242, -2, v242
    v_accvgpr_read_b32 v243, a243
    v_min_u32 v243, -2, v243
    global_store_dwordx4 v253, v[240:243], s[68:69] sc1
    global_store_dwordx4 v253, v[240:243], s[66:67] sc1
    v_accvgpr_read_b32 v244, a244
    v_min_u32 v244, -2, v244
    v_accvgpr_read_b32 v245, a245
    v_min_u32 v245, -2, v245
    v_accvgpr_read_b32 v246, a246
    v_min_u32 v246, -2, v246
    v_accvgpr_read_b32 v247, a247
    v_min_u32 v247, -2, v247
    global_store_dwordx4 v254, v[244:247], s[68:69] sc1
    global_store_dwordx4 v254, v[244:247], s[66:67] sc1
Lpz_9:
    ds_read_b128 v[32:35], v24 offset:0
    ds_read_b128 v[36:39], v24 offset:4096
    ds_read_b128 v[40:43], v24 offset:8192
    ds_read_b128 v[44:47], v24 offset:12288
    ds_read_b128 v[48:51], v24 offset:16384
    ds_read_b128 v[52:55], v24 offset:20480
    ds_read_b128 v[56:59], v24 offset:24576
    ds_read_b128 v[60:63], v25 offset:0
    ds_read_b128 v[64:67], v25 offset:4096
    ds_read_b128 v[68:71], v25 offset:8192
    ds_read_b128 v[72:75], v25 offset:12288
    ds_read_b128 v[76:79], v25 offset:16384
    ds_read_b128 v[80:83], v25 offset:20480
    ds_read_b128 v[84:87], v25 offset:24576
    s_waitcnt lgkmcnt(7)
    v_mfma_f32_16x16x32_bf16 a[0:3], v[144:147], v[32:35], 0
    v_mfma_f32_16x16x32_bf16 a[4:7], v[144:147], v[36:39], 0
    v_mfma_f32_16x16x32_bf16 a[8:11], v[144:147], v[40:43], 0
    v_mfma_f32_16x16x32_bf16 a[12:15], v[144:147], v[44:47], 0
    v_mfma_f32_16x16x32_bf16 a[16:19], v[144:147], v[48:51], 0
    v_mfma_f32_16x16x32_bf16 a[20:23], v[144:147], v[52:55], 0
    v_mfma_f32_16x16x32_bf16 a[24:27], v[144:147], v[56:59], 0
    v_mfma_f32_16x16x32_bf16 a[28:31], v[148:151], v[32:35], 0
    v_mfma_f32_16x16x32_bf16 a[32:35], v[148:151], v[36:39], 0
    v_mfma_f32_16x16x32_bf16 a[36:39], v[148:151], v[40:43], 0
    v_mfma_f32_16x16x32_bf16 a[40:43], v[148:151], v[44:47], 0
    v_mfma_f32_16x16x32_bf16 a[44:47], v[148:151], v[48:51], 0
    v_mfma_f32_16x16x32_bf16 a[48:51], v[148:151], v[52:55], 0
    v_mfma_f32_16x16x32_bf16 a[52:55], v[148:151], v[56:59], 0
    v_mfma_f32_16x16x32_bf16 a[56:59], v[152:155], v[32:35], 0
    v_mfma_f32_16x16x32_bf16 a[60:63], v[152:155], v[36:39], 0
    v_mfma_f32_16x16x32_bf16 a[64:67], v[152:155], v[40:43], 0
    v_mfma_f32_16x16x32_bf16 a[68:71], v[152:155], v[44:47], 0
    v_mfma_f32_16x16x32_bf16 a[72:75], v[152:155], v[48:51], 0
    v_mfma_f32_16x16x32_bf16 a[76:79], v[152:155], v[52:55], 0
    v_mfma_f32_16x16x32_bf16 a[80:83], v[152:155], v[56:59], 0
    v_mfma_f32_16x16x32_bf16 a[84:87], v[156:159], v[32:35], 0
    v_mfma_f32_16x16x32_bf16 a[88:91], v[156:159], v[36:39], 0
    v_mfma_f32_16x16x32_bf16 a[92:95], v[156:159], v[40:43], 0
    v_mfma_f32_16x16x32_bf16 a[96:99], v[156:159], v[44:47], 0
    v_mfma_f32_16x16x32_bf16 a[100:103], v[156:159], v[48:51], 0
    v_mfma_f32_16x16x32_bf16 a[104:107], v[156:159], v[52:55], 0
    v_mfma_f32_16x16x32_bf16 a[108:111], v[156:159], v[56:59], 0
    ds_read_b128 v[88:91], v26 offset:0
    ds_read_b128 v[92:95], v26 offset:4096
    ds_read_b128 v[96:99], v26 offset:8192
    ds_read_b128 v[100:103], v26 offset:12288
    ds_read_b128 v[104:107], v26 offset:16384
    ds_read_b128 v[108:111], v26 offset:20480
    ds_read_b128 v[112:115], v26 offset:24576
    s_waitcnt lgkmcnt(7)
    v_mfma_f32_16x16x32_bf16 a[0:3], v[160:163], v[60:63], a[0:3]
    v_mfma_f32_16x16x32_bf16 a[4:7], v[160:163], v[64:67], a[4:7]
    v_mfma_f32_16x16x32_bf16 a[8:11], v[160:163], v[68:71], a[8:11]
    v_mfma_f32_16x16x32_bf16 a[12:15], v[160:163], v[72:75], a[12:15]
    v_mfma_f32_16x16x32_bf16 a[16:19], v[160:163], v[76:79], a[16:19]
    v_mfma_f32_16x16x32_bf16 a[20:23], v[160:163], v[80:83], a[20:23]
    v_mfma_f32_16x16x32_bf16 a[24:27], v[160:163], v[84:87], a[24:27]
    v_mfma_f32_16x16x32_bf16 a[28:31], v[164:167], v[60:63], a[28:31]
    v_mfma_f32_16x16x32_bf16 a[32:35], v[164:167], v[64:67], a[32:35]
    v_mfma_f32_16x16x32_bf16 a[36:39], v[164:167], v[68:71], a[36:39]
    v_mfma_f32_16x16x32_bf16 a[40:43], v[164:167], v[72:75], a[40:43]
    v_mfma_f32_16x16x32_bf16 a[44:47], v[164:167], v[76:79], a[44:47]
    v_mfma_f32_16x16x32_bf16 a[48:51], v[164:167], v[80:83], a[48:51]
    v_mfma_f32_16x16x32_bf16 a[52:55], v[164:167], v[84:87], a[52:55]
    v_mfma_f32_16x16x32_bf16 a[56:59], v[168:171], v[60:63], a[56:59]
    v_mfma_f32_16x16x32_bf16 a[60:63], v[168:171], v[64:67], a[60:63]
    v_mfma_f32_16x16x32_bf16 a[64:67], v[168:171], v[68:71], a[64:67]
    v_mfma_f32_16x16x32_bf16 a[68:71], v[168:171], v[72:75], a[68:71]
    v_mfma_f32_16x16x32_bf16 a[72:75], v[168:171], v[76:79], a[72:75]
    v_mfma_f32_16x16x32_bf16 a[76:79], v[168:171], v[80:83], a[76:79]
    v_mfma_f32_16x16x32_bf16 a[80:83], v[168:171], v[84:87], a[80:83]
    v_mfma_f32_16x16x32_bf16 a[84:87], v[172:175], v[60:63], a[84:87]
    v_mfma_f32_16x16x32_bf16 a[88:91], v[172:175], v[64:67], a[88:91]
    v_mfma_f32_16x16x32_bf16 a[92:95], v[172:175], v[68:71], a[92:95]
    v_mfma_f32_16x16x32_bf16 a[96:99], v[172:175], v[72:75], a[96:99]
    v_mfma_f32_16x16x32_bf16 a[100:103], v[172:175], v[76:79], a[100:103]
    v_mfma_f32_16x16x32_bf16 a[104:107], v[172:175], v[80:83], a[104:107]
    v_mfma_f32_16x16x32_bf16 a[108:111], v[172:175], v[84:87], a[108:111]
    ds_read_b128 v[116:119], v27 offset:0
    ds_read_b128 v[120:123], v27 offset:4096
    ds_read_b128 v[124:127], v27 offset:8192
    ds_read_b128 v[128:131], v27 offset:12288
    ds_read_b128 v[132:135], v27 offset:16384
    ds_read_b128 v[136:139], v27 offset:20480
    ds_read_b128 v[140:143], v27 offset:24576
    s_waitcnt lgkmcnt(7)
    v_mfma_f32_16x16x32_bf16 a[0:3], v[176:179], v[88:91], a[0:3]
    v_mfma_f32_16x16x32_bf16 a[4:7], v[176:179], v[92:95], a[4:7]
    v_mfma_f32_16x16x32_bf16 a[8:11], v[176:179], v[96:99], a[8:11]
    v_mfma_f32_16x16x32_bf16 a[12:15], v[176:179], v[100:103], a[12:15]
    v_mfma_f32_16x16x32_bf16 a[16:19], v[176:179], v[104:107], a[16:19]
    v_mfma_f32_16x16x32_bf16 a[20:23], v[176:179], v[108:111], a[20:23]
    v_mfma_f32_16x16x32_bf16 a[24:27], v[176:179], v[112:115], a[24:27]
    v_mfma_f32_16x16x32_bf16 a[28:31], v[180:183], v[88:91], a[28:31]
    v_mfma_f32_16x16x32_bf16 a[32:35], v[180:183], v[92:95], a[32:35]
    v_mfma_f32_16x16x32_bf16 a[36:39], v[180:183], v[96:99], a[36:39]
    v_mfma_f32_16x16x32_bf16 a[40:43], v[180:183], v[100:103], a[40:43]
    v_mfma_f32_16x16x32_bf16 a[44:47], v[180:183], v[104:107], a[44:47]
    v_mfma_f32_16x16x32_bf16 a[48:51], v[180:183], v[108:111], a[48:51]
    v_mfma_f32_16x16x32_bf16 a[52:55], v[180:183], v[112:115], a[52:55]
    v_mfma_f32_16x16x32_bf16 a[56:59], v[184:187], v[88:91], a[56:59]
    v_mfma_f32_16x16x32_bf16 a[60:63], v[184:187], v[92:95], a[60:63]
    v_mfma_f32_16x16x32_bf16 a[64:67], v[184:187], v[96:99], a[64:67]
    v_mfma_f32_16x16x32_bf16 a[68:71], v[184:187], v[100:103], a[68:71]
    v_mfma_f32_16x16x32_bf16 a[72:75], v[184:187], v[104:107], a[72:75]
    v_mfma_f32_16x16x32_bf16 a[76:79], v[184:187], v[108:111], a[76:79]
    v_mfma_f32_16x16x32_bf16 a[80:83], v[184:187], v[112:115], a[80:83]
    v_mfma_f32_16x16x32_bf16 a[84:87], v[188:191], v[88:91], a[84:87]
    v_mfma_f32_16x16x32_bf16 a[88:91], v[188:191], v[92:95], a[88:91]
    v_mfma_f32_16x16x32_bf16 a[92:95], v[188:191], v[96:99], a[92:95]
    v_mfma_f32_16x16x32_bf16 a[96:99], v[188:191], v[100:103], a[96:99]
    v_mfma_f32_16x16x32_bf16 a[100:103], v[188:191], v[104:107], a[100:103]
    v_mfma_f32_16x16x32_bf16 a[104:107], v[188:191], v[108:111], a[104:107]
    v_mfma_f32_16x16x32_bf16 a[108:111], v[188:191], v[112:115], a[108:111]
    s_waitcnt lgkmcnt(0)
    v_mfma_f32_16x16x32_bf16 a[0:3], v[192:195], v[116:119], a[0:3]
    v_mfma_f32_16x16x32_bf16 a[4:7], v[192:195], v[120:123], a[4:7]
    v_mfma_f32_16x16x32_bf16 a[8:11], v[192:195], v[124:127], a[8:11]
    v_mfma_f32_16x16x32_bf16 a[12:15], v[192:195], v[128:131], a[12:15]
    v_mfma_f32_16x16x32_bf16 a[16:19], v[192:195], v[132:135], a[16:19]
    v_mfma_f32_16x16x32_bf16 a[20:23], v[192:195], v[136:139], a[20:23]
    v_mfma_f32_16x16x32_bf16 a[24:27], v[192:195], v[140:143], a[24:27]
    v_mfma_f32_16x16x32_bf16 a[28:31], v[196:199], v[116:119], a[28:31]
    v_mfma_f32_16x16x32_bf16 a[32:35], v[196:199], v[120:123], a[32:35]
    v_mfma_f32_16x16x32_bf16 a[36:39], v[196:199], v[124:127], a[36:39]
    v_mfma_f32_16x16x32_bf16 a[40:43], v[196:199], v[128:131], a[40:43]
    v_mfma_f32_16x16x32_bf16 a[44:47], v[196:199], v[132:135], a[44:47]
    v_mfma_f32_16x16x32_bf16 a[48:51], v[196:199], v[136:139], a[48:51]
    v_mfma_f32_16x16x32_bf16 a[52:55], v[196:199], v[140:143], a[52:55]
    v_mfma_f32_16x16x32_bf16 a[56:59], v[200:203], v[116:119], a[56:59]
    v_mfma_f32_16x16x32_bf16 a[60:63], v[200:203], v[120:123], a[60:63]
    v_mfma_f32_16x16x32_bf16 a[64:67], v[200:203], v[124:127], a[64:67]
    v_mfma_f32_16x16x32_bf16 a[68:71], v[200:203], v[128:131], a[68:71]
    v_mfma_f32_16x16x32_bf16 a[72:75], v[200:203], v[132:135], a[72:75]
    v_mfma_f32_16x16x32_bf16 a[76:79], v[200:203], v[136:139], a[76:79]
    v_mfma_f32_16x16x32_bf16 a[80:83], v[200:203], v[140:143], a[80:83]
    v_mfma_f32_16x16x32_bf16 a[84:87], v[204:207], v[116:119], a[84:87]
    v_mfma_f32_16x16x32_bf16 a[88:91], v[204:207], v[120:123], a[88:91]
    v_mfma_f32_16x16x32_bf16 a[92:95], v[204:207], v[124:127], a[92:95]
    v_mfma_f32_16x16x32_bf16 a[96:99], v[204:207], v[128:131], a[96:99]
    v_mfma_f32_16x16x32_bf16 a[100:103], v[204:207], v[132:135], a[100:103]
    v_mfma_f32_16x16x32_bf16 a[104:107], v[204:207], v[136:139], a[104:107]
    v_mfma_f32_16x16x32_bf16 a[108:111], v[204:207], v[140:143], a[108:111]
    s_waitcnt vmcnt(0)
    s_barrier
    ds_read_b128 v[144:147], v20 offset:0
    ds_read_b128 v[148:151], v20 offset:4096
    ds_read_b128 v[152:155], v20 offset:8192
    ds_read_b128 v[156:159], v20 offset:12288
    ds_read_b128 v[160:163], v21 offset:0
    ds_read_b128 v[164:167], v21 offset:4096
    ds_read_b128 v[168:171], v21 offset:8192
    ds_read_b128 v[172:175], v21 offset:12288
    ds_read_b128 v[176:179], v22 offset:0
    ds_read_b128 v[180:183], v22 offset:4096
    ds_read_b128 v[184:187], v22 offset:8192
    ds_read_b128 v[188:191], v22 offset:12288
    s_waitcnt lgkmcnt(4)
    ds_read_b128 v[192:195], v23 offset:0
    ds_read_b128 v[196:199], v23 offset:4096
    ds_read_b128 v[200:203], v23 offset:8192
    ds_read_b128 v[204:207], v23 offset:12288
    s_waitcnt lgkmcnt(0)
    ds_read_b128 v[32:35], v24 offset:28672
    ds_read_b128 v[36:39], v24 offset:32768
    ds_read_b128 v[40:43], v24 offset:36864
    ds_read_b128 v[44:47], v24 offset:40960
    ds_read_b128 v[48:51], v24 offset:45056
    ds_read_b128 v[52:55], v24 offset:49152
    ds_read_b128 v[56:59], v24 offset:53248
    ds_read_b128 v[60:63], v25 offset:28672
    ds_read_b128 v[64:67], v25 offset:32768
    ds_read_b128 v[68:71], v25 offset:36864
    ds_read_b128 v[72:75], v25 offset:40960
    ds_read_b128 v[76:79], v25 offset:45056
    ds_read_b128 v[80:83], v25 offset:49152
    ds_read_b128 v[84:87], v25 offset:53248
    s_waitcnt lgkmcnt(7)
    v_mfma_f32_16x16x32_bf16 a[0:3], v[144:147], v[32:35], a[0:3]
    v_mfma_f32_16x16x32_bf16 a[4:7], v[144:147], v[36:39], a[4:7]
    v_mfma_f32_16x16x32_bf16 a[8:11], v[144:147], v[40:43], a[8:11]
    v_mfma_f32_16x16x32_bf16 a[12:15], v[144:147], v[44:47], a[12:15]
    v_mfma_f32_16x16x32_bf16 a[16:19], v[144:147], v[48:51], a[16:19]
    v_mfma_f32_16x16x32_bf16 a[20:23], v[144:147], v[52:55], a[20:23]
    v_mfma_f32_16x16x32_bf16 a[24:27], v[144:147], v[56:59], a[24:27]
    v_mfma_f32_16x16x32_bf16 a[28:31], v[148:151], v[32:35], a[28:31]
    v_mfma_f32_16x16x32_bf16 a[32:35], v[148:151], v[36:39], a[32:35]
    v_mfma_f32_16x16x32_bf16 a[36:39], v[148:151], v[40:43], a[36:39]
    v_mfma_f32_16x16x32_bf16 a[40:43], v[148:151], v[44:47], a[40:43]
    v_mfma_f32_16x16x32_bf16 a[44:47], v[148:151], v[48:51], a[44:47]
    v_mfma_f32_16x16x32_bf16 a[48:51], v[148:151], v[52:55], a[48:51]
    v_mfma_f32_16x16x32_bf16 a[52:55], v[148:151], v[56:59], a[52:55]
    v_mfma_f32_16x16x32_bf16 a[56:59], v[152:155], v[32:35], a[56:59]
    v_mfma_f32_16x16x32_bf16 a[60:63], v[152:155], v[36:39], a[60:63]
    v_mfma_f32_16x16x32_bf16 a[64:67], v[152:155], v[40:43], a[64:67]
    v_mfma_f32_16x16x32_bf16 a[68:71], v[152:155], v[44:47], a[68:71]
    v_mfma_f32_16x16x32_bf16 a[72:75], v[152:155], v[48:51], a[72:75]
    v_mfma_f32_16x16x32_bf16 a[76:79], v[152:155], v[52:55], a[76:79]
    v_mfma_f32_16x16x32_bf16 a[80:83], v[152:155], v[56:59], a[80:83]
    v_mfma_f32_16x16x32_bf16 a[84:87], v[156:159], v[32:35], a[84:87]
    v_mfma_f32_16x16x32_bf16 a[88:91], v[156:159], v[36:39], a[88:91]
    v_mfma_f32_16x16x32_bf16 a[92:95], v[156:159], v[40:43], a[92:95]
    v_mfma_f32_16x16x32_bf16 a[96:99], v[156:159], v[44:47], a[96:99]
    v_mfma_f32_16x16x32_bf16 a[100:103], v[156:159], v[48:51], a[100:103]
    v_mfma_f32_16x16x32_bf16 a[104:107], v[156:159], v[52:55], a[104:107]
    v_mfma_f32_16x16x32_bf16 a[108:111], v[156:159], v[56:59], a[108:111]
    ds_read_b128 v[88:91], v26 offset:28672
    ds_read_b128 v[92:95], v26 offset:32768
    ds_read_b128 v[96:99], v26 offset:36864
    ds_read_b128 v[100:103], v26 offset:40960
    ds_read_b128 v[104:107], v26 offset:45056
    ds_read_b128 v[108:111], v26 offset:49152
    ds_read_b128 v[112:115], v26 offset:53248
    s_waitcnt lgkmcnt(7)
    v_mfma_f32_16x16x32_bf16 a[0:3], v[160:163], v[60:63], a[0:3]
    v_mfma_f32_16x16x32_bf16 a[4:7], v[160:163], v[64:67], a[4:7]
    v_mfma_f32_16x16x32_bf16 a[8:11], v[160:163], v[68:71], a[8:11]
    v_mfma_f32_16x16x32_bf16 a[12:15], v[160:163], v[72:75], a[12:15]
    v_mfma_f32_16x16x32_bf16 a[16:19], v[160:163], v[76:79], a[16:19]
    v_mfma_f32_16x16x32_bf16 a[20:23], v[160:163], v[80:83], a[20:23]
    v_mfma_f32_16x16x32_bf16 a[24:27], v[160:163], v[84:87], a[24:27]
    v_mfma_f32_16x16x32_bf16 a[28:31], v[164:167], v[60:63], a[28:31]
    v_mfma_f32_16x16x32_bf16 a[32:35], v[164:167], v[64:67], a[32:35]
    v_mfma_f32_16x16x32_bf16 a[36:39], v[164:167], v[68:71], a[36:39]
    v_mfma_f32_16x16x32_bf16 a[40:43], v[164:167], v[72:75], a[40:43]
    v_mfma_f32_16x16x32_bf16 a[44:47], v[164:167], v[76:79], a[44:47]
    v_mfma_f32_16x16x32_bf16 a[48:51], v[164:167], v[80:83], a[48:51]
    v_mfma_f32_16x16x32_bf16 a[52:55], v[164:167], v[84:87], a[52:55]
    v_mfma_f32_16x16x32_bf16 a[56:59], v[168:171], v[60:63], a[56:59]
    v_mfma_f32_16x16x32_bf16 a[60:63], v[168:171], v[64:67], a[60:63]
    v_mfma_f32_16x16x32_bf16 a[64:67], v[168:171], v[68:71], a[64:67]
    v_mfma_f32_16x16x32_bf16 a[68:71], v[168:171], v[72:75], a[68:71]
    v_mfma_f32_16x16x32_bf16 a[72:75], v[168:171], v[76:79], a[72:75]
    v_mfma_f32_16x16x32_bf16 a[76:79], v[168:171], v[80:83], a[76:79]
    v_mfma_f32_16x16x32_bf16 a[80:83], v[168:171], v[84:87], a[80:83]
    v_mfma_f32_16x16x32_bf16 a[84:87], v[172:175], v[60:63], a[84:87]
    v_mfma_f32_16x16x32_bf16 a[88:91], v[172:175], v[64:67], a[88:91]
    v_mfma_f32_16x16x32_bf16 a[92:95], v[172:175], v[68:71], a[92:95]
    v_mfma_f32_16x16x32_bf16 a[96:99], v[172:175], v[72:75], a[96:99]
    v_mfma_f32_16x16x32_bf16 a[100:103], v[172:175], v[76:79], a[100:103]
    v_mfma_f32_16x16x32_bf16 a[104:107], v[172:175], v[80:83], a[104:107]
    v_mfma_f32_16x16x32_bf16 a[108:111], v[172:175], v[84:87], a[108:111]
    ds_read_b128 v[116:119], v27 offset:28672
    ds_read_b128 v[120:123], v27 offset:32768
    ds_read_b128 v[124:127], v27 offset:36864
    ds_read_b128 v[128:131], v27 offset:40960
    ds_read_b128 v[132:135], v27 offset:45056
    ds_read_b128 v[136:139], v27 offset:49152
    ds_read_b128 v[140:143], v27 offset:53248
    s_waitcnt lgkmcnt(7)
    v_mfma_f32_16x16x32_bf16 a[0:3], v[176:179], v[88:91], a[0:3]
    v_mfma_f32_16x16x32_bf16 a[4:7], v[176:179], v[92:95], a[4:7]
    v_mfma_f32_16x16x32_bf16 a[8:11], v[176:179], v[96:99], a[8:11]
    v_mfma_f32_16x16x32_bf16 a[12:15], v[176:179], v[100:103], a[12:15]
    v_mfma_f32_16x16x32_bf16 a[16:19], v[176:179], v[104:107], a[16:19]
    v_mfma_f32_16x16x32_bf16 a[20:23], v[176:179], v[108:111], a[20:23]
    v_mfma_f32_16x16x32_bf16 a[24:27], v[176:179], v[112:115], a[24:27]
    v_mfma_f32_16x16x32_bf16 a[28:31], v[180:183], v[88:91], a[28:31]
    v_mfma_f32_16x16x32_bf16 a[32:35], v[180:183], v[92:95], a[32:35]
    v_mfma_f32_16x16x32_bf16 a[36:39], v[180:183], v[96:99], a[36:39]
    v_mfma_f32_16x16x32_bf16 a[40:43], v[180:183], v[100:103], a[40:43]
    v_mfma_f32_16x16x32_bf16 a[44:47], v[180:183], v[104:107], a[44:47]
    v_mfma_f32_16x16x32_bf16 a[48:51], v[180:183], v[108:111], a[48:51]
    v_mfma_f32_16x16x32_bf16 a[52:55], v[180:183], v[112:115], a[52:55]
    v_mfma_f32_16x16x32_bf16 a[56:59], v[184:187], v[88:91], a[56:59]
    v_mfma_f32_16x16x32_bf16 a[60:63], v[184:187], v[92:95], a[60:63]
    v_mfma_f32_16x16x32_bf16 a[64:67], v[184:187], v[96:99], a[64:67]
    v_mfma_f32_16x16x32_bf16 a[68:71], v[184:187], v[100:103], a[68:71]
    v_mfma_f32_16x16x32_bf16 a[72:75], v[184:187], v[104:107], a[72:75]
    v_mfma_f32_16x16x32_bf16 a[76:79], v[184:187], v[108:111], a[76:79]
    v_mfma_f32_16x16x32_bf16 a[80:83], v[184:187], v[112:115], a[80:83]
    v_mfma_f32_16x16x32_bf16 a[84:87], v[188:191], v[88:91], a[84:87]
    v_mfma_f32_16x16x32_bf16 a[88:91], v[188:191], v[92:95], a[88:91]
    v_mfma_f32_16x16x32_bf16 a[92:95], v[188:191], v[96:99], a[92:95]
    v_mfma_f32_16x16x32_bf16 a[96:99], v[188:191], v[100:103], a[96:99]
    v_mfma_f32_16x16x32_bf16 a[100:103], v[188:191], v[104:107], a[100:103]
    v_mfma_f32_16x16x32_bf16 a[104:107], v[188:191], v[108:111], a[104:107]
    v_mfma_f32_16x16x32_bf16 a[108:111], v[188:191], v[112:115], a[108:111]
    s_waitcnt lgkmcnt(0)
    v_mfma_f32_16x16x32_bf16 a[0:3], v[192:195], v[116:119], a[0:3]
    v_mfma_f32_16x16x32_bf16 a[4:7], v[192:195], v[120:123], a[4:7]
    v_mfma_f32_16x16x32_bf16 a[8:11], v[192:195], v[124:127], a[8:11]
    v_mfma_f32_16x16x32_bf16 a[12:15], v[192:195], v[128:131], a[12:15]
    v_mfma_f32_16x16x32_bf16 a[16:19], v[192:195], v[132:135], a[16:19]
    v_mfma_f32_16x16x32_bf16 a[20:23], v[192:195], v[136:139], a[20:23]
    v_mfma_f32_16x16x32_bf16 a[24:27], v[192:195], v[140:143], a[24:27]
    v_mfma_f32_16x16x32_bf16 a[28:31], v[196:199], v[116:119], a[28:31]
    v_mfma_f32_16x16x32_bf16 a[32:35], v[196:199], v[120:123], a[32:35]
    v_mfma_f32_16x16x32_bf16 a[36:39], v[196:199], v[124:127], a[36:39]
    v_mfma_f32_16x16x32_bf16 a[40:43], v[196:199], v[128:131], a[40:43]
    v_mfma_f32_16x16x32_bf16 a[44:47], v[196:199], v[132:135], a[44:47]
    v_mfma_f32_16x16x32_bf16 a[48:51], v[196:199], v[136:139], a[48:51]
    v_mfma_f32_16x16x32_bf16 a[52:55], v[196:199], v[140:143], a[52:55]
    v_mfma_f32_16x16x32_bf16 a[56:59], v[200:203], v[116:119], a[56:59]
    v_mfma_f32_16x16x32_bf16 a[60:63], v[200:203], v[120:123], a[60:63]
    v_mfma_f32_16x16x32_bf16 a[64:67], v[200:203], v[124:127], a[64:67]
    v_mfma_f32_16x16x32_bf16 a[68:71], v[200:203], v[128:131], a[68:71]
    v_mfma_f32_16x16x32_bf16 a[72:75], v[200:203], v[132:135], a[72:75]
    v_mfma_f32_16x16x32_bf16 a[76:79], v[200:203], v[136:139], a[76:79]
    v_mfma_f32_16x16x32_bf16 a[80:83], v[200:203], v[140:143], a[80:83]
    v_mfma_f32_16x16x32_bf16 a[84:87], v[204:207], v[116:119], a[84:87]
    v_mfma_f32_16x16x32_bf16 a[88:91], v[204:207], v[120:123], a[88:91]
    v_mfma_f32_16x16x32_bf16 a[92:95], v[204:207], v[124:127], a[92:95]
    v_mfma_f32_16x16x32_bf16 a[96:99], v[204:207], v[128:131], a[96:99]
    v_mfma_f32_16x16x32_bf16 a[100:103], v[204:207], v[132:135], a[100:103]
    v_mfma_f32_16x16x32_bf16 a[104:107], v[204:207], v[136:139], a[104:107]
    v_mfma_f32_16x16x32_bf16 a[108:111], v[204:207], v[140:143], a[108:111]
    s_branch Lgu_j_7
Lgu_u_6:
    s_mul_i32 s30, s27, 229376
    s_mul_i32 s31, s35, 224
    s_add_u32 s30, s30, s31
    s_mul_i32 s31, s23, 28672
    s_add_u32 s30, s30, s31
    s_add_u32 s32, s52, s30
    s_addc_u32 s33, s53, 0
    s_mul_i32 s36, s23, 7168
    v_add_u32 v8, 0, v1
    v_mul_u32_u24 v5, 4682, v8
    v_lshrrev_b32 v5, 16, v5
    v_mul_u32_u24 v19, 14, v5
    v_sub_u32 v8, v8, v19
    v_mul_u32_u24 v5, 896, v5
    v_lshl_add_u32 v208, v8, 4, v5
    v_add_u32 v8, 64, v1
    v_mul_u32_u24 v5, 4682, v8
    v_lshrrev_b32 v5, 16, v5
    v_mul_u32_u24 v19, 14, v5
    v_sub_u32 v8, v8, v19
    v_mul_u32_u24 v5, 896, v5
    v_lshl_add_u32 v209, v8, 4, v5
    v_add_u32 v8, 128, v1
    v_mul_u32_u24 v5, 4682, v8
    v_lshrrev_b32 v5, 16, v5
    v_mul_u32_u24 v19, 14, v5
    v_sub_u32 v8, v8, v19
    v_mul_u32_u24 v5, 896, v5
    v_lshl_add_u32 v210, v8, 4, v5
    v_add_u32 v8, 192, v1
    v_mul_u32_u24 v5, 4682, v8
    v_lshrrev_b32 v5, 16, v5
    v_mul_u32_u24 v19, 14, v5
    v_sub_u32 v8, v8, v19
    v_mul_u32_u24 v5, 896, v5
    v_lshl_add_u32 v211, v8, 4, v5
    v_add_u32 v8, 256, v1
    v_mul_u32_u24 v5, 4682, v8
    v_lshrrev_b32 v5, 16, v5
    v_mul_u32_u24 v19, 14, v5
    v_sub_u32 v8, v8, v19
    v_mul_u32_u24 v5, 896, v5
    v_lshl_add_u32 v212, v8, 4, v5
    v_add_u32 v8, 320, v1
    v_mul_u32_u24 v5, 4682, v8
    v_lshrrev_b32 v5, 16, v5
    v_mul_u32_u24 v19, 14, v5
    v_sub_u32 v8, v8, v19
    v_mul_u32_u24 v5, 896, v5
    v_lshl_add_u32 v213, v8, 4, v5
    v_add_u32 v8, 384, v1
    v_mul_u32_u24 v5, 4682, v8
    v_lshrrev_b32 v5, 16, v5
    v_mul_u32_u24 v19, 14, v5
    v_sub_u32 v8, v8, v19
    v_mul_u32_u24 v5, 896, v5
    v_lshl_add_u32 v214, v8, 4, v5
    s_add_u32 m0, s36, 0
    s_nop 0
    global_load_lds_dwordx4 v208, s[32:33]
    s_add_u32 m0, s36, 1024
    s_nop 0
    global_load_lds_dwordx4 v209, s[32:33]
    s_add_u32 m0, s36, 2048
    s_nop 0
    global_load_lds_dwordx4 v210, s[32:33]
    s_add_u32 m0, s36, 3072
    s_nop 0
    global_load_lds_dwordx4 v211, s[32:33]
    s_add_u32 m0, s36, 4096
    s_nop 0
    global_load_lds_dwordx4 v212, s[32:33]
    s_add_u32 m0, s36, 5120
    s_nop 0
    global_load_lds_dwordx4 v213, s[32:33]
    s_add_u32 m0, s36, 6144
    s_nop 0
    global_load_lds_dwordx4 v214, s[32:33]
    s_add_u32 s32, s32, 0x1c000
    s_addc_u32 s33, s33, 0
    s_add_u32 m0, s36, 28672
    s_nop 0
    global_load_lds_dwordx4 v208, s[32:33]
    s_add_u32 m0, s36, 29696
    s_nop 0
    global_load_lds_dwordx4 v209, s[32:33]
    s_add_u32 m0, s36, 30720
    s_nop 0
    global_load_lds_dwordx4 v210, s[32:33]
    s_add_u32 m0, s36, 31744
    s_nop 0
    global_load_lds_dwordx4 v211, s[32:33]
    s_add_u32 m0, s36, 32768
    s_nop 0
    global_load_lds_dwordx4 v212, s[32:33]
    s_add_u32 m0, s36, 33792
    s_nop 0
    global_load_lds_dwordx4 v213, s[32:33]
    s_add_u32 m0, s36, 34816
    s_nop 0
    global_load_lds_dwordx4 v214, s[32:33]
    s_add_u32 s32, s32, 0x1c000
    s_addc_u32 s33, s33, 0
    v_bfe_u32 v5, v1, 2, 2
    v_lshl_add_u32 v5, v7, 3, v5
    v_mul_u32_u24 v5, 224, v5
    v_and_b32 v19, 3, v1
    v_lshl_add_u32 v24, v19, 3, v5
    s_waitcnt vmcnt(30)
    v_lshlrev_b32 v32, 16, v240
    v_and_b32 v33, 0xffff0000, v240
    v_lshlrev_b32 v34, 16, v241
    v_and_b32 v35, 0xffff0000, v241
    v_lshlrev_b32 v36, 16, v242
    v_and_b32 v37, 0xffff0000, v242
    v_lshlrev_b32 v38, 16, v243
    v_and_b32 v39, 0xffff0000, v243
    v_lshlrev_b32 v40, 16, v244
    v_and_b32 v41, 0xffff0000, v244
    v_lshlrev_b32 v42, 16, v245
    v_and_b32 v43, 0xffff0000, v245
    v_lshlrev_b32 v44, 16, v246
    v_and_b32 v45, 0xffff0000, v246
    v_lshlrev_b32 v46, 16, v247
    v_and_b32 v47, 0xffff0000, v247
    v_add_f32 v56, v32, v33
    v_add_f32 v56, v56, v34
    v_add_f32 v56, v56, v35
    v_add_f32 v56, v56, v36
    v_add_f32 v56, v56, v37
    v_add_f32 v56, v56, v38
    v_add_f32 v56, v56, v39
    v_add_f32 v57, v40, v41
    v_add_f32 v57, v57, v42
    v_add_f32 v57, v57, v43
    v_add_f32 v57, v57, v44
    v_add_f32 v57, v57, v45
    v_add_f32 v57, v57, v46
    v_add_f32 v57, v57, v47
    s_nop 1
    v_add_f32_dpp v56, v56, v56 quad_perm:[1,0,3,2] row_mask:0xf bank_mask:0xf
    v_add_f32_dpp v57, v57, v57 quad_perm:[1,0,3,2] row_mask:0xf bank_mask:0xf
    s_nop 1
    v_add_f32_dpp v56, v56, v56 quad_perm:[2,3,0,1] row_mask:0xf bank_mask:0xf
    v_add_f32_dpp v57, v57, v57 quad_perm:[2,3,0,1] row_mask:0xf bank_mask:0xf
    s_nop 1
    v_add_f32_dpp v56, v56, v56 row_half_mirror row_mask:0xf bank_mask:0xf
    v_add_f32_dpp v57, v57, v57 row_half_mirror row_mask:0xf bank_mask:0xf
    s_nop 1
    v_add_f32_dpp v56, v56, v56 row_mirror row_mask:0xf bank_mask:0xf
    v_add_f32_dpp v57, v57, v57 row_mirror row_mask:0xf bank_mask:0xf
    v_mov_b32 v58, v56
    v_mov_b32 v59, v57
    s_nop 1
    v_permlane16_swap_b32 v56, v58
    v_permlane16_swap_b32 v57, v59
    v_add_f32 v56, v56, v58
    v_add_f32 v57, v57, v59
    v_mov_b32 v58, v56
    v_mov_b32 v59, v57
    s_nop 1
    v_permlane32_swap_b32 v56, v58
    v_permlane32_swap_b32 v57, v59
    v_add_f32 v56, v56, v58
    v_add_f32 v57, v57, v59
    s_mov_b32 s66, 0x3b124925
    v_mul_f32 v60, s66, v56
    v_mul_f32 v61, s66, v57
    v_mov_b32 v56, 0
    v_sub_f32 v58, v32, v60
    v_fmac_f32 v56, v58, v58
    v_sub_f32 v58, v33, v60
    v_fmac_f32 v56, v58, v58
    v_sub_f32 v58, v34, v60
    v_fmac_f32 v56, v58, v58
    v_sub_f32 v58, v35, v60
    v_fmac_f32 v56, v58, v58
    v_sub_f32 v58, v36, v60
    v_fmac_f32 v56, v58, v58
    v_sub_f32 v58, v37, v60
    v_fmac_f32 v56, v58, v58
    v_sub_f32 v58, v38, v60
    v_fmac_f32 v56, v58, v58
    v_sub_f32 v58, v39, v60
    v_fmac_f32 v56, v58, v58
    v_cndmask_b32 v56, 0, v56, s[64:65]
    v_mov_b32 v57, 0
    v_sub_f32 v59, v40, v61
    v_fmac_f32 v57, v59, v59
    v_sub_f32 v59, v41, v61
    v_fmac_f32 v57, v59, v59
    v_sub_f32 v59, v42, v61
    v_fmac_f32 v57, v59, v59
    v_sub_f32 v59, v43, v61
    v_fmac_f32 v57, v59, v59
    v_sub_f32 v59, v44, v61
    v_fmac_f32 v57, v59, v59
    v_sub_f32 v59, v45, v61
    v_fmac_f32 v57, v59, v59
    v_sub_f32 v59, v46, v61
    v_fmac_f32 v57, v59, v59
    v_sub_f32 v59, v47, v61
    v_fmac_f32 v57, v59, v59
    v_cndmask_b32 v57, 0, v57, s[64:65]
    s_nop 1
    v_add_f32_dpp v56, v56, v56 quad_perm:[1,0,3,2] row_mask:0xf bank_mask:0xf
    v_add_f32_dpp v57, v57, v57 quad_perm:[1,0,3,2] row_mask:0xf bank_mask:0xf
    s_nop 1
    v_add_f32_dpp v56, v56, v56 quad_perm:[2,3,0,1] row_mask:0xf bank_mask:0xf
    v_add_f32_dpp v57, v57, v57 quad_perm:[2,3,0,1] row_mask:0xf bank_mask:0xf
    s_nop 1
    v_add_f32_dpp v56, v56, v56 row_half_mirror row_mask:0xf bank_mask:0xf
    v_add_f32_dpp v57, v57, v57 row_half_mirror row_mask:0xf bank_mask:0xf
    s_nop 1
    v_add_f32_dpp v56, v56, v56 row_mirror row_mask:0xf bank_mask:0xf
    v_add_f32_dpp v57, v57, v57 row_mirror row_mask:0xf bank_mask:0xf
    v_mov_b32 v58, v56
    v_mov_b32 v59, v57
    s_nop 1
    v_permlane16_swap_b32 v56, v58
    v_permlane16_swap_b32 v57, v59
    v_add_f32 v56, v56, v58
    v_add_f32 v57, v57, v59
    v_mov_b32 v58, v56
    v_mov_b32 v59, v57
    s_nop 1
    v_permlane32_swap_b32 v56, v58
    v_permlane32_swap_b32 v57, v59
    v_add_f32 v56, v56, v58
    v_add_f32 v57, v57, v59
    v_mul_f32 v56, s66, v56
    v_cvt_pk_bf16_f32 v56, v56, v56
    v_lshlrev_b32 v56, 16, v56
    v_cvt_pk_bf16_f32 v60, v60, v60
    v_lshlrev_b32 v60, 16, v60
    v_add_f32 v56, 0x3727c5ac, v56
    v_cvt_pk_bf16_f32 v56, v56, v56
    v_lshlrev_b32 v56, 16, v56
    v_sqrt_f32 v56, v56
    s_nop 0
    v_cvt_pk_bf16_f32 v56, v56, v56
    v_lshlrev_b32 v56, 16, v56
    v_rcp_f32 v58, v56
    s_nop 0
    v_mul_f32 v57, s66, v57
    v_cvt_pk_bf16_f32 v57, v57, v57
    v_lshlrev_b32 v57, 16, v57
    v_cvt_pk_bf16_f32 v61, v61, v61
    v_lshlrev_b32 v61, 16, v61
    v_add_f32 v57, 0x3727c5ac, v57
    v_cvt_pk_bf16_f32 v57, v57, v57
    v_lshlrev_b32 v57, 16, v57
    v_sqrt_f32 v57, v57
    s_nop 0
    v_cvt_pk_bf16_f32 v57, v57, v57
    v_lshlrev_b32 v57, 16, v57
    v_rcp_f32 v59, v57
    s_nop 0
    v_sub_f32 v32, v32, v60
    v_sub_f32 v33, v33, v60
    v_cvt_pk_bf16_f32 v240, v32, v33
    v_lshlrev_b32 v32, 16, v240
    v_and_b32 v33, 0xffff0000, v240
    v_mul_f32 v62, v32, v58
    v_fma_f32 v32, -v62, v56, v32
    v_fma_f32 v32, v32, v58, v62
    v_mul_f32 v63, v33, v58
    v_fma_f32 v33, -v63, v56, v33
    v_fma_f32 v33, v33, v58, v63
    v_cvt_pk_bf16_f32 v240, v32, v33
    v_sub_f32 v34, v34, v60
    v_sub_f32 v35, v35, v60
    v_cvt_pk_bf16_f32 v241, v34, v35
    v_lshlrev_b32 v34, 16, v241
    v_and_b32 v35, 0xffff0000, v241
    v_mul_f32 v62, v34, v58
    v_fma_f32 v34, -v62, v56, v34
    v_fma_f32 v34, v34, v58, v62
    v_mul_f32 v63, v35, v58
    v_fma_f32 v35, -v63, v56, v35
    v_fma_f32 v35, v35, v58, v63
    v_cvt_pk_bf16_f32 v241, v34, v35
    v_sub_f32 v36, v36, v60
    v_sub_f32 v37, v37, v60
    v_cvt_pk_bf16_f32 v242, v36, v37
    v_lshlrev_b32 v36, 16, v242
    v_and_b32 v37, 0xffff0000, v242
    v_mul_f32 v62, v36, v58
    v_fma_f32 v36, -v62, v56, v36
    v_fma_f32 v36, v36, v58, v62
    v_mul_f32 v63, v37, v58
    v_fma_f32 v37, -v63, v56, v37
    v_fma_f32 v37, v37, v58, v63
    v_cvt_pk_bf16_f32 v242, v36, v37
    v_sub_f32 v38, v38, v60
    v_sub_f32 v39, v39, v60
    v_cvt_pk_bf16_f32 v243, v38, v39
    v_lshlrev_b32 v38, 16, v243
    v_and_b32 v39, 0xffff0000, v243
    v_mul_f32 v62, v38, v58
    v_fma_f32 v38, -v62, v56, v38
    v_fma_f32 v38, v38, v58, v62
    v_mul_f32 v63, v39, v58
    v_fma_f32 v39, -v63, v56, v39
    v_fma_f32 v39, v39, v58, v63
    v_cvt_pk_bf16_f32 v243, v38, v39
    v_sub_f32 v40, v40, v61
    v_sub_f32 v41, v41, v61
    v_cvt_pk_bf16_f32 v244, v40, v41
    v_lshlrev_b32 v40, 16, v244
    v_and_b32 v41, 0xffff0000, v244
    v_mul_f32 v62, v40, v59
    v_fma_f32 v40, -v62, v57, v40
    v_fma_f32 v40, v40, v59, v62
    v_mul_f32 v63, v41, v59
    v_fma_f32 v41, -v63, v57, v41
    v_fma_f32 v41, v41, v59, v63
    v_cvt_pk_bf16_f32 v244, v40, v41
    v_sub_f32 v42, v42, v61
    v_sub_f32 v43, v43, v61
    v_cvt_pk_bf16_f32 v245, v42, v43
    v_lshlrev_b32 v42, 16, v245
    v_and_b32 v43, 0xffff0000, v245
    v_mul_f32 v62, v42, v59
    v_fma_f32 v42, -v62, v57, v42
    v_fma_f32 v42, v42, v59, v62
    v_mul_f32 v63, v43, v59
    v_fma_f32 v43, -v63, v57, v43
    v_fma_f32 v43, v43, v59, v63
    v_cvt_pk_bf16_f32 v245, v42, v43
    v_sub_f32 v44, v44, v61
    v_sub_f32 v45, v45, v61
    v_cvt_pk_bf16_f32 v246, v44, v45
    v_lshlrev_b32 v44, 16, v246
    v_and_b32 v45, 0xffff0000, v246
    v_mul_f32 v62, v44, v59
    v_fma_f32 v44, -v62, v57, v44
    v_fma_f32 v44, v44, v59, v62
    v_mul_f32 v63, v45, v59
    v_fma_f32 v45, -v63, v57, v45
    v_fma_f32 v45, v45, v59, v63
    v_cvt_pk_bf16_f32 v246, v44, v45
    v_sub_f32 v46, v46, v61
    v_sub_f32 v47, v47, v61
    v_cvt_pk_bf16_f32 v247, v46, v47
    v_lshlrev_b32 v46, 16, v247
    v_and_b32 v47, 0xffff0000, v247
    v_mul_f32 v62, v46, v59
    v_fma_f32 v46, -v62, v57, v46
    v_fma_f32 v46, v46, v59, v62
    v_mul_f32 v63, v47, v59
    v_fma_f32 v47, -v63, v57, v47
    v_fma_f32 v47, v47, v59, v63
    v_cvt_pk_bf16_f32 v247, v46, v47
    s_mov_b32 s66, 0xaaaaaaaa
    s_mov_b32 s67, 0xaaaaaaaa
    v_mov_b32_dpp v32, v240 quad_perm:[1,0,3,2] row_mask:0xf bank_mask:0xf
    v_mov_b32_dpp v33, v241 quad_perm:[1,0,3,2] row_mask:0xf bank_mask:0xf
    v_mov_b32_dpp v34, v242 quad_perm:[1,0,3,2] row_mask:0xf bank_mask:0xf
    v_mov_b32_dpp v35, v243 quad_perm:[1,0,3,2] row_mask:0xf bank_mask:0xf
    v_cndmask_b32 v64, v240, v34, s[66:67]
    v_cndmask_b32 v65, v32, v242, s[66:67]
    v_cndmask_b32 v66, v241, v35, s[66:67]
    v_cndmask_b32 v67, v33, v243, s[66:67]
    v_mov_b32_dpp v40, v244 quad_perm:[1,0,3,2] row_mask:0xf bank_mask:0xf
    v_mov_b32_dpp v41, v245 quad_perm:[1,0,3,2] row_mask:0xf bank_mask:0xf
    v_mov_b32_dpp v42, v246 quad_perm:[1,0,3,2] row_mask:0xf bank_mask:0xf
    v_mov_b32_dpp v43, v247 quad_perm:[1,0,3,2] row_mask:0xf bank_mask:0xf
    v_cndmask_b32 v68, v244, v42, s[66:67]
    v_cndmask_b32 v69, v40, v246, s[66:67]
    v_cndmask_b32 v70, v245, v43, s[66:67]
    v_cndmask_b32 v71, v41, v247, s[66:67]
    v_and_b32 v72, 63, v0
    s_lshl_b32 s68, s23, 5
    s_add_u32 s68, s68, 147456
    v_lshl_add_u32 v72, v72, 7, s68
    s_mov_b64 exec, s[64:65]
    ds_write_b128 v72, v[240:243] offset:0
    ds_write_b128 v72, v[64:67] offset:7168
    ds_write_b128 v72, v[244:247] offset:16
    ds_write_b128 v72, v[68:71] offset:7184
    s_mov_b64 exec, -1
    v_lshlrev_b32 v74, 4, v0
    v_mov_b32 v76, -1
    v_mov_b32 v77, -1
    v_mov_b32 v78, -1
    v_mov_b32 v79, -1
    s_lshl_b32 s66, s2, 1
    s_add_u32 s66, s66, 0
    s_min_u32 s66, s66, 507
    s_lshl_b32 s67, s66, 12
    s_add_u32 s68, s67, 0x6002000
    s_add_u32 s69, s67, 0x6184000
    s_add_u32 s67, s67, 0x6082000
    s_cmp_lt_u32 s66, 126
    s_cselect_b32 s67, s68, s67
    s_cmp_ge_u32 s66, 382
    s_cselect_b32 s67, s69, s67
    s_add_u32 s68, s4, s67
    s_addc_u32 s69, s5, 0
    global_store_dwordx4 v74, v[76:79], s[68:69] sc1
    s_lshl_b32 s66, s2, 1
    s_add_u32 s66, s66, 1
    s_min_u32 s66, s66, 507
    s_lshl_b32 s67, s66, 12
    s_add_u32 s68, s67, 0x6002000
    s_add_u32 s69, s67, 0x6184000
    s_add_u32 s67, s67, 0x6082000
    s_cmp_lt_u32 s66, 126
    s_cselect_b32 s67, s68, s67
    s_cmp_ge_u32 s66, 382
    s_cselect_b32 s67, s69, s67
    s_add_u32 s68, s4, s67
    s_addc_u32 s69, s5, 0
    global_store_dwordx4 v74, v[76:79], s[68:69] sc1
    s_waitcnt vmcnt(9) lgkmcnt(0)
    s_barrier
    ds_read_b128 v[144:147], v20 offset:0
    ds_read_b128 v[148:151], v20 offset:4096
    ds_read_b128 v[152:155], v20 offset:8192
    ds_read_b128 v[156:159], v20 offset:12288
    ds_read_b128 v[160:163], v21 offset:0
    ds_read_b128 v[164:167], v21 offset:4096
    ds_read_b128 v[168:171], v21 offset:8192
    ds_read_b128 v[172:175], v21 offset:12288
    ds_read_b128 v[176:179], v22 offset:0
    ds_read_b128 v[180:183], v22 offset:4096
    ds_read_b128 v[184:187], v22 offset:8192
    ds_read_b128 v[188:191], v22 offset:12288
    s_waitcnt lgkmcnt(4)
    ds_read_b128 v[192:195], v23 offset:0
    ds_read_b128 v[196:199], v23 offset:4096
    ds_read_b128 v[200:203], v23 offset:8192
    ds_read_b128 v[204:207], v23 offset:12288
    s_waitcnt lgkmcnt(0)
    v_add_u32 v5, 256, v4
    s_add_u32 m0, s34, 0
    s_nop 0
    global_load_lds_dwordx4 v5, s[28:29]
    v_add_u32 v5, 33024, v4
    s_add_u32 m0, s34, 1024
    s_nop 0
    global_load_lds_dwordx4 v5, s[28:29]
    v_add_u32 v5, 131328, v4
    s_add_u32 m0, s34, 2048
    s_nop 0
    global_load_lds_dwordx4 v5, s[28:29]
    v_add_u32 v5, 164096, v4
    s_add_u32 m0, s34, 3072
    s_nop 0
    global_load_lds_dwordx4 v5, s[28:29]
    v_add_u32 v5, 16640, v4
    s_add_u32 m0, s34, 4096
    s_nop 0
    global_load_lds_dwordx4 v5, s[28:29]
    v_add_u32 v5, 49408, v4
    s_add_u32 m0, s34, 5120
    s_nop 0
    global_load_lds_dwordx4 v5, s[28:29]
    v_add_u32 v5, 147712, v4
    s_add_u32 m0, s34, 6144
    s_nop 0
    global_load_lds_dwordx4 v5, s[28:29]
    v_add_u32 v5, 180480, v4
    s_add_u32 m0, s34, 7168
    s_nop 0
    global_load_lds_dwordx4 v5, s[28:29]
    v_add_u32 v5, 262400, v4
    s_add_u32 m0, s34, 8192
    s_nop 0
    global_load_lds_dwordx4 v5, s[28:29]
    v_add_u32 v5, 295168, v4
    s_add_u32 m0, s34, 9216
    s_nop 0
    global_load_lds_dwordx4 v5, s[28:29]
    v_add_u32 v5, 393472, v4
    s_add_u32 m0, s34, 10240
    s_nop 0
    global_load_lds_dwordx4 v5, s[28:29]
    v_add_u32 v5, 426240, v4
    s_add_u32 m0, s34, 11264
    s_nop 0
    global_load_lds_dwordx4 v5, s[28:29]
    v_add_u32 v5, 278784, v4
    s_add_u32 m0, s34, 12288
    s_nop 0
    global_load_lds_dwordx4 v5, s[28:29]
    v_add_u32 v5, 311552, v4
    s_add_u32 m0, s34, 13312
    s_nop 0
    global_load_lds_dwordx4 v5, s[28:29]
    v_add_u32 v5, 409856, v4
    s_add_u32 m0, s34, 14336
    s_nop 0
    global_load_lds_dwordx4 v5, s[28:29]
    v_add_u32 v5, 442624, v4
    s_add_u32 m0, s34, 15360
    s_nop 0
    global_load_lds_dwordx4 v5, s[28:29]
    v_mov_b32 v255, 0
    s_lshl_b32 s64, s23, 8
    s_add_u32 s64, s64, s2
    s_cmp_lg_u32 s64, 2
    s_cbranch_scc1 Lec_10
    s_mov_b64 exec, 1
    s_add_u32 s64, s70, 1
    v_mov_b32 v249, s64
    global_store_dword v255, v249, s[6:7] offset:128 sc1
    s_mov_b64 exec, -1
Lec_10:
    s_lshr_b32 s66, s20, 4
    s_mul_i32 s66, s66, 14336
    s_and_b32 s64, s20, 15
    s_lshl_b32 s64, s64, 4
    s_add_u32 s66, s66, s64
    s_add_u32 s64, s66, 0x200000
    s_add_u32 s68, s4, s64
    s_addc_u32 s69, s5, 0
    s_add_u32 s66, s4, s66
    s_addc_u32 s67, s5, 0
    v_add_u32 v216, 0, v0
    v_min_u32 v216, 447, v216
    v_lshlrev_b32 v217, 4, v216
    v_add_u32 v217, 147456, v217
    ds_read_b128 v[220:223], v217
    ds_read_b128 v[224:227], v217 offset:7168
    v_lshrrev_b32 v218, 3, v216
    v_and_b32 v216, 7, v216
    v_lshlrev_b32 v216, 4, v216
    v_lshl_add_u32 v216, v218, 8, v216
    v_add_u32 v228, 256, v0
    v_min_u32 v228, 447, v228
    v_lshlrev_b32 v229, 4, v228
    v_add_u32 v229, 147456, v229
    ds_read_b128 v[232:235], v229
    ds_read_b128 v[236:239], v229 offset:7168
    v_lshrrev_b32 v230, 3, v228
    v_and_b32 v228, 7, v228
    v_lshlrev_b32 v228, 4, v228
    v_lshl_add_u32 v228, v230, 8, v228
    s_waitcnt lgkmcnt(0)
    global_store_dwordx4 v216, v[220:223], s[66:67] sc1
    global_store_dwordx4 v216, v[224:227], s[68:69] sc1
    global_store_dwordx4 v228, v[232:235], s[66:67] sc1
    global_store_dwordx4 v228, v[236:239], s[68:69] sc1
    s_cmp_lg_u32 s2, 0
    s_cbranch_scc1 Lpz_11
    s_add_u32 s68, s4, 0x6000000
    s_addc_u32 s69, s5, 0
    s_add_u32 s66, s4, 0x6300000
    s_addc_u32 s67, s5, 0
    v_accvgpr_read_b32 v240, a240
    v_min_u32 v240, -2, v240
    v_accvgpr_read_b32 v241, a241
    v_min_u32 v241, -2, v241
    v_accvgpr_read_b32 v242, a242
    v_min_u32 v242, -2, v242
    v_accvgpr_read_b32 v243, a243
    v_min_u32 v243, -2, v243
    global_store_dwordx4 v253, v[240:243], s[68:69] sc1
    global_store_dwordx4 v253, v[240:243], s[66:67] sc1
    v_accvgpr_read_b32 v244, a244
    v_min_u32 v244, -2, v244
    v_accvgpr_read_b32 v245, a245
    v_min_u32 v245, -2, v245
    v_accvgpr_read_b32 v246, a246
    v_min_u32 v246, -2, v246
    v_accvgpr_read_b32 v247, a247
    v_min_u32 v247, -2, v247
    global_store_dwordx4 v254, v[244:247], s[68:69] sc1
    global_store_dwordx4 v254, v[244:247], s[66:67] sc1
Lpz_11:
    ds_read_b64_tr_b16 v[32:33], v24 offset:0
    ds_read_b64_tr_b16 v[34:35], v24 offset:896
    ds_read_b64_tr_b16 v[36:37], v24 offset:32
    ds_read_b64_tr_b16 v[38:39], v24 offset:928
    ds_read_b64_tr_b16 v[40:41], v24 offset:64
    ds_read_b64_tr_b16 v[42:43], v24 offset:960
    ds_read_b64_tr_b16 v[44:45], v24 offset:96
    ds_read_b64_tr_b16 v[46:47], v24 offset:992
    ds_read_b64_tr_b16 v[48:49], v24 offset:128
    ds_read_b64_tr_b16 v[50:51], v24 offset:1024
    ds_read_b64_tr_b16 v[52:53], v24 offset:160
    ds_read_b64_tr_b16 v[54:55], v24 offset:1056
    ds_read_b64_tr_b16 v[56:57], v24 offset:192
    ds_read_b64_tr_b16 v[58:59], v24 offset:1088
    s_waitcnt lgkmcnt(0)
    ds_read_b64_tr_b16 v[60:61], v24 offset:7168
    ds_read_b64_tr_b16 v[62:63], v24 offset:8064
    ds_read_b64_tr_b16 v[64:65], v24 offset:7200
    ds_read_b64_tr_b16 v[66:67], v24 offset:8096
    ds_read_b64_tr_b16 v[68:69], v24 offset:7232
    ds_read_b64_tr_b16 v[70:71], v24 offset:8128
    ds_read_b64_tr_b16 v[72:73], v24 offset:7264
    ds_read_b64_tr_b16 v[74:75], v24 offset:8160
    ds_read_b64_tr_b16 v[76:77], v24 offset:7296
    ds_read_b64_tr_b16 v[78:79], v24 offset:8192
    ds_read_b64_tr_b16 v[80:81], v24 offset:7328
    ds_read_b64_tr_b16 v[82:83], v24 offset:8224
    ds_read_b64_tr_b16 v[84:85], v24 offset:7360
    ds_read_b64_tr_b16 v[86:87], v24 offset:8256
    v_mfma_f32_16x16x32_bf16 a[0:3], v[144:147], v[32:35], 0
    v_mfma_f32_16x16x32_bf16 a[4:7], v[144:147], v[36:39], 0
    v_mfma_f32_16x16x32_bf16 a[8:11], v[144:147], v[40:43], 0
    v_mfma_f32_16x16x32_bf16 a[12:15], v[144:147], v[44:47], 0
    v_mfma_f32_16x16x32_bf16 a[16:19], v[144:147], v[48:51], 0
    v_mfma_f32_16x16x32_bf16 a[20:23], v[144:147], v[52:55], 0
    v_mfma_f32_16x16x32_bf16 a[24:27], v[144:147], v[56:59], 0
    v_mfma_f32_16x16x32_bf16 a[28:31], v[148:151], v[32:35], 0
    v_mfma_f32_16x16x32_bf16 a[32:35], v[148:151], v[36:39], 0
    v_mfma_f32_16x16x32_bf16 a[36:39], v[148:151], v[40:43], 0
    v_mfma_f32_16x16x32_bf16 a[40:43], v[148:151], v[44:47], 0
    v_mfma_f32_16x16x32_bf16 a[44:47], v[148:151], v[48:51], 0
    v_mfma_f32_16x16x32_bf16 a[48:51], v[148:151], v[52:55], 0
    v_mfma_f32_16x16x32_bf16 a[52:55], v[148:151], v[56:59], 0
    v_mfma_f32_16x16x32_bf16 a[56:59], v[152:155], v[32:35], 0
    v_mfma_f32_16x16x32_bf16 a[60:63], v[152:155], v[36:39], 0
    v_mfma_f32_16x16x32_bf16 a[64:67], v[152:155], v[40:43], 0
    v_mfma_f32_16x16x32_bf16 a[68:71], v[152:155], v[44:47], 0
    v_mfma_f32_16x16x32_bf16 a[72:75], v[152:155], v[48:51], 0
    v_mfma_f32_16x16x32_bf16 a[76:79], v[152:155], v[52:55], 0
    v_mfma_f32_16x16x32_bf16 a[80:83], v[152:155], v[56:59], 0
    v_mfma_f32_16x16x32_bf16 a[84:87], v[156:159], v[32:35], 0
    v_mfma_f32_16x16x32_bf16 a[88:91], v[156:159], v[36:39], 0
    v_mfma_f32_16x16x32_bf16 a[92:95], v[156:159], v[40:43], 0
    v_mfma_f32_16x16x32_bf16 a[96:99], v[156:159], v[44:47], 0
    v_mfma_f32_16x16x32_bf16 a[100:103], v[156:159], v[48:51], 0
    v_mfma_f32_16x16x32_bf16 a[104:107], v[156:159], v[52:55], 0
    v_mfma_f32_16x16x32_bf16 a[108:111], v[156:159], v[56:59], 0
    s_waitcnt lgkmcnt(0)
    ds_read_b64_tr_b16 v[88:89], v24 offset:14336
    ds_read_b64_tr_b16 v[90:91], v24 offset:15232
    ds_read_b64_tr_b16 v[92:93], v24 offset:14368
    ds_read_b64_tr_b16 v[94:95], v24 offset:15264
    ds_read_b64_tr_b16 v[96:97], v24 offset:14400
    ds_read_b64_tr_b16 v[98:99], v24 offset:15296
    ds_read_b64_tr_b16 v[100:101], v24 offset:14432
    ds_read_b64_tr_b16 v[102:103], v24 offset:15328
    ds_read_b64_tr_b16 v[104:105], v24 offset:14464
    ds_read_b64_tr_b16 v[106:107], v24 offset:15360
    ds_read_b64_tr_b16 v[108:109], v24 offset:14496
    ds_read_b64_tr_b16 v[110:111], v24 offset:15392
    ds_read_b64_tr_b16 v[112:113], v24 offset:14528
    ds_read_b64_tr_b16 v[114:115], v24 offset:15424
    v_mfma_f32_16x16x32_bf16 a[0:3], v[160:163], v[60:63], a[0:3]
    v_mfma_f32_16x16x32_bf16 a[4:7], v[160:163], v[64:67], a[4:7]
    v_mfma_f32_16x16x32_bf16 a[8:11], v[160:163], v[68:71], a[8:11]
    v_mfma_f32_16x16x32_bf16 a[12:15], v[160:163], v[72:75], a[12:15]
    v_mfma_f32_16x16x32_bf16 a[16:19], v[160:163], v[76:79], a[16:19]
    v_mfma_f32_16x16x32_bf16 a[20:23], v[160:163], v[80:83], a[20:23]
    v_mfma_f32_16x16x32_bf16 a[24:27], v[160:163], v[84:87], a[24:27]
    v_mfma_f32_16x16x32_bf16 a[28:31], v[164:167], v[60:63], a[28:31]
    v_mfma_f32_16x16x32_bf16 a[32:35], v[164:167], v[64:67], a[32:35]
    v_mfma_f32_16x16x32_bf16 a[36:39], v[164:167], v[68:71], a[36:39]
    v_mfma_f32_16x16x32_bf16 a[40:43], v[164:167], v[72:75], a[40:43]
    v_mfma_f32_16x16x32_bf16 a[44:47], v[164:167], v[76:79], a[44:47]
    v_mfma_f32_16x16x32_bf16 a[48:51], v[164:167], v[80:83], a[48:51]
    v_mfma_f32_16x16x32_bf16 a[52:55], v[164:167], v[84:87], a[52:55]
    v_mfma_f32_16x16x32_bf16 a[56:59], v[168:171], v[60:63], a[56:59]
    v_mfma_f32_16x16x32_bf16 a[60:63], v[168:171], v[64:67], a[60:63]
    v_mfma_f32_16x16x32_bf16 a[64:67], v[168:171], v[68:71], a[64:67]
    v_mfma_f32_16x16x32_bf16 a[68:71], v[168:171], v[72:75], a[68:71]
    v_mfma_f32_16x16x32_bf16 a[72:75], v[168:171], v[76:79], a[72:75]
    v_mfma_f32_16x16x32_bf16 a[76:79], v[168:171], v[80:83], a[76:79]
    v_mfma_f32_16x16x32_bf16 a[80:83], v[168:171], v[84:87], a[80:83]
    v_mfma_f32_16x16x32_bf16 a[84:87], v[172:175], v[60:63], a[84:87]
    v_mfma_f32_16x16x32_bf16 a[88:91], v[172:175], v[64:67], a[88:91]
    v_mfma_f32_16x16x32_bf16 a[92:95], v[172:175], v[68:71], a[92:95]
    v_mfma_f32_16x16x32_bf16 a[96:99], v[172:175], v[72:75], a[96:99]
    v_mfma_f32_16x16x32_bf16 a[100:103], v[172:175], v[76:79], a[100:103]
    v_mfma_f32_16x16x32_bf16 a[104:107], v[172:175], v[80:83], a[104:107]
    v_mfma_f32_16x16x32_bf16 a[108:111], v[172:175], v[84:87], a[108:111]
    s_waitcnt lgkmcnt(0)
    ds_read_b64_tr_b16 v[116:117], v24 offset:21504
    ds_read_b64_tr_b16 v[118:119], v24 offset:22400
    ds_read_b64_tr_b16 v[120:121], v24 offset:21536
    ds_read_b64_tr_b16 v[122:123], v24 offset:22432
    ds_read_b64_tr_b16 v[124:125], v24 offset:21568
    ds_read_b64_tr_b16 v[126:127], v24 offset:22464
    ds_read_b64_tr_b16 v[128:129], v24 offset:21600
    ds_read_b64_tr_b16 v[130:131], v24 offset:22496
    ds_read_b64_tr_b16 v[132:133], v24 offset:21632
    ds_read_b64_tr_b16 v[134:135], v24 offset:22528
    ds_read_b64_tr_b16 v[136:137], v24 offset:21664
    ds_read_b64_tr_b16 v[138:139], v24 offset:22560
    ds_read_b64_tr_b16 v[140:141], v24 offset:21696
    ds_read_b64_tr_b16 v[142:143], v24 offset:22592
    v_mfma_f32_16x16x32_bf16 a[0:3], v[176:179], v[88:91], a[0:3]
    v_mfma_f32_16x16x32_bf16 a[4:7], v[176:179], v[92:95], a[4:7]
    v_mfma_f32_16x16x32_bf16 a[8:11], v[176:179], v[96:99], a[8:11]
    v_mfma_f32_16x16x32_bf16 a[12:15], v[176:179], v[100:103], a[12:15]
    v_mfma_f32_16x16x32_bf16 a[16:19], v[176:179], v[104:107], a[16:19]
    v_mfma_f32_16x16x32_bf16 a[20:23], v[176:179], v[108:111], a[20:23]
    v_mfma_f32_16x16x32_bf16 a[24:27], v[176:179], v[112:115], a[24:27]
    v_mfma_f32_16x16x32_bf16 a[28:31], v[180:183], v[88:91], a[28:31]
    v_mfma_f32_16x16x32_bf16 a[32:35], v[180:183], v[92:95], a[32:35]
    v_mfma_f32_16x16x32_bf16 a[36:39], v[180:183], v[96:99], a[36:39]
    v_mfma_f32_16x16x32_bf16 a[40:43], v[180:183], v[100:103], a[40:43]
    v_mfma_f32_16x16x32_bf16 a[44:47], v[180:183], v[104:107], a[44:47]
    v_mfma_f32_16x16x32_bf16 a[48:51], v[180:183], v[108:111], a[48:51]
    v_mfma_f32_16x16x32_bf16 a[52:55], v[180:183], v[112:115], a[52:55]
    v_mfma_f32_16x16x32_bf16 a[56:59], v[184:187], v[88:91], a[56:59]
    v_mfma_f32_16x16x32_bf16 a[60:63], v[184:187], v[92:95], a[60:63]
    v_mfma_f32_16x16x32_bf16 a[64:67], v[184:187], v[96:99], a[64:67]
    v_mfma_f32_16x16x32_bf16 a[68:71], v[184:187], v[100:103], a[68:71]
    v_mfma_f32_16x16x32_bf16 a[72:75], v[184:187], v[104:107], a[72:75]
    v_mfma_f32_16x16x32_bf16 a[76:79], v[184:187], v[108:111], a[76:79]
    v_mfma_f32_16x16x32_bf16 a[80:83], v[184:187], v[112:115], a[80:83]
    v_mfma_f32_16x16x32_bf16 a[84:87], v[188:191], v[88:91], a[84:87]
    v_mfma_f32_16x16x32_bf16 a[88:91], v[188:191], v[92:95], a[88:91]
    v_mfma_f32_16x16x32_bf16 a[92:95], v[188:191], v[96:99], a[92:95]
    v_mfma_f32_16x16x32_bf16 a[96:99], v[188:191], v[100:103], a[96:99]
    v_mfma_f32_16x16x32_bf16 a[100:103], v[188:191], v[104:107], a[100:103]
    v_mfma_f32_16x16x32_bf16 a[104:107], v[188:191], v[108:111], a[104:107]
    v_mfma_f32_16x16x32_bf16 a[108:111], v[188:191], v[112:115], a[108:111]
    s_waitcnt lgkmcnt(0)
    v_mfma_f32_16x16x32_bf16 a[0:3], v[192:195], v[116:119], a[0:3]
    v_mfma_f32_16x16x32_bf16 a[4:7], v[192:195], v[120:123], a[4:7]
    v_mfma_f32_16x16x32_bf16 a[8:11], v[192:195], v[124:127], a[8:11]
    v_mfma_f32_16x16x32_bf16 a[12:15], v[192:195], v[128:131], a[12:15]
    v_mfma_f32_16x16x32_bf16 a[16:19], v[192:195], v[132:135], a[16:19]
    v_mfma_f32_16x16x32_bf16 a[20:23], v[192:195], v[136:139], a[20:23]
    v_mfma_f32_16x16x32_bf16 a[24:27], v[192:195], v[140:143], a[24:27]
    v_mfma_f32_16x16x32_bf16 a[28:31], v[196:199], v[116:119], a[28:31]
    v_mfma_f32_16x16x32_bf16 a[32:35], v[196:199], v[120:123], a[32:35]
    v_mfma_f32_16x16x32_bf16 a[36:39], v[196:199], v[124:127], a[36:39]
    v_mfma_f32_16x16x32_bf16 a[40:43], v[196:199], v[128:131], a[40:43]
    v_mfma_f32_16x16x32_bf16 a[44:47], v[196:199], v[132:135], a[44:47]
    v_mfma_f32_16x16x32_bf16 a[48:51], v[196:199], v[136:139], a[48:51]
    v_mfma_f32_16x16x32_bf16 a[52:55], v[196:199], v[140:143], a[52:55]
    v_mfma_f32_16x16x32_bf16 a[56:59], v[200:203], v[116:119], a[56:59]
    v_mfma_f32_16x16x32_bf16 a[60:63], v[200:203], v[120:123], a[60:63]
    v_mfma_f32_16x16x32_bf16 a[64:67], v[200:203], v[124:127], a[64:67]
    v_mfma_f32_16x16x32_bf16 a[68:71], v[200:203], v[128:131], a[68:71]
    v_mfma_f32_16x16x32_bf16 a[72:75], v[200:203], v[132:135], a[72:75]
    v_mfma_f32_16x16x32_bf16 a[76:79], v[200:203], v[136:139], a[76:79]
    v_mfma_f32_16x16x32_bf16 a[80:83], v[200:203], v[140:143], a[80:83]
    v_mfma_f32_16x16x32_bf16 a[84:87], v[204:207], v[116:119], a[84:87]
    v_mfma_f32_16x16x32_bf16 a[88:91], v[204:207], v[120:123], a[88:91]
    v_mfma_f32_16x16x32_bf16 a[92:95], v[204:207], v[124:127], a[92:95]
    v_mfma_f32_16x16x32_bf16 a[96:99], v[204:207], v[128:131], a[96:99]
    v_mfma_f32_16x16x32_bf16 a[100:103], v[204:207], v[132:135], a[100:103]
    v_mfma_f32_16x16x32_bf16 a[104:107], v[204:207], v[136:139], a[104:107]
    v_mfma_f32_16x16x32_bf16 a[108:111], v[204:207], v[140:143], a[108:111]
    s_waitcnt vmcnt(0)
    s_barrier
    ds_read_b128 v[144:147], v20 offset:0
    ds_read_b128 v[148:151], v20 offset:4096
    ds_read_b128 v[152:155], v20 offset:8192
    ds_read_b128 v[156:159], v20 offset:12288
    ds_read_b128 v[160:163], v21 offset:0
    ds_read_b128 v[164:167], v21 offset:4096
    ds_read_b128 v[168:171], v21 offset:8192
    ds_read_b128 v[172:175], v21 offset:12288
    ds_read_b128 v[176:179], v22 offset:0
    ds_read_b128 v[180:183], v22 offset:4096
    ds_read_b128 v[184:187], v22 offset:8192
    ds_read_b128 v[188:191], v22 offset:12288
    s_waitcnt lgkmcnt(4)
    ds_read_b128 v[192:195], v23 offset:0
    ds_read_b128 v[196:199], v23 offset:4096
    ds_read_b128 v[200:203], v23 offset:8192
    ds_read_b128 v[204:207], v23 offset:12288
    s_waitcnt lgkmcnt(0)
    ds_read_b64_tr_b16 v[32:33], v24 offset:28672
    ds_read_b64_tr_b16 v[34:35], v24 offset:29568
    ds_read_b64_tr_b16 v[36:37], v24 offset:28704
    ds_read_b64_tr_b16 v[38:39], v24 offset:29600
    ds_read_b64_tr_b16 v[40:41], v24 offset:28736
    ds_read_b64_tr_b16 v[42:43], v24 offset:29632
    ds_read_b64_tr_b16 v[44:45], v24 offset:28768
    ds_read_b64_tr_b16 v[46:47], v24 offset:29664
    ds_read_b64_tr_b16 v[48:49], v24 offset:28800
    ds_read_b64_tr_b16 v[50:51], v24 offset:29696
    ds_read_b64_tr_b16 v[52:53], v24 offset:28832
    ds_read_b64_tr_b16 v[54:55], v24 offset:29728
    ds_read_b64_tr_b16 v[56:57], v24 offset:28864
    ds_read_b64_tr_b16 v[58:59], v24 offset:29760
    s_waitcnt lgkmcnt(0)
    ds_read_b64_tr_b16 v[60:61], v24 offset:35840
    ds_read_b64_tr_b16 v[62:63], v24 offset:36736
    ds_read_b64_tr_b16 v[64:65], v24 offset:35872
    ds_read_b64_tr_b16 v[66:67], v24 offset:36768
    ds_read_b64_tr_b16 v[68:69], v24 offset:35904
    ds_read_b64_tr_b16 v[70:71], v24 offset:36800
    ds_read_b64_tr_b16 v[72:73], v24 offset:35936
    ds_read_b64_tr_b16 v[74:75], v24 offset:36832
    ds_read_b64_tr_b16 v[76:77], v24 offset:35968
    ds_read_b64_tr_b16 v[78:79], v24 offset:36864
    ds_read_b64_tr_b16 v[80:81], v24 offset:36000
    ds_read_b64_tr_b16 v[82:83], v24 offset:36896
    ds_read_b64_tr_b16 v[84:85], v24 offset:36032
    ds_read_b64_tr_b16 v[86:87], v24 offset:36928
    v_mfma_f32_16x16x32_bf16 a[0:3], v[144:147], v[32:35], a[0:3]
    v_mfma_f32_16x16x32_bf16 a[4:7], v[144:147], v[36:39], a[4:7]
    v_mfma_f32_16x16x32_bf16 a[8:11], v[144:147], v[40:43], a[8:11]
    v_mfma_f32_16x16x32_bf16 a[12:15], v[144:147], v[44:47], a[12:15]
    v_mfma_f32_16x16x32_bf16 a[16:19], v[144:147], v[48:51], a[16:19]
    v_mfma_f32_16x16x32_bf16 a[20:23], v[144:147], v[52:55], a[20:23]
    v_mfma_f32_16x16x32_bf16 a[24:27], v[144:147], v[56:59], a[24:27]
    v_mfma_f32_16x16x32_bf16 a[28:31], v[148:151], v[32:35], a[28:31]
    v_mfma_f32_16x16x32_bf16 a[32:35], v[148:151], v[36:39], a[32:35]
    v_mfma_f32_16x16x32_bf16 a[36:39], v[148:151], v[40:43], a[36:39]
    v_mfma_f32_16x16x32_bf16 a[40:43], v[148:151], v[44:47], a[40:43]
    v_mfma_f32_16x16x32_bf16 a[44:47], v[148:151], v[48:51], a[44:47]
    v_mfma_f32_16x16x32_bf16 a[48:51], v[148:151], v[52:55], a[48:51]
    v_mfma_f32_16x16x32_bf16 a[52:55], v[148:151], v[56:59], a[52:55]
    v_mfma_f32_16x16x32_bf16 a[56:59], v[152:155], v[32:35], a[56:59]
    v_mfma_f32_16x16x32_bf16 a[60:63], v[152:155], v[36:39], a[60:63]
    v_mfma_f32_16x16x32_bf16 a[64:67], v[152:155], v[40:43], a[64:67]
    v_mfma_f32_16x16x32_bf16 a[68:71], v[152:155], v[44:47], a[68:71]
    v_mfma_f32_16x16x32_bf16 a[72:75], v[152:155], v[48:51], a[72:75]
    v_mfma_f32_16x16x32_bf16 a[76:79], v[152:155], v[52:55], a[76:79]
    v_mfma_f32_16x16x32_bf16 a[80:83], v[152:155], v[56:59], a[80:83]
    v_mfma_f32_16x16x32_bf16 a[84:87], v[156:159], v[32:35], a[84:87]
    v_mfma_f32_16x16x32_bf16 a[88:91], v[156:159], v[36:39], a[88:91]
    v_mfma_f32_16x16x32_bf16 a[92:95], v[156:159], v[40:43], a[92:95]
    v_mfma_f32_16x16x32_bf16 a[96:99], v[156:159], v[44:47], a[96:99]
    v_mfma_f32_16x16x32_bf16 a[100:103], v[156:159], v[48:51], a[100:103]
    v_mfma_f32_16x16x32_bf16 a[104:107], v[156:159], v[52:55], a[104:107]
    v_mfma_f32_16x16x32_bf16 a[108:111], v[156:159], v[56:59], a[108:111]
    s_waitcnt lgkmcnt(0)
    ds_read_b64_tr_b16 v[88:89], v24 offset:43008
    ds_read_b64_tr_b16 v[90:91], v24 offset:43904
    ds_read_b64_tr_b16 v[92:93], v24 offset:43040
    ds_read_b64_tr_b16 v[94:95], v24 offset:43936
    ds_read_b64_tr_b16 v[96:97], v24 offset:43072
    ds_read_b64_tr_b16 v[98:99], v24 offset:43968
    ds_read_b64_tr_b16 v[100:101], v24 offset:43104
    ds_read_b64_tr_b16 v[102:103], v24 offset:44000
    ds_read_b64_tr_b16 v[104:105], v24 offset:43136
    ds_read_b64_tr_b16 v[106:107], v24 offset:44032
    ds_read_b64_tr_b16 v[108:109], v24 offset:43168
    ds_read_b64_tr_b16 v[110:111], v24 offset:44064
    ds_read_b64_tr_b16 v[112:113], v24 offset:43200
    ds_read_b64_tr_b16 v[114:115], v24 offset:44096
    v_mfma_f32_16x16x32_bf16 a[0:3], v[160:163], v[60:63], a[0:3]
    v_mfma_f32_16x16x32_bf16 a[4:7], v[160:163], v[64:67], a[4:7]
    v_mfma_f32_16x16x32_bf16 a[8:11], v[160:163], v[68:71], a[8:11]
    v_mfma_f32_16x16x32_bf16 a[12:15], v[160:163], v[72:75], a[12:15]
    v_mfma_f32_16x16x32_bf16 a[16:19], v[160:163], v[76:79], a[16:19]
    v_mfma_f32_16x16x32_bf16 a[20:23], v[160:163], v[80:83], a[20:23]
    v_mfma_f32_16x16x32_bf16 a[24:27], v[160:163], v[84:87], a[24:27]
    v_mfma_f32_16x16x32_bf16 a[28:31], v[164:167], v[60:63], a[28:31]
    v_mfma_f32_16x16x32_bf16 a[32:35], v[164:167], v[64:67], a[32:35]
    v_mfma_f32_16x16x32_bf16 a[36:39], v[164:167], v[68:71], a[36:39]
    v_mfma_f32_16x16x32_bf16 a[40:43], v[164:167], v[72:75], a[40:43]
    v_mfma_f32_16x16x32_bf16 a[44:47], v[164:167], v[76:79], a[44:47]
    v_mfma_f32_16x16x32_bf16 a[48:51], v[164:167], v[80:83], a[48:51]
    v_mfma_f32_16x16x32_bf16 a[52:55], v[164:167], v[84:87], a[52:55]
    v_mfma_f32_16x16x32_bf16 a[56:59], v[168:171], v[60:63], a[56:59]
    v_mfma_f32_16x16x32_bf16 a[60:63], v[168:171], v[64:67], a[60:63]
    v_mfma_f32_16x16x32_bf16 a[64:67], v[168:171], v[68:71], a[64:67]
    v_mfma_f32_16x16x32_bf16 a[68:71], v[168:171], v[72:75], a[68:71]
    v_mfma_f32_16x16x32_bf16 a[72:75], v[168:171], v[76:79], a[72:75]
    v_mfma_f32_16x16x32_bf16 a[76:79], v[168:171], v[80:83], a[76:79]
    v_mfma_f32_16x16x32_bf16 a[80:83], v[168:171], v[84:87], a[80:83]
    v_mfma_f32_16x16x32_bf16 a[84:87], v[172:175], v[60:63], a[84:87]
    v_mfma_f32_16x16x32_bf16 a[88:91], v[172:175], v[64:67], a[88:91]
    v_mfma_f32_16x16x32_bf16 a[92:95], v[172:175], v[68:71], a[92:95]
    v_mfma_f32_16x16x32_bf16 a[96:99], v[172:175], v[72:75], a[96:99]
    v_mfma_f32_16x16x32_bf16 a[100:103], v[172:175], v[76:79], a[100:103]
    v_mfma_f32_16x16x32_bf16 a[104:107], v[172:175], v[80:83], a[104:107]
    v_mfma_f32_16x16x32_bf16 a[108:111], v[172:175], v[84:87], a[108:111]
    s_waitcnt lgkmcnt(0)
    ds_read_b64_tr_b16 v[116:117], v24 offset:50176
    ds_read_b64_tr_b16 v[118:119], v24 offset:51072
    ds_read_b64_tr_b16 v[120:121], v24 offset:50208
    ds_read_b64_tr_b16 v[122:123], v24 offset:51104
    ds_read_b64_tr_b16 v[124:125], v24 offset:50240
    ds_read_b64_tr_b16 v[126:127], v24 offset:51136
    ds_read_b64_tr_b16 v[128:129], v24 offset:50272
    ds_read_b64_tr_b16 v[130:131], v24 offset:51168
    ds_read_b64_tr_b16 v[132:133], v24 offset:50304
    ds_read_b64_tr_b16 v[134:135], v24 offset:51200
    ds_read_b64_tr_b16 v[136:137], v24 offset:50336
    ds_read_b64_tr_b16 v[138:139], v24 offset:51232
    ds_read_b64_tr_b16 v[140:141], v24 offset:50368
    ds_read_b64_tr_b16 v[142:143], v24 offset:51264
    v_mfma_f32_16x16x32_bf16 a[0:3], v[176:179], v[88:91], a[0:3]
    v_mfma_f32_16x16x32_bf16 a[4:7], v[176:179], v[92:95], a[4:7]
    v_mfma_f32_16x16x32_bf16 a[8:11], v[176:179], v[96:99], a[8:11]
    v_mfma_f32_16x16x32_bf16 a[12:15], v[176:179], v[100:103], a[12:15]
    v_mfma_f32_16x16x32_bf16 a[16:19], v[176:179], v[104:107], a[16:19]
    v_mfma_f32_16x16x32_bf16 a[20:23], v[176:179], v[108:111], a[20:23]
    v_mfma_f32_16x16x32_bf16 a[24:27], v[176:179], v[112:115], a[24:27]
    v_mfma_f32_16x16x32_bf16 a[28:31], v[180:183], v[88:91], a[28:31]
    v_mfma_f32_16x16x32_bf16 a[32:35], v[180:183], v[92:95], a[32:35]
    v_mfma_f32_16x16x32_bf16 a[36:39], v[180:183], v[96:99], a[36:39]
    v_mfma_f32_16x16x32_bf16 a[40:43], v[180:183], v[100:103], a[40:43]
    v_mfma_f32_16x16x32_bf16 a[44:47], v[180:183], v[104:107], a[44:47]
    v_mfma_f32_16x16x32_bf16 a[48:51], v[180:183], v[108:111], a[48:51]
    v_mfma_f32_16x16x32_bf16 a[52:55], v[180:183], v[112:115], a[52:55]
    v_mfma_f32_16x16x32_bf16 a[56:59], v[184:187], v[88:91], a[56:59]
    v_mfma_f32_16x16x32_bf16 a[60:63], v[184:187], v[92:95], a[60:63]
    v_mfma_f32_16x16x32_bf16 a[64:67], v[184:187], v[96:99], a[64:67]
    v_mfma_f32_16x16x32_bf16 a[68:71], v[184:187], v[100:103], a[68:71]
    v_mfma_f32_16x16x32_bf16 a[72:75], v[184:187], v[104:107], a[72:75]
    v_mfma_f32_16x16x32_bf16 a[76:79], v[184:187], v[108:111], a[76:79]
    v_mfma_f32_16x16x32_bf16 a[80:83], v[184:187], v[112:115], a[80:83]
    v_mfma_f32_16x16x32_bf16 a[84:87], v[188:191], v[88:91], a[84:87]
    v_mfma_f32_16x16x32_bf16 a[88:91], v[188:191], v[92:95], a[88:91]
    v_mfma_f32_16x16x32_bf16 a[92:95], v[188:191], v[96:99], a[92:95]
    v_mfma_f32_16x16x32_bf16 a[96:99], v[188:191], v[100:103], a[96:99]
    v_mfma_f32_16x16x32_bf16 a[100:103], v[188:191], v[104:107], a[100:103]
    v_mfma_f32_16x16x32_bf16 a[104:107], v[188:191], v[108:111], a[104:107]
    v_mfma_f32_16x16x32_bf16 a[108:111], v[188:191], v[112:115], a[108:111]
    s_waitcnt lgkmcnt(0)
    v_mfma_f32_16x16x32_bf16 a[0:3], v[192:195], v[116:119], a[0:3]
    v_mfma_f32_16x16x32_bf16 a[4:7], v[192:195], v[120:123], a[4:7]
    v_mfma_f32_16x16x32_bf16 a[8:11], v[192:195], v[124:127], a[8:11]
    v_mfma_f32_16x16x32_bf16 a[12:15], v[192:195], v[128:131], a[12:15]
    v_mfma_f32_16x16x32_bf16 a[16:19], v[192:195], v[132:135], a[16:19]
    v_mfma_f32_16x16x32_bf16 a[20:23], v[192:195], v[136:139], a[20:23]
    v_mfma_f32_16x16x32_bf16 a[24:27], v[192:195], v[140:143], a[24:27]
    v_mfma_f32_16x16x32_bf16 a[28:31], v[196:199], v[116:119], a[28:31]
    v_mfma_f32_16x16x32_bf16 a[32:35], v[196:199], v[120:123], a[32:35]
    v_mfma_f32_16x16x32_bf16 a[36:39], v[196:199], v[124:127], a[36:39]
    v_mfma_f32_16x16x32_bf16 a[40:43], v[196:199], v[128:131], a[40:43]
    v_mfma_f32_16x16x32_bf16 a[44:47], v[196:199], v[132:135], a[44:47]
    v_mfma_f32_16x16x32_bf16 a[48:51], v[196:199], v[136:139], a[48:51]
    v_mfma_f32_16x16x32_bf16 a[52:55], v[196:199], v[140:143], a[52:55]
    v_mfma_f32_16x16x32_bf16 a[56:59], v[200:203], v[116:119], a[56:59]
    v_mfma_f32_16x16x32_bf16 a[60:63], v[200:203], v[120:123], a[60:63]
    v_mfma_f32_16x16x32_bf16 a[64:67], v[200:203], v[124:127], a[64:67]
    v_mfma_f32_16x16x32_bf16 a[68:71], v[200:203], v[128:131], a[68:71]
    v_mfma_f32_16x16x32_bf16 a[72:75], v[200:203], v[132:135], a[72:75]
    v_mfma_f32_16x16x32_bf16 a[76:79], v[200:203], v[136:139], a[76:79]
    v_mfma_f32_16x16x32_bf16 a[80:83], v[200:203], v[140:143], a[80:83]
    v_mfma_f32_16x16x32_bf16 a[84:87], v[204:207], v[116:119], a[84:87]
    v_mfma_f32_16x16x32_bf16 a[88:91], v[204:207], v[120:123], a[88:91]
    v_mfma_f32_16x16x32_bf16 a[92:95], v[204:207], v[124:127], a[92:95]
    v_mfma_f32_16x16x32_bf16 a[96:99], v[204:207], v[128:131], a[96:99]
    v_mfma_f32_16x16x32_bf16 a[100:103], v[204:207], v[132:135], a[100:103]
    v_mfma_f32_16x16x32_bf16 a[104:107], v[204:207], v[136:139], a[104:107]
    v_mfma_f32_16x16x32_bf16 a[108:111], v[204:207], v[140:143], a[108:111]
Lgu_j_7:
    s_mul_i32 s30, s25, 28
    s_mul_i32 s31, s35, 7
    s_add_u32 s30, s30, s31
    s_mul_i32 s30, s30, 14
    s_add_u32 s30, s30, s26
    s_lshl_b32 s30, s30, 10
    s_add_u32 s30, s30, 0x400000
    s_add_u32 s32, s4, s30
    s_addc_u32 s33, s5, 0
    s_nop 7
    v_lshlrev_b32 v4, 4, v1
    v_accvgpr_read_b32 v48, a56
    v_accvgpr_read_b32 v49, a57
    v_accvgpr_read_b32 v50, a58
    v_accvgpr_read_b32 v51, a59
    v_accvgpr_read_b32 v52, a84
    v_accvgpr_read_b32 v53, a85
    v_accvgpr_read_b32 v54, a86
    v_accvgpr_read_b32 v55, a87
    v_cvt_pk_bf16_f32 v44, v48, v49
    v_cvt_pk_bf16_f32 v45, v50, v51
    v_cvt_pk_bf16_f32 v46, v52, v53
    v_cvt_pk_bf16_f32 v47, v54, v55
    global_store_dwordx4 v4, v[44:47], s[32:33] offset:1024 sc1
    v_add_u32 v4, 14336, v4
    v_accvgpr_read_b32 v72, a60
    v_accvgpr_read_b32 v73, a61
    v_accvgpr_read_b32 v74, a62
    v_accvgpr_read_b32 v75, a63
    v_accvgpr_read_b32 v76, a88
    v_accvgpr_read_b32 v77, a89
    v_accvgpr_read_b32 v78, a90
    v_accvgpr_read_b32 v79, a91
    v_cvt_pk_bf16_f32 v68, v72, v73
    v_cvt_pk_bf16_f32 v69, v74, v75
    v_cvt_pk_bf16_f32 v70, v76, v77
    v_cvt_pk_bf16_f32 v71, v78, v79
    global_store_dwordx4 v4, v[68:71], s[32:33] offset:1024 sc1
    v_add_u32 v4, 14336, v4
    v_accvgpr_read_b32 v96, a64
    v_accvgpr_read_b32 v97, a65
    v_accvgpr_read_b32 v98, a66
    v_accvgpr_read_b32 v99, a67
    v_accvgpr_read_b32 v100, a92
    v_accvgpr_read_b32 v101, a93
    v_accvgpr_read_b32 v102, a94
    v_accvgpr_read_b32 v103, a95
    v_cvt_pk_bf16_f32 v92, v96, v97
    v_cvt_pk_bf16_f32 v93, v98, v99
    v_cvt_pk_bf16_f32 v94, v100, v101
    v_cvt_pk_bf16_f32 v95, v102, v103
    global_store_dwordx4 v4, v[92:95], s[32:33] offset:1024 sc1
    v_add_u32 v4, 14336, v4
    v_accvgpr_read_b32 v120, a68
    v_accvgpr_read_b32 v121, a69
    v_accvgpr_read_b32 v122, a70
    v_accvgpr_read_b32 v123, a71
    v_accvgpr_read_b32 v124, a96
    v_accvgpr_read_b32 v125, a97
    v_accvgpr_read_b32 v126, a98
    v_accvgpr_read_b32 v127, a99
    v_cvt_pk_bf16_f32 v116, v120, v121
    v_cvt_pk_bf16_f32 v117, v122, v123
    v_cvt_pk_bf16_f32 v118, v124, v125
    v_cvt_pk_bf16_f32 v119, v126, v127
    global_store_dwordx4 v4, v[116:119], s[32:33] offset:1024 sc1
    v_add_u32 v4, 14336, v4
    v_accvgpr_read_b32 v144, a72
    v_accvgpr_read_b32 v145, a73
    v_accvgpr_read_b32 v146, a74
    v_accvgpr_read_b32 v147, a75
    v_accvgpr_read_b32 v148, a100
    v_accvgpr_read_b32 v149, a101
    v_accvgpr_read_b32 v150, a102
    v_accvgpr_read_b32 v151, a103
    v_cvt_pk_bf16_f32 v140, v144, v145
    v_cvt_pk_bf16_f32 v141, v146, v147
    v_cvt_pk_bf16_f32 v142, v148, v149
    v_cvt_pk_bf16_f32 v143, v150, v151
    global_store_dwordx4 v4, v[140:143], s[32:33] offset:1024 sc1
    v_add_u32 v4, 14336, v4
    v_accvgpr_read_b32 v168, a76
    v_accvgpr_read_b32 v169, a77
    v_accvgpr_read_b32 v170, a78
    v_accvgpr_read_b32 v171, a79
    v_accvgpr_read_b32 v172, a104
    v_accvgpr_read_b32 v173, a105
    v_accvgpr_read_b32 v174, a106
    v_accvgpr_read_b32 v175, a107
    v_cvt_pk_bf16_f32 v164, v168, v169
    v_cvt_pk_bf16_f32 v165, v170, v171
    v_cvt_pk_bf16_f32 v166, v172, v173
    v_cvt_pk_bf16_f32 v167, v174, v175
    global_store_dwordx4 v4, v[164:167], s[32:33] offset:1024 sc1
    v_add_u32 v4, 14336, v4
    v_accvgpr_read_b32 v192, a80
    v_accvgpr_read_b32 v193, a81
    v_accvgpr_read_b32 v194, a82
    v_accvgpr_read_b32 v195, a83
    v_accvgpr_read_b32 v196, a108
    v_accvgpr_read_b32 v197, a109
    v_accvgpr_read_b32 v198, a110
    v_accvgpr_read_b32 v199, a111
    v_cvt_pk_bf16_f32 v188, v192, v193
    v_cvt_pk_bf16_f32 v189, v194, v195
    v_cvt_pk_bf16_f32 v190, v196, v197
    v_cvt_pk_bf16_f32 v191, v198, v199
    global_store_dwordx4 v4, v[188:191], s[32:33] offset:1024 sc1
    s_cmp_eq_u32 s23, 3
    s_cbranch_scc1 Lgu_sk_12
    v_lshlrev_b32 v4, 4, v1
    v_accvgpr_read_b32 v36, a0
    v_accvgpr_read_b32 v37, a1
    v_accvgpr_read_b32 v38, a2
    v_accvgpr_read_b32 v39, a3
    v_accvgpr_read_b32 v40, a28
    v_accvgpr_read_b32 v41, a29
    v_accvgpr_read_b32 v42, a30
    v_accvgpr_read_b32 v43, a31
    v_cvt_pk_bf16_f32 v32, v36, v37
    v_cvt_pk_bf16_f32 v33, v38, v39
    v_cvt_pk_bf16_f32 v34, v40, v41
    v_cvt_pk_bf16_f32 v35, v42, v43
    global_store_dwordx4 v4, v[32:35], s[32:33] offset:0 sc1
    v_add_u32 v4, 14336, v4
    v_accvgpr_read_b32 v60, a4
    v_accvgpr_read_b32 v61, a5
    v_accvgpr_read_b32 v62, a6
    v_accvgpr_read_b32 v63, a7
    v_accvgpr_read_b32 v64, a32
    v_accvgpr_read_b32 v65, a33
    v_accvgpr_read_b32 v66, a34
    v_accvgpr_read_b32 v67, a35
    v_cvt_pk_bf16_f32 v56, v60, v61
    v_cvt_pk_bf16_f32 v57, v62, v63
    v_cvt_pk_bf16_f32 v58, v64, v65
    v_cvt_pk_bf16_f32 v59, v66, v67
    global_store_dwordx4 v4, v[56:59], s[32:33] offset:0 sc1
    v_add_u32 v4, 14336, v4
    v_accvgpr_read_b32 v84, a8
    v_accvgpr_read_b32 v85, a9
    v_accvgpr_read_b32 v86, a10
    v_accvgpr_read_b32 v87, a11
    v_accvgpr_read_b32 v88, a36
    v_accvgpr_read_b32 v89, a37
    v_accvgpr_read_b32 v90, a38
    v_accvgpr_read_b32 v91, a39
    v_cvt_pk_bf16_f32 v80, v84, v85
    v_cvt_pk_bf16_f32 v81, v86, v87
    v_cvt_pk_bf16_f32 v82, v88, v89
    v_cvt_pk_bf16_f32 v83, v90, v91
    global_store_dwordx4 v4, v[80:83], s[32:33] offset:0 sc1
    v_add_u32 v4, 14336, v4
    v_accvgpr_read_b32 v108, a12
    v_accvgpr_read_b32 v109, a13
    v_accvgpr_read_b32 v110, a14
    v_accvgpr_read_b32 v111, a15
    v_accvgpr_read_b32 v112, a40
    v_accvgpr_read_b32 v113, a41
    v_accvgpr_read_b32 v114, a42
    v_accvgpr_read_b32 v115, a43
    v_cvt_pk_bf16_f32 v104, v108, v109
    v_cvt_pk_bf16_f32 v105, v110, v111
    v_cvt_pk_bf16_f32 v106, v112, v113
    v_cvt_pk_bf16_f32 v107, v114, v115
    global_store_dwordx4 v4, v[104:107], s[32:33] offset:0 sc1
    v_add_u32 v4, 14336, v4
    v_accvgpr_read_b32 v132, a16
    v_accvgpr_read_b32 v133, a17
    v_accvgpr_read_b32 v134, a18
    v_accvgpr_read_b32 v135, a19
    v_accvgpr_read_b32 v136, a44
    v_accvgpr_read_b32 v137, a45
    v_accvgpr_read_b32 v138, a46
    v_accvgpr_read_b32 v139, a47
    v_cvt_pk_bf16_f32 v128, v132, v133
    v_cvt_pk_bf16_f32 v129, v134, v135
    v_cvt_pk_bf16_f32 v130, v136, v137
    v_cvt_pk_bf16_f32 v131, v138, v139
    global_store_dwordx4 v4, v[128:131], s[32:33] offset:0 sc1
    v_add_u32 v4, 14336, v4
    v_accvgpr_read_b32 v156, a20
    v_accvgpr_read_b32 v157, a21
    v_accvgpr_read_b32 v158, a22
    v_accvgpr_read_b32 v159, a23
    v_accvgpr_read_b32 v160, a48
    v_accvgpr_read_b32 v161, a49
    v_accvgpr_read_b32 v162, a50
    v_accvgpr_read_b32 v163, a51
    v_cvt_pk_bf16_f32 v152, v156, v157
    v_cvt_pk_bf16_f32 v153, v158, v159
    v_cvt_pk_bf16_f32 v154, v160, v161
    v_cvt_pk_bf16_f32 v155, v162, v163
    global_store_dwordx4 v4, v[152:155], s[32:33] offset:0 sc1
    v_add_u32 v4, 14336, v4
    v_accvgpr_read_b32 v180, a24
    v_accvgpr_read_b32 v181, a25
    v_accvgpr_read_b32 v182, a26
    v_accvgpr_read_b32 v183, a27
    v_accvgpr_read_b32 v184, a52
    v_accvgpr_read_b32 v185, a53
    v_accvgpr_read_b32 v186, a54
    v_accvgpr_read_b32 v187, a55
    v_cvt_pk_bf16_f32 v176, v180, v181
    v_cvt_pk_bf16_f32 v177, v182, v183
    v_cvt_pk_bf16_f32 v178, v184, v185
    v_cvt_pk_bf16_f32 v179, v186, v187
    global_store_dwordx4 v4, v[176:179], s[32:33] offset:0 sc1
Lgu_sk_12:
    s_mov_b32 s21, s25
    s_branch Lgo_13
Lexit0_2:
    s_endpgm
Lgo_13:
    s_waitcnt vmcnt(0)
    s_barrier
    s_cmp_lg_u32 s23, 0
    s_cbranch_scc1 Lwrole_14
    s_mov_b64 exec, 1
    v_readfirstlane_b32 s71, v250
    v_mov_b32 v1, 0
    s_mov_b32 s78, 1048576
Lbar_15:
    global_load_dword v4, v1, s[6:7] offset:128 sc1
    global_load_dwordx4 v[12:15], v1, s[6:7] sc1
    global_load_dwordx4 v[16:19], v1, s[6:7] offset:16 sc1
    s_sub_u32 s78, s78, 1
    s_cmp_eq_u32 s78, 0
    s_cbranch_scc1 Lexit0_2
    s_waitcnt vmcnt(0)
    v_add3_u32 v5, v12, v13, v14
    v_add3_u32 v6, v15, v16, v17
    v_add3_u32 v5, v5, v18, v19
    v_min_u32 v7, 1, v4
    v_add3_u32 v7, v7, v5, v6
    v_cmp_eq_u32 vcc, 257, v7
    s_cbranch_vccnz Lbarok_16
    s_sleep 8
    s_branch Lbar_15
Lbarok_16:
    s_lshl_b32 s25, s21, 7
    s_add_u32 s25, s25, 0x7906000
    s_add_u32 s76, s4, s25
    s_addc_u32 s77, s5, 0
    global_atomic_add v1, v252, s[76:77]
    s_lshr_b32 s25, s2, 5
    s_lshl_b32 s25, s25, 7
    s_add_u32 s25, s25, 0x7907000
    s_add_u32 s76, s4, s25
    s_addc_u32 s77, s5, 0
    global_atomic_add v1, v252, s[76:77]
    v_readfirstlane_b32 s80, v12
    v_readfirstlane_b32 s81, v13
    v_readfirstlane_b32 s82, v14
    v_readfirstlane_b32 s83, v15
    v_readfirstlane_b32 s84, v16
    v_readfirstlane_b32 s85, v17
    v_readfirstlane_b32 s86, v18
    v_readfirstlane_b32 s87, v19
    v_readfirstlane_b32 s79, v4
    s_nop 3
    s_mov_b32 s88, 8
    s_cmp_ge_u32 s87, 32
    s_cselect_b32 s88, 7, s88
    s_cmp_ge_u32 s86, 32
    s_cselect_b32 s88, 6, s88
    s_cmp_ge_u32 s85, 32
    s_cselect_b32 s88, 5, s88
    s_cmp_ge_u32 s84, 32
    s_cselect_b32 s88, 4, s88
    s_cmp_ge_u32 s83, 32
    s_cselect_b32 s88, 3, s88
    s_cmp_ge_u32 s82, 32
    s_cselect_b32 s88, 2, s88
    s_cmp_ge_u32 s81, 32
    s_cselect_b32 s88, 1, s88
    s_cmp_ge_u32 s80, 32
    s_cselect_b32 s88, 0, s88
    s_cmp_lg_u32 s79, 1
    s_cbranch_scc1 Lpf_17
    s_cmp_ge_u32 s80, 32
    s_cselect_b32 s88, 0, s88
Lpf_17:
    s_cmp_lg_u32 s79, 2
    s_cbranch_scc1 Lpf_18
    s_cmp_ge_u32 s81, 32
    s_cselect_b32 s88, 1, s88
Lpf_18:
    s_cmp_lg_u32 s79, 3
    s_cbranch_scc1 Lpf_19
    s_cmp_ge_u32 s82, 32
    s_cselect_b32 s88, 2, s88
Lpf_19:
    s_cmp_lg_u32 s79, 4
    s_cbranch_scc1 Lpf_20
    s_cmp_ge_u32 s83, 32
    s_cselect_b32 s88, 3, s88
Lpf_20:
    s_cmp_lg_u32 s79, 5
    s_cbranch_scc1 Lpf_21
    s_cmp_ge_u32 s84, 32
    s_cselect_b32 s88, 4, s88
Lpf_21:
    s_cmp_lg_u32 s79, 6
    s_cbranch_scc1 Lpf_22
    s_cmp_ge_u32 s85, 32
    s_cselect_b32 s88, 5, s88
Lpf_22:
    s_cmp_lg_u32 s79, 7
    s_cbranch_scc1 Lpf_23
    s_cmp_ge_u32 s86, 32
    s_cselect_b32 s88, 6, s88
Lpf_23:
    s_cmp_lg_u32 s79, 8
    s_cbranch_scc1 Lpf_24
    s_cmp_ge_u32 s87, 32
    s_cselect_b32 s88, 7, s88
Lpf_24:
    s_mov_b32 s89, 0
    s_add_u32 s25, s89, s80
    s_cmp_gt_u32 s70, 0
    s_cselect_b32 s89, s25, s89
    s_add_u32 s25, s89, s81
    s_cmp_gt_u32 s70, 1
    s_cselect_b32 s89, s25, s89
    s_add_u32 s25, s89, s82
    s_cmp_gt_u32 s70, 2
    s_cselect_b32 s89, s25, s89
    s_add_u32 s25, s89, s83
    s_cmp_gt_u32 s70, 3
    s_cselect_b32 s89, s25, s89
    s_add_u32 s25, s89, s84
    s_cmp_gt_u32 s70, 4
    s_cselect_b32 s89, s25, s89
    s_add_u32 s25, s89, s85
    s_cmp_gt_u32 s70, 5
    s_cselect_b32 s89, s25, s89
    s_add_u32 s25, s89, s86
    s_cmp_gt_u32 s70, 6
    s_cselect_b32 s89, s25, s89
    s_add_u32 s89, s89, s71
    s_cmp_eq_u32 s88, 8
    s_cbranch_scc1 Lfb_25
    s_mov_b32 s24, 0
    s_mov_b32 s22, 255
    s_cmp_eq_u32 s70, s88
    s_cselect_b32 s22, s71, s22
    s_sub_u32 s25, s89, 32
    s_cmp_ge_u32 s70, s88
    s_cselect_b32 s72, s25, s89
    s_branch Lrd_26
Lfb_25:
    s_mov_b32 s24, 1
    s_mov_b32 s22, s89
    s_sub_u32 s72, s89, 32
Lrd_26:
    s_cmp_ge_u32 s22, 32
    s_cselect_b32 s22, 255, s22
    v_mov_b32 v4, s22
    v_mov_b32 v5, s24
    v_mov_b32 v6, s72
    v_mov_b32 v7, 0
    v_mov_b32 v2, 161792
    ds_write_b128 v2, v[4:7]
    s_mov_b64 exec, -1
Lwrole_14:
    s_waitcnt lgkmcnt(0)
    s_barrier
    v_mov_b32 v2, 161792
    ds_read_b128 v[4:7], v2
    s_waitcnt lgkmcnt(0)
    v_readfirstlane_b32 s22, v4
    v_readfirstlane_b32 s24, v5
    v_readfirstlane_b32 s72, v6
    s_nop 3
    s_cmp_ge_u32 s22, 32
    s_cbranch_scc1 Lworker_27
    s_cmp_ge_u32 s22, 30
    s_cbranch_scc1 Lrole_h_30
    s_cmp_ge_u32 s22, 16
    s_cbranch_scc1 Lrole_u_29
    s_waitcnt vmcnt(0)
    s_cmp_lg_u32 s23, 0
    s_cbranch_scc1 Lwo_31
    s_lshl_b32 s25, s22, 7
    s_add_u32 s25, s25, 0x7906000
    s_add_u32 s76, s4, s25
    s_addc_u32 s77, s5, 0
    v_mbcnt_lo_u32_b32 v8, -1, 0
    v_mbcnt_hi_u32_b32 v8, -1, v8
    v_lshlrev_b32 v8, 2, v8
    s_mov_b32 s78, 1048576
    s_mov_b32 exec_lo, 0x1
    s_mov_b32 exec_hi, 0x0
Lwf_32:
    global_load_dword v9, v8, s[76:77] sc1
    s_sub_u32 s78, s78, 1
    s_cmp_eq_u32 s78, 0
    s_cbranch_scc1 Lexitc_28
    s_waitcnt vmcnt(0)
    v_cmp_ne_u32 vcc, 8, v9
    s_cbranch_vccz Lwfd_33
    s_sleep 4
    s_branch Lwf_32
Lwfd_33:
    s_mov_b64 exec, -1
Lwo_31:
    s_barrier
    v_and_b32 v119, 63, v0
    s_lshl_b32 s25, s23, 1
    s_add_u32 s25, s25, 0
    s_sub_u32 s26, s25, 7
    s_cmp_ge_u32 s25, 7
    s_cselect_b32 s25, s26, s25
    s_lshl_b32 s25, s25, 10
    v_lshl_add_u32 v100, v119, 4, s25
    s_lshl_b32 s25, s23, 1
    s_add_u32 s25, s25, 1
    s_sub_u32 s26, s25, 7
    s_cmp_ge_u32 s25, 7
    s_cselect_b32 s25, s26, s25
    s_lshl_b32 s25, s25, 10
    v_lshl_add_u32 v101, v119, 4, s25
    s_lshl_b32 s25, s23, 1
    s_add_u32 s25, s25, 2
    s_sub_u32 s26, s25, 7
    s_cmp_ge_u32 s25, 7
    s_cselect_b32 s25, s26, s25
    s_lshl_b32 s25, s25, 10
    v_lshl_add_u32 v102, v119, 4, s25
    s_lshl_b32 s25, s23, 1
    s_add_u32 s25, s25, 3
    s_sub_u32 s26, s25, 7
    s_cmp_ge_u32 s25, 7
    s_cselect_b32 s25, s26, s25
    s_lshl_b32 s25, s25, 10
    v_lshl_add_u32 v103, v119, 4, s25
    s_lshl_b32 s25, s23, 1
    s_add_u32 s25, s25, 4
    s_sub_u32 s26, s25, 7
    s_cmp_ge_u32 s25, 7
    s_cselect_b32 s25, s26, s25
    s_lshl_b32 s25, s25, 10
    v_lshl_add_u32 v104, v119, 4, s25
    s_lshl_b32 s25, s23, 1
    s_add_u32 s25, s25, 5
    s_sub_u32 s26, s25, 7
    s_cmp_ge_u32 s25, 7
    s_cselect_b32 s25, s26, s25
    s_lshl_b32 s25, s25, 10
    v_lshl_add_u32 v105, v119, 4, s25
    s_lshl_b32 s25, s23, 1
    s_add_u32 s25, s25, 6
    s_sub_u32 s26, s25, 7
    s_cmp_ge_u32 s25, 7
    s_cselect_b32 s25, s26, s25
    s_lshl_b32 s25, s25, 10
    v_lshl_add_u32 v106, v119, 4, s25
    s_mul_i32 s25, s22, 28
    s_mul_i32 s26, s23, 7
    s_add_u32 s25, s25, s26
    s_mul_i32 s25, s25, 14336
    s_add_u32 s25, s25, 0x400000
    s_add_u32 s40, s4, s25
    s_addc_u32 s41, s5, 0
    v_lshlrev_b32 v117, 4, v119
    v_lshlrev_b32 v1, 1, v100
    v_sub_u32 v1, v1, v117
    v_lshlrev_b32 v2, 1, v101
    v_sub_u32 v2, v2, v117
    v_lshlrev_b32 v3, 1, v102
    v_sub_u32 v3, v3, v117
    v_lshlrev_b32 v4, 1, v103
    v_sub_u32 v4, v4, v117
    v_lshlrev_b32 v5, 1, v104
    v_sub_u32 v5, v5, v117
    v_lshlrev_b32 v6, 1, v105
    v_sub_u32 v6, v6, v117
    v_lshlrev_b32 v7, 1, v106
    v_sub_u32 v7, v7, v117
    global_load_dwordx4 a[0:3], v1, s[40:41] sc1
    global_load_dwordx4 a[4:7], v1, s[40:41] offset:1024 sc1
    global_load_dwordx4 a[8:11], v2, s[40:41] sc1
    global_load_dwordx4 a[12:15], v2, s[40:41] offset:1024 sc1
    global_load_dwordx4 a[16:19], v3, s[40:41] sc1
    global_load_dwordx4 a[20:23], v3, s[40:41] offset:1024 sc1
    global_load_dwordx4 a[24:27], v4, s[40:41] sc1
    global_load_dwordx4 a[28:31], v4, s[40:41] offset:1024 sc1
    global_load_dwordx4 a[32:35], v5, s[40:41] sc1
    global_load_dwordx4 a[36:39], v5, s[40:41] offset:1024 sc1
    global_load_dwordx4 a[40:43], v6, s[40:41] sc1
    global_load_dwordx4 a[44:47], v6, s[40:41] offset:1024 sc1
    global_load_dwordx4 a[48:51], v7, s[40:41] sc1
    global_load_dwordx4 a[52:55], v7, s[40:41] offset:1024 sc1
    s_add_u32 s40, s40, 0x3800
    s_addc_u32 s41, s41, 0
    global_load_dwordx4 a[56:59], v1, s[40:41] sc1
    global_load_dwordx4 a[60:63], v1, s[40:41] offset:1024 sc1
    global_load_dwordx4 a[64:67], v2, s[40:41] sc1
    global_load_dwordx4 a[68:71], v2, s[40:41] offset:1024 sc1
    global_load_dwordx4 a[72:75], v3, s[40:41] sc1
    global_load_dwordx4 a[76:79], v3, s[40:41] offset:1024 sc1
    global_load_dwordx4 a[80:83], v4, s[40:41] sc1
    global_load_dwordx4 a[84:87], v4, s[40:41] offset:1024 sc1
    global_load_dwordx4 a[88:91], v5, s[40:41] sc1
    global_load_dwordx4 a[92:95], v5, s[40:41] offset:1024 sc1
    global_load_dwordx4 a[96:99], v6, s[40:41] sc1
    global_load_dwordx4 a[100:103], v6, s[40:41] offset:1024 sc1
    global_load_dwordx4 a[104:107], v7, s[40:41] sc1
    global_load_dwordx4 a[108:111], v7, s[40:41] offset:1024 sc1
    s_add_u32 s40, s40, 0x3800
    s_addc_u32 s41, s41, 0
    global_load_dwordx4 a[112:115], v1, s[40:41] sc1
    global_load_dwordx4 a[116:119], v1, s[40:41] offset:1024 sc1
    global_load_dwordx4 a[120:123], v2, s[40:41] sc1
    global_load_dwordx4 a[124:127], v2, s[40:41] offset:1024 sc1
    global_load_dwordx4 a[128:131], v3, s[40:41] sc1
    global_load_dwordx4 a[132:135], v3, s[40:41] offset:1024 sc1
    global_load_dwordx4 a[136:139], v4, s[40:41] sc1
    global_load_dwordx4 a[140:143], v4, s[40:41] offset:1024 sc1
    global_load_dwordx4 a[144:147], v5, s[40:41] sc1
    global_load_dwordx4 a[148:151], v5, s[40:41] offset:1024 sc1
    global_load_dwordx4 a[152:155], v6, s[40:41] sc1
    global_load_dwordx4 a[156:159], v6, s[40:41] offset:1024 sc1
    global_load_dwordx4 a[160:163], v7, s[40:41] sc1
    global_load_dwordx4 a[164:167], v7, s[40:41] offset:1024 sc1
    s_add_u32 s40, s40, 0x3800
    s_addc_u32 s41, s41, 0
    global_load_dwordx4 a[168:171], v1, s[40:41] sc1
    global_load_dwordx4 a[172:175], v1, s[40:41] offset:1024 sc1
    global_load_dwordx4 a[176:179], v2, s[40:41] sc1
    global_load_dwordx4 a[180:183], v2, s[40:41] offset:1024 sc1
    global_load_dwordx4 a[184:187], v3, s[40:41] sc1
    global_load_dwordx4 a[188:191], v3, s[40:41] offset:1024 sc1
    global_load_dwordx4 a[192:195], v4, s[40:41] sc1
    global_load_dwordx4 a[196:199], v4, s[40:41] offset:1024 sc1
    global_load_dwordx4 a[200:203], v5, s[40:41] sc1
    global_load_dwordx4 a[204:207], v5, s[40:41] offset:1024 sc1
    global_load_dwordx4 a[208:211], v6, s[40:41] sc1
    global_load_dwordx4 a[212:215], v6, s[40:41] offset:1024 sc1
    global_load_dwordx4 a[216:219], v7, s[40:41] sc1
    global_load_dwordx4 a[220:223], v7, s[40:41] offset:1024 sc1
    s_add_u32 s40, s40, 0x3800
    s_addc_u32 s41, s41, 0
    global_load_dwordx4 a[224:227], v1, s[40:41] sc1
    global_load_dwordx4 a[228:231], v1, s[40:41] offset:1024 sc1
    global_load_dwordx4 a[232:235], v2, s[40:41] sc1
    global_load_dwordx4 a[236:239], v2, s[40:41] offset:1024 sc1
    global_load_dwordx4 a[240:243], v3, s[40:41] sc1
    global_load_dwordx4 a[244:247], v3, s[40:41] offset:1024 sc1
    global_load_dwordx4 a[248:251], v4, s[40:41] sc1
    global_load_dwordx4 a[252:255], v4, s[40:41] offset:1024 sc1
    global_load_dwordx4 v[120:123], v5, s[40:41] sc1
    global_load_dwordx4 v[124:127], v5, s[40:41] offset:1024 sc1
    global_load_dwordx4 v[128:131], v6, s[40:41] sc1
    global_load_dwordx4 v[132:135], v6, s[40:41] offset:1024 sc1
    global_load_dwordx4 v[136:139], v7, s[40:41] sc1
    global_load_dwordx4 v[140:143], v7, s[40:41] offset:1024 sc1
    s_add_u32 s40, s40, 0x3800
    s_addc_u32 s41, s41, 0
    global_load_dwordx4 v[144:147], v1, s[40:41] sc1
    global_load_dwordx4 v[148:151], v1, s[40:41] offset:1024 sc1
    global_load_dwordx4 v[152:155], v2, s[40:41] sc1
    global_load_dwordx4 v[156:159], v2, s[40:41] offset:1024 sc1
    global_load_dwordx4 v[160:163], v3, s[40:41] sc1
    global_load_dwordx4 v[164:167], v3, s[40:41] offset:1024 sc1
    global_load_dwordx4 v[168:171], v4, s[40:41] sc1
    global_load_dwordx4 v[172:175], v4, s[40:41] offset:1024 sc1
    global_load_dwordx4 v[176:179], v5, s[40:41] sc1
    global_load_dwordx4 v[180:183], v5, s[40:41] offset:1024 sc1
    global_load_dwordx4 v[184:187], v6, s[40:41] sc1
    global_load_dwordx4 v[188:191], v6, s[40:41] offset:1024 sc1
    global_load_dwordx4 v[192:195], v7, s[40:41] sc1
    global_load_dwordx4 v[196:199], v7, s[40:41] offset:1024 sc1
    s_add_u32 s40, s40, 0x3800
    s_addc_u32 s41, s41, 0
    global_load_dwordx4 v[200:203], v1, s[40:41] sc1
    global_load_dwordx4 v[204:207], v1, s[40:41] offset:1024 sc1
    global_load_dwordx4 v[208:211], v2, s[40:41] sc1
    global_load_dwordx4 v[212:215], v2, s[40:41] offset:1024 sc1
    global_load_dwordx4 v[216:219], v3, s[40:41] sc1
    global_load_dwordx4 v[220:223], v3, s[40:41] offset:1024 sc1
    global_load_dwordx4 v[224:227], v4, s[40:41] sc1
    global_load_dwordx4 v[228:231], v4, s[40:41] offset:1024 sc1
    global_load_dwordx4 v[232:235], v5, s[40:41] sc1
    global_load_dwordx4 v[236:239], v5, s[40:41] offset:1024 sc1
    global_load_dwordx4 v[240:243], v6, s[40:41] sc1
    global_load_dwordx4 v[244:247], v6, s[40:41] offset:1024 sc1
    global_load_dwordx4 v[248:251], v7, s[40:41] sc1
    global_load_dwordx4 v[252:255], v7, s[40:41] offset:1024 sc1
    v_and_b32 v117, 8, v119
    v_mov_b32 v107, 0x4444
    v_mov_b32 v118, 0xeeee
    v_cmp_ne_u32 vcc, 0, v117
    s_nop 1
    v_cndmask_b32 v107, v107, v118, vcc
    s_mul_i32 s25, s23, 4352
    s_add_u32 s25, s25, 8192
    v_lshrrev_b32 v117, 4, v119
    v_lshl_add_u32 v108, v117, 10, s25
    v_bfe_u32 v117, v119, 4, 1
    v_lshl_add_u32 v108, v117, 5, v108
    v_bfe_u32 v117, v119, 5, 1
    v_lshl_add_u32 v108, v117, 7, v108
    v_and_b32 v117, 15, v119
    v_lshl_add_u32 v108, v117, 3, v108
    v_mov_b32 v8, 0
    v_mov_b32 v9, 0
    ds_write_b64 v108, v[8:9] offset:896
    v_lshlrev_b32 v118, 2, v0
    ds_write_b32 v118, v8 offset:7168
    v_and_b32 v117, 3, v119
    v_lshl_add_u32 v109, v117, 10, s25
    v_bfe_u32 v117, v119, 0, 1
    v_lshl_add_u32 v109, v117, 5, v109
    v_bfe_u32 v117, v119, 1, 1
    v_lshl_add_u32 v109, v117, 7, v109
    v_lshrrev_b32 v117, 4, v119
    v_lshl_add_u32 v109, v117, 6, v109
    v_bfe_u32 v117, v119, 2, 2
    v_lshl_add_u32 v109, v117, 3, v109
    s_mul_i32 s25, s23, 1792
    v_lshrrev_b32 v117, 4, v119
    v_lshl_add_u32 v110, v117, 7, s25
    v_and_b32 v117, 7, v119
    v_lshl_add_u32 v110, v117, 4, v110
    s_mul_i32 s25, s23, 3584
    v_lshl_add_u32 v111, v119, 4, s25
    s_lshl_b32 s25, s23, 11
    s_add_u32 s25, s25, 25600
    v_and_b32 v117, 7, v119
    v_mul_u32_u24 v117, 208, v117
    v_lshrrev_b32 v118, 4, v119
    v_lshl_add_u32 v112, v118, 4, s25
    v_add_u32 v112, v112, v117
    v_add_u32 v113, 128, v112
    v_bfe_u32 v117, v119, 3, 1
    v_lshl_add_u32 v112, v117, 6, v112
    s_mul_i32 s25, s23, 416
    s_add_u32 s25, s25, 25600
    v_bfe_u32 v117, v119, 4, 1
    v_mul_u32_u24 v117, 208, v117
    v_add_u32 v117, s25, v117
    v_and_b32 v118, 15, v119
    v_lshl_add_u32 v114, v118, 3, v117
    v_lshl_add_u32 v115, v118, 2, v117
    v_add_u32 v115, 128, v115
    s_lshr_b32 s25, s22, 2
    s_mul_i32 s25, s25, 3072
    s_lshl_b32 s26, s23, 5
    s_add_u32 s25, s25, s26
    s_bfe_u32 s26, s22, 0x10001
    s_and_b32 s27, s22, 1
    s_lshl_b32 s28, s26, 10
    s_lshl_b32 s29, s27, 9
    s_add_u32 s28, s28, s29
    s_add_u32 s28, s28, s25
    s_lshl_b32 s26, s26, 8
    s_lshl_b32 s27, s27, 2
    s_add_u32 s26, s26, s27
    s_add_u32 s26, s26, s25
    s_add_u32 s26, s26, 2048
    v_bfe_u32 v117, v119, 0, 1
    v_lshl_add_u32 v116, v117, 7, s28
    v_bfe_u32 v117, v119, 2, 1
    v_lshl_add_u32 v116, v117, 8, v116
    v_bfe_u32 v117, v119, 1, 1
    v_lshl_add_u32 v116, v117, 3, v116
    v_bfe_u32 v117, v119, 3, 1
    v_lshl_add_u32 v116, v117, 2, v116
    v_bfe_u32 v117, v119, 1, 1
    v_lshl_add_u32 v118, v117, 7, s26
    v_bfe_u32 v117, v119, 2, 1
    v_lshl_add_u32 v118, v117, 3, v118
    s_mov_b32 s34, 0
    s_mov_b32 s35, -1
    v_cndmask_b32 v116, v116, v118, s[34:35]
    v_bfe_u32 v117, v119, 4, 1
    v_lshl_add_u32 v116, v117, 4, v116
    s_mov_b32 s32, 0x00ff00ff
    s_mov_b32 s33, 0x00ff00ff
    s_mov_b32 s36, -1
    s_mov_b32 s37, 0x00aa00aa
    s_mov_b32 s38, 0x3db8aa3b
    s_mov_b32 s39, 0x42800000
    s_add_u32 s8, s4, 0x6000000
    s_addc_u32 s9, s5, 0
    s_add_u32 s10, s4, 0x6100000
    s_addc_u32 s11, s5, 0
    s_add_u32 s12, s4, 0x0
    s_addc_u32 s13, s5, 0
    s_add_u32 s14, s4, 0x3800
    s_addc_u32 s15, s5, 0
    s_mov_b32 s20, 0
    s_mov_b32 s21, 2097152
    s_lshl_b32 s25, s22, 2
    s_add_u32 s25, s25, s23
    s_mul_i32 s25, s25, 0
    s_mul_i32 s26, s23, 3584
    s_sub_u32 s25, s25, s26
    s_add_u32 s25, s25, 0x4000000
    s_add_u32 s42, s4, s25
    s_addc_u32 s43, s5, 0
    s_add_u32 s44, s42, 0x1000
    s_addc_u32 s45, s43, 0
    s_mov_b32 m0, 40960
    s_waitcnt vmcnt(0) lgkmcnt(0)
    s_add_u32 s76, s4, 0x7907000
    s_addc_u32 s77, s5, 0
    v_mbcnt_lo_u32_b32 v8, -1, 0
    v_mbcnt_hi_u32_b32 v8, -1, v8
    v_lshlrev_b32 v8, 7, v8
    s_mov_b32 s78, 1048576
    s_mov_b32 exec_lo, 0xff
    s_mov_b32 exec_hi, 0x0
Lwf_34:
    global_load_dword v9, v8, s[76:77] sc1
    s_sub_u32 s78, s78, 1
    s_cmp_eq_u32 s78, 0
    s_cbranch_scc1 Lexitc_28
    s_waitcnt vmcnt(0)
    v_cmp_ne_u32 vcc, 32, v9
    s_cbranch_vccz Lwfd_35
    s_sleep 4
    s_branch Lwf_34
Lwfd_35:
    s_mov_b64 exec, -1
    s_add_u32 s76, s4, 0x7900000
    s_addc_u32 s77, s5, 0
    v_mbcnt_lo_u32_b32 v8, -1, 0
    v_mbcnt_hi_u32_b32 v8, -1, v8
    v_lshlrev_b32 v8, 7, v8
    s_mov_b32 s78, 1048576
    s_mov_b32 exec_lo, 0x3
    s_mov_b32 exec_hi, 0x0
Lwf_36:
    global_load_dword v9, v8, s[76:77] sc1
    s_sub_u32 s78, s78, 1
    s_cmp_eq_u32 s78, 0
    s_cbranch_scc1 Lexitc_28
    s_waitcnt vmcnt(0)
    v_cmp_ne_u32 vcc, 112, v9
    s_cbranch_vccz Lwfd_37
    s_sleep 4
    s_branch Lwf_36
Lwfd_37:
    s_mov_b64 exec, -1
    s_add_u32 s42, s42, 0x70000
    s_addc_u32 s43, s43, 0
    s_add_u32 s44, s44, 0x70000
    s_addc_u32 s45, s45, 0
    s_add_u32 s42, s42, 0x70000
    s_addc_u32 s43, s43, 0
    s_add_u32 s44, s44, 0x70000
    s_addc_u32 s45, s45, 0
    global_load_dwordx4 v[56:59], v111, s[12:13] offset:0 sc1
    global_load_dwordx4 v[60:63], v111, s[12:13] offset:1024 sc1
    global_load_dwordx4 v[64:67], v111, s[12:13] offset:2048 sc1
    global_load_dwordx4 v[68:71], v111, s[12:13] offset:3072 sc1
    global_load_dwordx4 v[72:75], v111, s[14:15] offset:0 sc1
    global_load_dwordx4 v[76:79], v111, s[14:15] offset:1024 sc1
    global_load_dwordx4 v[80:83], v111, s[14:15] offset:2048 sc1
    global_load_dwordx4 v[84:87], v111, s[14:15] offset:3072 sc1
    v_mov_b32 v28, 0
    v_mov_b32 v29, 0
    v_mov_b32 v30, 0
    v_mov_b32 v31, 0
    v_mov_b32 v32, 0
    v_mov_b32 v33, 0
    v_mov_b32 v34, 0
    v_mov_b32 v35, 0
    v_mov_b32 v36, 0
    v_mov_b32 v37, 0
    v_mov_b32 v38, 0
    v_mov_b32 v39, 0
    v_mov_b32 v40, 0
    v_mov_b32 v41, 0
    v_mov_b32 v42, 0
    v_mov_b32 v43, 0
    v_mov_b32 v44, 0
    v_mov_b32 v45, 0
    v_mov_b32 v46, 0
    v_mov_b32 v47, 0
    v_mov_b32 v48, 0
    v_mov_b32 v49, 0
    v_mov_b32 v50, 0
    v_mov_b32 v51, 0
    v_mov_b32 v52, 0
    v_mov_b32 v53, 0
    v_mov_b32 v54, 0
    v_mov_b32 v55, 0
    s_barrier
Lgloop_38:
    global_load_dwordx4 v[0:3], v100, s[8:9] sc1
    global_load_dwordx4 v[4:7], v101, s[8:9] sc1
    s_sleep 2
    global_load_dwordx4 v[0:3], v100, s[8:9] sc1
    global_load_dwordx4 v[4:7], v101, s[8:9] sc1
    s_branch Lpoll_39
Lpollu_40:
    global_load_dwordx4 v[0:3], v100, s[8:9] sc1
    global_load_dwordx4 v[4:7], v101, s[8:9] sc1
    s_nop 3
    v_mov_b32 v28, 0
    v_mov_b32 v29, 0
    v_mov_b32 v30, 0
    v_mov_b32 v31, 0
    v_mov_b32 v32, 0
    v_mov_b32 v33, 0
    v_mov_b32 v34, 0
    v_mov_b32 v35, 0
    v_mov_b32 v36, 0
    v_mov_b32 v37, 0
    v_mov_b32 v38, 0
    v_mov_b32 v39, 0
Lpoll_39:
    s_sub_u32 s21, s21, 1
    s_cmp_eq_u32 s21, 0
    s_cbranch_scc1 Lexitc_28
    s_waitcnt vmcnt(2)
    v_max3_u32 v88, v0, v1, v2
    v_max3_u32 v89, v3, v4, v5
    v_smfmac_f32_16x16x64_bf16 v[28:31], v[0:3], a[0:7], v107
    v_max3_u32 v88, v88, v6, v7
    v_smfmac_f32_16x16x64_bf16 v[32:35], v[0:3], a[56:63], v107
    v_max_u32 v88, v88, v89
    v_smfmac_f32_16x16x64_bf16 v[36:39], v[0:3], a[112:119], v107
    v_cmp_eq_u32 vcc, -1, v88
    s_cbranch_vccnz Lpollu_40
    ds_write_b128 v100, v[0:3]
    ds_write_b128 v101, v[4:7]
    v_smfmac_f32_16x16x64_bf16 v[40:43], v[0:3], a[168:175], v107
    v_smfmac_f32_16x16x64_bf16 v[44:47], v[0:3], a[224:231], v107
    v_smfmac_f32_16x16x64_bf16 v[48:51], v[0:3], v[144:151], v107
    s_waitcnt lgkmcnt(0)
    s_barrier
    ds_read_b128 v[8:11], v102
    ds_read_b128 v[12:15], v103
    ds_read_b128 v[16:19], v104
    ds_read_b128 v[20:23], v105
    ds_read_b128 v[24:27], v106
    v_smfmac_f32_16x16x64_bf16 v[52:55], v[0:3], v[200:207], v107
    v_smfmac_f32_16x16x64_bf16 v[28:31], v[4:7], a[8:15], v107
    v_smfmac_f32_16x16x64_bf16 v[32:35], v[4:7], a[64:71], v107
    v_smfmac_f32_16x16x64_bf16 v[36:39], v[4:7], a[120:127], v107
    v_smfmac_f32_16x16x64_bf16 v[40:43], v[4:7], a[176:183], v107
    v_smfmac_f32_16x16x64_bf16 v[44:47], v[4:7], a[232:239], v107
    v_smfmac_f32_16x16x64_bf16 v[48:51], v[4:7], v[152:159], v107
    v_smfmac_f32_16x16x64_bf16 v[52:55], v[4:7], v[208:215], v107
    s_waitcnt lgkmcnt(0)
    v_smfmac_f32_16x16x64_bf16 v[28:31], v[8:11], a[16:23], v107
    v_smfmac_f32_16x16x64_bf16 v[28:31], v[12:15], a[24:31], v107
    v_smfmac_f32_16x16x64_bf16 v[28:31], v[16:19], a[32:39], v107
    v_smfmac_f32_16x16x64_bf16 v[28:31], v[20:23], a[40:47], v107
    v_smfmac_f32_16x16x64_bf16 v[28:31], v[24:27], a[48:55], v107
    v_smfmac_f32_16x16x64_bf16 v[32:35], v[8:11], a[72:79], v107
    v_smfmac_f32_16x16x64_bf16 v[32:35], v[12:15], a[80:87], v107
    v_smfmac_f32_16x16x64_bf16 v[32:35], v[16:19], a[88:95], v107
    v_cvt_pk_bf16_f32 v28, v28, v29
    v_smfmac_f32_16x16x64_bf16 v[32:35], v[20:23], a[96:103], v107
    v_cvt_pk_bf16_f32 v29, v30, v31
    v_smfmac_f32_16x16x64_bf16 v[32:35], v[24:27], a[104:111], v107
    ds_write_b64 v108, v[28:29] offset:0
    v_smfmac_f32_16x16x64_bf16 v[36:39], v[8:11], a[128:135], v107
    v_smfmac_f32_16x16x64_bf16 v[36:39], v[12:15], a[136:143], v107
    v_smfmac_f32_16x16x64_bf16 v[36:39], v[16:19], a[144:151], v107
    v_cvt_pk_bf16_f32 v32, v32, v33
    v_smfmac_f32_16x16x64_bf16 v[36:39], v[20:23], a[152:159], v107
    v_cvt_pk_bf16_f32 v33, v34, v35
    v_smfmac_f32_16x16x64_bf16 v[36:39], v[24:27], a[160:167], v107
    ds_write_b64 v108, v[32:33] offset:128
    v_smfmac_f32_16x16x64_bf16 v[40:43], v[8:11], a[184:191], v107
    ds_read_b64_tr_b16 v[28:29], v109 offset:0
    v_smfmac_f32_16x16x64_bf16 v[40:43], v[12:15], a[192:199], v107
    ds_read_b64_tr_b16 v[30:31], v109 offset:32
    ds_read_b128 v[32:35], v110 offset:0
    v_smfmac_f32_16x16x64_bf16 v[40:43], v[16:19], a[200:207], v107
    v_cvt_pk_bf16_f32 v36, v36, v37
    v_smfmac_f32_16x16x64_bf16 v[40:43], v[20:23], a[208:215], v107
    v_cvt_pk_bf16_f32 v37, v38, v39
    v_smfmac_f32_16x16x64_bf16 v[40:43], v[24:27], a[216:223], v107
    ds_write_b64 v108, v[36:37] offset:256
    v_smfmac_f32_16x16x64_bf16 v[44:47], v[8:11], a[240:247], v107
    s_waitcnt vmcnt(0)
    ds_read_b128 v[0:3], v110 offset:1536
    v_smfmac_f32_16x16x64_bf16 v[44:47], v[12:15], a[248:255], v107
    v_smfmac_f32_16x16x64_bf16 v[44:47], v[16:19], v[120:127], v107
    v_cvt_pk_bf16_f32 v40, v40, v41
    v_smfmac_f32_16x16x64_bf16 v[44:47], v[20:23], v[128:135], v107
    v_cvt_pk_bf16_f32 v41, v42, v43
    v_smfmac_f32_16x16x64_bf16 v[44:47], v[24:27], v[136:143], v107
    ds_write_b64 v108, v[40:41] offset:384
    v_smfmac_f32_16x16x64_bf16 v[48:51], v[8:11], v[160:167], v107
    ds_read_b64_tr_b16 v[36:37], v109 offset:256
    v_smfmac_f32_16x16x64_bf16 v[48:51], v[12:15], v[168:175], v107
    ds_read_b64_tr_b16 v[38:39], v109 offset:288
    ds_read_b128 v[40:43], v110 offset:512
    v_smfmac_f32_16x16x64_bf16 v[48:51], v[16:19], v[176:183], v107
    v_cvt_pk_bf16_f32 v44, v44, v45
    v_smfmac_f32_16x16x64_bf16 v[48:51], v[20:23], v[184:191], v107
    v_cvt_pk_bf16_f32 v45, v46, v47
    v_smfmac_f32_16x16x64_bf16 v[48:51], v[24:27], v[192:199], v107
    ds_write_b64 v108, v[44:45] offset:512
    v_smfmac_f32_16x16x64_bf16 v[52:55], v[8:11], v[216:223], v107
    v_smfmac_f32_16x16x64_bf16 v[52:55], v[12:15], v[224:231], v107
    v_smfmac_f32_16x16x64_bf16 v[52:55], v[16:19], v[232:239], v107
    v_cvt_pk_bf16_f32 v48, v48, v49
    v_smfmac_f32_16x16x64_bf16 v[52:55], v[20:23], v[240:247], v107
    v_cvt_pk_bf16_f32 v49, v50, v51
    v_smfmac_f32_16x16x64_bf16 v[52:55], v[24:27], v[248:255], v107
    ds_write_b64 v108, v[48:49] offset:640
    ds_read_b64_tr_b16 v[44:45], v109 offset:512
    ds_read_b64_tr_b16 v[46:47], v109 offset:544
    ds_read_b128 v[48:51], v110 offset:1024
    s_waitcnt lgkmcnt(5)
    v_mfma_f32_16x16x32_bf16 v[88:91], v[56:59], v[28:31], 0
    v_mfma_f32_16x16x32_bf16 v[92:95], v[72:75], v[28:31], 0
    v_cvt_pk_bf16_f32 v52, v52, v53
    v_cvt_pk_bf16_f32 v53, v54, v55
    ds_write_b64 v108, v[52:53] offset:768
    ds_read_b64_tr_b16 v[52:53], v109 offset:768
    ds_read_b64_tr_b16 v[54:55], v109 offset:800
    v_mfma_f32_16x16x32_bf16 v[96:99], v[32:35], v[28:31], 0
    v_mfma_f32_16x16x32_bf16 v[88:91], v[60:63], v[36:39], v[88:91]
    v_mfma_f32_16x16x32_bf16 v[92:95], v[76:79], v[36:39], v[92:95]
    v_mfma_f32_16x16x32_bf16 v[96:99], v[40:43], v[36:39], v[96:99]
    s_waitcnt lgkmcnt(3)
    v_mfma_f32_16x16x32_bf16 v[88:91], v[64:67], v[44:47], v[88:91]
    v_mfma_f32_16x16x32_bf16 v[92:95], v[80:83], v[44:47], v[92:95]
    v_mfma_f32_16x16x32_bf16 v[96:99], v[48:51], v[44:47], v[96:99]
    s_waitcnt lgkmcnt(0)
    v_mfma_f32_16x16x32_bf16 v[88:91], v[68:71], v[52:55], v[88:91]
    v_mfma_f32_16x16x32_bf16 v[92:95], v[84:87], v[52:55], v[92:95]
    v_mfma_f32_16x16x32_bf16 v[96:99], v[0:3], v[52:55], v[96:99]
    s_nop 0
    v_add_f32_dpp v28, v88, v88 row_ror:8 row_mask:0xf bank_mask:0x3
    v_add_f32_dpp v29, v89, v89 row_ror:8 row_mask:0xf bank_mask:0x3
    v_add_f32_dpp v30, v90, v90 row_ror:8 row_mask:0xf bank_mask:0x3
    v_add_f32_dpp v31, v91, v91 row_ror:8 row_mask:0xf bank_mask:0x3
    v_add_f32_dpp v28, v92, v92 row_ror:8 row_mask:0xf bank_mask:0xc
    v_add_f32_dpp v29, v93, v93 row_ror:8 row_mask:0xf bank_mask:0xc
    v_add_f32_dpp v30, v94, v94 row_ror:8 row_mask:0xf bank_mask:0xc
    v_add_f32_dpp v31, v95, v95 row_ror:8 row_mask:0xf bank_mask:0xc
    ds_write_b128 v112, v[28:31]
    v_add_f32_dpp v32, v96, v96 row_ror:8 row_mask:0xf bank_mask:0xf
    v_add_f32_dpp v33, v97, v97 row_ror:8 row_mask:0xf bank_mask:0xf
    v_add_f32_dpp v34, v98, v98 row_ror:8 row_mask:0xf bank_mask:0xf
    v_add_f32_dpp v35, v99, v99 row_ror:8 row_mask:0xf bank_mask:0xf
    ds_write_b128 v113, v[32:35]
    s_cmp_eq_u32 s24, 0
    s_waitcnt lgkmcnt(0)
    s_barrier
    ds_read2st64_b64 v[36:39], v114 offset0:0 offset1:4
    ds_read2st64_b64 v[40:43], v114 offset0:8 offset1:12
    ds_read2st64_b32 v[44:45], v115 offset0:0 offset1:8
    ds_read2st64_b32 v[46:47], v115 offset0:16 offset1:24
    s_waitcnt lgkmcnt(3)
    v_pk_add_f32 v[36:37], v[36:37], v[38:39]
    s_waitcnt lgkmcnt(2)
    v_pk_add_f32 v[40:41], v[40:41], v[42:43]
    s_waitcnt lgkmcnt(0)
    v_pk_add_f32 v[44:45], v[44:45], v[46:47]
    v_pk_add_f32 v[36:37], v[36:37], v[40:41]
    v_add_f32 v44, v44, v45
    v_mul_f32 v49, s38, v36
    v_mul_f32 v50, s38, v37
    v_mul_f32 v51, s38, v44
    v_max3_f32 v48, abs(v49), abs(v50), abs(v51)
    v_exp_f32 v49, v49
    v_cmp_nge_f32 vcc, s39, v48
    v_exp_f32 v50, v50
    v_exp_f32 v51, v51
    s_cbranch_vccnz Lgmax_41
Lgmaxb_42:
    v_add_f32 v52, v49, v50
    v_cndmask_b32 v53, 0, v51, s[32:33]
    v_add_f32 v52, v52, v53
    v_mov_b32_dpp v53, v51 quad_perm:[1,0,3,2] row_mask:0xf bank_mask:0xf
    v_cndmask_b32 v50, v50, v51, s[34:35]
    v_add_f32_dpp v52, v52, v52 quad_perm:[1,0,3,2] row_mask:0xf bank_mask:0xf
    v_cndmask_b32 v49, v49, v53, s[34:35]
    s_nop 0
    v_add_f32_dpp v52, v52, v52 quad_perm:[2,3,0,1] row_mask:0xf bank_mask:0xf
    s_nop 1
    v_add_f32_dpp v52, v52, v52 row_half_mirror row_mask:0xf bank_mask:0xf
    s_nop 1
    v_add_f32_dpp v52, v52, v52 row_mirror row_mask:0xf bank_mask:0xf
    v_rcp_f32 v52, v52
    s_mov_b64 exec, s[36:37]
    v_mul_f32 v49, v49, v52
    v_mul_f32 v50, v50, v52
    v_cvt_pk_bf16_f32 v49, v49, v50
    v_min_u32 v49, -2, v49
    s_cbranch_scc0 Lgslow_43
    global_store_dword v116, v49, s[10:11]
Lgback_44:
    s_mov_b64 exec, -1
    s_add_u32 s8, s8, 0x2000
    s_addc_u32 s9, s9, 0
    s_add_u32 s10, s10, 0x4000
    s_addc_u32 s11, s11, 0
    s_add_u32 s12, s12, 0x7000
    s_addc_u32 s13, s13, 0
    s_add_u32 s14, s14, 0x7000
    s_addc_u32 s15, s15, 0
    s_add_u32 s42, s42, 0x70000
    s_addc_u32 s43, s43, 0
    s_add_u32 s20, s20, 1
    s_cmp_ge_u32 s20, 63
    s_cbranch_scc1 Lexitc_28
    s_cmp_lg_u32 s20, 11
    s_cbranch_scc1 Llate_45
    s_add_u32 s76, s4, 0x7900100
    s_addc_u32 s77, s5, 0
    v_mbcnt_lo_u32_b32 v8, -1, 0
    v_mbcnt_hi_u32_b32 v8, -1, v8
    v_lshlrev_b32 v8, 7, v8
    s_mov_b32 s78, 1048576
    s_mov_b32 exec_lo, 0x3f
    s_mov_b32 exec_hi, 0x0
Lwf_46:
    global_load_dword v9, v8, s[76:77] sc1
    s_sub_u32 s78, s78, 1
    s_cmp_eq_u32 s78, 0
    s_cbranch_scc1 Lexitc_28
    s_waitcnt vmcnt(0)
    v_cmp_ne_u32 vcc, 28, v9
    s_cbranch_vccz Lwfd_47
    s_sleep 4
    s_branch Lwf_46
Lwfd_47:
    s_mov_b64 exec, -1
Llate_45:
    v_mov_b32 v28, 0
    v_mov_b32 v29, 0
    v_mov_b32 v30, 0
    v_mov_b32 v31, 0
    v_mov_b32 v32, 0
    v_mov_b32 v33, 0
    v_mov_b32 v34, 0
    v_mov_b32 v35, 0
    v_mov_b32 v36, 0
    v_mov_b32 v37, 0
    v_mov_b32 v38, 0
    v_mov_b32 v39, 0
    v_mov_b32 v40, 0
    v_mov_b32 v41, 0
    v_mov_b32 v42, 0
    v_mov_b32 v43, 0
    v_mov_b32 v44, 0
    v_mov_b32 v45, 0
    v_mov_b32 v46, 0
    v_mov_b32 v47, 0
    v_mov_b32 v48, 0
    v_mov_b32 v49, 0
    v_mov_b32 v50, 0
    v_mov_b32 v51, 0
    v_mov_b32 v52, 0
    v_mov_b32 v53, 0
    v_mov_b32 v54, 0
    v_mov_b32 v55, 0
    global_load_dwordx4 v[56:59], v111, s[12:13] offset:0 sc1
    global_load_dwordx4 v[60:63], v111, s[12:13] offset:1024 sc1
    global_load_dwordx4 v[64:67], v111, s[12:13] offset:2048 sc1
    global_load_dwordx4 v[68:71], v111, s[12:13] offset:3072 sc1
    global_load_dwordx4 v[72:75], v111, s[14:15] offset:0 sc1
    global_load_dwordx4 v[76:79], v111, s[14:15] offset:1024 sc1
    global_load_dwordx4 v[80:83], v111, s[14:15] offset:2048 sc1
    global_load_dwordx4 v[84:87], v111, s[14:15] offset:3072 sc1
    s_add_u32 s44, s44, 0x70000
    s_addc_u32 s45, s45, 0
    s_branch Lgloop_38
Lgslow_43:
    global_store_dword v116, v49, s[10:11] sc1
    s_branch Lgback_44
Lgmax_41:
    v_max3_f32 v48, v36, v37, v44
    s_nop 1
    v_max_f32_dpp v48, v48, v48 quad_perm:[1,0,3,2] row_mask:0xf bank_mask:0xf
    s_nop 1
    v_max_f32_dpp v48, v48, v48 quad_perm:[2,3,0,1] row_mask:0xf bank_mask:0xf
    s_nop 1
    v_max_f32_dpp v48, v48, v48 row_half_mirror row_mask:0xf bank_mask:0xf
    s_nop 1
    v_max_f32_dpp v48, v48, v48 row_mirror row_mask:0xf bank_mask:0xf
    v_sub_f32 v51, v44, v48
    v_sub_f32 v49, v36, v48
    v_sub_f32 v50, v37, v48
    v_mul_f32 v51, s38, v51
    v_mul_f32 v49, s38, v49
    v_mul_f32 v50, s38, v50
    v_exp_f32 v51, v51
    v_exp_f32 v49, v49
    v_exp_f32 v50, v50
    s_nop 0
    s_branch Lgmaxb_42
Lrole_u_29:
    s_lshl_b32 s20, s23, 2
    s_lshl_b32 s25, s20, 7
    s_add_u32 s25, s25, 0x7906800
    s_add_u32 s76, s4, s25
    s_addc_u32 s77, s5, 0
    v_mbcnt_lo_u32_b32 v8, -1, 0
    v_mbcnt_hi_u32_b32 v8, -1, v8
    v_lshlrev_b32 v8, 7, v8
    s_mov_b32 s78, 1048576
    s_mov_b32 exec_lo, 0xf
    s_mov_b32 exec_hi, 0x0
Lwf_48:
    global_load_dword v9, v8, s[76:77] sc1
    s_sub_u32 s78, s78, 1
    s_cmp_eq_u32 s78, 0
    s_cbranch_scc1 Lexitc_28
    s_waitcnt vmcnt(0)
    v_cmp_ne_u32 vcc, 8, v9
    s_cbranch_vccz Lwfd_49
    s_sleep 4
    s_branch Lwf_48
Lwfd_49:
    s_mov_b64 exec, -1
    s_mov_b32 s46, 0
    s_mov_b32 s20, 0
Lushadow_50:
    s_sub_u32 s22, s22, 16
    v_and_b32 v184, 63, v0
    s_lshl_b32 s25, s23, 1
    s_add_u32 s25, s25, 0
    s_sub_u32 s26, s25, 7
    s_cmp_ge_u32 s25, 7
    s_cselect_b32 s25, s26, s25
    s_lshl_b32 s25, s25, 10
    v_lshl_add_u32 v160, v184, 4, s25
    s_lshl_b32 s25, s23, 1
    s_add_u32 s25, s25, 1
    s_sub_u32 s26, s25, 7
    s_cmp_ge_u32 s25, 7
    s_cselect_b32 s25, s26, s25
    s_lshl_b32 s25, s25, 10
    v_lshl_add_u32 v161, v184, 4, s25
    s_lshl_b32 s25, s23, 1
    s_add_u32 s25, s25, 2
    s_sub_u32 s26, s25, 7
    s_cmp_ge_u32 s25, 7
    s_cselect_b32 s25, s26, s25
    s_lshl_b32 s25, s25, 10
    v_lshl_add_u32 v162, v184, 4, s25
    s_lshl_b32 s25, s23, 1
    s_add_u32 s25, s25, 3
    s_sub_u32 s26, s25, 7
    s_cmp_ge_u32 s25, 7
    s_cselect_b32 s25, s26, s25
    s_lshl_b32 s25, s25, 10
    v_lshl_add_u32 v163, v184, 4, s25
    s_lshl_b32 s25, s23, 1
    s_add_u32 s25, s25, 4
    s_sub_u32 s26, s25, 7
    s_cmp_ge_u32 s25, 7
    s_cselect_b32 s25, s26, s25
    s_lshl_b32 s25, s25, 10
    v_lshl_add_u32 v164, v184, 4, s25
    s_lshl_b32 s25, s23, 1
    s_add_u32 s25, s25, 5
    s_sub_u32 s26, s25, 7
    s_cmp_ge_u32 s25, 7
    s_cselect_b32 s25, s26, s25
    s_lshl_b32 s25, s25, 10
    v_lshl_add_u32 v165, v184, 4, s25
    s_lshl_b32 s25, s23, 1
    s_add_u32 s25, s25, 6
    s_sub_u32 s26, s25, 7
    s_cmp_ge_u32 s25, 7
    s_cselect_b32 s25, s26, s25
    s_lshl_b32 s25, s25, 10
    v_lshl_add_u32 v166, v184, 4, s25
    v_lshlrev_b32 v1, 1, v160
    v_lshlrev_b32 v180, 4, v184
    v_sub_u32 v1, v1, v180
    v_lshlrev_b32 v2, 1, v161
    v_lshlrev_b32 v180, 4, v184
    v_sub_u32 v2, v2, v180
    v_lshlrev_b32 v3, 1, v162
    v_lshlrev_b32 v180, 4, v184
    v_sub_u32 v3, v3, v180
    v_lshlrev_b32 v4, 1, v163
    v_lshlrev_b32 v180, 4, v184
    v_sub_u32 v4, v4, v180
    v_lshlrev_b32 v5, 1, v164
    v_lshlrev_b32 v180, 4, v184
    v_sub_u32 v5, v5, v180
    v_lshlrev_b32 v6, 1, v165
    v_lshlrev_b32 v180, 4, v184
    v_sub_u32 v6, v6, v180
    v_lshlrev_b32 v7, 1, v166
    v_lshlrev_b32 v180, 4, v184
    v_sub_u32 v7, v7, v180
    s_lshl_b32 s25, s23, 15
    s_add_u32 s25, s25, 12288
    v_lshl_add_u32 v168, v184, 4, s25
    s_lshl_b32 s25, s23, 2
    s_add_u32 s25, s25, 16
    s_mul_i32 s25, s25, 28
    s_lshl_b32 s26, s22, 1
    s_add_u32 s25, s25, s26
    s_add_u32 s25, s25, 0
    s_mul_i32 s25, s25, 14336
    s_add_u32 s25, s25, 0x400000
    s_add_u32 s40, s4, s25
    s_addc_u32 s41, s5, 0
    global_load_dwordx4 a[0:3], v1, s[40:41] sc1
    global_load_dwordx4 a[4:7], v1, s[40:41] offset:1024 sc1
    global_load_dwordx4 a[8:11], v2, s[40:41] sc1
    global_load_dwordx4 a[12:15], v2, s[40:41] offset:1024 sc1
    global_load_dwordx4 a[16:19], v3, s[40:41] sc1
    global_load_dwordx4 a[20:23], v3, s[40:41] offset:1024 sc1
    global_load_dwordx4 a[24:27], v4, s[40:41] sc1
    global_load_dwordx4 a[28:31], v4, s[40:41] offset:1024 sc1
    global_load_dwordx4 a[32:35], v5, s[40:41] sc1
    global_load_dwordx4 a[36:39], v5, s[40:41] offset:1024 sc1
    global_load_dwordx4 v[28:31], v6, s[40:41] sc1
    global_load_dwordx4 v[32:35], v6, s[40:41] offset:1024 sc1
    global_load_dwordx4 v[36:39], v7, s[40:41] sc1
    global_load_dwordx4 v[40:43], v7, s[40:41] offset:1024 sc1
    s_lshl_b32 s25, s23, 2
    s_add_u32 s25, s25, 16
    s_mul_i32 s25, s25, 28
    s_lshl_b32 s26, s22, 1
    s_add_u32 s25, s25, s26
    s_add_u32 s25, s25, 1
    s_mul_i32 s25, s25, 14336
    s_add_u32 s25, s25, 0x400000
    s_add_u32 s40, s4, s25
    s_addc_u32 s41, s5, 0
    global_load_dwordx4 a[40:43], v1, s[40:41] sc1
    global_load_dwordx4 a[44:47], v1, s[40:41] offset:1024 sc1
    global_load_dwordx4 a[48:51], v2, s[40:41] sc1
    global_load_dwordx4 a[52:55], v2, s[40:41] offset:1024 sc1
    global_load_dwordx4 a[56:59], v3, s[40:41] sc1
    global_load_dwordx4 a[60:63], v3, s[40:41] offset:1024 sc1
    global_load_dwordx4 a[64:67], v4, s[40:41] sc1
    global_load_dwordx4 a[68:71], v4, s[40:41] offset:1024 sc1
    global_load_dwordx4 a[72:75], v5, s[40:41] sc1
    global_load_dwordx4 a[76:79], v5, s[40:41] offset:1024 sc1
    global_load_dwordx4 v[44:47], v6, s[40:41] sc1
    global_load_dwordx4 v[48:51], v6, s[40:41] offset:1024 sc1
    global_load_dwordx4 v[52:55], v7, s[40:41] sc1
    global_load_dwordx4 v[56:59], v7, s[40:41] offset:1024 sc1
    s_lshl_b32 s25, s23, 2
    s_add_u32 s25, s25, 17
    s_mul_i32 s25, s25, 28
    s_lshl_b32 s26, s22, 1
    s_add_u32 s25, s25, s26
    s_add_u32 s25, s25, 0
    s_mul_i32 s25, s25, 14336
    s_add_u32 s25, s25, 0x400000
    s_add_u32 s40, s4, s25
    s_addc_u32 s41, s5, 0
    global_load_dwordx4 a[80:83], v1, s[40:41] sc1
    global_load_dwordx4 a[84:87], v1, s[40:41] offset:1024 sc1
    global_load_dwordx4 a[88:91], v2, s[40:41] sc1
    global_load_dwordx4 a[92:95], v2, s[40:41] offset:1024 sc1
    global_load_dwordx4 a[96:99], v3, s[40:41] sc1
    global_load_dwordx4 a[100:103], v3, s[40:41] offset:1024 sc1
    global_load_dwordx4 a[104:107], v4, s[40:41] sc1
    global_load_dwordx4 a[108:111], v4, s[40:41] offset:1024 sc1
    global_load_dwordx4 a[112:115], v5, s[40:41] sc1
    global_load_dwordx4 a[116:119], v5, s[40:41] offset:1024 sc1
    global_load_dwordx4 v[60:63], v6, s[40:41] sc1
    global_load_dwordx4 v[64:67], v6, s[40:41] offset:1024 sc1
    global_load_dwordx4 v[68:71], v7, s[40:41] sc1
    global_load_dwordx4 v[72:75], v7, s[40:41] offset:1024 sc1
    s_lshl_b32 s25, s23, 2
    s_add_u32 s25, s25, 17
    s_mul_i32 s25, s25, 28
    s_lshl_b32 s26, s22, 1
    s_add_u32 s25, s25, s26
    s_add_u32 s25, s25, 1
    s_mul_i32 s25, s25, 14336
    s_add_u32 s25, s25, 0x400000
    s_add_u32 s40, s4, s25
    s_addc_u32 s41, s5, 0
    global_load_dwordx4 a[120:123], v1, s[40:41] sc1
    global_load_dwordx4 a[124:127], v1, s[40:41] offset:1024 sc1
    global_load_dwordx4 a[128:131], v2, s[40:41] sc1
    global_load_dwordx4 a[132:135], v2, s[40:41] offset:1024 sc1
    global_load_dwordx4 a[136:139], v3, s[40:41] sc1
    global_load_dwordx4 a[140:143], v3, s[40:41] offset:1024 sc1
    global_load_dwordx4 a[144:147], v4, s[40:41] sc1
    global_load_dwordx4 a[148:151], v4, s[40:41] offset:1024 sc1
    global_load_dwordx4 a[152:155], v5, s[40:41] sc1
    global_load_dwordx4 a[156:159], v5, s[40:41] offset:1024 sc1
    global_load_dwordx4 v[76:79], v6, s[40:41] sc1
    global_load_dwordx4 v[80:83], v6, s[40:41] offset:1024 sc1
    global_load_dwordx4 v[84:87], v7, s[40:41] sc1
    global_load_dwordx4 v[88:91], v7, s[40:41] offset:1024 sc1
    s_lshl_b32 s25, s23, 2
    s_add_u32 s25, s25, 18
    s_mul_i32 s25, s25, 28
    s_lshl_b32 s26, s22, 1
    s_add_u32 s25, s25, s26
    s_add_u32 s25, s25, 0
    s_mul_i32 s25, s25, 14336
    s_add_u32 s25, s25, 0x400000
    s_add_u32 s40, s4, s25
    s_addc_u32 s41, s5, 0
    global_load_dwordx4 a[160:163], v1, s[40:41] sc1
    global_load_dwordx4 a[164:167], v1, s[40:41] offset:1024 sc1
    global_load_dwordx4 a[168:171], v2, s[40:41] sc1
    global_load_dwordx4 a[172:175], v2, s[40:41] offset:1024 sc1
    global_load_dwordx4 a[176:179], v3, s[40:41] sc1
    global_load_dwordx4 a[180:183], v3, s[40:41] offset:1024 sc1
    global_load_dwordx4 a[184:187], v4, s[40:41] sc1
    global_load_dwordx4 a[188:191], v4, s[40:41] offset:1024 sc1
    global_load_dwordx4 a[192:195], v5, s[40:41] sc1
    global_load_dwordx4 a[196:199], v5, s[40:41] offset:1024 sc1
    global_load_dwordx4 v[92:95], v6, s[40:41] sc1
    global_load_dwordx4 v[96:99], v6, s[40:41] offset:1024 sc1
    global_load_dwordx4 v[100:103], v7, s[40:41] sc1
    global_load_dwordx4 v[104:107], v7, s[40:41] offset:1024 sc1
    s_lshl_b32 s25, s23, 2
    s_add_u32 s25, s25, 18
    s_mul_i32 s25, s25, 28
    s_lshl_b32 s26, s22, 1
    s_add_u32 s25, s25, s26
    s_add_u32 s25, s25, 1
    s_mul_i32 s25, s25, 14336
    s_add_u32 s25, s25, 0x400000
    s_add_u32 s40, s4, s25
    s_addc_u32 s41, s5, 0
    global_load_dwordx4 a[200:203], v1, s[40:41] sc1
    global_load_dwordx4 a[204:207], v1, s[40:41] offset:1024 sc1
    global_load_dwordx4 a[208:211], v2, s[40:41] sc1
    global_load_dwordx4 a[212:215], v2, s[40:41] offset:1024 sc1
    global_load_dwordx4 a[216:219], v3, s[40:41] sc1
    global_load_dwordx4 a[220:223], v3, s[40:41] offset:1024 sc1
    global_load_dwordx4 a[224:227], v4, s[40:41] sc1
    global_load_dwordx4 a[228:231], v4, s[40:41] offset:1024 sc1
    global_load_dwordx4 a[232:235], v5, s[40:41] sc1
    global_load_dwordx4 a[236:239], v5, s[40:41] offset:1024 sc1
    global_load_dwordx4 v[108:111], v6, s[40:41] sc1
    global_load_dwordx4 v[112:115], v6, s[40:41] offset:1024 sc1
    global_load_dwordx4 v[116:119], v7, s[40:41] sc1
    global_load_dwordx4 v[120:123], v7, s[40:41] offset:1024 sc1
    s_lshl_b32 s25, s23, 2
    s_add_u32 s25, s25, 19
    s_mul_i32 s25, s25, 28
    s_lshl_b32 s26, s22, 1
    s_add_u32 s25, s25, s26
    s_add_u32 s25, s25, 0
    s_mul_i32 s25, s25, 14336
    s_add_u32 s25, s25, 0x400000
    s_add_u32 s40, s4, s25
    s_addc_u32 s41, s5, 0
    global_load_dwordx4 a[240:243], v1, s[40:41] sc1
    global_load_dwordx4 a[244:247], v1, s[40:41] offset:1024 sc1
    global_load_dwordx4 a[248:251], v2, s[40:41] sc1
    global_load_dwordx4 a[252:255], v2, s[40:41] offset:1024 sc1
    global_load_dwordx4 v[192:195], v3, s[40:41] sc1
    global_load_dwordx4 v[196:199], v3, s[40:41] offset:1024 sc1
    global_load_dwordx4 v[200:203], v4, s[40:41] sc1
    global_load_dwordx4 v[204:207], v4, s[40:41] offset:1024 sc1
    global_load_dwordx4 v[208:211], v5, s[40:41] sc1
    global_load_dwordx4 v[212:215], v5, s[40:41] offset:1024 sc1
    global_load_dwordx4 v[124:127], v6, s[40:41] sc1
    global_load_dwordx4 v[128:131], v6, s[40:41] offset:1024 sc1
    global_load_dwordx4 v[132:135], v7, s[40:41] sc1
    global_load_dwordx4 v[136:139], v7, s[40:41] offset:1024 sc1
    s_lshl_b32 s25, s23, 2
    s_add_u32 s25, s25, 19
    s_mul_i32 s25, s25, 28
    s_lshl_b32 s26, s22, 1
    s_add_u32 s25, s25, s26
    s_add_u32 s25, s25, 1
    s_mul_i32 s25, s25, 14336
    s_add_u32 s25, s25, 0x400000
    s_add_u32 s40, s4, s25
    s_addc_u32 s41, s5, 0
    global_load_dwordx4 v[216:219], v1, s[40:41] sc1
    global_load_dwordx4 v[220:223], v1, s[40:41] offset:1024 sc1
    global_load_dwordx4 v[224:227], v2, s[40:41] sc1
    global_load_dwordx4 v[228:231], v2, s[40:41] offset:1024 sc1
    global_load_dwordx4 v[232:235], v3, s[40:41] sc1
    global_load_dwordx4 v[236:239], v3, s[40:41] offset:1024 sc1
    global_load_dwordx4 v[240:243], v4, s[40:41] sc1
    global_load_dwordx4 v[244:247], v4, s[40:41] offset:1024 sc1
    global_load_dwordx4 v[248:251], v5, s[40:41] sc1
    global_load_dwordx4 v[252:255], v5, s[40:41] offset:1024 sc1
    global_load_dwordx4 v[140:143], v6, s[40:41] sc1
    global_load_dwordx4 v[144:147], v6, s[40:41] offset:1024 sc1
    global_load_dwordx4 v[148:151], v7, s[40:41] sc1
    global_load_dwordx4 v[152:155], v7, s[40:41] offset:1024 sc1
    s_waitcnt vmcnt(0)
    ds_write_b128 v168, v[28:31] offset:0
    ds_write_b128 v168, v[32:35] offset:1024
    ds_write_b128 v168, v[36:39] offset:2048
    ds_write_b128 v168, v[40:43] offset:3072
    ds_write_b128 v168, v[44:47] offset:4096
    ds_write_b128 v168, v[48:51] offset:5120
    ds_write_b128 v168, v[52:55] offset:6144
    ds_write_b128 v168, v[56:59] offset:7168
    ds_write_b128 v168, v[60:63] offset:8192
    ds_write_b128 v168, v[64:67] offset:9216
    ds_write_b128 v168, v[68:71] offset:10240
    ds_write_b128 v168, v[72:75] offset:11264
    ds_write_b128 v168, v[76:79] offset:12288
    ds_write_b128 v168, v[80:83] offset:13312
    ds_write_b128 v168, v[84:87] offset:14336
    ds_write_b128 v168, v[88:91] offset:15360
    ds_write_b128 v168, v[92:95] offset:16384
    ds_write_b128 v168, v[96:99] offset:17408
    ds_write_b128 v168, v[100:103] offset:18432
    ds_write_b128 v168, v[104:107] offset:19456
    ds_write_b128 v168, v[108:111] offset:20480
    ds_write_b128 v168, v[112:115] offset:21504
    ds_write_b128 v168, v[116:119] offset:22528
    ds_write_b128 v168, v[120:123] offset:23552
    ds_write_b128 v168, v[124:127] offset:24576
    ds_write_b128 v168, v[128:131] offset:25600
    ds_write_b128 v168, v[132:135] offset:26624
    ds_write_b128 v168, v[136:139] offset:27648
    ds_write_b128 v168, v[140:143] offset:28672
    ds_write_b128 v168, v[144:147] offset:29696
    ds_write_b128 v168, v[148:151] offset:30720
    ds_write_b128 v168, v[152:155] offset:31744
    v_and_b32 v180, 8, v184
    v_mov_b32 v167, 0x4444
    v_mov_b32 v181, 0xeeee
    v_cmp_ne_u32 vcc, 0, v180
    s_nop 1
    v_cndmask_b32 v167, v167, v181, vcc
    s_lshl_b32 s25, s23, 2
    s_add_u32 s25, s25, 0
    s_mul_i32 s25, s25, 28
    s_lshl_b32 s26, s22, 1
    s_add_u32 s25, s25, s26
    s_lshl_b32 s25, s25, 10
    v_lshl_add_u32 v169, v184, 4, s25
    s_lshl_b32 s25, s23, 2
    s_add_u32 s25, s25, 1
    s_mul_i32 s25, s25, 28
    s_lshl_b32 s26, s22, 1
    s_add_u32 s25, s25, s26
    s_lshl_b32 s25, s25, 10
    v_lshl_add_u32 v170, v184, 4, s25
    s_lshl_b32 s25, s23, 2
    s_add_u32 s25, s25, 2
    s_mul_i32 s25, s25, 28
    s_lshl_b32 s26, s22, 1
    s_add_u32 s25, s25, s26
    s_lshl_b32 s25, s25, 10
    v_lshl_add_u32 v171, v184, 4, s25
    s_lshl_b32 s25, s23, 2
    s_add_u32 s25, s25, 3
    s_mul_i32 s25, s25, 28
    s_lshl_b32 s26, s22, 1
    s_add_u32 s25, s25, s26
    s_lshl_b32 s25, s25, 10
    v_lshl_add_u32 v172, v184, 4, s25
    s_mul_i32 s25, s23, 3072
    v_lshl_add_u32 v173, v184, 4, s25
    v_and_b32 v180, 15, v184
    v_lshl_add_u32 v187, v180, 4, s25
    v_lshrrev_b32 v180, 5, v184
    v_lshl_add_u32 v187, v180, 8, v187
    s_lshl_b32 s25, s23, 10
    s_add_u32 s25, s25, 8192
    v_and_b32 v180, 15, v184
    v_lshl_add_u32 v174, v180, 4, s25
    v_bfe_u32 v180, v184, 4, 1
    v_lshl_add_u32 v174, v180, 9, v174
    v_lshrrev_b32 v180, 5, v184
    v_lshl_add_u32 v174, v180, 3, v174
    v_and_b32 v182, 127, v0
    v_bfe_u32 v180, v182, 4, 1
    v_lshlrev_b32 v175, 9, v180
    v_bfe_u32 v180, v182, 2, 2
    v_lshl_add_u32 v175, v180, 2, v175
    v_lshrrev_b32 v180, 5, v182
    v_lshl_add_u32 v175, v180, 7, v175
    v_and_b32 v180, 3, v182
    v_lshl_add_u32 v175, v180, 5, v175
    v_add_u32 v175, 8192, v175
    v_add_u32 v176, 16, v175
    s_lshl_b32 s25, s22, 9
    v_lshl_add_u32 v177, v182, 2, s25
    s_lshl_b32 s25, s22, 3
    s_add_u32 s25, s25, s23
    s_lshl_b32 s25, s25, 10
    v_lshl_add_u32 v178, v184, 4, s25
    v_add_u32 v179, 4096, v178
    s_lshl_b32 s25, s20, 13
    s_add_u32 s26, s25, 0x6300000
    s_add_u32 s25, s25, 0x6000000
    s_cmp_eq_u32 s46, 0
    s_cselect_b32 s25, s25, s26
    s_add_u32 s8, s4, s25
    s_addc_u32 s9, s5, 0
    s_add_u32 s10, s4, 0x6100000
    s_addc_u32 s11, s5, 0
    s_add_u32 s12, s4, 0x4000000
    s_addc_u32 s13, s5, 0
    s_add_u32 s16, s4, 0x6002000
    s_addc_u32 s17, s5, 0
    v_mov_b32 v185, 0
    v_mov_b32 v186, 1
    s_mov_b32 s21, 2097152
    s_waitcnt lgkmcnt(0)
    s_add_u32 s76, s4, 0x7907000
    s_addc_u32 s77, s5, 0
    v_mbcnt_lo_u32_b32 v8, -1, 0
    v_mbcnt_hi_u32_b32 v8, -1, v8
    v_lshlrev_b32 v8, 7, v8
    s_mov_b32 s78, 1048576
    s_mov_b32 exec_lo, 0xff
    s_mov_b32 exec_hi, 0x0
Lwf_51:
    global_load_dword v9, v8, s[76:77] sc1
    s_sub_u32 s78, s78, 1
    s_cmp_eq_u32 s78, 0
    s_cbranch_scc1 Lexitc_28
    s_waitcnt vmcnt(0)
    v_cmp_ne_u32 vcc, 32, v9
    s_cbranch_vccz Lwfd_52
    s_sleep 4
    s_branch Lwf_51
Lwfd_52:
    s_mov_b64 exec, -1
    s_add_u32 s76, s4, 0x7900000
    s_addc_u32 s77, s5, 0
    v_mbcnt_lo_u32_b32 v8, -1, 0
    v_mbcnt_hi_u32_b32 v8, -1, v8
    v_lshlrev_b32 v8, 7, v8
    s_mov_b32 s78, 1048576
    s_mov_b32 exec_lo, 0x3
    s_mov_b32 exec_hi, 0x0
Lwf_53:
    global_load_dword v9, v8, s[76:77] sc1
    s_sub_u32 s78, s78, 1
    s_cmp_eq_u32 s78, 0
    s_cbranch_scc1 Lexitc_28
    s_waitcnt vmcnt(0)
    v_cmp_ne_u32 vcc, 112, v9
    s_cbranch_vccz Lwfd_54
    s_sleep 4
    s_branch Lwf_53
Lwfd_54:
    s_mov_b64 exec, -1
    v_mov_b32 v28, 0
    v_mov_b32 v29, 0
    v_mov_b32 v30, 0
    v_mov_b32 v31, 0
    v_mov_b32 v32, 0
    v_mov_b32 v33, 0
    v_mov_b32 v34, 0
    v_mov_b32 v35, 0
    v_mov_b32 v36, 0
    v_mov_b32 v37, 0
    v_mov_b32 v38, 0
    v_mov_b32 v39, 0
    v_mov_b32 v40, 0
    v_mov_b32 v41, 0
    v_mov_b32 v42, 0
    v_mov_b32 v43, 0
    v_mov_b32 v44, 0
    v_mov_b32 v45, 0
    v_mov_b32 v46, 0
    v_mov_b32 v47, 0
    v_mov_b32 v48, 0
    v_mov_b32 v49, 0
    v_mov_b32 v50, 0
    v_mov_b32 v51, 0
    v_mov_b32 v52, 0
    v_mov_b32 v53, 0
    v_mov_b32 v54, 0
    v_mov_b32 v55, 0
    v_mov_b32 v56, 0
    v_mov_b32 v57, 0
    v_mov_b32 v58, 0
    v_mov_b32 v59, 0
    v_mov_b32 v120, 0
    v_mov_b32 v121, 0
    v_mov_b32 v122, 0
    v_mov_b32 v123, 0
    v_mov_b32 v124, 0
    v_mov_b32 v125, 0
    v_mov_b32 v126, 0
    v_mov_b32 v127, 0
    ds_read_b128 v[128:131], v168 offset:0
    ds_read_b128 v[132:135], v168 offset:1024
    ds_read_b128 v[136:139], v168 offset:2048
    ds_read_b128 v[140:143], v168 offset:3072
    ds_read_b128 v[144:147], v168 offset:8192
    ds_read_b128 v[148:151], v168 offset:9216
    ds_read_b128 v[152:155], v168 offset:10240
    ds_read_b128 v[156:159], v168 offset:11264
Luloop_55:
Lpollm_56:
    global_load_dwordx4 v[0:3], v160, s[8:9] sc1
    global_load_dwordx4 v[4:7], v161, s[8:9] sc1
    s_sub_u32 s21, s21, 1
    s_cmp_eq_u32 s21, 0
    s_cbranch_scc1 Lexitc_28
    s_waitcnt vmcnt(1)
    v_max3_u32 v180, v0, v1, v2
    s_waitcnt vmcnt(0)
    v_max3_u32 v181, v3, v4, v5
    v_max3_u32 v180, v180, v6, v7
    v_max_u32 v180, v180, v181
    v_cmp_eq_u32 vcc, -1, v180
    s_cbranch_vccz Lpollok_57
    s_cmp_eq_u32 s46, 0
    s_cbranch_scc1 Lpollm_56
    s_sleep 8
    s_branch Lpollm_56
Lpollok_57:
    ds_write_b128 v160, v[0:3]
    ds_write_b128 v161, v[4:7]
    v_smfmac_f32_16x16x64_bf16 v[28:31], v[0:3], a[0:7], v167
    v_smfmac_f32_16x16x64_bf16 v[36:39], v[0:3], a[80:87], v167
    v_smfmac_f32_16x16x64_bf16 v[32:35], v[0:3], a[40:47], v167
    v_smfmac_f32_16x16x64_bf16 v[40:43], v[0:3], a[120:127], v167
    s_waitcnt lgkmcnt(0)
    s_barrier
    ds_read_b128 v[8:11], v162
    ds_read_b128 v[12:15], v163
    ds_read_b128 v[16:19], v164
    ds_read_b128 v[20:23], v165
    ds_read_b128 v[24:27], v166
    v_smfmac_f32_16x16x64_bf16 v[44:47], v[0:3], a[160:167], v167
    global_load_dwordx4 v[76:79], v169, s[12:13] offset:0 sc1
    v_smfmac_f32_16x16x64_bf16 v[52:55], v[0:3], a[240:247], v167
    global_load_dwordx4 v[92:95], v169, s[12:13] offset:1024 sc1
    v_smfmac_f32_16x16x64_bf16 v[48:51], v[0:3], a[200:207], v167
    global_load_dwordx4 v[80:83], v170, s[12:13] offset:0 sc1
    v_smfmac_f32_16x16x64_bf16 v[56:59], v[0:3], v[216:223], v167
    global_load_dwordx4 v[96:99], v170, s[12:13] offset:1024 sc1
    v_smfmac_f32_16x16x64_bf16 v[28:31], v[4:7], a[8:15], v167
    global_load_dwordx4 v[84:87], v171, s[12:13] offset:0 sc1
    v_smfmac_f32_16x16x64_bf16 v[36:39], v[4:7], a[88:95], v167
    global_load_dwordx4 v[100:103], v171, s[12:13] offset:1024 sc1
    v_smfmac_f32_16x16x64_bf16 v[32:35], v[4:7], a[48:55], v167
    global_load_dwordx4 v[88:91], v172, s[12:13] offset:0 sc1
    v_smfmac_f32_16x16x64_bf16 v[40:43], v[4:7], a[128:135], v167
    global_load_dwordx4 v[104:107], v172, s[12:13] offset:1024 sc1
    v_smfmac_f32_16x16x64_bf16 v[44:47], v[4:7], a[168:175], v167
    v_smfmac_f32_16x16x64_bf16 v[52:55], v[4:7], a[248:255], v167
    v_smfmac_f32_16x16x64_bf16 v[48:51], v[4:7], a[208:215], v167
    v_smfmac_f32_16x16x64_bf16 v[56:59], v[4:7], v[224:231], v167
    s_waitcnt lgkmcnt(0)
    v_smfmac_f32_16x16x64_bf16 v[28:31], v[8:11], a[16:23], v167
    v_smfmac_f32_16x16x64_bf16 v[28:31], v[12:15], a[24:31], v167
    v_smfmac_f32_16x16x64_bf16 v[28:31], v[16:19], a[32:39], v167
    v_smfmac_f32_16x16x64_bf16 v[28:31], v[20:23], v[128:135], v167
    v_smfmac_f32_16x16x64_bf16 v[28:31], v[24:27], v[136:143], v167
    ds_read_b128 v[128:131], v168 offset:4096
    ds_read_b128 v[132:135], v168 offset:5120
    ds_read_b128 v[136:139], v168 offset:6144
    ds_read_b128 v[140:143], v168 offset:7168
    v_smfmac_f32_16x16x64_bf16 v[36:39], v[8:11], a[96:103], v167
    v_smfmac_f32_16x16x64_bf16 v[36:39], v[12:15], a[104:111], v167
    v_smfmac_f32_16x16x64_bf16 v[36:39], v[16:19], a[112:119], v167
    v_cvt_pk_bf16_f32 v60, v28, v29
    v_cvt_pk_bf16_f32 v61, v30, v31
    v_smfmac_f32_16x16x64_bf16 v[36:39], v[20:23], v[144:151], v167
    v_smfmac_f32_16x16x64_bf16 v[36:39], v[24:27], v[152:159], v167
    ds_read_b128 v[144:147], v168 offset:12288
    ds_read_b128 v[148:151], v168 offset:13312
    ds_read_b128 v[152:155], v168 offset:14336
    ds_read_b128 v[156:159], v168 offset:15360
    v_smfmac_f32_16x16x64_bf16 v[32:35], v[8:11], a[56:63], v167
    v_smfmac_f32_16x16x64_bf16 v[32:35], v[12:15], a[64:71], v167
    v_smfmac_f32_16x16x64_bf16 v[32:35], v[16:19], a[72:79], v167
    v_cvt_pk_bf16_f32 v62, v36, v37
    v_cvt_pk_bf16_f32 v63, v38, v39
    s_waitcnt lgkmcnt(4)
    v_smfmac_f32_16x16x64_bf16 v[32:35], v[20:23], v[128:135], v167
    v_smfmac_f32_16x16x64_bf16 v[32:35], v[24:27], v[136:143], v167
    ds_read_b128 v[128:131], v168 offset:16384
    ds_read_b128 v[132:135], v168 offset:17408
    ds_read_b128 v[136:139], v168 offset:18432
    ds_read_b128 v[140:143], v168 offset:19456
    v_smfmac_f32_16x16x64_bf16 v[40:43], v[8:11], a[136:143], v167
    v_smfmac_f32_16x16x64_bf16 v[40:43], v[12:15], a[144:151], v167
    v_smfmac_f32_16x16x64_bf16 v[40:43], v[16:19], a[152:159], v167
    v_cvt_pk_bf16_f32 v68, v32, v33
    v_cvt_pk_bf16_f32 v69, v34, v35
    s_waitcnt lgkmcnt(4)
    v_smfmac_f32_16x16x64_bf16 v[40:43], v[20:23], v[144:151], v167
    v_smfmac_f32_16x16x64_bf16 v[40:43], v[24:27], v[152:159], v167
    ds_read_b128 v[144:147], v168 offset:24576
    ds_read_b128 v[148:151], v168 offset:25600
    ds_read_b128 v[152:155], v168 offset:26624
    ds_read_b128 v[156:159], v168 offset:27648
    v_smfmac_f32_16x16x64_bf16 v[44:47], v[8:11], a[176:183], v167
    v_smfmac_f32_16x16x64_bf16 v[44:47], v[12:15], a[184:191], v167
    v_smfmac_f32_16x16x64_bf16 v[44:47], v[16:19], a[192:199], v167
    v_cvt_pk_bf16_f32 v70, v40, v41
    v_cvt_pk_bf16_f32 v71, v42, v43
    s_waitcnt lgkmcnt(4)
    v_smfmac_f32_16x16x64_bf16 v[44:47], v[20:23], v[128:135], v167
    v_smfmac_f32_16x16x64_bf16 v[44:47], v[24:27], v[136:143], v167
    ds_read_b128 v[128:131], v168 offset:20480
    ds_read_b128 v[132:135], v168 offset:21504
    ds_read_b128 v[136:139], v168 offset:22528
    ds_read_b128 v[140:143], v168 offset:23552
    v_smfmac_f32_16x16x64_bf16 v[52:55], v[8:11], v[192:199], v167
    v_smfmac_f32_16x16x64_bf16 v[52:55], v[12:15], v[200:207], v167
    v_smfmac_f32_16x16x64_bf16 v[52:55], v[16:19], v[208:215], v167
    v_cvt_pk_bf16_f32 v64, v44, v45
    v_cvt_pk_bf16_f32 v65, v46, v47
    s_waitcnt lgkmcnt(4)
    v_smfmac_f32_16x16x64_bf16 v[52:55], v[20:23], v[144:151], v167
    v_smfmac_f32_16x16x64_bf16 v[52:55], v[24:27], v[152:159], v167
    ds_read_b128 v[144:147], v168 offset:28672
    ds_read_b128 v[148:151], v168 offset:29696
    ds_read_b128 v[152:155], v168 offset:30720
    ds_read_b128 v[156:159], v168 offset:31744
    v_smfmac_f32_16x16x64_bf16 v[48:51], v[8:11], a[216:223], v167
    v_smfmac_f32_16x16x64_bf16 v[48:51], v[12:15], a[224:231], v167
    v_smfmac_f32_16x16x64_bf16 v[48:51], v[16:19], a[232:239], v167
    v_cvt_pk_bf16_f32 v66, v52, v53
    v_cvt_pk_bf16_f32 v67, v54, v55
    s_waitcnt lgkmcnt(4)
    v_smfmac_f32_16x16x64_bf16 v[48:51], v[20:23], v[128:135], v167
    v_smfmac_f32_16x16x64_bf16 v[48:51], v[24:27], v[136:143], v167
    v_smfmac_f32_16x16x64_bf16 v[56:59], v[8:11], v[232:239], v167
    v_smfmac_f32_16x16x64_bf16 v[56:59], v[12:15], v[240:247], v167
    v_smfmac_f32_16x16x64_bf16 v[56:59], v[16:19], v[248:255], v167
    v_cvt_pk_bf16_f32 v72, v48, v49
    v_cvt_pk_bf16_f32 v73, v50, v51
    s_waitcnt lgkmcnt(0)
    v_smfmac_f32_16x16x64_bf16 v[56:59], v[20:23], v[144:151], v167
    v_smfmac_f32_16x16x64_bf16 v[56:59], v[24:27], v[152:159], v167
    s_nop 7
    v_cvt_pk_bf16_f32 v74, v56, v57
    v_cvt_pk_bf16_f32 v75, v58, v59
    s_cmp_ge_u32 s20, 63
    s_cbranch_scc1 Lufin_58
    s_cmp_lg_u32 s46, 0
    s_cbranch_scc1 Lufin_58
    global_load_dwordx4 v[108:111], v173, s[10:11] offset:0 sc1
    global_load_dwordx4 v[112:115], v173, s[10:11] offset:1024 sc1
    global_load_dwordx4 v[116:119], v187, s[10:11] offset:2048 sc1
    s_sleep 2
    global_load_dwordx4 v[108:111], v173, s[10:11] offset:0 sc1
    global_load_dwordx4 v[112:115], v173, s[10:11] offset:1024 sc1
    global_load_dwordx4 v[116:119], v187, s[10:11] offset:2048 sc1
    s_branch Lpoll_64
Lpollu_65:
    global_load_dwordx4 v[108:111], v173, s[10:11] offset:0 sc1
    global_load_dwordx4 v[112:115], v173, s[10:11] offset:1024 sc1
    global_load_dwordx4 v[116:119], v187, s[10:11] offset:2048 sc1
    s_nop 3
    v_mov_b32 v120, 0
    v_mov_b32 v121, 0
    v_mov_b32 v122, 0
    v_mov_b32 v123, 0
    v_mov_b32 v124, 0
    v_mov_b32 v125, 0
    v_mov_b32 v126, 0
    v_mov_b32 v127, 0
Lpoll_64:
    s_sub_u32 s21, s21, 1
    s_cmp_eq_u32 s21, 0
    s_cbranch_scc1 Lexitc_28
    s_waitcnt vmcnt(3)
    v_max3_u32 v180, v108, v109, v110
    v_max3_u32 v181, v111, v112, v113
    v_smfmac_f32_16x16x64_bf16 v[120:123], v[108:111], v[76:83], v167
    v_max3_u32 v180, v180, v114, v115
    v_smfmac_f32_16x16x64_bf16 v[120:123], v[112:115], v[84:91], v167
    v_max3_u32 v181, v181, v116, v117
    v_max3_u32 v180, v180, v118, v119
    v_smfmac_f32_16x16x64_bf16 v[120:123], v[116:119], v[60:67], v167
    v_max_u32 v180, v180, v181
    v_smfmac_f32_16x16x64_bf16 v[124:127], v[108:111], v[92:99], v167
    v_cmp_eq_u32 vcc, -1, v180
    v_smfmac_f32_16x16x64_bf16 v[124:127], v[112:115], v[100:107], v167
    v_smfmac_f32_16x16x64_bf16 v[124:127], v[116:119], v[68:75], v167
    s_cbranch_vccnz Lpollu_65
Lc1_62:
Lc2_63:
    v_permlane32_swap_b32 v120, v122
    v_permlane32_swap_b32 v121, v123
    v_pk_add_f32 v[120:121], v[120:121], v[122:123]
    ds_write_b64 v174, v[120:121] offset:0
    s_nop 3
    v_permlane32_swap_b32 v124, v126
    v_permlane32_swap_b32 v125, v127
    v_pk_add_f32 v[124:125], v[124:125], v[126:127]
    ds_write_b64 v174, v[124:125] offset:256
    s_cmp_ge_u32 s23, 2
    s_waitcnt lgkmcnt(0)
    s_barrier
    s_cbranch_scc1 Luskip_67
    ds_read2st64_b32 v[28:29], v175 offset0:0 offset1:4
    ds_read2st64_b32 v[30:31], v175 offset0:8 offset1:12
    ds_read2st64_b32 v[32:33], v176 offset0:0 offset1:4
    ds_read2st64_b32 v[34:35], v176 offset0:8 offset1:12
    s_cmp_eq_u32 s24, 0
    s_waitcnt lgkmcnt(2)
    v_add_f32 v28, v28, v29
    v_add_f32 v30, v30, v31
    v_add_f32 v28, v28, v30
    s_waitcnt lgkmcnt(0)
    v_add_f32 v32, v32, v33
    v_add_f32 v34, v34, v35
    v_add_f32 v32, v32, v34
    v_cvt_pk_bf16_f32 v182, v28, v32
    v_min_u32 v182, -2, v182
    s_cbranch_scc0 Luslow_68
    global_store_dword v177, v182, s[16:17]
Lusk3_69:
    s_cmp_lg_u32 s20, 62
    s_cbranch_scc1 Luskip_67
    s_add_u32 s18, s4, 0x637e000
    s_addc_u32 s19, s5, 0
    global_store_dword v177, v182, s[18:19] sc1
Luskip_67:
    s_add_u32 s8, s8, 0x2000
    s_addc_u32 s9, s9, 0
    s_add_u32 s16, s16, 0x2000
    s_addc_u32 s17, s17, 0
    s_add_u32 s10, s10, 0x4000
    s_addc_u32 s11, s11, 0
    s_add_u32 s12, s12, 0x70000
    s_addc_u32 s13, s13, 0
    s_add_u32 s20, s20, 1
    s_cmp_lg_u32 s20, 11
    s_cbranch_scc1 Llate_71
    s_add_u32 s76, s4, 0x7900100
    s_addc_u32 s77, s5, 0
    v_mbcnt_lo_u32_b32 v8, -1, 0
    v_mbcnt_hi_u32_b32 v8, -1, v8
    v_lshlrev_b32 v8, 7, v8
    s_mov_b32 s78, 1048576
    s_mov_b32 exec_lo, 0x3f
    s_mov_b32 exec_hi, 0x0
Lwf_72:
    global_load_dword v9, v8, s[76:77] sc1
    s_sub_u32 s78, s78, 1
    s_cmp_eq_u32 s78, 0
    s_cbranch_scc1 Lexitc_28
    s_waitcnt vmcnt(0)
    v_cmp_ne_u32 vcc, 28, v9
    s_cbranch_vccz Lwfd_73
    s_sleep 4
    s_branch Lwf_72
Lwfd_73:
    s_mov_b64 exec, -1
Llate_71:
    v_mov_b32 v28, 0
    v_mov_b32 v29, 0
    v_mov_b32 v30, 0
    v_mov_b32 v31, 0
    v_mov_b32 v32, 0
    v_mov_b32 v33, 0
    v_mov_b32 v34, 0
    v_mov_b32 v35, 0
    v_mov_b32 v36, 0
    v_mov_b32 v37, 0
    v_mov_b32 v38, 0
    v_mov_b32 v39, 0
    v_mov_b32 v40, 0
    v_mov_b32 v41, 0
    v_mov_b32 v42, 0
    v_mov_b32 v43, 0
    v_mov_b32 v44, 0
    v_mov_b32 v45, 0
    v_mov_b32 v46, 0
    v_mov_b32 v47, 0
    v_mov_b32 v48, 0
    v_mov_b32 v49, 0
    v_mov_b32 v50, 0
    v_mov_b32 v51, 0
    v_mov_b32 v52, 0
    v_mov_b32 v53, 0
    v_mov_b32 v54, 0
    v_mov_b32 v55, 0
    v_mov_b32 v56, 0
    v_mov_b32 v57, 0
    v_mov_b32 v58, 0
    v_mov_b32 v59, 0
    v_mov_b32 v120, 0
    v_mov_b32 v121, 0
    v_mov_b32 v122, 0
    v_mov_b32 v123, 0
    v_mov_b32 v124, 0
    v_mov_b32 v125, 0
    v_mov_b32 v126, 0
    v_mov_b32 v127, 0
    ds_read_b128 v[128:131], v168 offset:0
    ds_read_b128 v[132:135], v168 offset:1024
    ds_read_b128 v[136:139], v168 offset:2048
    ds_read_b128 v[140:143], v168 offset:3072
    ds_read_b128 v[144:147], v168 offset:8192
    ds_read_b128 v[148:151], v168 offset:9216
    ds_read_b128 v[152:155], v168 offset:10240
    ds_read_b128 v[156:159], v168 offset:11264
    s_branch Luloop_55
Luslow_68:
    global_store_dword v177, v182, s[16:17] sc1
    s_branch Lusk3_69
Lr1_60:
    global_load_dwordx4 v[112:115], v173, s[10:11] offset:1024 sc1
    global_load_dwordx4 v[116:119], v187, s[10:11] offset:2048 sc1
    s_sub_u32 s21, s21, 1
    s_cmp_eq_u32 s21, 0
    s_cbranch_scc1 Lexitc_28
    s_waitcnt vmcnt(0)
    s_branch Lc1_62
Lr2_61:
    global_load_dwordx4 v[116:119], v187, s[10:11] offset:2048 sc1
    s_sub_u32 s21, s21, 1
    s_cmp_eq_u32 s21, 0
    s_cbranch_scc1 Lexitc_28
    s_waitcnt vmcnt(0)
    s_branch Lc2_63
Lufin_58:
    s_mul_i32 s25, s20, 114688
    s_add_u32 s25, s25, 0x6400000
    s_add_u32 s44, s4, s25
    s_addc_u32 s45, s5, 0
    v_permlane32_swap_b32 v28, v30
    v_permlane32_swap_b32 v29, v31
    v_pk_add_f32 v[28:29], v[28:29], v[30:31]
    v_cvt_pk_bf16_f32 v60, v28, v29
    v_permlane32_swap_b32 v36, v38
    v_permlane32_swap_b32 v37, v39
    v_pk_add_f32 v[36:37], v[36:37], v[38:39]
    v_cvt_pk_bf16_f32 v61, v36, v37
    v_permlane32_swap_b32 v44, v46
    v_permlane32_swap_b32 v45, v47
    v_pk_add_f32 v[44:45], v[44:45], v[46:47]
    v_cvt_pk_bf16_f32 v62, v44, v45
    v_permlane32_swap_b32 v52, v54
    v_permlane32_swap_b32 v53, v55
    v_pk_add_f32 v[52:53], v[52:53], v[54:55]
    v_cvt_pk_bf16_f32 v63, v52, v53
    global_store_dwordx4 v178, v[60:63], s[44:45] sc1
    v_permlane32_swap_b32 v32, v34
    v_permlane32_swap_b32 v33, v35
    v_pk_add_f32 v[32:33], v[32:33], v[34:35]
    v_cvt_pk_bf16_f32 v68, v32, v33
    v_permlane32_swap_b32 v40, v42
    v_permlane32_swap_b32 v41, v43
    v_pk_add_f32 v[40:41], v[40:41], v[42:43]
    v_cvt_pk_bf16_f32 v69, v40, v41
    v_permlane32_swap_b32 v48, v50
    v_permlane32_swap_b32 v49, v51
    v_pk_add_f32 v[48:49], v[48:49], v[50:51]
    v_cvt_pk_bf16_f32 v70, v48, v49
    v_permlane32_swap_b32 v56, v58
    v_permlane32_swap_b32 v57, v59
    v_pk_add_f32 v[56:57], v[56:57], v[58:59]
    v_cvt_pk_bf16_f32 v71, v56, v57
    global_store_dwordx4 v179, v[68:71], s[44:45] sc1
    s_or_b32 s25, s22, s46
    s_cmp_lg_u32 s25, 0
    s_cbranch_scc1 Lnomg_74
    s_add_u32 s18, s4, 0x637e000
    s_addc_u32 s19, s5, 0
    global_store_dwordx4 v160, v[0:3], s[18:19] sc1
    global_store_dwordx4 v161, v[4:7], s[18:19] sc1
Lnomg_74:
    s_lshl_b32 s25, s22, 2
    s_add_u32 s25, s25, s23
    s_lshl_b32 s25, s25, 2
    s_lshl_b32 s26, s20, 8
    s_add_u32 s25, s25, s26
    s_add_u32 s25, s25, 0x7901200
    s_add_u32 s42, s4, s25
    s_addc_u32 s43, s5, 0
    v_mov_b32 v28, 0
    v_mov_b32 v29, 0
    v_mov_b32 v30, 0
    v_mov_b32 v31, 0
    v_mov_b32 v32, 0
    v_mov_b32 v33, 0
    v_mov_b32 v34, 0
    v_mov_b32 v35, 0
    v_mov_b32 v36, 0
    v_mov_b32 v37, 0
    v_mov_b32 v38, 0
    v_mov_b32 v39, 0
    v_mov_b32 v40, 0
    v_mov_b32 v41, 0
    v_mov_b32 v42, 0
    v_mov_b32 v43, 0
    v_mov_b32 v44, 0
    v_mov_b32 v45, 0
    v_mov_b32 v46, 0
    v_mov_b32 v47, 0
    v_mov_b32 v48, 0
    v_mov_b32 v49, 0
    v_mov_b32 v50, 0
    v_mov_b32 v51, 0
    v_mov_b32 v52, 0
    v_mov_b32 v53, 0
    v_mov_b32 v54, 0
    v_mov_b32 v55, 0
    v_mov_b32 v56, 0
    v_mov_b32 v57, 0
    v_mov_b32 v58, 0
    v_mov_b32 v59, 0
    v_mov_b32 v120, 0
    v_mov_b32 v121, 0
    v_mov_b32 v122, 0
    v_mov_b32 v123, 0
    v_mov_b32 v124, 0
    v_mov_b32 v125, 0
    v_mov_b32 v126, 0
    v_mov_b32 v127, 0
    ds_read_b128 v[128:131], v168 offset:0
    ds_read_b128 v[132:135], v168 offset:1024
    ds_read_b128 v[136:139], v168 offset:2048
    ds_read_b128 v[140:143], v168 offset:3072
    ds_read_b128 v[144:147], v168 offset:8192
    ds_read_b128 v[148:151], v168 offset:9216
    ds_read_b128 v[152:155], v168 offset:10240
    ds_read_b128 v[156:159], v168 offset:11264
    s_waitcnt vmcnt(0)
    s_mov_b64 exec, 1
    global_store_dword v185, v186, s[42:43] sc1
    s_mov_b64 exec, -1
    s_add_u32 s20, s20, 3
    s_cmp_ge_u32 s20, 63
    s_cbranch_scc1 Lexitc_28
    s_add_u32 s8, s8, 0x6000
    s_addc_u32 s9, s9, 0
    s_barrier
    s_branch Luloop_55
Lrole_h_30:
    v_and_b32 v1, 63, v0
    v_lshlrev_b32 v1, 4, v1
    v_mov_b32 v2, 0
    s_sub_u32 s22, s22, 30
    s_mov_b32 s20, s23
    s_mov_b32 s21, 2097152
    s_sub_u32 s19, 4, s22
    s_add_u32 s25, s22, s23
    s_mov_b32 s18, s25
    s_add_u32 s76, s4, 0x7907000
    s_addc_u32 s77, s5, 0
    v_mbcnt_lo_u32_b32 v8, -1, 0
    v_mbcnt_hi_u32_b32 v8, -1, v8
    v_lshlrev_b32 v8, 7, v8
    s_mov_b32 s78, 1048576
    s_mov_b32 exec_lo, 0xff
    s_mov_b32 exec_hi, 0x0
Lwf_76:
    global_load_dword v9, v8, s[76:77] sc1
    s_sub_u32 s78, s78, 1
    s_cmp_eq_u32 s78, 0
    s_cbranch_scc1 Lexitc_28
    s_waitcnt vmcnt(0)
    v_cmp_ne_u32 vcc, 32, v9
    s_cbranch_vccz Lwfd_77
    s_sleep 4
    s_branch Lwf_76
Lwfd_77:
    s_mov_b64 exec, -1
    s_add_u32 s76, s4, 0x7900000
    s_addc_u32 s77, s5, 0
    v_mbcnt_lo_u32_b32 v8, -1, 0
    v_mbcnt_hi_u32_b32 v8, -1, v8
    v_lshlrev_b32 v8, 7, v8
    s_mov_b32 s78, 1048576
    s_mov_b32 exec_lo, 0x3
    s_mov_b32 exec_hi, 0x0
Lwf_78:
    global_load_dword v9, v8, s[76:77] sc1
    s_sub_u32 s78, s78, 1
    s_cmp_eq_u32 s78, 0
    s_cbranch_scc1 Lexitc_28
    s_waitcnt vmcnt(0)
    v_cmp_ne_u32 vcc, 112, v9
    s_cbranch_vccz Lwfd_79
    s_sleep 4
    s_branch Lwf_78
Lwfd_79:
    s_mov_b64 exec, -1
    s_cmp_eq_u32 s18, 4
    s_cbranch_scc1 Lhpub_75
Lhloop_80:
    s_cmp_lt_u32 s20, 4
    s_cbranch_scc1 Lhgo_81
    s_lshl_b32 s25, s20, 13
    s_add_u32 s25, s25, 0x5ffa000
    s_add_u32 s8, s4, s25
    s_addc_u32 s9, s5, 0
Lhpoll_82:
    global_load_dword v3, v2, s[8:9] sc1
    s_sub_u32 s21, s21, 1
    s_cmp_eq_u32 s21, 0
    s_cbranch_scc1 Lexitc_28
    s_waitcnt vmcnt(0)
    v_cmp_ne_u32 vcc, -1, v3
    s_cbranch_vccnz Lhgo_81
    s_sleep 6
    s_branch Lhpoll_82
Lhgo_81:
    s_sub_u32 s25, s20, 12
    s_cmp_ge_u32 s25, 4
    s_cbranch_scc1 Llate_83
    s_add_u32 s76, s4, 0x7900100
    s_addc_u32 s77, s5, 0
    v_mbcnt_lo_u32_b32 v8, -1, 0
    v_mbcnt_hi_u32_b32 v8, -1, v8
    v_lshlrev_b32 v8, 7, v8
    s_mov_b32 s78, 1048576
    s_mov_b32 exec_lo, 0x3f
    s_mov_b32 exec_hi, 0x0
Lwf_84:
    global_load_dword v9, v8, s[76:77] sc1
    s_sub_u32 s78, s78, 1
    s_cmp_eq_u32 s78, 0
    s_cbranch_scc1 Lexitc_28
    s_waitcnt vmcnt(0)
    v_cmp_ne_u32 vcc, 28, v9
    s_cbranch_vccz Lwfd_85
    s_sleep 4
    s_branch Lwf_84
Lwfd_85:
    s_mov_b64 exec, -1
Llate_83:
    s_cmp_eq_u32 s22, 0
    s_cbranch_scc0 Lh1_86
    s_mul_i32 s25, s20, 28672
    s_add_u32 s25, s25, 0x0
    s_add_u32 s12, s4, s25
    s_addc_u32 s13, s5, 0
    v_mov_b32 v5, v1
    global_load_dwordx4 v[8:11], v5, s[12:13] offset:0
    global_load_dwordx4 v[12:15], v5, s[12:13] offset:1024
    global_load_dwordx4 v[16:19], v5, s[12:13] offset:2048
    global_load_dwordx4 v[20:23], v5, s[12:13] offset:3072
    v_add_u32 v5, 4096, v5
    global_load_dwordx4 v[24:27], v5, s[12:13] offset:0
    global_load_dwordx4 v[28:31], v5, s[12:13] offset:1024
    global_load_dwordx4 v[32:35], v5, s[12:13] offset:2048
    global_load_dwordx4 v[36:39], v5, s[12:13] offset:3072
    v_add_u32 v5, 4096, v5
    global_load_dwordx4 v[40:43], v5, s[12:13] offset:0
    global_load_dwordx4 v[44:47], v5, s[12:13] offset:1024
    global_load_dwordx4 v[48:51], v5, s[12:13] offset:2048
    global_load_dwordx4 v[52:55], v5, s[12:13] offset:3072
    v_add_u32 v5, 4096, v5
    global_load_dwordx4 v[56:59], v5, s[12:13] offset:0
    global_load_dwordx4 v[60:63], v5, s[12:13] offset:1024
    global_load_dwordx4 v[64:67], v5, s[12:13] offset:2048
    global_load_dwordx4 v[68:71], v5, s[12:13] offset:3072
    v_add_u32 v5, 4096, v5
    global_load_dwordx4 v[8:11], v5, s[12:13] offset:0
    global_load_dwordx4 v[12:15], v5, s[12:13] offset:1024
    global_load_dwordx4 v[16:19], v5, s[12:13] offset:2048
    global_load_dwordx4 v[20:23], v5, s[12:13] offset:3072
    v_add_u32 v5, 4096, v5
    global_load_dwordx4 v[24:27], v5, s[12:13] offset:0
    global_load_dwordx4 v[28:31], v5, s[12:13] offset:1024
    global_load_dwordx4 v[32:35], v5, s[12:13] offset:2048
    global_load_dwordx4 v[36:39], v5, s[12:13] offset:3072
    v_add_u32 v5, 4096, v5
    global_load_dwordx4 v[40:43], v5, s[12:13] offset:0
    global_load_dwordx4 v[44:47], v5, s[12:13] offset:1024
    global_load_dwordx4 v[48:51], v5, s[12:13] offset:2048
    global_load_dwordx4 v[52:55], v5, s[12:13] offset:3072
    v_add_u32 v5, 4096, v5
    s_branch Lh2_87
Lh1_86:
    s_lshl_b32 s25, s20, 14
    s_add_u32 s25, s25, 0x6100000
    s_add_u32 s12, s4, s25
    s_addc_u32 s13, s5, 0
    v_mov_b32 v5, v1
    global_load_dwordx4 v[8:11], v5, s[12:13] offset:0 sc1
    global_load_dwordx4 v[12:15], v5, s[12:13] offset:1024 sc1
    global_load_dwordx4 v[16:19], v5, s[12:13] offset:2048 sc1
    global_load_dwordx4 v[20:23], v5, s[12:13] offset:3072 sc1
    v_add_u32 v5, 4096, v5
    global_load_dwordx4 v[24:27], v5, s[12:13] offset:0 sc1
    global_load_dwordx4 v[28:31], v5, s[12:13] offset:1024 sc1
    global_load_dwordx4 v[32:35], v5, s[12:13] offset:2048 sc1
    global_load_dwordx4 v[36:39], v5, s[12:13] offset:3072 sc1
    v_add_u32 v5, 4096, v5
    global_load_dwordx4 v[40:43], v5, s[12:13] offset:0 sc1
    global_load_dwordx4 v[44:47], v5, s[12:13] offset:1024 sc1
    global_load_dwordx4 v[48:51], v5, s[12:13] offset:2048 sc1
    global_load_dwordx4 v[52:55], v5, s[12:13] offset:3072 sc1
    v_add_u32 v5, 4096, v5
    s_lshl_b32 s25, s20, 13
    s_add_u32 s25, s25, 0x6002000
    s_add_u32 s12, s4, s25
    s_addc_u32 s13, s5, 0
    v_mov_b32 v5, v1
    global_load_dwordx4 v[8:11], v5, s[12:13] offset:0 sc1
    global_load_dwordx4 v[12:15], v5, s[12:13] offset:1024 sc1
    global_load_dwordx4 v[16:19], v5, s[12:13] offset:2048 sc1
    global_load_dwordx4 v[20:23], v5, s[12:13] offset:3072 sc1
    v_add_u32 v5, 4096, v5
    global_load_dwordx4 v[24:27], v5, s[12:13] offset:0 sc1
    global_load_dwordx4 v[28:31], v5, s[12:13] offset:1024 sc1
    global_load_dwordx4 v[32:35], v5, s[12:13] offset:2048 sc1
Lh2_87:
    s_mul_i32 s25, s20, 458752
    s_mul_i32 s26, s22, 49152
    s_add_u32 s25, s25, s26
    s_add_u32 s25, s25, 0x4000000
    s_add_u32 s12, s4, s25
    s_addc_u32 s13, s5, 0
    v_mov_b32 v5, v1
    global_load_dwordx4 v[8:11], v5, s[12:13] offset:0
    global_load_dwordx4 v[12:15], v5, s[12:13] offset:1024
    global_load_dwordx4 v[16:19], v5, s[12:13] offset:2048
    global_load_dwordx4 v[20:23], v5, s[12:13] offset:3072
    v_add_u32 v5, 4096, v5
    global_load_dwordx4 v[24:27], v5, s[12:13] offset:0
    global_load_dwordx4 v[28:31], v5, s[12:13] offset:1024
    global_load_dwordx4 v[32:35], v5, s[12:13] offset:2048
    global_load_dwordx4 v[36:39], v5, s[12:13] offset:3072
    v_add_u32 v5, 4096, v5
    global_load_dwordx4 v[40:43], v5, s[12:13] offset:0
    global_load_dwordx4 v[44:47], v5, s[12:13] offset:1024
    global_load_dwordx4 v[48:51], v5, s[12:13] offset:2048
    global_load_dwordx4 v[52:55], v5, s[12:13] offset:3072
    v_add_u32 v5, 4096, v5
    global_load_dwordx4 v[56:59], v5, s[12:13] offset:0
    global_load_dwordx4 v[60:63], v5, s[12:13] offset:1024
    global_load_dwordx4 v[64:67], v5, s[12:13] offset:2048
    global_load_dwordx4 v[68:71], v5, s[12:13] offset:3072
    v_add_u32 v5, 4096, v5
    global_load_dwordx4 v[8:11], v5, s[12:13] offset:0
    global_load_dwordx4 v[12:15], v5, s[12:13] offset:1024
    global_load_dwordx4 v[16:19], v5, s[12:13] offset:2048
    global_load_dwordx4 v[20:23], v5, s[12:13] offset:3072
    v_add_u32 v5, 4096, v5
    global_load_dwordx4 v[24:27], v5, s[12:13] offset:0
    global_load_dwordx4 v[28:31], v5, s[12:13] offset:1024
    global_load_dwordx4 v[32:35], v5, s[12:13] offset:2048
    global_load_dwordx4 v[36:39], v5, s[12:13] offset:3072
    v_add_u32 v5, 4096, v5
    global_load_dwordx4 v[40:43], v5, s[12:13] offset:0
    global_load_dwordx4 v[44:47], v5, s[12:13] offset:1024
    global_load_dwordx4 v[48:51], v5, s[12:13] offset:2048
    global_load_dwordx4 v[52:55], v5, s[12:13] offset:3072
    v_add_u32 v5, 4096, v5
    global_load_dwordx4 v[56:59], v5, s[12:13] offset:0
    global_load_dwordx4 v[60:63], v5, s[12:13] offset:1024
    global_load_dwordx4 v[64:67], v5, s[12:13] offset:2048
    global_load_dwordx4 v[68:71], v5, s[12:13] offset:3072
    v_add_u32 v5, 4096, v5
    global_load_dwordx4 v[8:11], v5, s[12:13] offset:0
    global_load_dwordx4 v[12:15], v5, s[12:13] offset:1024
    global_load_dwordx4 v[16:19], v5, s[12:13] offset:2048
    global_load_dwordx4 v[20:23], v5, s[12:13] offset:3072
    v_add_u32 v5, 4096, v5
    global_load_dwordx4 v[24:27], v5, s[12:13] offset:0
    global_load_dwordx4 v[28:31], v5, s[12:13] offset:1024
    global_load_dwordx4 v[32:35], v5, s[12:13] offset:2048
    global_load_dwordx4 v[36:39], v5, s[12:13] offset:3072
    v_add_u32 v5, 4096, v5
    global_load_dwordx4 v[40:43], v5, s[12:13] offset:0
    global_load_dwordx4 v[44:47], v5, s[12:13] offset:1024
    global_load_dwordx4 v[48:51], v5, s[12:13] offset:2048
    global_load_dwordx4 v[52:55], v5, s[12:13] offset:3072
    v_add_u32 v5, 4096, v5
    global_load_dwordx4 v[56:59], v5, s[12:13] offset:0
    global_load_dwordx4 v[60:63], v5, s[12:13] offset:1024
    global_load_dwordx4 v[64:67], v5, s[12:13] offset:2048
    global_load_dwordx4 v[68:71], v5, s[12:13] offset:3072
    v_add_u32 v5, 4096, v5
    s_add_u32 s20, s20, s19
    s_cmp_lt_u32 s20, 63
    s_cbranch_scc1 Lhloop_80
    s_branch Lexitc_28
Lhpub_75:
    s_add_u32 s8, s4, 0x6002000
    s_addc_u32 s9, s5, 0
    s_add_u32 s10, s4, 0x6302000
    s_addc_u32 s11, s5, 0
    v_add_u32 v4, 4096, v1
    s_mov_b32 s20, 1
Lhpl_88:
    global_load_dwordx4 v[8:11], v1, s[8:9] offset:0 sc1
    global_load_dwordx4 v[12:15], v1, s[8:9] offset:1024 sc1
    global_load_dwordx4 v[16:19], v1, s[8:9] offset:2048 sc1
    global_load_dwordx4 v[20:23], v1, s[8:9] offset:3072 sc1
    global_load_dwordx4 v[24:27], v4, s[8:9] offset:0 sc1
    global_load_dwordx4 v[28:31], v4, s[8:9] offset:1024 sc1
    global_load_dwordx4 v[32:35], v4, s[8:9] offset:2048 sc1
    s_sub_u32 s21, s21, 1
    s_cmp_eq_u32 s21, 0
    s_cbranch_scc1 Lexitc_28
    s_waitcnt vmcnt(0)
    v_max3_u32 v3, v8, v9, v10
    v_max3_u32 v3, v3, v11, v12
    v_max3_u32 v3, v3, v13, v14
    v_max3_u32 v3, v3, v15, v16
    v_max3_u32 v3, v3, v17, v18
    v_max3_u32 v3, v3, v19, v20
    v_max3_u32 v3, v3, v21, v22
    v_max3_u32 v3, v3, v23, v24
    v_max3_u32 v3, v3, v25, v26
    v_max3_u32 v3, v3, v27, v28
    v_max3_u32 v3, v3, v29, v30
    v_max3_u32 v3, v3, v31, v32
    v_max3_u32 v3, v3, v33, v34
    v_max_u32 v3, v3, v35
    v_cmp_eq_u32 vcc, -1, v3
    s_cbranch_vccz Lhpk_89
    s_sleep 5
    s_branch Lhpl_88
Lhpk_89:
    global_store_dwordx4 v1, v[8:11], s[10:11] offset:0 sc1
    global_store_dwordx4 v1, v[12:15], s[10:11] offset:1024 sc1
    global_store_dwordx4 v1, v[16:19], s[10:11] offset:2048 sc1
    global_store_dwordx4 v1, v[20:23], s[10:11] offset:3072 sc1
    global_store_dwordx4 v4, v[24:27], s[10:11] offset:0 sc1
    global_store_dwordx4 v4, v[28:31], s[10:11] offset:1024 sc1
    global_store_dwordx4 v4, v[32:35], s[10:11] offset:2048 sc1
    s_add_u32 s8, s8, 0x2000
    s_addc_u32 s9, s9, 0
    s_add_u32 s10, s10, 0x2000
    s_addc_u32 s11, s11, 0
    s_add_u32 s20, s20, 1
    s_sleep 16
    s_cmp_le_u32 s20, 63
    s_cbranch_scc1 Lhpl_88
    s_branch Lexitc_28
Lexitc_28:
    s_waitcnt vmcnt(0)
    s_endpgm
Lworker_27:
    s_cmp_ge_u32 s72, 224
    s_cbranch_scc1 Lexitc_28
    s_and_b32 s73, s72, 1
    s_lshr_b32 s74, s72, 1
    s_mul_i32 s20, s74, 9363
    s_lshr_b32 s20, s20, 16
    s_waitcnt vmcnt(0)
    s_cmp_lg_u32 s23, 0
    s_cbranch_scc1 Lwo_90
    s_lshl_b32 s25, s20, 7
    s_add_u32 s25, s25, 0x7906800
    s_add_u32 s76, s4, s25
    s_addc_u32 s77, s5, 0
    v_mbcnt_lo_u32_b32 v8, -1, 0
    v_mbcnt_hi_u32_b32 v8, -1, v8
    v_lshlrev_b32 v8, 2, v8
    s_mov_b32 s78, 1048576
    s_mov_b32 exec_lo, 0x1
    s_mov_b32 exec_hi, 0x0
Lwf_91:
    global_load_dword v9, v8, s[76:77] sc1
    s_sub_u32 s78, s78, 1
    s_cmp_eq_u32 s78, 0
    s_cbranch_scc1 Lexitc_28
    s_waitcnt vmcnt(0)
    v_cmp_ne_u32 vcc, 8, v9
    s_cbranch_vccz Lwfd_92
    s_sleep 4
    s_branch Lwf_91
Lwfd_92:
    s_mov_b64 exec, -1
Lwo_90:
    s_barrier
    s_waitcnt vmcnt(0)
    s_cmp_lg_u32 s23, 0
    s_cbranch_scc1 Lwo_93
    s_lshl_b32 s25, s73, 7
    s_add_u32 s25, s25, 0x7907000
    s_add_u32 s76, s4, s25
    s_addc_u32 s77, s5, 0
    v_mbcnt_lo_u32_b32 v8, -1, 0
    v_mbcnt_hi_u32_b32 v8, -1, v8
    v_lshlrev_b32 v8, 2, v8
    s_mov_b32 s78, 1048576
    s_mov_b32 exec_lo, 0x1
    s_mov_b32 exec_hi, 0x0
Lwf_94:
    global_load_dword v9, v8, s[76:77] sc1
    s_sub_u32 s78, s78, 1
    s_cmp_eq_u32 s78, 0
    s_cbranch_scc1 Lexitc_28
    s_waitcnt vmcnt(0)
    v_cmp_ne_u32 vcc, 32, v9
    s_cbranch_vccz Lwfd_95
    s_sleep 4
    s_branch Lwf_94
Lwfd_95:
    s_mov_b64 exec, -1
Lwo_93:
    s_barrier
    v_and_b32 v1, 63, v0
    v_lshlrev_b32 v2, 4, v1
    v_lshlrev_b32 v3, 4, v1
    v_add_u32 v3, 4096, v3
    v_lshlrev_b32 v4, 4, v1
    v_add_u32 v4, 8192, v4
    v_lshlrev_b32 v5, 4, v1
    v_add_u32 v5, 12288, v5
    v_and_b32 v14, 3, v1
    v_bfe_u32 v15, v1, 2, 1
    v_lshl_add_u32 v14, v15, 3, v14
    v_lshrrev_b32 v15, 4, v1
    v_lshl_add_u32 v14, v15, 4, v14
    v_lshlrev_b32 v14, 4, v14
    v_bfe_u32 v15, v1, 3, 1
    v_mul_u32_u24 v15, 14336, v15
    v_add_u32 v14, v14, v15
    v_add_u32 v6, 0, v2
    v_add_u32 v9, 0, v14
    v_add_u32 v7, 57344, v2
    v_add_u32 v10, 57344, v14
    v_add_u32 v8, 114688, v2
    v_add_u32 v11, 114688, v14
    s_mul_i32 s39, s23, 7168
    v_add_u32 v12, s39, v2
    v_add_u32 v13, 4096, v12
    s_lshl_b32 s28, s73, 4
    s_lshl_b32 s29, s23, 2
    s_add_u32 s28, s28, s29
    s_mul_i32 s25, s74, 57344
    s_add_u32 s25, s25, 0xa20000
    s_add_u32 s30, s4, s25
    s_addc_u32 s31, s5, 0
    s_lshr_b32 s25, s28, 1
    s_mul_i32 s25, s25, 458752
    s_mul_i32 s26, s74, 4096
    s_add_u32 s25, s25, s26
    s_add_u32 s25, s25, 0x4000000
    s_add_u32 s34, s4, s25
    s_addc_u32 s35, s5, 0
    s_add_u32 s36, s34, 0x70000
    s_addc_u32 s37, s35, 0
    s_barrier
    s_add_u32 m0, s39, 0
    s_nop 0
    global_load_lds_dwordx4 v12, s[30:31] offset:0 sc1
    s_add_u32 m0, s39, 0
    s_nop 0
    global_load_lds_dwordx4 v12, s[30:31] offset:1024 sc1
    s_add_u32 m0, s39, 0
    s_nop 0
    global_load_lds_dwordx4 v12, s[30:31] offset:2048 sc1
    s_add_u32 m0, s39, 0
    s_nop 0
    global_load_lds_dwordx4 v12, s[30:31] offset:3072 sc1
    s_add_u32 m0, s39, 4096
    s_nop 0
    global_load_lds_dwordx4 v13, s[30:31] offset:0 sc1
    s_add_u32 m0, s39, 4096
    s_nop 0
    global_load_lds_dwordx4 v13, s[30:31] offset:1024 sc1
    s_add_u32 m0, s39, 4096
    s_nop 0
    global_load_lds_dwordx4 v13, s[30:31] offset:2048 sc1
    s_add_u32 s30, s30, 0x7000
    s_addc_u32 s31, s31, 0
    s_lshl_b32 s25, s73, 4
    s_lshl_b32 s26, s23, 2
    s_add_u32 s25, s25, s26
    s_mul_i32 s26, s25, 14336
    s_add_u32 s26, s26, 0x200000
    s_add_u32 s80, s4, s26
    s_addc_u32 s81, s5, 0
    s_add_u32 s82, s80, 0x3800
    s_addc_u32 s83, s81, 0
    s_add_u32 s84, s82, 0x3800
    s_addc_u32 s85, s83, 0
    s_add_u32 s86, s84, 0x3800
    s_addc_u32 s87, s85, 0
    global_load_dwordx4 a[0:3], v2, s[80:81] offset:0 sc1
    global_load_dwordx4 a[56:59], v2, s[82:83] offset:0 sc1
    global_load_dwordx4 a[112:115], v2, s[84:85] offset:0 sc1
    global_load_dwordx4 a[168:171], v2, s[86:87] offset:0 sc1
    global_load_dwordx4 a[4:7], v2, s[80:81] offset:1024 sc1
    global_load_dwordx4 a[60:63], v2, s[82:83] offset:1024 sc1
    global_load_dwordx4 a[116:119], v2, s[84:85] offset:1024 sc1
    global_load_dwordx4 a[172:175], v2, s[86:87] offset:1024 sc1
    global_load_dwordx4 a[8:11], v2, s[80:81] offset:2048 sc1
    global_load_dwordx4 a[64:67], v2, s[82:83] offset:2048 sc1
    global_load_dwordx4 a[120:123], v2, s[84:85] offset:2048 sc1
    global_load_dwordx4 a[176:179], v2, s[86:87] offset:2048 sc1
    global_load_dwordx4 a[12:15], v2, s[80:81] offset:3072 sc1
    global_load_dwordx4 a[68:71], v2, s[82:83] offset:3072 sc1
    global_load_dwordx4 a[124:127], v2, s[84:85] offset:3072 sc1
    global_load_dwordx4 a[180:183], v2, s[86:87] offset:3072 sc1
    global_load_dwordx4 a[16:19], v3, s[80:81] offset:0 sc1
    global_load_dwordx4 a[72:75], v3, s[82:83] offset:0 sc1
    global_load_dwordx4 a[128:131], v3, s[84:85] offset:0 sc1
    global_load_dwordx4 a[184:187], v3, s[86:87] offset:0 sc1
    global_load_dwordx4 a[20:23], v3, s[80:81] offset:1024 sc1
    global_load_dwordx4 a[76:79], v3, s[82:83] offset:1024 sc1
    global_load_dwordx4 a[132:135], v3, s[84:85] offset:1024 sc1
    global_load_dwordx4 a[188:191], v3, s[86:87] offset:1024 sc1
    global_load_dwordx4 a[24:27], v3, s[80:81] offset:2048 sc1
    global_load_dwordx4 a[80:83], v3, s[82:83] offset:2048 sc1
    global_load_dwordx4 a[136:139], v3, s[84:85] offset:2048 sc1
    global_load_dwordx4 a[192:195], v3, s[86:87] offset:2048 sc1
    global_load_dwordx4 a[28:31], v3, s[80:81] offset:3072 sc1
    global_load_dwordx4 a[84:87], v3, s[82:83] offset:3072 sc1
    global_load_dwordx4 a[140:143], v3, s[84:85] offset:3072 sc1
    global_load_dwordx4 a[196:199], v3, s[86:87] offset:3072 sc1
    global_load_dwordx4 a[32:35], v4, s[80:81] offset:0 sc1
    global_load_dwordx4 a[88:91], v4, s[82:83] offset:0 sc1
    global_load_dwordx4 a[144:147], v4, s[84:85] offset:0 sc1
    global_load_dwordx4 a[200:203], v4, s[86:87] offset:0 sc1
    global_load_dwordx4 a[36:39], v4, s[80:81] offset:1024 sc1
    global_load_dwordx4 a[92:95], v4, s[82:83] offset:1024 sc1
    global_load_dwordx4 a[148:151], v4, s[84:85] offset:1024 sc1
    global_load_dwordx4 a[204:207], v4, s[86:87] offset:1024 sc1
    global_load_dwordx4 a[40:43], v4, s[80:81] offset:2048 sc1
    global_load_dwordx4 a[96:99], v4, s[82:83] offset:2048 sc1
    global_load_dwordx4 a[152:155], v4, s[84:85] offset:2048 sc1
    global_load_dwordx4 a[208:211], v4, s[86:87] offset:2048 sc1
    global_load_dwordx4 a[44:47], v4, s[80:81] offset:3072 sc1
    global_load_dwordx4 a[100:103], v4, s[82:83] offset:3072 sc1
    global_load_dwordx4 a[156:159], v4, s[84:85] offset:3072 sc1
    global_load_dwordx4 a[212:215], v4, s[86:87] offset:3072 sc1
    global_load_dwordx4 a[48:51], v5, s[80:81] offset:0 sc1
    global_load_dwordx4 a[104:107], v5, s[82:83] offset:0 sc1
    global_load_dwordx4 a[160:163], v5, s[84:85] offset:0 sc1
    global_load_dwordx4 a[216:219], v5, s[86:87] offset:0 sc1
    global_load_dwordx4 a[52:55], v5, s[80:81] offset:1024 sc1
    global_load_dwordx4 a[108:111], v5, s[82:83] offset:1024 sc1
    global_load_dwordx4 a[164:167], v5, s[84:85] offset:1024 sc1
    global_load_dwordx4 a[220:223], v5, s[86:87] offset:1024 sc1
    s_add_u32 m0, s39, 28672
    s_nop 0
    global_load_lds_dwordx4 v12, s[30:31] offset:0 sc1
    s_add_u32 m0, s39, 28672
    s_nop 0
    global_load_lds_dwordx4 v12, s[30:31] offset:1024 sc1
    s_add_u32 m0, s39, 28672
    s_nop 0
    global_load_lds_dwordx4 v12, s[30:31] offset:2048 sc1
    s_add_u32 m0, s39, 28672
    s_nop 0
    global_load_lds_dwordx4 v12, s[30:31] offset:3072 sc1
    s_add_u32 m0, s39, 32768
    s_nop 0
    global_load_lds_dwordx4 v13, s[30:31] offset:0 sc1
    s_add_u32 m0, s39, 32768
    s_nop 0
    global_load_lds_dwordx4 v13, s[30:31] offset:1024 sc1
    s_add_u32 m0, s39, 32768
    s_nop 0
    global_load_lds_dwordx4 v13, s[30:31] offset:2048 sc1
    s_add_u32 s30, s30, 0x7000
    s_addc_u32 s31, s31, 0
    s_waitcnt vmcnt(63)
    s_barrier
    ds_read_b128 v[24:27], v6 offset:0
    ds_read_b128 v[28:31], v6 offset:1024
    ds_read_b128 v[32:35], v6 offset:2048
    ds_read_b128 v[36:39], v6 offset:3072
    ds_read_b128 v[40:43], v6 offset:4096
    ds_read_b128 v[44:47], v6 offset:5120
    ds_read_b128 v[48:51], v6 offset:6144
    ds_read_b128 v[52:55], v6 offset:7168
    ds_read_b128 v[56:59], v6 offset:8192
    ds_read_b128 v[60:63], v6 offset:9216
    ds_read_b128 v[64:67], v6 offset:10240
    ds_read_b128 v[68:71], v6 offset:11264
    ds_read_b128 v[72:75], v6 offset:12288
    ds_read_b128 v[76:79], v6 offset:13312
    s_waitcnt lgkmcnt(0)
    s_waitcnt vmcnt(59)
    v_mfma_f32_16x16x32_bf16 v[192:195], a[0:3], v[24:27], 0
    v_mfma_f32_16x16x32_bf16 v[196:199], a[56:59], v[24:27], 0
    ds_read_b128 v[80:83], v6 offset:14336
    v_mfma_f32_16x16x32_bf16 v[200:203], a[112:115], v[24:27], 0
    v_mfma_f32_16x16x32_bf16 v[204:207], a[168:171], v[24:27], 0
    s_waitcnt vmcnt(55)
    v_mfma_f32_16x16x32_bf16 v[192:195], a[4:7], v[28:31], v[192:195]
    v_mfma_f32_16x16x32_bf16 v[196:199], a[60:63], v[28:31], v[196:199]
    ds_read_b128 v[84:87], v6 offset:15360
    v_mfma_f32_16x16x32_bf16 v[200:203], a[116:119], v[28:31], v[200:203]
    v_mfma_f32_16x16x32_bf16 v[204:207], a[172:175], v[28:31], v[204:207]
    s_waitcnt vmcnt(51)
    v_mfma_f32_16x16x32_bf16 v[192:195], a[8:11], v[32:35], v[192:195]
    v_mfma_f32_16x16x32_bf16 v[196:199], a[64:67], v[32:35], v[196:199]
    ds_read_b128 v[88:91], v6 offset:16384
    v_mfma_f32_16x16x32_bf16 v[200:203], a[120:123], v[32:35], v[200:203]
    v_mfma_f32_16x16x32_bf16 v[204:207], a[176:179], v[32:35], v[204:207]
    s_waitcnt vmcnt(47)
    v_mfma_f32_16x16x32_bf16 v[192:195], a[12:15], v[36:39], v[192:195]
    v_mfma_f32_16x16x32_bf16 v[196:199], a[68:71], v[36:39], v[196:199]
    ds_read_b128 v[92:95], v6 offset:17408
    v_mfma_f32_16x16x32_bf16 v[200:203], a[124:127], v[36:39], v[200:203]
    v_mfma_f32_16x16x32_bf16 v[204:207], a[180:183], v[36:39], v[204:207]
    s_waitcnt vmcnt(43)
    v_mfma_f32_16x16x32_bf16 v[192:195], a[16:19], v[40:43], v[192:195]
    v_mfma_f32_16x16x32_bf16 v[196:199], a[72:75], v[40:43], v[196:199]
    ds_read_b128 v[96:99], v6 offset:18432
    v_mfma_f32_16x16x32_bf16 v[200:203], a[128:131], v[40:43], v[200:203]
    v_mfma_f32_16x16x32_bf16 v[204:207], a[184:187], v[40:43], v[204:207]
    s_waitcnt vmcnt(39)
    v_mfma_f32_16x16x32_bf16 v[192:195], a[20:23], v[44:47], v[192:195]
    v_mfma_f32_16x16x32_bf16 v[196:199], a[76:79], v[44:47], v[196:199]
    ds_read_b128 v[100:103], v6 offset:19456
    v_mfma_f32_16x16x32_bf16 v[200:203], a[132:135], v[44:47], v[200:203]
    v_mfma_f32_16x16x32_bf16 v[204:207], a[188:191], v[44:47], v[204:207]
    s_waitcnt vmcnt(35)
    v_mfma_f32_16x16x32_bf16 v[192:195], a[24:27], v[48:51], v[192:195]
    v_mfma_f32_16x16x32_bf16 v[196:199], a[80:83], v[48:51], v[196:199]
    ds_read_b128 v[104:107], v6 offset:20480
    v_mfma_f32_16x16x32_bf16 v[200:203], a[136:139], v[48:51], v[200:203]
    v_mfma_f32_16x16x32_bf16 v[204:207], a[192:195], v[48:51], v[204:207]
    s_waitcnt vmcnt(31)
    v_mfma_f32_16x16x32_bf16 v[192:195], a[28:31], v[52:55], v[192:195]
    v_mfma_f32_16x16x32_bf16 v[196:199], a[84:87], v[52:55], v[196:199]
    ds_read_b128 v[108:111], v6 offset:21504
    v_mfma_f32_16x16x32_bf16 v[200:203], a[140:143], v[52:55], v[200:203]
    v_mfma_f32_16x16x32_bf16 v[204:207], a[196:199], v[52:55], v[204:207]
    s_waitcnt vmcnt(27)
    v_mfma_f32_16x16x32_bf16 v[192:195], a[32:35], v[56:59], v[192:195]
    v_mfma_f32_16x16x32_bf16 v[196:199], a[88:91], v[56:59], v[196:199]
    ds_read_b128 v[112:115], v6 offset:22528
    v_mfma_f32_16x16x32_bf16 v[200:203], a[144:147], v[56:59], v[200:203]
    v_mfma_f32_16x16x32_bf16 v[204:207], a[200:203], v[56:59], v[204:207]
    s_waitcnt vmcnt(23)
    v_mfma_f32_16x16x32_bf16 v[192:195], a[36:39], v[60:63], v[192:195]
    v_mfma_f32_16x16x32_bf16 v[196:199], a[92:95], v[60:63], v[196:199]
    ds_read_b128 v[116:119], v6 offset:23552
    v_mfma_f32_16x16x32_bf16 v[200:203], a[148:151], v[60:63], v[200:203]
    v_mfma_f32_16x16x32_bf16 v[204:207], a[204:207], v[60:63], v[204:207]
    s_waitcnt vmcnt(19)
    v_mfma_f32_16x16x32_bf16 v[192:195], a[40:43], v[64:67], v[192:195]
    v_mfma_f32_16x16x32_bf16 v[196:199], a[96:99], v[64:67], v[196:199]
    ds_read_b128 v[120:123], v6 offset:24576
    v_mfma_f32_16x16x32_bf16 v[200:203], a[152:155], v[64:67], v[200:203]
    v_mfma_f32_16x16x32_bf16 v[204:207], a[208:211], v[64:67], v[204:207]
    s_waitcnt vmcnt(15)
    v_mfma_f32_16x16x32_bf16 v[192:195], a[44:47], v[68:71], v[192:195]
    v_mfma_f32_16x16x32_bf16 v[196:199], a[100:103], v[68:71], v[196:199]
    ds_read_b128 v[124:127], v6 offset:25600
    v_mfma_f32_16x16x32_bf16 v[200:203], a[156:159], v[68:71], v[200:203]
    v_mfma_f32_16x16x32_bf16 v[204:207], a[212:215], v[68:71], v[204:207]
    s_waitcnt vmcnt(11)
    v_mfma_f32_16x16x32_bf16 v[192:195], a[48:51], v[72:75], v[192:195]
    v_mfma_f32_16x16x32_bf16 v[196:199], a[104:107], v[72:75], v[196:199]
    ds_read_b128 v[128:131], v6 offset:26624
    v_mfma_f32_16x16x32_bf16 v[200:203], a[160:163], v[72:75], v[200:203]
    v_mfma_f32_16x16x32_bf16 v[204:207], a[216:219], v[72:75], v[204:207]
    s_waitcnt vmcnt(7)
    v_mfma_f32_16x16x32_bf16 v[192:195], a[52:55], v[76:79], v[192:195]
    v_mfma_f32_16x16x32_bf16 v[196:199], a[108:111], v[76:79], v[196:199]
    ds_read_b128 v[132:135], v6 offset:27648
    v_mfma_f32_16x16x32_bf16 v[200:203], a[164:167], v[76:79], v[200:203]
    v_mfma_f32_16x16x32_bf16 v[204:207], a[220:223], v[76:79], v[204:207]
    s_nop 7
    v_cvt_pk_bf16_f32 v208, v192, v193
    v_cvt_pk_bf16_f32 v209, v194, v195
    v_cvt_pk_bf16_f32 v210, v196, v197
    v_cvt_pk_bf16_f32 v211, v198, v199
    global_store_dwordx4 v2, v[208:211], s[34:35] offset:0 sc1
    v_cvt_pk_bf16_f32 v212, v200, v201
    v_cvt_pk_bf16_f32 v213, v202, v203
    v_cvt_pk_bf16_f32 v214, v204, v205
    v_cvt_pk_bf16_f32 v215, v206, v207
    global_store_dwordx4 v2, v[212:215], s[36:37] offset:0 sc1
    s_waitcnt lgkmcnt(0)
    s_waitcnt vmcnt(2)
    s_barrier
    v_mfma_f32_16x16x32_bf16 v[192:195], a[0:3], v[80:83], 0
    v_mfma_f32_16x16x32_bf16 v[196:199], a[56:59], v[80:83], 0
    ds_read_b128 v[136:139], v6 offset:28672
    v_mfma_f32_16x16x32_bf16 v[200:203], a[112:115], v[80:83], 0
    v_mfma_f32_16x16x32_bf16 v[204:207], a[168:171], v[80:83], 0
    v_mfma_f32_16x16x32_bf16 v[192:195], a[4:7], v[84:87], v[192:195]
    v_mfma_f32_16x16x32_bf16 v[196:199], a[60:63], v[84:87], v[196:199]
    ds_read_b128 v[140:143], v6 offset:29696
    v_mfma_f32_16x16x32_bf16 v[200:203], a[116:119], v[84:87], v[200:203]
    v_mfma_f32_16x16x32_bf16 v[204:207], a[172:175], v[84:87], v[204:207]
    v_mfma_f32_16x16x32_bf16 v[192:195], a[8:11], v[88:91], v[192:195]
    v_mfma_f32_16x16x32_bf16 v[196:199], a[64:67], v[88:91], v[196:199]
    ds_read_b128 v[144:147], v6 offset:30720
    v_mfma_f32_16x16x32_bf16 v[200:203], a[120:123], v[88:91], v[200:203]
    v_mfma_f32_16x16x32_bf16 v[204:207], a[176:179], v[88:91], v[204:207]
    v_mfma_f32_16x16x32_bf16 v[192:195], a[12:15], v[92:95], v[192:195]
    v_mfma_f32_16x16x32_bf16 v[196:199], a[68:71], v[92:95], v[196:199]
    ds_read_b128 v[148:151], v6 offset:31744
    v_mfma_f32_16x16x32_bf16 v[200:203], a[124:127], v[92:95], v[200:203]
    v_mfma_f32_16x16x32_bf16 v[204:207], a[180:183], v[92:95], v[204:207]
    v_mfma_f32_16x16x32_bf16 v[192:195], a[16:19], v[96:99], v[192:195]
    v_mfma_f32_16x16x32_bf16 v[196:199], a[72:75], v[96:99], v[196:199]
    ds_read_b128 v[152:155], v6 offset:32768
    v_mfma_f32_16x16x32_bf16 v[200:203], a[128:131], v[96:99], v[200:203]
    v_mfma_f32_16x16x32_bf16 v[204:207], a[184:187], v[96:99], v[204:207]
    v_mfma_f32_16x16x32_bf16 v[192:195], a[20:23], v[100:103], v[192:195]
    v_mfma_f32_16x16x32_bf16 v[196:199], a[76:79], v[100:103], v[196:199]
    ds_read_b128 v[156:159], v6 offset:33792
    v_mfma_f32_16x16x32_bf16 v[200:203], a[132:135], v[100:103], v[200:203]
    v_mfma_f32_16x16x32_bf16 v[204:207], a[188:191], v[100:103], v[204:207]
    v_mfma_f32_16x16x32_bf16 v[192:195], a[24:27], v[104:107], v[192:195]
    v_mfma_f32_16x16x32_bf16 v[196:199], a[80:83], v[104:107], v[196:199]
    ds_read_b128 v[160:163], v6 offset:34816
    v_mfma_f32_16x16x32_bf16 v[200:203], a[136:139], v[104:107], v[200:203]
    v_mfma_f32_16x16x32_bf16 v[204:207], a[192:195], v[104:107], v[204:207]
    v_mfma_f32_16x16x32_bf16 v[192:195], a[28:31], v[108:111], v[192:195]
    v_mfma_f32_16x16x32_bf16 v[196:199], a[84:87], v[108:111], v[196:199]
    ds_read_b128 v[164:167], v6 offset:35840
    v_mfma_f32_16x16x32_bf16 v[200:203], a[140:143], v[108:111], v[200:203]
    v_mfma_f32_16x16x32_bf16 v[204:207], a[196:199], v[108:111], v[204:207]
    v_mfma_f32_16x16x32_bf16 v[192:195], a[32:35], v[112:115], v[192:195]
    v_mfma_f32_16x16x32_bf16 v[196:199], a[88:91], v[112:115], v[196:199]
    ds_read_b128 v[168:171], v6 offset:36864
    v_mfma_f32_16x16x32_bf16 v[200:203], a[144:147], v[112:115], v[200:203]
    v_mfma_f32_16x16x32_bf16 v[204:207], a[200:203], v[112:115], v[204:207]
    v_mfma_f32_16x16x32_bf16 v[192:195], a[36:39], v[116:119], v[192:195]
    v_mfma_f32_16x16x32_bf16 v[196:199], a[92:95], v[116:119], v[196:199]
    ds_read_b128 v[172:175], v6 offset:37888
    v_mfma_f32_16x16x32_bf16 v[200:203], a[148:151], v[116:119], v[200:203]
    v_mfma_f32_16x16x32_bf16 v[204:207], a[204:207], v[116:119], v[204:207]
    v_mfma_f32_16x16x32_bf16 v[192:195], a[40:43], v[120:123], v[192:195]
    v_mfma_f32_16x16x32_bf16 v[196:199], a[96:99], v[120:123], v[196:199]
    ds_read_b128 v[176:179], v6 offset:38912
    v_mfma_f32_16x16x32_bf16 v[200:203], a[152:155], v[120:123], v[200:203]
    v_mfma_f32_16x16x32_bf16 v[204:207], a[208:211], v[120:123], v[204:207]
    v_mfma_f32_16x16x32_bf16 v[192:195], a[44:47], v[124:127], v[192:195]
    v_mfma_f32_16x16x32_bf16 v[196:199], a[100:103], v[124:127], v[196:199]
    ds_read_b128 v[180:183], v6 offset:39936
    v_mfma_f32_16x16x32_bf16 v[200:203], a[156:159], v[124:127], v[200:203]
    v_mfma_f32_16x16x32_bf16 v[204:207], a[212:215], v[124:127], v[204:207]
    v_mfma_f32_16x16x32_bf16 v[192:195], a[48:51], v[128:131], v[192:195]
    v_mfma_f32_16x16x32_bf16 v[196:199], a[104:107], v[128:131], v[196:199]
    ds_read_b128 v[184:187], v6 offset:40960
    v_mfma_f32_16x16x32_bf16 v[200:203], a[160:163], v[128:131], v[200:203]
    v_mfma_f32_16x16x32_bf16 v[204:207], a[216:219], v[128:131], v[204:207]
    v_mfma_f32_16x16x32_bf16 v[192:195], a[52:55], v[132:135], v[192:195]
    v_mfma_f32_16x16x32_bf16 v[196:199], a[108:111], v[132:135], v[196:199]
    ds_read_b128 v[188:191], v6 offset:41984
    v_mfma_f32_16x16x32_bf16 v[200:203], a[164:167], v[132:135], v[200:203]
    v_mfma_f32_16x16x32_bf16 v[204:207], a[220:223], v[132:135], v[204:207]
    s_nop 7
    v_cvt_pk_bf16_f32 v216, v192, v193
    v_cvt_pk_bf16_f32 v217, v194, v195
    v_cvt_pk_bf16_f32 v218, v196, v197
    v_cvt_pk_bf16_f32 v219, v198, v199
    global_store_dwordx4 v2, v[216:219], s[34:35] offset:1024 sc1
    v_cvt_pk_bf16_f32 v220, v200, v201
    v_cvt_pk_bf16_f32 v221, v202, v203
    v_cvt_pk_bf16_f32 v222, v204, v205
    v_cvt_pk_bf16_f32 v223, v206, v207
    global_store_dwordx4 v2, v[220:223], s[36:37] offset:1024 sc1
    s_waitcnt lgkmcnt(0)
    v_mfma_f32_16x16x32_bf16 v[192:195], a[0:3], v[136:139], 0
    v_mfma_f32_16x16x32_bf16 v[196:199], a[56:59], v[136:139], 0
    ds_read_b128 v[24:27], v6 offset:43008
    v_mfma_f32_16x16x32_bf16 v[200:203], a[112:115], v[136:139], 0
    v_mfma_f32_16x16x32_bf16 v[204:207], a[168:171], v[136:139], 0
    v_mfma_f32_16x16x32_bf16 v[192:195], a[4:7], v[140:143], v[192:195]
    v_mfma_f32_16x16x32_bf16 v[196:199], a[60:63], v[140:143], v[196:199]
    ds_read_b128 v[28:31], v6 offset:44032
    v_mfma_f32_16x16x32_bf16 v[200:203], a[116:119], v[140:143], v[200:203]
    v_mfma_f32_16x16x32_bf16 v[204:207], a[172:175], v[140:143], v[204:207]
    v_mfma_f32_16x16x32_bf16 v[192:195], a[8:11], v[144:147], v[192:195]
    v_mfma_f32_16x16x32_bf16 v[196:199], a[64:67], v[144:147], v[196:199]
    ds_read_b128 v[32:35], v6 offset:45056
    v_mfma_f32_16x16x32_bf16 v[200:203], a[120:123], v[144:147], v[200:203]
    v_mfma_f32_16x16x32_bf16 v[204:207], a[176:179], v[144:147], v[204:207]
    v_mfma_f32_16x16x32_bf16 v[192:195], a[12:15], v[148:151], v[192:195]
    v_mfma_f32_16x16x32_bf16 v[196:199], a[68:71], v[148:151], v[196:199]
    ds_read_b128 v[36:39], v6 offset:46080
    v_mfma_f32_16x16x32_bf16 v[200:203], a[124:127], v[148:151], v[200:203]
    v_mfma_f32_16x16x32_bf16 v[204:207], a[180:183], v[148:151], v[204:207]
    v_mfma_f32_16x16x32_bf16 v[192:195], a[16:19], v[152:155], v[192:195]
    v_mfma_f32_16x16x32_bf16 v[196:199], a[72:75], v[152:155], v[196:199]
    ds_read_b128 v[40:43], v6 offset:47104
    v_mfma_f32_16x16x32_bf16 v[200:203], a[128:131], v[152:155], v[200:203]
    v_mfma_f32_16x16x32_bf16 v[204:207], a[184:187], v[152:155], v[204:207]
    v_mfma_f32_16x16x32_bf16 v[192:195], a[20:23], v[156:159], v[192:195]
    v_mfma_f32_16x16x32_bf16 v[196:199], a[76:79], v[156:159], v[196:199]
    ds_read_b128 v[44:47], v6 offset:48128
    v_mfma_f32_16x16x32_bf16 v[200:203], a[132:135], v[156:159], v[200:203]
    v_mfma_f32_16x16x32_bf16 v[204:207], a[188:191], v[156:159], v[204:207]
    v_mfma_f32_16x16x32_bf16 v[192:195], a[24:27], v[160:163], v[192:195]
    v_mfma_f32_16x16x32_bf16 v[196:199], a[80:83], v[160:163], v[196:199]
    ds_read_b128 v[48:51], v6 offset:49152
    v_mfma_f32_16x16x32_bf16 v[200:203], a[136:139], v[160:163], v[200:203]
    v_mfma_f32_16x16x32_bf16 v[204:207], a[192:195], v[160:163], v[204:207]
    v_mfma_f32_16x16x32_bf16 v[192:195], a[28:31], v[164:167], v[192:195]
    v_mfma_f32_16x16x32_bf16 v[196:199], a[84:87], v[164:167], v[196:199]
    ds_read_b128 v[52:55], v6 offset:50176
    v_mfma_f32_16x16x32_bf16 v[200:203], a[140:143], v[164:167], v[200:203]
    v_mfma_f32_16x16x32_bf16 v[204:207], a[196:199], v[164:167], v[204:207]
    v_mfma_f32_16x16x32_bf16 v[192:195], a[32:35], v[168:171], v[192:195]
    v_mfma_f32_16x16x32_bf16 v[196:199], a[88:91], v[168:171], v[196:199]
    ds_read_b128 v[56:59], v6 offset:51200
    v_mfma_f32_16x16x32_bf16 v[200:203], a[144:147], v[168:171], v[200:203]
    v_mfma_f32_16x16x32_bf16 v[204:207], a[200:203], v[168:171], v[204:207]
    v_mfma_f32_16x16x32_bf16 v[192:195], a[36:39], v[172:175], v[192:195]
    v_mfma_f32_16x16x32_bf16 v[196:199], a[92:95], v[172:175], v[196:199]
    ds_read_b128 v[60:63], v6 offset:52224
    v_mfma_f32_16x16x32_bf16 v[200:203], a[148:151], v[172:175], v[200:203]
    v_mfma_f32_16x16x32_bf16 v[204:207], a[204:207], v[172:175], v[204:207]
    v_mfma_f32_16x16x32_bf16 v[192:195], a[40:43], v[176:179], v[192:195]
    v_mfma_f32_16x16x32_bf16 v[196:199], a[96:99], v[176:179], v[196:199]
    ds_read_b128 v[64:67], v6 offset:53248
    v_mfma_f32_16x16x32_bf16 v[200:203], a[152:155], v[176:179], v[200:203]
    v_mfma_f32_16x16x32_bf16 v[204:207], a[208:211], v[176:179], v[204:207]
    v_mfma_f32_16x16x32_bf16 v[192:195], a[44:47], v[180:183], v[192:195]
    v_mfma_f32_16x16x32_bf16 v[196:199], a[100:103], v[180:183], v[196:199]
    ds_read_b128 v[68:71], v6 offset:54272
    v_mfma_f32_16x16x32_bf16 v[200:203], a[156:159], v[180:183], v[200:203]
    v_mfma_f32_16x16x32_bf16 v[204:207], a[212:215], v[180:183], v[204:207]
    v_mfma_f32_16x16x32_bf16 v[192:195], a[48:51], v[184:187], v[192:195]
    v_mfma_f32_16x16x32_bf16 v[196:199], a[104:107], v[184:187], v[196:199]
    ds_read_b128 v[72:75], v6 offset:55296
    v_mfma_f32_16x16x32_bf16 v[200:203], a[160:163], v[184:187], v[200:203]
    v_mfma_f32_16x16x32_bf16 v[204:207], a[216:219], v[184:187], v[204:207]
    v_mfma_f32_16x16x32_bf16 v[192:195], a[52:55], v[188:191], v[192:195]
    v_mfma_f32_16x16x32_bf16 v[196:199], a[108:111], v[188:191], v[196:199]
    ds_read_b128 v[76:79], v6 offset:56320
    v_mfma_f32_16x16x32_bf16 v[200:203], a[164:167], v[188:191], v[200:203]
    v_mfma_f32_16x16x32_bf16 v[204:207], a[220:223], v[188:191], v[204:207]
    s_nop 7
    v_cvt_pk_bf16_f32 v208, v192, v193
    v_cvt_pk_bf16_f32 v209, v194, v195
    v_cvt_pk_bf16_f32 v210, v196, v197
    v_cvt_pk_bf16_f32 v211, v198, v199
    global_store_dwordx4 v2, v[208:211], s[34:35] offset:2048 sc1
    v_cvt_pk_bf16_f32 v212, v200, v201
    v_cvt_pk_bf16_f32 v213, v202, v203
    v_cvt_pk_bf16_f32 v214, v204, v205
    v_cvt_pk_bf16_f32 v215, v206, v207
    global_store_dwordx4 v2, v[212:215], s[36:37] offset:2048 sc1
    s_waitcnt lgkmcnt(0)
    v_mfma_f32_16x16x32_bf16 v[192:195], a[0:3], v[24:27], 0
    v_mfma_f32_16x16x32_bf16 v[196:199], a[56:59], v[24:27], 0
    v_mfma_f32_16x16x32_bf16 v[200:203], a[112:115], v[24:27], 0
    v_mfma_f32_16x16x32_bf16 v[204:207], a[168:171], v[24:27], 0
    v_mfma_f32_16x16x32_bf16 v[192:195], a[4:7], v[28:31], v[192:195]
    v_mfma_f32_16x16x32_bf16 v[196:199], a[60:63], v[28:31], v[196:199]
    v_mfma_f32_16x16x32_bf16 v[200:203], a[116:119], v[28:31], v[200:203]
    v_mfma_f32_16x16x32_bf16 v[204:207], a[172:175], v[28:31], v[204:207]
    v_mfma_f32_16x16x32_bf16 v[192:195], a[8:11], v[32:35], v[192:195]
    v_mfma_f32_16x16x32_bf16 v[196:199], a[64:67], v[32:35], v[196:199]
    v_mfma_f32_16x16x32_bf16 v[200:203], a[120:123], v[32:35], v[200:203]
    v_mfma_f32_16x16x32_bf16 v[204:207], a[176:179], v[32:35], v[204:207]
    v_mfma_f32_16x16x32_bf16 v[192:195], a[12:15], v[36:39], v[192:195]
    v_mfma_f32_16x16x32_bf16 v[196:199], a[68:71], v[36:39], v[196:199]
    v_mfma_f32_16x16x32_bf16 v[200:203], a[124:127], v[36:39], v[200:203]
    v_mfma_f32_16x16x32_bf16 v[204:207], a[180:183], v[36:39], v[204:207]
    v_mfma_f32_16x16x32_bf16 v[192:195], a[16:19], v[40:43], v[192:195]
    v_mfma_f32_16x16x32_bf16 v[196:199], a[72:75], v[40:43], v[196:199]
    v_mfma_f32_16x16x32_bf16 v[200:203], a[128:131], v[40:43], v[200:203]
    v_mfma_f32_16x16x32_bf16 v[204:207], a[184:187], v[40:43], v[204:207]
    v_mfma_f32_16x16x32_bf16 v[192:195], a[20:23], v[44:47], v[192:195]
    v_mfma_f32_16x16x32_bf16 v[196:199], a[76:79], v[44:47], v[196:199]
    v_mfma_f32_16x16x32_bf16 v[200:203], a[132:135], v[44:47], v[200:203]
    v_mfma_f32_16x16x32_bf16 v[204:207], a[188:191], v[44:47], v[204:207]
    v_mfma_f32_16x16x32_bf16 v[192:195], a[24:27], v[48:51], v[192:195]
    v_mfma_f32_16x16x32_bf16 v[196:199], a[80:83], v[48:51], v[196:199]
    v_mfma_f32_16x16x32_bf16 v[200:203], a[136:139], v[48:51], v[200:203]
    v_mfma_f32_16x16x32_bf16 v[204:207], a[192:195], v[48:51], v[204:207]
    v_mfma_f32_16x16x32_bf16 v[192:195], a[28:31], v[52:55], v[192:195]
    v_mfma_f32_16x16x32_bf16 v[196:199], a[84:87], v[52:55], v[196:199]
    v_mfma_f32_16x16x32_bf16 v[200:203], a[140:143], v[52:55], v[200:203]
    v_mfma_f32_16x16x32_bf16 v[204:207], a[196:199], v[52:55], v[204:207]
    v_mfma_f32_16x16x32_bf16 v[192:195], a[32:35], v[56:59], v[192:195]
    v_mfma_f32_16x16x32_bf16 v[196:199], a[88:91], v[56:59], v[196:199]
    v_mfma_f32_16x16x32_bf16 v[200:203], a[144:147], v[56:59], v[200:203]
    v_mfma_f32_16x16x32_bf16 v[204:207], a[200:203], v[56:59], v[204:207]
    v_mfma_f32_16x16x32_bf16 v[192:195], a[36:39], v[60:63], v[192:195]
    v_mfma_f32_16x16x32_bf16 v[196:199], a[92:95], v[60:63], v[196:199]
    v_mfma_f32_16x16x32_bf16 v[200:203], a[148:151], v[60:63], v[200:203]
    v_mfma_f32_16x16x32_bf16 v[204:207], a[204:207], v[60:63], v[204:207]
    v_mfma_f32_16x16x32_bf16 v[192:195], a[40:43], v[64:67], v[192:195]
    v_mfma_f32_16x16x32_bf16 v[196:199], a[96:99], v[64:67], v[196:199]
    v_mfma_f32_16x16x32_bf16 v[200:203], a[152:155], v[64:67], v[200:203]
    v_mfma_f32_16x16x32_bf16 v[204:207], a[208:211], v[64:67], v[204:207]
    v_mfma_f32_16x16x32_bf16 v[192:195], a[44:47], v[68:71], v[192:195]
    v_mfma_f32_16x16x32_bf16 v[196:199], a[100:103], v[68:71], v[196:199]
    v_mfma_f32_16x16x32_bf16 v[200:203], a[156:159], v[68:71], v[200:203]
    v_mfma_f32_16x16x32_bf16 v[204:207], a[212:215], v[68:71], v[204:207]
    v_mfma_f32_16x16x32_bf16 v[192:195], a[48:51], v[72:75], v[192:195]
    v_mfma_f32_16x16x32_bf16 v[196:199], a[104:107], v[72:75], v[196:199]
    v_mfma_f32_16x16x32_bf16 v[200:203], a[160:163], v[72:75], v[200:203]
    v_mfma_f32_16x16x32_bf16 v[204:207], a[216:219], v[72:75], v[204:207]
    v_mfma_f32_16x16x32_bf16 v[192:195], a[52:55], v[76:79], v[192:195]
    v_mfma_f32_16x16x32_bf16 v[196:199], a[108:111], v[76:79], v[196:199]
    v_mfma_f32_16x16x32_bf16 v[200:203], a[164:167], v[76:79], v[200:203]
    v_mfma_f32_16x16x32_bf16 v[204:207], a[220:223], v[76:79], v[204:207]
    s_nop 7
    v_cvt_pk_bf16_f32 v216, v192, v193
    v_cvt_pk_bf16_f32 v217, v194, v195
    v_cvt_pk_bf16_f32 v218, v196, v197
    v_cvt_pk_bf16_f32 v219, v198, v199
    global_store_dwordx4 v2, v[216:219], s[34:35] offset:3072 sc1
    v_cvt_pk_bf16_f32 v220, v200, v201
    v_cvt_pk_bf16_f32 v221, v202, v203
    v_cvt_pk_bf16_f32 v222, v204, v205
    v_cvt_pk_bf16_f32 v223, v206, v207
    global_store_dwordx4 v2, v[220:223], s[36:37] offset:3072 sc1
    s_waitcnt vmcnt(0)
    s_barrier
    s_cmp_lg_u32 s23, 0
    s_cbranch_scc1 Lsig_96
    s_lshl_b32 s25, s73, 7
    s_add_u32 s25, s25, 0x7900000
    s_add_u32 s76, s4, s25
    s_addc_u32 s77, s5, 0
    s_mov_b64 exec, 1
    v_mov_b32 v22, 0
    v_mov_b32 v23, 1
    global_atomic_add v22, v23, s[76:77]
    s_mov_b64 exec, -1
Lsig_96:
    s_waitcnt vmcnt(0)
    s_cmp_lg_u32 s23, 0
    s_cbranch_scc1 Lwo_97
    s_add_u32 s76, s4, 0x7906000
    s_addc_u32 s77, s5, 0
    v_mbcnt_lo_u32_b32 v8, -1, 0
    v_mbcnt_hi_u32_b32 v8, -1, v8
    v_lshlrev_b32 v8, 7, v8
    s_mov_b32 s78, 1048576
    s_mov_b32 exec_lo, 0xffffffff
    s_mov_b32 exec_hi, 0x0
Lwf_98:
    global_load_dword v9, v8, s[76:77] sc1
    s_sub_u32 s78, s78, 1
    s_cmp_eq_u32 s78, 0
    s_cbranch_scc1 Lexitc_28
    s_waitcnt vmcnt(0)
    v_cmp_ne_u32 vcc, 8, v9
    s_cbranch_vccz Lwfd_99
    s_sleep 4
    s_branch Lwf_98
Lwfd_99:
    s_mov_b64 exec, -1
Lwo_97:
    s_barrier
    v_and_b32 v1, 63, v0
    v_lshlrev_b32 v2, 4, v1
    v_lshlrev_b32 v3, 4, v1
    v_add_u32 v3, 4096, v3
    v_lshlrev_b32 v4, 4, v1
    v_add_u32 v4, 8192, v4
    v_lshlrev_b32 v5, 4, v1
    v_add_u32 v5, 12288, v5
    v_and_b32 v14, 3, v1
    v_bfe_u32 v15, v1, 2, 1
    v_lshl_add_u32 v14, v15, 3, v14
    v_lshrrev_b32 v15, 4, v1
    v_lshl_add_u32 v14, v15, 4, v14
    v_lshlrev_b32 v14, 4, v14
    v_bfe_u32 v15, v1, 3, 1
    v_mul_u32_u24 v15, 14336, v15
    v_add_u32 v14, v14, v15
    v_add_u32 v6, 0, v2
    v_add_u32 v9, 0, v14
    v_add_u32 v7, 57344, v2
    v_add_u32 v10, 57344, v14
    v_add_u32 v8, 114688, v2
    v_add_u32 v11, 114688, v14
    s_mul_i32 s39, s23, 7168
    v_add_u32 v12, s39, v2
    v_add_u32 v13, 4096, v12
    s_and_b32 s73, s72, 7
    s_lshr_b32 s74, s72, 3
    s_cmp_lt_u32 s73, 2
    s_cbranch_scc1 Lnovo_100
    s_lshl_b32 s28, s73, 4
    s_lshl_b32 s29, s23, 2
    s_add_u32 s28, s28, s29
    s_mul_i32 s25, s74, 229376
    s_add_u32 s25, s25, 0xa20000
    s_add_u32 s30, s4, s25
    s_addc_u32 s31, s5, 0
    s_lshr_b32 s25, s28, 1
    s_mul_i32 s25, s25, 458752
    s_mul_i32 s26, s74, 16384
    s_add_u32 s25, s25, s26
    s_add_u32 s25, s25, 0x4000000
    s_add_u32 s34, s4, s25
    s_addc_u32 s35, s5, 0
    s_add_u32 s36, s34, 0x70000
    s_addc_u32 s37, s35, 0
    s_barrier
    s_add_u32 m0, s39, 0
    s_nop 0
    global_load_lds_dwordx4 v12, s[30:31] offset:0 sc1
    s_add_u32 m0, s39, 0
    s_nop 0
    global_load_lds_dwordx4 v12, s[30:31] offset:1024 sc1
    s_add_u32 m0, s39, 0
    s_nop 0
    global_load_lds_dwordx4 v12, s[30:31] offset:2048 sc1
    s_add_u32 m0, s39, 0
    s_nop 0
    global_load_lds_dwordx4 v12, s[30:31] offset:3072 sc1
    s_add_u32 m0, s39, 4096
    s_nop 0
    global_load_lds_dwordx4 v13, s[30:31] offset:0 sc1
    s_add_u32 m0, s39, 4096
    s_nop 0
    global_load_lds_dwordx4 v13, s[30:31] offset:1024 sc1
    s_add_u32 m0, s39, 4096
    s_nop 0
    global_load_lds_dwordx4 v13, s[30:31] offset:2048 sc1
    s_add_u32 s30, s30, 0x7000
    s_addc_u32 s31, s31, 0
    s_lshl_b32 s25, s73, 4
    s_lshl_b32 s26, s23, 2
    s_add_u32 s25, s25, s26
    s_mul_i32 s26, s25, 14336
    s_add_u32 s26, s26, 0x200000
    s_add_u32 s80, s4, s26
    s_addc_u32 s81, s5, 0
    s_add_u32 s82, s80, 0x3800
    s_addc_u32 s83, s81, 0
    s_add_u32 s84, s82, 0x3800
    s_addc_u32 s85, s83, 0
    s_add_u32 s86, s84, 0x3800
    s_addc_u32 s87, s85, 0
    global_load_dwordx4 a[0:3], v2, s[80:81] offset:0 sc1
    global_load_dwordx4 a[56:59], v2, s[82:83] offset:0 sc1
    global_load_dwordx4 a[112:115], v2, s[84:85] offset:0 sc1
    global_load_dwordx4 a[168:171], v2, s[86:87] offset:0 sc1
    global_load_dwordx4 a[4:7], v2, s[80:81] offset:1024 sc1
    global_load_dwordx4 a[60:63], v2, s[82:83] offset:1024 sc1
    global_load_dwordx4 a[116:119], v2, s[84:85] offset:1024 sc1
    global_load_dwordx4 a[172:175], v2, s[86:87] offset:1024 sc1
    global_load_dwordx4 a[8:11], v2, s[80:81] offset:2048 sc1
    global_load_dwordx4 a[64:67], v2, s[82:83] offset:2048 sc1
    global_load_dwordx4 a[120:123], v2, s[84:85] offset:2048 sc1
    global_load_dwordx4 a[176:179], v2, s[86:87] offset:2048 sc1
    global_load_dwordx4 a[12:15], v2, s[80:81] offset:3072 sc1
    global_load_dwordx4 a[68:71], v2, s[82:83] offset:3072 sc1
    global_load_dwordx4 a[124:127], v2, s[84:85] offset:3072 sc1
    global_load_dwordx4 a[180:183], v2, s[86:87] offset:3072 sc1
    global_load_dwordx4 a[16:19], v3, s[80:81] offset:0 sc1
    global_load_dwordx4 a[72:75], v3, s[82:83] offset:0 sc1
    global_load_dwordx4 a[128:131], v3, s[84:85] offset:0 sc1
    global_load_dwordx4 a[184:187], v3, s[86:87] offset:0 sc1
    global_load_dwordx4 a[20:23], v3, s[80:81] offset:1024 sc1
    global_load_dwordx4 a[76:79], v3, s[82:83] offset:1024 sc1
    global_load_dwordx4 a[132:135], v3, s[84:85] offset:1024 sc1
    global_load_dwordx4 a[188:191], v3, s[86:87] offset:1024 sc1
    global_load_dwordx4 a[24:27], v3, s[80:81] offset:2048 sc1
    global_load_dwordx4 a[80:83], v3, s[82:83] offset:2048 sc1
    global_load_dwordx4 a[136:139], v3, s[84:85] offset:2048 sc1
    global_load_dwordx4 a[192:195], v3, s[86:87] offset:2048 sc1
    global_load_dwordx4 a[28:31], v3, s[80:81] offset:3072 sc1
    global_load_dwordx4 a[84:87], v3, s[82:83] offset:3072 sc1
    global_load_dwordx4 a[140:143], v3, s[84:85] offset:3072 sc1
    global_load_dwordx4 a[196:199], v3, s[86:87] offset:3072 sc1
    global_load_dwordx4 a[32:35], v4, s[80:81] offset:0 sc1
    global_load_dwordx4 a[88:91], v4, s[82:83] offset:0 sc1
    global_load_dwordx4 a[144:147], v4, s[84:85] offset:0 sc1
    global_load_dwordx4 a[200:203], v4, s[86:87] offset:0 sc1
    global_load_dwordx4 a[36:39], v4, s[80:81] offset:1024 sc1
    global_load_dwordx4 a[92:95], v4, s[82:83] offset:1024 sc1
    global_load_dwordx4 a[148:151], v4, s[84:85] offset:1024 sc1
    global_load_dwordx4 a[204:207], v4, s[86:87] offset:1024 sc1
    global_load_dwordx4 a[40:43], v4, s[80:81] offset:2048 sc1
    global_load_dwordx4 a[96:99], v4, s[82:83] offset:2048 sc1
    global_load_dwordx4 a[152:155], v4, s[84:85] offset:2048 sc1
    global_load_dwordx4 a[208:211], v4, s[86:87] offset:2048 sc1
    global_load_dwordx4 a[44:47], v4, s[80:81] offset:3072 sc1
    global_load_dwordx4 a[100:103], v4, s[82:83] offset:3072 sc1
    global_load_dwordx4 a[156:159], v4, s[84:85] offset:3072 sc1
    global_load_dwordx4 a[212:215], v4, s[86:87] offset:3072 sc1
    global_load_dwordx4 a[48:51], v5, s[80:81] offset:0 sc1
    global_load_dwordx4 a[104:107], v5, s[82:83] offset:0 sc1
    global_load_dwordx4 a[160:163], v5, s[84:85] offset:0 sc1
    global_load_dwordx4 a[216:219], v5, s[86:87] offset:0 sc1
    global_load_dwordx4 a[52:55], v5, s[80:81] offset:1024 sc1
    global_load_dwordx4 a[108:111], v5, s[82:83] offset:1024 sc1
    global_load_dwordx4 a[164:167], v5, s[84:85] offset:1024 sc1
    global_load_dwordx4 a[220:223], v5, s[86:87] offset:1024 sc1
    s_add_u32 m0, s39, 28672
    s_nop 0
    global_load_lds_dwordx4 v12, s[30:31] offset:0 sc1
    s_add_u32 m0, s39, 28672
    s_nop 0
    global_load_lds_dwordx4 v12, s[30:31] offset:1024 sc1
    s_add_u32 m0, s39, 28672
    s_nop 0
    global_load_lds_dwordx4 v12, s[30:31] offset:2048 sc1
    s_add_u32 m0, s39, 28672
    s_nop 0
    global_load_lds_dwordx4 v12, s[30:31] offset:3072 sc1
    s_add_u32 m0, s39, 32768
    s_nop 0
    global_load_lds_dwordx4 v13, s[30:31] offset:0 sc1
    s_add_u32 m0, s39, 32768
    s_nop 0
    global_load_lds_dwordx4 v13, s[30:31] offset:1024 sc1
    s_add_u32 m0, s39, 32768
    s_nop 0
    global_load_lds_dwordx4 v13, s[30:31] offset:2048 sc1
    s_add_u32 s30, s30, 0x7000
    s_addc_u32 s31, s31, 0
    s_add_u32 m0, s39, 57344
    s_nop 0
    global_load_lds_dwordx4 v12, s[30:31] offset:0 sc1
    s_add_u32 m0, s39, 57344
    s_nop 0
    global_load_lds_dwordx4 v12, s[30:31] offset:1024 sc1
    s_add_u32 m0, s39, 57344
    s_nop 0
    global_load_lds_dwordx4 v12, s[30:31] offset:2048 sc1
    s_add_u32 m0, s39, 57344
    s_nop 0
    global_load_lds_dwordx4 v12, s[30:31] offset:3072 sc1
    s_add_u32 m0, s39, 61440
    s_nop 0
    global_load_lds_dwordx4 v13, s[30:31] offset:0 sc1
    s_add_u32 m0, s39, 61440
    s_nop 0
    global_load_lds_dwordx4 v13, s[30:31] offset:1024 sc1
    s_add_u32 m0, s39, 61440
    s_nop 0
    global_load_lds_dwordx4 v13, s[30:31] offset:2048 sc1
    s_add_u32 s30, s30, 0x7000
    s_addc_u32 s31, s31, 0
    s_waitcnt vmcnt(63)
    s_barrier
    ds_read_b128 v[24:27], v6 offset:0
    ds_read_b128 v[28:31], v6 offset:1024
    ds_read_b128 v[32:35], v6 offset:2048
    ds_read_b128 v[36:39], v6 offset:3072
    ds_read_b128 v[40:43], v6 offset:4096
    ds_read_b128 v[44:47], v6 offset:5120
    ds_read_b128 v[48:51], v6 offset:6144
    ds_read_b128 v[52:55], v6 offset:7168
    ds_read_b128 v[56:59], v6 offset:8192
    ds_read_b128 v[60:63], v6 offset:9216
    ds_read_b128 v[64:67], v6 offset:10240
    ds_read_b128 v[68:71], v6 offset:11264
    ds_read_b128 v[72:75], v6 offset:12288
    ds_read_b128 v[76:79], v6 offset:13312
    s_waitcnt lgkmcnt(0)
    s_waitcnt vmcnt(63)
    v_mfma_f32_16x16x32_bf16 v[192:195], a[0:3], v[24:27], 0
    v_mfma_f32_16x16x32_bf16 v[196:199], a[56:59], v[24:27], 0
    ds_read_b128 v[80:83], v6 offset:14336
    v_mfma_f32_16x16x32_bf16 v[200:203], a[112:115], v[24:27], 0
    v_mfma_f32_16x16x32_bf16 v[204:207], a[168:171], v[24:27], 0
    s_add_u32 m0, s39, 86016
    s_nop 0
    global_load_lds_dwordx4 v12, s[30:31] offset:0 sc1
    s_add_u32 m0, s39, 86016
    s_nop 0
    global_load_lds_dwordx4 v12, s[30:31] offset:1024 sc1
    s_waitcnt vmcnt(63)
    v_mfma_f32_16x16x32_bf16 v[192:195], a[4:7], v[28:31], v[192:195]
    v_mfma_f32_16x16x32_bf16 v[196:199], a[60:63], v[28:31], v[196:199]
    ds_read_b128 v[84:87], v6 offset:15360
    v_mfma_f32_16x16x32_bf16 v[200:203], a[116:119], v[28:31], v[200:203]
    v_mfma_f32_16x16x32_bf16 v[204:207], a[172:175], v[28:31], v[204:207]
    s_add_u32 m0, s39, 86016
    s_nop 0
    global_load_lds_dwordx4 v12, s[30:31] offset:2048 sc1
    s_add_u32 m0, s39, 86016
    s_nop 0
    global_load_lds_dwordx4 v12, s[30:31] offset:3072 sc1
    s_waitcnt vmcnt(62)
    v_mfma_f32_16x16x32_bf16 v[192:195], a[8:11], v[32:35], v[192:195]
    v_mfma_f32_16x16x32_bf16 v[196:199], a[64:67], v[32:35], v[196:199]
    ds_read_b128 v[88:91], v6 offset:16384
    v_mfma_f32_16x16x32_bf16 v[200:203], a[120:123], v[32:35], v[200:203]
    v_mfma_f32_16x16x32_bf16 v[204:207], a[176:179], v[32:35], v[204:207]
    s_add_u32 m0, s39, 90112
    s_nop 0
    global_load_lds_dwordx4 v13, s[30:31] offset:0 sc1
    s_add_u32 m0, s39, 90112
    s_nop 0
    global_load_lds_dwordx4 v13, s[30:31] offset:1024 sc1
    s_waitcnt vmcnt(60)
    v_mfma_f32_16x16x32_bf16 v[192:195], a[12:15], v[36:39], v[192:195]
    v_mfma_f32_16x16x32_bf16 v[196:199], a[68:71], v[36:39], v[196:199]
    ds_read_b128 v[92:95], v6 offset:17408
    v_mfma_f32_16x16x32_bf16 v[200:203], a[124:127], v[36:39], v[200:203]
    v_mfma_f32_16x16x32_bf16 v[204:207], a[180:183], v[36:39], v[204:207]
    s_add_u32 m0, s39, 90112
    s_nop 0
    global_load_lds_dwordx4 v13, s[30:31] offset:2048 sc1
    s_add_u32 s30, s30, 0x7000
    s_addc_u32 s31, s31, 0
    s_waitcnt vmcnt(57)
    v_mfma_f32_16x16x32_bf16 v[192:195], a[16:19], v[40:43], v[192:195]
    v_mfma_f32_16x16x32_bf16 v[196:199], a[72:75], v[40:43], v[196:199]
    ds_read_b128 v[96:99], v6 offset:18432
    v_mfma_f32_16x16x32_bf16 v[200:203], a[128:131], v[40:43], v[200:203]
    v_mfma_f32_16x16x32_bf16 v[204:207], a[184:187], v[40:43], v[204:207]
    s_waitcnt vmcnt(53)
    v_mfma_f32_16x16x32_bf16 v[192:195], a[20:23], v[44:47], v[192:195]
    v_mfma_f32_16x16x32_bf16 v[196:199], a[76:79], v[44:47], v[196:199]
    ds_read_b128 v[100:103], v6 offset:19456
    v_mfma_f32_16x16x32_bf16 v[200:203], a[132:135], v[44:47], v[200:203]
    v_mfma_f32_16x16x32_bf16 v[204:207], a[188:191], v[44:47], v[204:207]
    s_waitcnt vmcnt(49)
    v_mfma_f32_16x16x32_bf16 v[192:195], a[24:27], v[48:51], v[192:195]
    v_mfma_f32_16x16x32_bf16 v[196:199], a[80:83], v[48:51], v[196:199]
    ds_read_b128 v[104:107], v6 offset:20480
    v_mfma_f32_16x16x32_bf16 v[200:203], a[136:139], v[48:51], v[200:203]
    v_mfma_f32_16x16x32_bf16 v[204:207], a[192:195], v[48:51], v[204:207]
    s_waitcnt vmcnt(45)
    v_mfma_f32_16x16x32_bf16 v[192:195], a[28:31], v[52:55], v[192:195]
    v_mfma_f32_16x16x32_bf16 v[196:199], a[84:87], v[52:55], v[196:199]
    ds_read_b128 v[108:111], v6 offset:21504
    v_mfma_f32_16x16x32_bf16 v[200:203], a[140:143], v[52:55], v[200:203]
    v_mfma_f32_16x16x32_bf16 v[204:207], a[196:199], v[52:55], v[204:207]
    s_waitcnt vmcnt(41)
    v_mfma_f32_16x16x32_bf16 v[192:195], a[32:35], v[56:59], v[192:195]
    v_mfma_f32_16x16x32_bf16 v[196:199], a[88:91], v[56:59], v[196:199]
    ds_read_b128 v[112:115], v6 offset:22528
    v_mfma_f32_16x16x32_bf16 v[200:203], a[144:147], v[56:59], v[200:203]
    v_mfma_f32_16x16x32_bf16 v[204:207], a[200:203], v[56:59], v[204:207]
    s_waitcnt vmcnt(37)
    v_mfma_f32_16x16x32_bf16 v[192:195], a[36:39], v[60:63], v[192:195]
    v_mfma_f32_16x16x32_bf16 v[196:199], a[92:95], v[60:63], v[196:199]
    ds_read_b128 v[116:119], v6 offset:23552
    v_mfma_f32_16x16x32_bf16 v[200:203], a[148:151], v[60:63], v[200:203]
    v_mfma_f32_16x16x32_bf16 v[204:207], a[204:207], v[60:63], v[204:207]
    s_waitcnt vmcnt(33)
    v_mfma_f32_16x16x32_bf16 v[192:195], a[40:43], v[64:67], v[192:195]
    v_mfma_f32_16x16x32_bf16 v[196:199], a[96:99], v[64:67], v[196:199]
    ds_read_b128 v[120:123], v6 offset:24576
    v_mfma_f32_16x16x32_bf16 v[200:203], a[152:155], v[64:67], v[200:203]
    v_mfma_f32_16x16x32_bf16 v[204:207], a[208:211], v[64:67], v[204:207]
    s_waitcnt vmcnt(29)
    v_mfma_f32_16x16x32_bf16 v[192:195], a[44:47], v[68:71], v[192:195]
    v_mfma_f32_16x16x32_bf16 v[196:199], a[100:103], v[68:71], v[196:199]
    ds_read_b128 v[124:127], v6 offset:25600
    v_mfma_f32_16x16x32_bf16 v[200:203], a[156:159], v[68:71], v[200:203]
    v_mfma_f32_16x16x32_bf16 v[204:207], a[212:215], v[68:71], v[204:207]
    s_waitcnt vmcnt(25)
    v_mfma_f32_16x16x32_bf16 v[192:195], a[48:51], v[72:75], v[192:195]
    v_mfma_f32_16x16x32_bf16 v[196:199], a[104:107], v[72:75], v[196:199]
    ds_read_b128 v[128:131], v6 offset:26624
    v_mfma_f32_16x16x32_bf16 v[200:203], a[160:163], v[72:75], v[200:203]
    v_mfma_f32_16x16x32_bf16 v[204:207], a[216:219], v[72:75], v[204:207]
    s_waitcnt vmcnt(21)
    v_mfma_f32_16x16x32_bf16 v[192:195], a[52:55], v[76:79], v[192:195]
    v_mfma_f32_16x16x32_bf16 v[196:199], a[108:111], v[76:79], v[196:199]
    ds_read_b128 v[132:135], v6 offset:27648
    v_mfma_f32_16x16x32_bf16 v[200:203], a[164:167], v[76:79], v[200:203]
    v_mfma_f32_16x16x32_bf16 v[204:207], a[220:223], v[76:79], v[204:207]
    s_nop 7
    v_cvt_pk_bf16_f32 v208, v192, v193
    v_cvt_pk_bf16_f32 v209, v194, v195
    v_cvt_pk_bf16_f32 v210, v196, v197
    v_cvt_pk_bf16_f32 v211, v198, v199
    global_store_dwordx4 v2, v[208:211], s[34:35] offset:0 sc1
    v_cvt_pk_bf16_f32 v212, v200, v201
    v_cvt_pk_bf16_f32 v213, v202, v203
    v_cvt_pk_bf16_f32 v214, v204, v205
    v_cvt_pk_bf16_f32 v215, v206, v207
    global_store_dwordx4 v2, v[212:215], s[36:37] offset:0 sc1
    s_waitcnt lgkmcnt(0)
    s_waitcnt vmcnt(16)
    s_barrier
    v_mfma_f32_16x16x32_bf16 v[192:195], a[0:3], v[80:83], 0
    v_mfma_f32_16x16x32_bf16 v[196:199], a[56:59], v[80:83], 0
    ds_read_b128 v[136:139], v6 offset:28672
    v_mfma_f32_16x16x32_bf16 v[200:203], a[112:115], v[80:83], 0
    v_mfma_f32_16x16x32_bf16 v[204:207], a[168:171], v[80:83], 0
    v_mfma_f32_16x16x32_bf16 v[192:195], a[4:7], v[84:87], v[192:195]
    v_mfma_f32_16x16x32_bf16 v[196:199], a[60:63], v[84:87], v[196:199]
    ds_read_b128 v[140:143], v6 offset:29696
    v_mfma_f32_16x16x32_bf16 v[200:203], a[116:119], v[84:87], v[200:203]
    v_mfma_f32_16x16x32_bf16 v[204:207], a[172:175], v[84:87], v[204:207]
    v_mfma_f32_16x16x32_bf16 v[192:195], a[8:11], v[88:91], v[192:195]
    v_mfma_f32_16x16x32_bf16 v[196:199], a[64:67], v[88:91], v[196:199]
    ds_read_b128 v[144:147], v6 offset:30720
    v_mfma_f32_16x16x32_bf16 v[200:203], a[120:123], v[88:91], v[200:203]
    v_mfma_f32_16x16x32_bf16 v[204:207], a[176:179], v[88:91], v[204:207]
    v_mfma_f32_16x16x32_bf16 v[192:195], a[12:15], v[92:95], v[192:195]
    v_mfma_f32_16x16x32_bf16 v[196:199], a[68:71], v[92:95], v[196:199]
    ds_read_b128 v[148:151], v6 offset:31744
    v_mfma_f32_16x16x32_bf16 v[200:203], a[124:127], v[92:95], v[200:203]
    v_mfma_f32_16x16x32_bf16 v[204:207], a[180:183], v[92:95], v[204:207]
    v_mfma_f32_16x16x32_bf16 v[192:195], a[16:19], v[96:99], v[192:195]
    v_mfma_f32_16x16x32_bf16 v[196:199], a[72:75], v[96:99], v[196:199]
    ds_read_b128 v[152:155], v6 offset:32768
    v_mfma_f32_16x16x32_bf16 v[200:203], a[128:131], v[96:99], v[200:203]
    v_mfma_f32_16x16x32_bf16 v[204:207], a[184:187], v[96:99], v[204:207]
    v_mfma_f32_16x16x32_bf16 v[192:195], a[20:23], v[100:103], v[192:195]
    v_mfma_f32_16x16x32_bf16 v[196:199], a[76:79], v[100:103], v[196:199]
    ds_read_b128 v[156:159], v6 offset:33792
    v_mfma_f32_16x16x32_bf16 v[200:203], a[132:135], v[100:103], v[200:203]
    v_mfma_f32_16x16x32_bf16 v[204:207], a[188:191], v[100:103], v[204:207]
    v_mfma_f32_16x16x32_bf16 v[192:195], a[24:27], v[104:107], v[192:195]
    v_mfma_f32_16x16x32_bf16 v[196:199], a[80:83], v[104:107], v[196:199]
    ds_read_b128 v[160:163], v6 offset:34816
    v_mfma_f32_16x16x32_bf16 v[200:203], a[136:139], v[104:107], v[200:203]
    v_mfma_f32_16x16x32_bf16 v[204:207], a[192:195], v[104:107], v[204:207]
    v_mfma_f32_16x16x32_bf16 v[192:195], a[28:31], v[108:111], v[192:195]
    v_mfma_f32_16x16x32_bf16 v[196:199], a[84:87], v[108:111], v[196:199]
    ds_read_b128 v[164:167], v6 offset:35840
    v_mfma_f32_16x16x32_bf16 v[200:203], a[140:143], v[108:111], v[200:203]
    v_mfma_f32_16x16x32_bf16 v[204:207], a[196:199], v[108:111], v[204:207]
    v_mfma_f32_16x16x32_bf16 v[192:195], a[32:35], v[112:115], v[192:195]
    v_mfma_f32_16x16x32_bf16 v[196:199], a[88:91], v[112:115], v[196:199]
    ds_read_b128 v[168:171], v6 offset:36864
    v_mfma_f32_16x16x32_bf16 v[200:203], a[144:147], v[112:115], v[200:203]
    v_mfma_f32_16x16x32_bf16 v[204:207], a[200:203], v[112:115], v[204:207]
    v_mfma_f32_16x16x32_bf16 v[192:195], a[36:39], v[116:119], v[192:195]
    v_mfma_f32_16x16x32_bf16 v[196:199], a[92:95], v[116:119], v[196:199]
    ds_read_b128 v[172:175], v6 offset:37888
    v_mfma_f32_16x16x32_bf16 v[200:203], a[148:151], v[116:119], v[200:203]
    v_mfma_f32_16x16x32_bf16 v[204:207], a[204:207], v[116:119], v[204:207]
    v_mfma_f32_16x16x32_bf16 v[192:195], a[40:43], v[120:123], v[192:195]
    v_mfma_f32_16x16x32_bf16 v[196:199], a[96:99], v[120:123], v[196:199]
    ds_read_b128 v[176:179], v6 offset:38912
    v_mfma_f32_16x16x32_bf16 v[200:203], a[152:155], v[120:123], v[200:203]
    v_mfma_f32_16x16x32_bf16 v[204:207], a[208:211], v[120:123], v[204:207]
    v_mfma_f32_16x16x32_bf16 v[192:195], a[44:47], v[124:127], v[192:195]
    v_mfma_f32_16x16x32_bf16 v[196:199], a[100:103], v[124:127], v[196:199]
    ds_read_b128 v[180:183], v6 offset:39936
    v_mfma_f32_16x16x32_bf16 v[200:203], a[156:159], v[124:127], v[200:203]
    v_mfma_f32_16x16x32_bf16 v[204:207], a[212:215], v[124:127], v[204:207]
    v_mfma_f32_16x16x32_bf16 v[192:195], a[48:51], v[128:131], v[192:195]
    v_mfma_f32_16x16x32_bf16 v[196:199], a[104:107], v[128:131], v[196:199]
    ds_read_b128 v[184:187], v6 offset:40960
    v_mfma_f32_16x16x32_bf16 v[200:203], a[160:163], v[128:131], v[200:203]
    v_mfma_f32_16x16x32_bf16 v[204:207], a[216:219], v[128:131], v[204:207]
    v_mfma_f32_16x16x32_bf16 v[192:195], a[52:55], v[132:135], v[192:195]
    v_mfma_f32_16x16x32_bf16 v[196:199], a[108:111], v[132:135], v[196:199]
    ds_read_b128 v[188:191], v6 offset:41984
    v_mfma_f32_16x16x32_bf16 v[200:203], a[164:167], v[132:135], v[200:203]
    v_mfma_f32_16x16x32_bf16 v[204:207], a[220:223], v[132:135], v[204:207]
    s_nop 7
    v_cvt_pk_bf16_f32 v216, v192, v193
    v_cvt_pk_bf16_f32 v217, v194, v195
    v_cvt_pk_bf16_f32 v218, v196, v197
    v_cvt_pk_bf16_f32 v219, v198, v199
    global_store_dwordx4 v2, v[216:219], s[34:35] offset:1024 sc1
    v_cvt_pk_bf16_f32 v220, v200, v201
    v_cvt_pk_bf16_f32 v221, v202, v203
    v_cvt_pk_bf16_f32 v222, v204, v205
    v_cvt_pk_bf16_f32 v223, v206, v207
    global_store_dwordx4 v2, v[220:223], s[36:37] offset:1024 sc1
    s_waitcnt lgkmcnt(0)
    v_mfma_f32_16x16x32_bf16 v[192:195], a[0:3], v[136:139], 0
    v_mfma_f32_16x16x32_bf16 v[196:199], a[56:59], v[136:139], 0
    ds_read_b128 v[24:27], v6 offset:43008
    v_mfma_f32_16x16x32_bf16 v[200:203], a[112:115], v[136:139], 0
    v_mfma_f32_16x16x32_bf16 v[204:207], a[168:171], v[136:139], 0
    s_add_u32 m0, s39, 114688
    s_nop 0
    global_load_lds_dwordx4 v12, s[30:31] offset:0 sc1
    s_add_u32 m0, s39, 114688
    s_nop 0
    global_load_lds_dwordx4 v12, s[30:31] offset:1024 sc1
    v_mfma_f32_16x16x32_bf16 v[192:195], a[4:7], v[140:143], v[192:195]
    v_mfma_f32_16x16x32_bf16 v[196:199], a[60:63], v[140:143], v[196:199]
    ds_read_b128 v[28:31], v6 offset:44032
    v_mfma_f32_16x16x32_bf16 v[200:203], a[116:119], v[140:143], v[200:203]
    v_mfma_f32_16x16x32_bf16 v[204:207], a[172:175], v[140:143], v[204:207]
    s_add_u32 m0, s39, 114688
    s_nop 0
    global_load_lds_dwordx4 v12, s[30:31] offset:2048 sc1
    s_add_u32 m0, s39, 114688
    s_nop 0
    global_load_lds_dwordx4 v12, s[30:31] offset:3072 sc1
    v_mfma_f32_16x16x32_bf16 v[192:195], a[8:11], v[144:147], v[192:195]
    v_mfma_f32_16x16x32_bf16 v[196:199], a[64:67], v[144:147], v[196:199]
    ds_read_b128 v[32:35], v6 offset:45056
    v_mfma_f32_16x16x32_bf16 v[200:203], a[120:123], v[144:147], v[200:203]
    v_mfma_f32_16x16x32_bf16 v[204:207], a[176:179], v[144:147], v[204:207]
    s_add_u32 m0, s39, 118784
    s_nop 0
    global_load_lds_dwordx4 v13, s[30:31] offset:0 sc1
    s_add_u32 m0, s39, 118784
    s_nop 0
    global_load_lds_dwordx4 v13, s[30:31] offset:1024 sc1
    v_mfma_f32_16x16x32_bf16 v[192:195], a[12:15], v[148:151], v[192:195]
    v_mfma_f32_16x16x32_bf16 v[196:199], a[68:71], v[148:151], v[196:199]
    ds_read_b128 v[36:39], v6 offset:46080
    v_mfma_f32_16x16x32_bf16 v[200:203], a[124:127], v[148:151], v[200:203]
    v_mfma_f32_16x16x32_bf16 v[204:207], a[180:183], v[148:151], v[204:207]
    s_add_u32 m0, s39, 118784
    s_nop 0
    global_load_lds_dwordx4 v13, s[30:31] offset:2048 sc1
    s_add_u32 s30, s30, 0x7000
    s_addc_u32 s31, s31, 0
    v_mfma_f32_16x16x32_bf16 v[192:195], a[16:19], v[152:155], v[192:195]
    v_mfma_f32_16x16x32_bf16 v[196:199], a[72:75], v[152:155], v[196:199]
    ds_read_b128 v[40:43], v6 offset:47104
    v_mfma_f32_16x16x32_bf16 v[200:203], a[128:131], v[152:155], v[200:203]
    v_mfma_f32_16x16x32_bf16 v[204:207], a[184:187], v[152:155], v[204:207]
    v_mfma_f32_16x16x32_bf16 v[192:195], a[20:23], v[156:159], v[192:195]
    v_mfma_f32_16x16x32_bf16 v[196:199], a[76:79], v[156:159], v[196:199]
    ds_read_b128 v[44:47], v6 offset:48128
    v_mfma_f32_16x16x32_bf16 v[200:203], a[132:135], v[156:159], v[200:203]
    v_mfma_f32_16x16x32_bf16 v[204:207], a[188:191], v[156:159], v[204:207]
    v_mfma_f32_16x16x32_bf16 v[192:195], a[24:27], v[160:163], v[192:195]
    v_mfma_f32_16x16x32_bf16 v[196:199], a[80:83], v[160:163], v[196:199]
    ds_read_b128 v[48:51], v6 offset:49152
    v_mfma_f32_16x16x32_bf16 v[200:203], a[136:139], v[160:163], v[200:203]
    v_mfma_f32_16x16x32_bf16 v[204:207], a[192:195], v[160:163], v[204:207]
    v_mfma_f32_16x16x32_bf16 v[192:195], a[28:31], v[164:167], v[192:195]
    v_mfma_f32_16x16x32_bf16 v[196:199], a[84:87], v[164:167], v[196:199]
    ds_read_b128 v[52:55], v6 offset:50176
    v_mfma_f32_16x16x32_bf16 v[200:203], a[140:143], v[164:167], v[200:203]
    v_mfma_f32_16x16x32_bf16 v[204:207], a[196:199], v[164:167], v[204:207]
    v_mfma_f32_16x16x32_bf16 v[192:195], a[32:35], v[168:171], v[192:195]
    v_mfma_f32_16x16x32_bf16 v[196:199], a[88:91], v[168:171], v[196:199]
    ds_read_b128 v[56:59], v6 offset:51200
    v_mfma_f32_16x16x32_bf16 v[200:203], a[144:147], v[168:171], v[200:203]
    v_mfma_f32_16x16x32_bf16 v[204:207], a[200:203], v[168:171], v[204:207]
    v_mfma_f32_16x16x32_bf16 v[192:195], a[36:39], v[172:175], v[192:195]
    v_mfma_f32_16x16x32_bf16 v[196:199], a[92:95], v[172:175], v[196:199]
    ds_read_b128 v[60:63], v6 offset:52224
    v_mfma_f32_16x16x32_bf16 v[200:203], a[148:151], v[172:175], v[200:203]
    v_mfma_f32_16x16x32_bf16 v[204:207], a[204:207], v[172:175], v[204:207]
    v_mfma_f32_16x16x32_bf16 v[192:195], a[40:43], v[176:179], v[192:195]
    v_mfma_f32_16x16x32_bf16 v[196:199], a[96:99], v[176:179], v[196:199]
    ds_read_b128 v[64:67], v6 offset:53248
    v_mfma_f32_16x16x32_bf16 v[200:203], a[152:155], v[176:179], v[200:203]
    v_mfma_f32_16x16x32_bf16 v[204:207], a[208:211], v[176:179], v[204:207]
    v_mfma_f32_16x16x32_bf16 v[192:195], a[44:47], v[180:183], v[192:195]
    v_mfma_f32_16x16x32_bf16 v[196:199], a[100:103], v[180:183], v[196:199]
    ds_read_b128 v[68:71], v6 offset:54272
    v_mfma_f32_16x16x32_bf16 v[200:203], a[156:159], v[180:183], v[200:203]
    v_mfma_f32_16x16x32_bf16 v[204:207], a[212:215], v[180:183], v[204:207]
    v_mfma_f32_16x16x32_bf16 v[192:195], a[48:51], v[184:187], v[192:195]
    v_mfma_f32_16x16x32_bf16 v[196:199], a[104:107], v[184:187], v[196:199]
    ds_read_b128 v[72:75], v6 offset:55296
    v_mfma_f32_16x16x32_bf16 v[200:203], a[160:163], v[184:187], v[200:203]
    v_mfma_f32_16x16x32_bf16 v[204:207], a[216:219], v[184:187], v[204:207]
    v_mfma_f32_16x16x32_bf16 v[192:195], a[52:55], v[188:191], v[192:195]
    v_mfma_f32_16x16x32_bf16 v[196:199], a[108:111], v[188:191], v[196:199]
    ds_read_b128 v[76:79], v6 offset:56320
    v_mfma_f32_16x16x32_bf16 v[200:203], a[164:167], v[188:191], v[200:203]
    v_mfma_f32_16x16x32_bf16 v[204:207], a[220:223], v[188:191], v[204:207]
    s_nop 7
    v_cvt_pk_bf16_f32 v208, v192, v193
    v_cvt_pk_bf16_f32 v209, v194, v195
    v_cvt_pk_bf16_f32 v210, v196, v197
    v_cvt_pk_bf16_f32 v211, v198, v199
    global_store_dwordx4 v2, v[208:211], s[34:35] offset:2048 sc1
    v_cvt_pk_bf16_f32 v212, v200, v201
    v_cvt_pk_bf16_f32 v213, v202, v203
    v_cvt_pk_bf16_f32 v214, v204, v205
    v_cvt_pk_bf16_f32 v215, v206, v207
    global_store_dwordx4 v2, v[212:215], s[36:37] offset:2048 sc1
    s_waitcnt lgkmcnt(0)
    s_waitcnt vmcnt(20)
    s_barrier
    v_mfma_f32_16x16x32_bf16 v[192:195], a[0:3], v[24:27], 0
    v_mfma_f32_16x16x32_bf16 v[196:199], a[56:59], v[24:27], 0
    ds_read_b128 v[80:83], v7 offset:0
    v_mfma_f32_16x16x32_bf16 v[200:203], a[112:115], v[24:27], 0
    v_mfma_f32_16x16x32_bf16 v[204:207], a[168:171], v[24:27], 0
    v_mfma_f32_16x16x32_bf16 v[192:195], a[4:7], v[28:31], v[192:195]
    v_mfma_f32_16x16x32_bf16 v[196:199], a[60:63], v[28:31], v[196:199]
    ds_read_b128 v[84:87], v7 offset:1024
    v_mfma_f32_16x16x32_bf16 v[200:203], a[116:119], v[28:31], v[200:203]
    v_mfma_f32_16x16x32_bf16 v[204:207], a[172:175], v[28:31], v[204:207]
    v_mfma_f32_16x16x32_bf16 v[192:195], a[8:11], v[32:35], v[192:195]
    v_mfma_f32_16x16x32_bf16 v[196:199], a[64:67], v[32:35], v[196:199]
    ds_read_b128 v[88:91], v7 offset:2048
    v_mfma_f32_16x16x32_bf16 v[200:203], a[120:123], v[32:35], v[200:203]
    v_mfma_f32_16x16x32_bf16 v[204:207], a[176:179], v[32:35], v[204:207]
    v_mfma_f32_16x16x32_bf16 v[192:195], a[12:15], v[36:39], v[192:195]
    v_mfma_f32_16x16x32_bf16 v[196:199], a[68:71], v[36:39], v[196:199]
    ds_read_b128 v[92:95], v7 offset:3072
    v_mfma_f32_16x16x32_bf16 v[200:203], a[124:127], v[36:39], v[200:203]
    v_mfma_f32_16x16x32_bf16 v[204:207], a[180:183], v[36:39], v[204:207]
    v_mfma_f32_16x16x32_bf16 v[192:195], a[16:19], v[40:43], v[192:195]
    v_mfma_f32_16x16x32_bf16 v[196:199], a[72:75], v[40:43], v[196:199]
    ds_read_b128 v[96:99], v7 offset:4096
    v_mfma_f32_16x16x32_bf16 v[200:203], a[128:131], v[40:43], v[200:203]
    v_mfma_f32_16x16x32_bf16 v[204:207], a[184:187], v[40:43], v[204:207]
    v_mfma_f32_16x16x32_bf16 v[192:195], a[20:23], v[44:47], v[192:195]
    v_mfma_f32_16x16x32_bf16 v[196:199], a[76:79], v[44:47], v[196:199]
    ds_read_b128 v[100:103], v7 offset:5120
    v_mfma_f32_16x16x32_bf16 v[200:203], a[132:135], v[44:47], v[200:203]
    v_mfma_f32_16x16x32_bf16 v[204:207], a[188:191], v[44:47], v[204:207]
    v_mfma_f32_16x16x32_bf16 v[192:195], a[24:27], v[48:51], v[192:195]
    v_mfma_f32_16x16x32_bf16 v[196:199], a[80:83], v[48:51], v[196:199]
    ds_read_b128 v[104:107], v7 offset:6144
    v_mfma_f32_16x16x32_bf16 v[200:203], a[136:139], v[48:51], v[200:203]
    v_mfma_f32_16x16x32_bf16 v[204:207], a[192:195], v[48:51], v[204:207]
    v_mfma_f32_16x16x32_bf16 v[192:195], a[28:31], v[52:55], v[192:195]
    v_mfma_f32_16x16x32_bf16 v[196:199], a[84:87], v[52:55], v[196:199]
    ds_read_b128 v[108:111], v7 offset:7168
    v_mfma_f32_16x16x32_bf16 v[200:203], a[140:143], v[52:55], v[200:203]
    v_mfma_f32_16x16x32_bf16 v[204:207], a[196:199], v[52:55], v[204:207]
    v_mfma_f32_16x16x32_bf16 v[192:195], a[32:35], v[56:59], v[192:195]
    v_mfma_f32_16x16x32_bf16 v[196:199], a[88:91], v[56:59], v[196:199]
    ds_read_b128 v[112:115], v7 offset:8192
    v_mfma_f32_16x16x32_bf16 v[200:203], a[144:147], v[56:59], v[200:203]
    v_mfma_f32_16x16x32_bf16 v[204:207], a[200:203], v[56:59], v[204:207]
    v_mfma_f32_16x16x32_bf16 v[192:195], a[36:39], v[60:63], v[192:195]
    v_mfma_f32_16x16x32_bf16 v[196:199], a[92:95], v[60:63], v[196:199]
    ds_read_b128 v[116:119], v7 offset:9216
    v_mfma_f32_16x16x32_bf16 v[200:203], a[148:151], v[60:63], v[200:203]
    v_mfma_f32_16x16x32_bf16 v[204:207], a[204:207], v[60:63], v[204:207]
    v_mfma_f32_16x16x32_bf16 v[192:195], a[40:43], v[64:67], v[192:195]
    v_mfma_f32_16x16x32_bf16 v[196:199], a[96:99], v[64:67], v[196:199]
    ds_read_b128 v[120:123], v7 offset:10240
    v_mfma_f32_16x16x32_bf16 v[200:203], a[152:155], v[64:67], v[200:203]
    v_mfma_f32_16x16x32_bf16 v[204:207], a[208:211], v[64:67], v[204:207]
    v_mfma_f32_16x16x32_bf16 v[192:195], a[44:47], v[68:71], v[192:195]
    v_mfma_f32_16x16x32_bf16 v[196:199], a[100:103], v[68:71], v[196:199]
    ds_read_b128 v[124:127], v7 offset:11264
    v_mfma_f32_16x16x32_bf16 v[200:203], a[156:159], v[68:71], v[200:203]
    v_mfma_f32_16x16x32_bf16 v[204:207], a[212:215], v[68:71], v[204:207]
    v_mfma_f32_16x16x32_bf16 v[192:195], a[48:51], v[72:75], v[192:195]
    v_mfma_f32_16x16x32_bf16 v[196:199], a[104:107], v[72:75], v[196:199]
    ds_read_b128 v[128:131], v7 offset:12288
    v_mfma_f32_16x16x32_bf16 v[200:203], a[160:163], v[72:75], v[200:203]
    v_mfma_f32_16x16x32_bf16 v[204:207], a[216:219], v[72:75], v[204:207]
    v_mfma_f32_16x16x32_bf16 v[192:195], a[52:55], v[76:79], v[192:195]
    v_mfma_f32_16x16x32_bf16 v[196:199], a[108:111], v[76:79], v[196:199]
    ds_read_b128 v[132:135], v7 offset:13312
    v_mfma_f32_16x16x32_bf16 v[200:203], a[164:167], v[76:79], v[200:203]
    v_mfma_f32_16x16x32_bf16 v[204:207], a[220:223], v[76:79], v[204:207]
    s_nop 7
    v_cvt_pk_bf16_f32 v216, v192, v193
    v_cvt_pk_bf16_f32 v217, v194, v195
    v_cvt_pk_bf16_f32 v218, v196, v197
    v_cvt_pk_bf16_f32 v219, v198, v199
    global_store_dwordx4 v2, v[216:219], s[34:35] offset:3072 sc1
    v_cvt_pk_bf16_f32 v220, v200, v201
    v_cvt_pk_bf16_f32 v221, v202, v203
    v_cvt_pk_bf16_f32 v222, v204, v205
    v_cvt_pk_bf16_f32 v223, v206, v207
    global_store_dwordx4 v2, v[220:223], s[36:37] offset:3072 sc1
    s_waitcnt lgkmcnt(0)
    v_mfma_f32_16x16x32_bf16 v[192:195], a[0:3], v[80:83], 0
    v_mfma_f32_16x16x32_bf16 v[196:199], a[56:59], v[80:83], 0
    ds_read_b128 v[136:139], v7 offset:14336
    v_mfma_f32_16x16x32_bf16 v[200:203], a[112:115], v[80:83], 0
    v_mfma_f32_16x16x32_bf16 v[204:207], a[168:171], v[80:83], 0
    s_add_u32 m0, s39, 0
    s_nop 0
    global_load_lds_dwordx4 v12, s[30:31] offset:0 sc1
    s_add_u32 m0, s39, 0
    s_nop 0
    global_load_lds_dwordx4 v12, s[30:31] offset:1024 sc1
    v_mfma_f32_16x16x32_bf16 v[192:195], a[4:7], v[84:87], v[192:195]
    v_mfma_f32_16x16x32_bf16 v[196:199], a[60:63], v[84:87], v[196:199]
    ds_read_b128 v[140:143], v7 offset:15360
    v_mfma_f32_16x16x32_bf16 v[200:203], a[116:119], v[84:87], v[200:203]
    v_mfma_f32_16x16x32_bf16 v[204:207], a[172:175], v[84:87], v[204:207]
    s_add_u32 m0, s39, 0
    s_nop 0
    global_load_lds_dwordx4 v12, s[30:31] offset:2048 sc1
    s_add_u32 m0, s39, 0
    s_nop 0
    global_load_lds_dwordx4 v12, s[30:31] offset:3072 sc1
    v_mfma_f32_16x16x32_bf16 v[192:195], a[8:11], v[88:91], v[192:195]
    v_mfma_f32_16x16x32_bf16 v[196:199], a[64:67], v[88:91], v[196:199]
    ds_read_b128 v[144:147], v7 offset:16384
    v_mfma_f32_16x16x32_bf16 v[200:203], a[120:123], v[88:91], v[200:203]
    v_mfma_f32_16x16x32_bf16 v[204:207], a[176:179], v[88:91], v[204:207]
    s_add_u32 m0, s39, 4096
    s_nop 0
    global_load_lds_dwordx4 v13, s[30:31] offset:0 sc1
    s_add_u32 m0, s39, 4096
    s_nop 0
    global_load_lds_dwordx4 v13, s[30:31] offset:1024 sc1
    v_mfma_f32_16x16x32_bf16 v[192:195], a[12:15], v[92:95], v[192:195]
    v_mfma_f32_16x16x32_bf16 v[196:199], a[68:71], v[92:95], v[196:199]
    ds_read_b128 v[148:151], v7 offset:17408
    v_mfma_f32_16x16x32_bf16 v[200:203], a[124:127], v[92:95], v[200:203]
    v_mfma_f32_16x16x32_bf16 v[204:207], a[180:183], v[92:95], v[204:207]
    s_add_u32 m0, s39, 4096
    s_nop 0
    global_load_lds_dwordx4 v13, s[30:31] offset:2048 sc1
    s_add_u32 s30, s30, 0x7000
    s_addc_u32 s31, s31, 0
    v_mfma_f32_16x16x32_bf16 v[192:195], a[16:19], v[96:99], v[192:195]
    v_mfma_f32_16x16x32_bf16 v[196:199], a[72:75], v[96:99], v[196:199]
    ds_read_b128 v[152:155], v7 offset:18432
    v_mfma_f32_16x16x32_bf16 v[200:203], a[128:131], v[96:99], v[200:203]
    v_mfma_f32_16x16x32_bf16 v[204:207], a[184:187], v[96:99], v[204:207]
    v_mfma_f32_16x16x32_bf16 v[192:195], a[20:23], v[100:103], v[192:195]
    v_mfma_f32_16x16x32_bf16 v[196:199], a[76:79], v[100:103], v[196:199]
    ds_read_b128 v[156:159], v7 offset:19456
    v_mfma_f32_16x16x32_bf16 v[200:203], a[132:135], v[100:103], v[200:203]
    v_mfma_f32_16x16x32_bf16 v[204:207], a[188:191], v[100:103], v[204:207]
    v_mfma_f32_16x16x32_bf16 v[192:195], a[24:27], v[104:107], v[192:195]
    v_mfma_f32_16x16x32_bf16 v[196:199], a[80:83], v[104:107], v[196:199]
    ds_read_b128 v[160:163], v7 offset:20480
    v_mfma_f32_16x16x32_bf16 v[200:203], a[136:139], v[104:107], v[200:203]
    v_mfma_f32_16x16x32_bf16 v[204:207], a[192:195], v[104:107], v[204:207]
    v_mfma_f32_16x16x32_bf16 v[192:195], a[28:31], v[108:111], v[192:195]
    v_mfma_f32_16x16x32_bf16 v[196:199], a[84:87], v[108:111], v[196:199]
    ds_read_b128 v[164:167], v7 offset:21504
    v_mfma_f32_16x16x32_bf16 v[200:203], a[140:143], v[108:111], v[200:203]
    v_mfma_f32_16x16x32_bf16 v[204:207], a[196:199], v[108:111], v[204:207]
    v_mfma_f32_16x16x32_bf16 v[192:195], a[32:35], v[112:115], v[192:195]
    v_mfma_f32_16x16x32_bf16 v[196:199], a[88:91], v[112:115], v[196:199]
    ds_read_b128 v[168:171], v7 offset:22528
    v_mfma_f32_16x16x32_bf16 v[200:203], a[144:147], v[112:115], v[200:203]
    v_mfma_f32_16x16x32_bf16 v[204:207], a[200:203], v[112:115], v[204:207]
    v_mfma_f32_16x16x32_bf16 v[192:195], a[36:39], v[116:119], v[192:195]
    v_mfma_f32_16x16x32_bf16 v[196:199], a[92:95], v[116:119], v[196:199]
    ds_read_b128 v[172:175], v7 offset:23552
    v_mfma_f32_16x16x32_bf16 v[200:203], a[148:151], v[116:119], v[200:203]
    v_mfma_f32_16x16x32_bf16 v[204:207], a[204:207], v[116:119], v[204:207]
    v_mfma_f32_16x16x32_bf16 v[192:195], a[40:43], v[120:123], v[192:195]
    v_mfma_f32_16x16x32_bf16 v[196:199], a[96:99], v[120:123], v[196:199]
    ds_read_b128 v[176:179], v7 offset:24576
    v_mfma_f32_16x16x32_bf16 v[200:203], a[152:155], v[120:123], v[200:203]
    v_mfma_f32_16x16x32_bf16 v[204:207], a[208:211], v[120:123], v[204:207]
    v_mfma_f32_16x16x32_bf16 v[192:195], a[44:47], v[124:127], v[192:195]
    v_mfma_f32_16x16x32_bf16 v[196:199], a[100:103], v[124:127], v[196:199]
    ds_read_b128 v[180:183], v7 offset:25600
    v_mfma_f32_16x16x32_bf16 v[200:203], a[156:159], v[124:127], v[200:203]
    v_mfma_f32_16x16x32_bf16 v[204:207], a[212:215], v[124:127], v[204:207]
    v_mfma_f32_16x16x32_bf16 v[192:195], a[48:51], v[128:131], v[192:195]
    v_mfma_f32_16x16x32_bf16 v[196:199], a[104:107], v[128:131], v[196:199]
    ds_read_b128 v[184:187], v7 offset:26624
    v_mfma_f32_16x16x32_bf16 v[200:203], a[160:163], v[128:131], v[200:203]
    v_mfma_f32_16x16x32_bf16 v[204:207], a[216:219], v[128:131], v[204:207]
    v_mfma_f32_16x16x32_bf16 v[192:195], a[52:55], v[132:135], v[192:195]
    v_mfma_f32_16x16x32_bf16 v[196:199], a[108:111], v[132:135], v[196:199]
    ds_read_b128 v[188:191], v7 offset:27648
    v_mfma_f32_16x16x32_bf16 v[200:203], a[164:167], v[132:135], v[200:203]
    v_mfma_f32_16x16x32_bf16 v[204:207], a[220:223], v[132:135], v[204:207]
    s_nop 7
    v_cvt_pk_bf16_f32 v208, v192, v193
    v_cvt_pk_bf16_f32 v209, v194, v195
    v_cvt_pk_bf16_f32 v210, v196, v197
    v_cvt_pk_bf16_f32 v211, v198, v199
    global_store_dwordx4 v3, v[208:211], s[34:35] offset:0 sc1
    v_cvt_pk_bf16_f32 v212, v200, v201
    v_cvt_pk_bf16_f32 v213, v202, v203
    v_cvt_pk_bf16_f32 v214, v204, v205
    v_cvt_pk_bf16_f32 v215, v206, v207
    global_store_dwordx4 v3, v[212:215], s[36:37] offset:0 sc1
    s_waitcnt lgkmcnt(0)
    s_waitcnt vmcnt(24)
    s_barrier
    v_mfma_f32_16x16x32_bf16 v[192:195], a[0:3], v[136:139], 0
    v_mfma_f32_16x16x32_bf16 v[196:199], a[56:59], v[136:139], 0
    ds_read_b128 v[24:27], v7 offset:28672
    v_mfma_f32_16x16x32_bf16 v[200:203], a[112:115], v[136:139], 0
    v_mfma_f32_16x16x32_bf16 v[204:207], a[168:171], v[136:139], 0
    v_mfma_f32_16x16x32_bf16 v[192:195], a[4:7], v[140:143], v[192:195]
    v_mfma_f32_16x16x32_bf16 v[196:199], a[60:63], v[140:143], v[196:199]
    ds_read_b128 v[28:31], v7 offset:29696
    v_mfma_f32_16x16x32_bf16 v[200:203], a[116:119], v[140:143], v[200:203]
    v_mfma_f32_16x16x32_bf16 v[204:207], a[172:175], v[140:143], v[204:207]
    v_mfma_f32_16x16x32_bf16 v[192:195], a[8:11], v[144:147], v[192:195]
    v_mfma_f32_16x16x32_bf16 v[196:199], a[64:67], v[144:147], v[196:199]
    ds_read_b128 v[32:35], v7 offset:30720
    v_mfma_f32_16x16x32_bf16 v[200:203], a[120:123], v[144:147], v[200:203]
    v_mfma_f32_16x16x32_bf16 v[204:207], a[176:179], v[144:147], v[204:207]
    v_mfma_f32_16x16x32_bf16 v[192:195], a[12:15], v[148:151], v[192:195]
    v_mfma_f32_16x16x32_bf16 v[196:199], a[68:71], v[148:151], v[196:199]
    ds_read_b128 v[36:39], v7 offset:31744
    v_mfma_f32_16x16x32_bf16 v[200:203], a[124:127], v[148:151], v[200:203]
    v_mfma_f32_16x16x32_bf16 v[204:207], a[180:183], v[148:151], v[204:207]
    v_mfma_f32_16x16x32_bf16 v[192:195], a[16:19], v[152:155], v[192:195]
    v_mfma_f32_16x16x32_bf16 v[196:199], a[72:75], v[152:155], v[196:199]
    ds_read_b128 v[40:43], v7 offset:32768
    v_mfma_f32_16x16x32_bf16 v[200:203], a[128:131], v[152:155], v[200:203]
    v_mfma_f32_16x16x32_bf16 v[204:207], a[184:187], v[152:155], v[204:207]
    v_mfma_f32_16x16x32_bf16 v[192:195], a[20:23], v[156:159], v[192:195]
    v_mfma_f32_16x16x32_bf16 v[196:199], a[76:79], v[156:159], v[196:199]
    ds_read_b128 v[44:47], v7 offset:33792
    v_mfma_f32_16x16x32_bf16 v[200:203], a[132:135], v[156:159], v[200:203]
    v_mfma_f32_16x16x32_bf16 v[204:207], a[188:191], v[156:159], v[204:207]
    v_mfma_f32_16x16x32_bf16 v[192:195], a[24:27], v[160:163], v[192:195]
    v_mfma_f32_16x16x32_bf16 v[196:199], a[80:83], v[160:163], v[196:199]
    ds_read_b128 v[48:51], v7 offset:34816
    v_mfma_f32_16x16x32_bf16 v[200:203], a[136:139], v[160:163], v[200:203]
    v_mfma_f32_16x16x32_bf16 v[204:207], a[192:195], v[160:163], v[204:207]
    v_mfma_f32_16x16x32_bf16 v[192:195], a[28:31], v[164:167], v[192:195]
    v_mfma_f32_16x16x32_bf16 v[196:199], a[84:87], v[164:167], v[196:199]
    ds_read_b128 v[52:55], v7 offset:35840
    v_mfma_f32_16x16x32_bf16 v[200:203], a[140:143], v[164:167], v[200:203]
    v_mfma_f32_16x16x32_bf16 v[204:207], a[196:199], v[164:167], v[204:207]
    v_mfma_f32_16x16x32_bf16 v[192:195], a[32:35], v[168:171], v[192:195]
    v_mfma_f32_16x16x32_bf16 v[196:199], a[88:91], v[168:171], v[196:199]
    ds_read_b128 v[56:59], v7 offset:36864
    v_mfma_f32_16x16x32_bf16 v[200:203], a[144:147], v[168:171], v[200:203]
    v_mfma_f32_16x16x32_bf16 v[204:207], a[200:203], v[168:171], v[204:207]
    v_mfma_f32_16x16x32_bf16 v[192:195], a[36:39], v[172:175], v[192:195]
    v_mfma_f32_16x16x32_bf16 v[196:199], a[92:95], v[172:175], v[196:199]
    ds_read_b128 v[60:63], v7 offset:37888
    v_mfma_f32_16x16x32_bf16 v[200:203], a[148:151], v[172:175], v[200:203]
    v_mfma_f32_16x16x32_bf16 v[204:207], a[204:207], v[172:175], v[204:207]
    v_mfma_f32_16x16x32_bf16 v[192:195], a[40:43], v[176:179], v[192:195]
    v_mfma_f32_16x16x32_bf16 v[196:199], a[96:99], v[176:179], v[196:199]
    ds_read_b128 v[64:67], v7 offset:38912
    v_mfma_f32_16x16x32_bf16 v[200:203], a[152:155], v[176:179], v[200:203]
    v_mfma_f32_16x16x32_bf16 v[204:207], a[208:211], v[176:179], v[204:207]
    v_mfma_f32_16x16x32_bf16 v[192:195], a[44:47], v[180:183], v[192:195]
    v_mfma_f32_16x16x32_bf16 v[196:199], a[100:103], v[180:183], v[196:199]
    ds_read_b128 v[68:71], v7 offset:39936
    v_mfma_f32_16x16x32_bf16 v[200:203], a[156:159], v[180:183], v[200:203]
    v_mfma_f32_16x16x32_bf16 v[204:207], a[212:215], v[180:183], v[204:207]
    v_mfma_f32_16x16x32_bf16 v[192:195], a[48:51], v[184:187], v[192:195]
    v_mfma_f32_16x16x32_bf16 v[196:199], a[104:107], v[184:187], v[196:199]
    ds_read_b128 v[72:75], v7 offset:40960
    v_mfma_f32_16x16x32_bf16 v[200:203], a[160:163], v[184:187], v[200:203]
    v_mfma_f32_16x16x32_bf16 v[204:207], a[216:219], v[184:187], v[204:207]
    v_mfma_f32_16x16x32_bf16 v[192:195], a[52:55], v[188:191], v[192:195]
    v_mfma_f32_16x16x32_bf16 v[196:199], a[108:111], v[188:191], v[196:199]
    ds_read_b128 v[76:79], v7 offset:41984
    v_mfma_f32_16x16x32_bf16 v[200:203], a[164:167], v[188:191], v[200:203]
    v_mfma_f32_16x16x32_bf16 v[204:207], a[220:223], v[188:191], v[204:207]
    s_nop 7
    v_cvt_pk_bf16_f32 v216, v192, v193
    v_cvt_pk_bf16_f32 v217, v194, v195
    v_cvt_pk_bf16_f32 v218, v196, v197
    v_cvt_pk_bf16_f32 v219, v198, v199
    global_store_dwordx4 v3, v[216:219], s[34:35] offset:1024 sc1
    v_cvt_pk_bf16_f32 v220, v200, v201
    v_cvt_pk_bf16_f32 v221, v202, v203
    v_cvt_pk_bf16_f32 v222, v204, v205
    v_cvt_pk_bf16_f32 v223, v206, v207
    global_store_dwordx4 v3, v[220:223], s[36:37] offset:1024 sc1
    s_waitcnt lgkmcnt(0)
    v_mfma_f32_16x16x32_bf16 v[192:195], a[0:3], v[24:27], 0
    v_mfma_f32_16x16x32_bf16 v[196:199], a[56:59], v[24:27], 0
    ds_read_b128 v[80:83], v7 offset:43008
    v_mfma_f32_16x16x32_bf16 v[200:203], a[112:115], v[24:27], 0
    v_mfma_f32_16x16x32_bf16 v[204:207], a[168:171], v[24:27], 0
    s_add_u32 m0, s39, 28672
    s_nop 0
    global_load_lds_dwordx4 v12, s[30:31] offset:0 sc1
    s_add_u32 m0, s39, 28672
    s_nop 0
    global_load_lds_dwordx4 v12, s[30:31] offset:1024 sc1
    v_mfma_f32_16x16x32_bf16 v[192:195], a[4:7], v[28:31], v[192:195]
    v_mfma_f32_16x16x32_bf16 v[196:199], a[60:63], v[28:31], v[196:199]
    ds_read_b128 v[84:87], v7 offset:44032
    v_mfma_f32_16x16x32_bf16 v[200:203], a[116:119], v[28:31], v[200:203]
    v_mfma_f32_16x16x32_bf16 v[204:207], a[172:175], v[28:31], v[204:207]
    s_add_u32 m0, s39, 28672
    s_nop 0
    global_load_lds_dwordx4 v12, s[30:31] offset:2048 sc1
    s_add_u32 m0, s39, 28672
    s_nop 0
    global_load_lds_dwordx4 v12, s[30:31] offset:3072 sc1
    v_mfma_f32_16x16x32_bf16 v[192:195], a[8:11], v[32:35], v[192:195]
    v_mfma_f32_16x16x32_bf16 v[196:199], a[64:67], v[32:35], v[196:199]
    ds_read_b128 v[88:91], v7 offset:45056
    v_mfma_f32_16x16x32_bf16 v[200:203], a[120:123], v[32:35], v[200:203]
    v_mfma_f32_16x16x32_bf16 v[204:207], a[176:179], v[32:35], v[204:207]
    s_add_u32 m0, s39, 32768
    s_nop 0
    global_load_lds_dwordx4 v13, s[30:31] offset:0 sc1
    s_add_u32 m0, s39, 32768
    s_nop 0
    global_load_lds_dwordx4 v13, s[30:31] offset:1024 sc1
    v_mfma_f32_16x16x32_bf16 v[192:195], a[12:15], v[36:39], v[192:195]
    v_mfma_f32_16x16x32_bf16 v[196:199], a[68:71], v[36:39], v[196:199]
    ds_read_b128 v[92:95], v7 offset:46080
    v_mfma_f32_16x16x32_bf16 v[200:203], a[124:127], v[36:39], v[200:203]
    v_mfma_f32_16x16x32_bf16 v[204:207], a[180:183], v[36:39], v[204:207]
    s_add_u32 m0, s39, 32768
    s_nop 0
    global_load_lds_dwordx4 v13, s[30:31] offset:2048 sc1
    s_add_u32 s30, s30, 0x7000
    s_addc_u32 s31, s31, 0
    v_mfma_f32_16x16x32_bf16 v[192:195], a[16:19], v[40:43], v[192:195]
    v_mfma_f32_16x16x32_bf16 v[196:199], a[72:75], v[40:43], v[196:199]
    ds_read_b128 v[96:99], v7 offset:47104
    v_mfma_f32_16x16x32_bf16 v[200:203], a[128:131], v[40:43], v[200:203]
    v_mfma_f32_16x16x32_bf16 v[204:207], a[184:187], v[40:43], v[204:207]
    v_mfma_f32_16x16x32_bf16 v[192:195], a[20:23], v[44:47], v[192:195]
    v_mfma_f32_16x16x32_bf16 v[196:199], a[76:79], v[44:47], v[196:199]
    ds_read_b128 v[100:103], v7 offset:48128
    v_mfma_f32_16x16x32_bf16 v[200:203], a[132:135], v[44:47], v[200:203]
    v_mfma_f32_16x16x32_bf16 v[204:207], a[188:191], v[44:47], v[204:207]
    v_mfma_f32_16x16x32_bf16 v[192:195], a[24:27], v[48:51], v[192:195]
    v_mfma_f32_16x16x32_bf16 v[196:199], a[80:83], v[48:51], v[196:199]
    ds_read_b128 v[104:107], v7 offset:49152
    v_mfma_f32_16x16x32_bf16 v[200:203], a[136:139], v[48:51], v[200:203]
    v_mfma_f32_16x16x32_bf16 v[204:207], a[192:195], v[48:51], v[204:207]
    v_mfma_f32_16x16x32_bf16 v[192:195], a[28:31], v[52:55], v[192:195]
    v_mfma_f32_16x16x32_bf16 v[196:199], a[84:87], v[52:55], v[196:199]
    ds_read_b128 v[108:111], v7 offset:50176
    v_mfma_f32_16x16x32_bf16 v[200:203], a[140:143], v[52:55], v[200:203]
    v_mfma_f32_16x16x32_bf16 v[204:207], a[196:199], v[52:55], v[204:207]
    v_mfma_f32_16x16x32_bf16 v[192:195], a[32:35], v[56:59], v[192:195]
    v_mfma_f32_16x16x32_bf16 v[196:199], a[88:91], v[56:59], v[196:199]
    ds_read_b128 v[112:115], v7 offset:51200
    v_mfma_f32_16x16x32_bf16 v[200:203], a[144:147], v[56:59], v[200:203]
    v_mfma_f32_16x16x32_bf16 v[204:207], a[200:203], v[56:59], v[204:207]
    v_mfma_f32_16x16x32_bf16 v[192:195], a[36:39], v[60:63], v[192:195]
    v_mfma_f32_16x16x32_bf16 v[196:199], a[92:95], v[60:63], v[196:199]
    ds_read_b128 v[116:119], v7 offset:52224
    v_mfma_f32_16x16x32_bf16 v[200:203], a[148:151], v[60:63], v[200:203]
    v_mfma_f32_16x16x32_bf16 v[204:207], a[204:207], v[60:63], v[204:207]
    v_mfma_f32_16x16x32_bf16 v[192:195], a[40:43], v[64:67], v[192:195]
    v_mfma_f32_16x16x32_bf16 v[196:199], a[96:99], v[64:67], v[196:199]
    ds_read_b128 v[120:123], v7 offset:53248
    v_mfma_f32_16x16x32_bf16 v[200:203], a[152:155], v[64:67], v[200:203]
    v_mfma_f32_16x16x32_bf16 v[204:207], a[208:211], v[64:67], v[204:207]
    v_mfma_f32_16x16x32_bf16 v[192:195], a[44:47], v[68:71], v[192:195]
    v_mfma_f32_16x16x32_bf16 v[196:199], a[100:103], v[68:71], v[196:199]
    ds_read_b128 v[124:127], v7 offset:54272
    v_mfma_f32_16x16x32_bf16 v[200:203], a[156:159], v[68:71], v[200:203]
    v_mfma_f32_16x16x32_bf16 v[204:207], a[212:215], v[68:71], v[204:207]
    v_mfma_f32_16x16x32_bf16 v[192:195], a[48:51], v[72:75], v[192:195]
    v_mfma_f32_16x16x32_bf16 v[196:199], a[104:107], v[72:75], v[196:199]
    ds_read_b128 v[128:131], v7 offset:55296
    v_mfma_f32_16x16x32_bf16 v[200:203], a[160:163], v[72:75], v[200:203]
    v_mfma_f32_16x16x32_bf16 v[204:207], a[216:219], v[72:75], v[204:207]
    v_mfma_f32_16x16x32_bf16 v[192:195], a[52:55], v[76:79], v[192:195]
    v_mfma_f32_16x16x32_bf16 v[196:199], a[108:111], v[76:79], v[196:199]
    ds_read_b128 v[132:135], v7 offset:56320
    v_mfma_f32_16x16x32_bf16 v[200:203], a[164:167], v[76:79], v[200:203]
    v_mfma_f32_16x16x32_bf16 v[204:207], a[220:223], v[76:79], v[204:207]
    s_nop 7
    v_cvt_pk_bf16_f32 v208, v192, v193
    v_cvt_pk_bf16_f32 v209, v194, v195
    v_cvt_pk_bf16_f32 v210, v196, v197
    v_cvt_pk_bf16_f32 v211, v198, v199
    global_store_dwordx4 v3, v[208:211], s[34:35] offset:2048 sc1
    v_cvt_pk_bf16_f32 v212, v200, v201
    v_cvt_pk_bf16_f32 v213, v202, v203
    v_cvt_pk_bf16_f32 v214, v204, v205
    v_cvt_pk_bf16_f32 v215, v206, v207
    global_store_dwordx4 v3, v[212:215], s[36:37] offset:2048 sc1
    s_waitcnt lgkmcnt(0)
    s_waitcnt vmcnt(24)
    s_barrier
    v_mfma_f32_16x16x32_bf16 v[192:195], a[0:3], v[80:83], 0
    v_mfma_f32_16x16x32_bf16 v[196:199], a[56:59], v[80:83], 0
    ds_read_b128 v[136:139], v8 offset:0
    v_mfma_f32_16x16x32_bf16 v[200:203], a[112:115], v[80:83], 0
    v_mfma_f32_16x16x32_bf16 v[204:207], a[168:171], v[80:83], 0
    v_mfma_f32_16x16x32_bf16 v[192:195], a[4:7], v[84:87], v[192:195]
    v_mfma_f32_16x16x32_bf16 v[196:199], a[60:63], v[84:87], v[196:199]
    ds_read_b128 v[140:143], v8 offset:1024
    v_mfma_f32_16x16x32_bf16 v[200:203], a[116:119], v[84:87], v[200:203]
    v_mfma_f32_16x16x32_bf16 v[204:207], a[172:175], v[84:87], v[204:207]
    v_mfma_f32_16x16x32_bf16 v[192:195], a[8:11], v[88:91], v[192:195]
    v_mfma_f32_16x16x32_bf16 v[196:199], a[64:67], v[88:91], v[196:199]
    ds_read_b128 v[144:147], v8 offset:2048
    v_mfma_f32_16x16x32_bf16 v[200:203], a[120:123], v[88:91], v[200:203]
    v_mfma_f32_16x16x32_bf16 v[204:207], a[176:179], v[88:91], v[204:207]
    v_mfma_f32_16x16x32_bf16 v[192:195], a[12:15], v[92:95], v[192:195]
    v_mfma_f32_16x16x32_bf16 v[196:199], a[68:71], v[92:95], v[196:199]
    ds_read_b128 v[148:151], v8 offset:3072
    v_mfma_f32_16x16x32_bf16 v[200:203], a[124:127], v[92:95], v[200:203]
    v_mfma_f32_16x16x32_bf16 v[204:207], a[180:183], v[92:95], v[204:207]
    v_mfma_f32_16x16x32_bf16 v[192:195], a[16:19], v[96:99], v[192:195]
    v_mfma_f32_16x16x32_bf16 v[196:199], a[72:75], v[96:99], v[196:199]
    ds_read_b128 v[152:155], v8 offset:4096
    v_mfma_f32_16x16x32_bf16 v[200:203], a[128:131], v[96:99], v[200:203]
    v_mfma_f32_16x16x32_bf16 v[204:207], a[184:187], v[96:99], v[204:207]
    v_mfma_f32_16x16x32_bf16 v[192:195], a[20:23], v[100:103], v[192:195]
    v_mfma_f32_16x16x32_bf16 v[196:199], a[76:79], v[100:103], v[196:199]
    ds_read_b128 v[156:159], v8 offset:5120
    v_mfma_f32_16x16x32_bf16 v[200:203], a[132:135], v[100:103], v[200:203]
    v_mfma_f32_16x16x32_bf16 v[204:207], a[188:191], v[100:103], v[204:207]
    v_mfma_f32_16x16x32_bf16 v[192:195], a[24:27], v[104:107], v[192:195]
    v_mfma_f32_16x16x32_bf16 v[196:199], a[80:83], v[104:107], v[196:199]
    ds_read_b128 v[160:163], v8 offset:6144
    v_mfma_f32_16x16x32_bf16 v[200:203], a[136:139], v[104:107], v[200:203]
    v_mfma_f32_16x16x32_bf16 v[204:207], a[192:195], v[104:107], v[204:207]
    v_mfma_f32_16x16x32_bf16 v[192:195], a[28:31], v[108:111], v[192:195]
    v_mfma_f32_16x16x32_bf16 v[196:199], a[84:87], v[108:111], v[196:199]
    ds_read_b128 v[164:167], v8 offset:7168
    v_mfma_f32_16x16x32_bf16 v[200:203], a[140:143], v[108:111], v[200:203]
    v_mfma_f32_16x16x32_bf16 v[204:207], a[196:199], v[108:111], v[204:207]
    v_mfma_f32_16x16x32_bf16 v[192:195], a[32:35], v[112:115], v[192:195]
    v_mfma_f32_16x16x32_bf16 v[196:199], a[88:91], v[112:115], v[196:199]
    ds_read_b128 v[168:171], v8 offset:8192
    v_mfma_f32_16x16x32_bf16 v[200:203], a[144:147], v[112:115], v[200:203]
    v_mfma_f32_16x16x32_bf16 v[204:207], a[200:203], v[112:115], v[204:207]
    v_mfma_f32_16x16x32_bf16 v[192:195], a[36:39], v[116:119], v[192:195]
    v_mfma_f32_16x16x32_bf16 v[196:199], a[92:95], v[116:119], v[196:199]
    ds_read_b128 v[172:175], v8 offset:9216
    v_mfma_f32_16x16x32_bf16 v[200:203], a[148:151], v[116:119], v[200:203]
    v_mfma_f32_16x16x32_bf16 v[204:207], a[204:207], v[116:119], v[204:207]
    v_mfma_f32_16x16x32_bf16 v[192:195], a[40:43], v[120:123], v[192:195]
    v_mfma_f32_16x16x32_bf16 v[196:199], a[96:99], v[120:123], v[196:199]
    ds_read_b128 v[176:179], v8 offset:10240
    v_mfma_f32_16x16x32_bf16 v[200:203], a[152:155], v[120:123], v[200:203]
    v_mfma_f32_16x16x32_bf16 v[204:207], a[208:211], v[120:123], v[204:207]
    v_mfma_f32_16x16x32_bf16 v[192:195], a[44:47], v[124:127], v[192:195]
    v_mfma_f32_16x16x32_bf16 v[196:199], a[100:103], v[124:127], v[196:199]
    ds_read_b128 v[180:183], v8 offset:11264
    v_mfma_f32_16x16x32_bf16 v[200:203], a[156:159], v[124:127], v[200:203]
    v_mfma_f32_16x16x32_bf16 v[204:207], a[212:215], v[124:127], v[204:207]
    v_mfma_f32_16x16x32_bf16 v[192:195], a[48:51], v[128:131], v[192:195]
    v_mfma_f32_16x16x32_bf16 v[196:199], a[104:107], v[128:131], v[196:199]
    ds_read_b128 v[184:187], v8 offset:12288
    v_mfma_f32_16x16x32_bf16 v[200:203], a[160:163], v[128:131], v[200:203]
    v_mfma_f32_16x16x32_bf16 v[204:207], a[216:219], v[128:131], v[204:207]
    v_mfma_f32_16x16x32_bf16 v[192:195], a[52:55], v[132:135], v[192:195]
    v_mfma_f32_16x16x32_bf16 v[196:199], a[108:111], v[132:135], v[196:199]
    ds_read_b128 v[188:191], v8 offset:13312
    v_mfma_f32_16x16x32_bf16 v[200:203], a[164:167], v[132:135], v[200:203]
    v_mfma_f32_16x16x32_bf16 v[204:207], a[220:223], v[132:135], v[204:207]
    s_nop 7
    v_cvt_pk_bf16_f32 v216, v192, v193
    v_cvt_pk_bf16_f32 v217, v194, v195
    v_cvt_pk_bf16_f32 v218, v196, v197
    v_cvt_pk_bf16_f32 v219, v198, v199
    global_store_dwordx4 v3, v[216:219], s[34:35] offset:3072 sc1
    v_cvt_pk_bf16_f32 v220, v200, v201
    v_cvt_pk_bf16_f32 v221, v202, v203
    v_cvt_pk_bf16_f32 v222, v204, v205
    v_cvt_pk_bf16_f32 v223, v206, v207
    global_store_dwordx4 v3, v[220:223], s[36:37] offset:3072 sc1
    s_waitcnt lgkmcnt(0)
    v_mfma_f32_16x16x32_bf16 v[192:195], a[0:3], v[136:139], 0
    v_mfma_f32_16x16x32_bf16 v[196:199], a[56:59], v[136:139], 0
    ds_read_b128 v[24:27], v8 offset:14336
    v_mfma_f32_16x16x32_bf16 v[200:203], a[112:115], v[136:139], 0
    v_mfma_f32_16x16x32_bf16 v[204:207], a[168:171], v[136:139], 0
    s_add_u32 m0, s39, 57344
    s_nop 0
    global_load_lds_dwordx4 v12, s[30:31] offset:0 sc1
    s_add_u32 m0, s39, 57344
    s_nop 0
    global_load_lds_dwordx4 v12, s[30:31] offset:1024 sc1
    v_mfma_f32_16x16x32_bf16 v[192:195], a[4:7], v[140:143], v[192:195]
    v_mfma_f32_16x16x32_bf16 v[196:199], a[60:63], v[140:143], v[196:199]
    ds_read_b128 v[28:31], v8 offset:15360
    v_mfma_f32_16x16x32_bf16 v[200:203], a[116:119], v[140:143], v[200:203]
    v_mfma_f32_16x16x32_bf16 v[204:207], a[172:175], v[140:143], v[204:207]
    s_add_u32 m0, s39, 57344
    s_nop 0
    global_load_lds_dwordx4 v12, s[30:31] offset:2048 sc1
    s_add_u32 m0, s39, 57344
    s_nop 0
    global_load_lds_dwordx4 v12, s[30:31] offset:3072 sc1
    v_mfma_f32_16x16x32_bf16 v[192:195], a[8:11], v[144:147], v[192:195]
    v_mfma_f32_16x16x32_bf16 v[196:199], a[64:67], v[144:147], v[196:199]
    ds_read_b128 v[32:35], v8 offset:16384
    v_mfma_f32_16x16x32_bf16 v[200:203], a[120:123], v[144:147], v[200:203]
    v_mfma_f32_16x16x32_bf16 v[204:207], a[176:179], v[144:147], v[204:207]
    s_add_u32 m0, s39, 61440
    s_nop 0
    global_load_lds_dwordx4 v13, s[30:31] offset:0 sc1
    s_add_u32 m0, s39, 61440
    s_nop 0
    global_load_lds_dwordx4 v13, s[30:31] offset:1024 sc1
    v_mfma_f32_16x16x32_bf16 v[192:195], a[12:15], v[148:151], v[192:195]
    v_mfma_f32_16x16x32_bf16 v[196:199], a[68:71], v[148:151], v[196:199]
    ds_read_b128 v[36:39], v8 offset:17408
    v_mfma_f32_16x16x32_bf16 v[200:203], a[124:127], v[148:151], v[200:203]
    v_mfma_f32_16x16x32_bf16 v[204:207], a[180:183], v[148:151], v[204:207]
    s_add_u32 m0, s39, 61440
    s_nop 0
    global_load_lds_dwordx4 v13, s[30:31] offset:2048 sc1
    s_add_u32 s30, s30, 0x7000
    s_addc_u32 s31, s31, 0
    v_mfma_f32_16x16x32_bf16 v[192:195], a[16:19], v[152:155], v[192:195]
    v_mfma_f32_16x16x32_bf16 v[196:199], a[72:75], v[152:155], v[196:199]
    ds_read_b128 v[40:43], v8 offset:18432
    v_mfma_f32_16x16x32_bf16 v[200:203], a[128:131], v[152:155], v[200:203]
    v_mfma_f32_16x16x32_bf16 v[204:207], a[184:187], v[152:155], v[204:207]
    v_mfma_f32_16x16x32_bf16 v[192:195], a[20:23], v[156:159], v[192:195]
    v_mfma_f32_16x16x32_bf16 v[196:199], a[76:79], v[156:159], v[196:199]
    ds_read_b128 v[44:47], v8 offset:19456
    v_mfma_f32_16x16x32_bf16 v[200:203], a[132:135], v[156:159], v[200:203]
    v_mfma_f32_16x16x32_bf16 v[204:207], a[188:191], v[156:159], v[204:207]
    v_mfma_f32_16x16x32_bf16 v[192:195], a[24:27], v[160:163], v[192:195]
    v_mfma_f32_16x16x32_bf16 v[196:199], a[80:83], v[160:163], v[196:199]
    ds_read_b128 v[48:51], v8 offset:20480
    v_mfma_f32_16x16x32_bf16 v[200:203], a[136:139], v[160:163], v[200:203]
    v_mfma_f32_16x16x32_bf16 v[204:207], a[192:195], v[160:163], v[204:207]
    v_mfma_f32_16x16x32_bf16 v[192:195], a[28:31], v[164:167], v[192:195]
    v_mfma_f32_16x16x32_bf16 v[196:199], a[84:87], v[164:167], v[196:199]
    ds_read_b128 v[52:55], v8 offset:21504
    v_mfma_f32_16x16x32_bf16 v[200:203], a[140:143], v[164:167], v[200:203]
    v_mfma_f32_16x16x32_bf16 v[204:207], a[196:199], v[164:167], v[204:207]
    v_mfma_f32_16x16x32_bf16 v[192:195], a[32:35], v[168:171], v[192:195]
    v_mfma_f32_16x16x32_bf16 v[196:199], a[88:91], v[168:171], v[196:199]
    ds_read_b128 v[56:59], v8 offset:22528
    v_mfma_f32_16x16x32_bf16 v[200:203], a[144:147], v[168:171], v[200:203]
    v_mfma_f32_16x16x32_bf16 v[204:207], a[200:203], v[168:171], v[204:207]
    v_mfma_f32_16x16x32_bf16 v[192:195], a[36:39], v[172:175], v[192:195]
    v_mfma_f32_16x16x32_bf16 v[196:199], a[92:95], v[172:175], v[196:199]
    ds_read_b128 v[60:63], v8 offset:23552
    v_mfma_f32_16x16x32_bf16 v[200:203], a[148:151], v[172:175], v[200:203]
    v_mfma_f32_16x16x32_bf16 v[204:207], a[204:207], v[172:175], v[204:207]
    v_mfma_f32_16x16x32_bf16 v[192:195], a[40:43], v[176:179], v[192:195]
    v_mfma_f32_16x16x32_bf16 v[196:199], a[96:99], v[176:179], v[196:199]
    ds_read_b128 v[64:67], v8 offset:24576
    v_mfma_f32_16x16x32_bf16 v[200:203], a[152:155], v[176:179], v[200:203]
    v_mfma_f32_16x16x32_bf16 v[204:207], a[208:211], v[176:179], v[204:207]
    v_mfma_f32_16x16x32_bf16 v[192:195], a[44:47], v[180:183], v[192:195]
    v_mfma_f32_16x16x32_bf16 v[196:199], a[100:103], v[180:183], v[196:199]
    ds_read_b128 v[68:71], v8 offset:25600
    v_mfma_f32_16x16x32_bf16 v[200:203], a[156:159], v[180:183], v[200:203]
    v_mfma_f32_16x16x32_bf16 v[204:207], a[212:215], v[180:183], v[204:207]
    v_mfma_f32_16x16x32_bf16 v[192:195], a[48:51], v[184:187], v[192:195]
    v_mfma_f32_16x16x32_bf16 v[196:199], a[104:107], v[184:187], v[196:199]
    ds_read_b128 v[72:75], v8 offset:26624
    v_mfma_f32_16x16x32_bf16 v[200:203], a[160:163], v[184:187], v[200:203]
    v_mfma_f32_16x16x32_bf16 v[204:207], a[216:219], v[184:187], v[204:207]
    v_mfma_f32_16x16x32_bf16 v[192:195], a[52:55], v[188:191], v[192:195]
    v_mfma_f32_16x16x32_bf16 v[196:199], a[108:111], v[188:191], v[196:199]
    ds_read_b128 v[76:79], v8 offset:27648
    v_mfma_f32_16x16x32_bf16 v[200:203], a[164:167], v[188:191], v[200:203]
    v_mfma_f32_16x16x32_bf16 v[204:207], a[220:223], v[188:191], v[204:207]
    s_nop 7
    v_cvt_pk_bf16_f32 v208, v192, v193
    v_cvt_pk_bf16_f32 v209, v194, v195
    v_cvt_pk_bf16_f32 v210, v196, v197
    v_cvt_pk_bf16_f32 v211, v198, v199
    global_store_dwordx4 v4, v[208:211], s[34:35] offset:0 sc1
    v_cvt_pk_bf16_f32 v212, v200, v201
    v_cvt_pk_bf16_f32 v213, v202, v203
    v_cvt_pk_bf16_f32 v214, v204, v205
    v_cvt_pk_bf16_f32 v215, v206, v207
    global_store_dwordx4 v4, v[212:215], s[36:37] offset:0 sc1
    s_waitcnt lgkmcnt(0)
    s_waitcnt vmcnt(24)
    s_barrier
    v_mfma_f32_16x16x32_bf16 v[192:195], a[0:3], v[24:27], 0
    v_mfma_f32_16x16x32_bf16 v[196:199], a[56:59], v[24:27], 0
    ds_read_b128 v[80:83], v6 offset:0
    v_mfma_f32_16x16x32_bf16 v[200:203], a[112:115], v[24:27], 0
    v_mfma_f32_16x16x32_bf16 v[204:207], a[168:171], v[24:27], 0
    v_mfma_f32_16x16x32_bf16 v[192:195], a[4:7], v[28:31], v[192:195]
    v_mfma_f32_16x16x32_bf16 v[196:199], a[60:63], v[28:31], v[196:199]
    ds_read_b128 v[84:87], v6 offset:1024
    v_mfma_f32_16x16x32_bf16 v[200:203], a[116:119], v[28:31], v[200:203]
    v_mfma_f32_16x16x32_bf16 v[204:207], a[172:175], v[28:31], v[204:207]
    v_mfma_f32_16x16x32_bf16 v[192:195], a[8:11], v[32:35], v[192:195]
    v_mfma_f32_16x16x32_bf16 v[196:199], a[64:67], v[32:35], v[196:199]
    ds_read_b128 v[88:91], v6 offset:2048
    v_mfma_f32_16x16x32_bf16 v[200:203], a[120:123], v[32:35], v[200:203]
    v_mfma_f32_16x16x32_bf16 v[204:207], a[176:179], v[32:35], v[204:207]
    v_mfma_f32_16x16x32_bf16 v[192:195], a[12:15], v[36:39], v[192:195]
    v_mfma_f32_16x16x32_bf16 v[196:199], a[68:71], v[36:39], v[196:199]
    ds_read_b128 v[92:95], v6 offset:3072
    v_mfma_f32_16x16x32_bf16 v[200:203], a[124:127], v[36:39], v[200:203]
    v_mfma_f32_16x16x32_bf16 v[204:207], a[180:183], v[36:39], v[204:207]
    v_mfma_f32_16x16x32_bf16 v[192:195], a[16:19], v[40:43], v[192:195]
    v_mfma_f32_16x16x32_bf16 v[196:199], a[72:75], v[40:43], v[196:199]
    ds_read_b128 v[96:99], v6 offset:4096
    v_mfma_f32_16x16x32_bf16 v[200:203], a[128:131], v[40:43], v[200:203]
    v_mfma_f32_16x16x32_bf16 v[204:207], a[184:187], v[40:43], v[204:207]
    v_mfma_f32_16x16x32_bf16 v[192:195], a[20:23], v[44:47], v[192:195]
    v_mfma_f32_16x16x32_bf16 v[196:199], a[76:79], v[44:47], v[196:199]
    ds_read_b128 v[100:103], v6 offset:5120
    v_mfma_f32_16x16x32_bf16 v[200:203], a[132:135], v[44:47], v[200:203]
    v_mfma_f32_16x16x32_bf16 v[204:207], a[188:191], v[44:47], v[204:207]
    v_mfma_f32_16x16x32_bf16 v[192:195], a[24:27], v[48:51], v[192:195]
    v_mfma_f32_16x16x32_bf16 v[196:199], a[80:83], v[48:51], v[196:199]
    ds_read_b128 v[104:107], v6 offset:6144
    v_mfma_f32_16x16x32_bf16 v[200:203], a[136:139], v[48:51], v[200:203]
    v_mfma_f32_16x16x32_bf16 v[204:207], a[192:195], v[48:51], v[204:207]
    v_mfma_f32_16x16x32_bf16 v[192:195], a[28:31], v[52:55], v[192:195]
    v_mfma_f32_16x16x32_bf16 v[196:199], a[84:87], v[52:55], v[196:199]
    ds_read_b128 v[108:111], v6 offset:7168
    v_mfma_f32_16x16x32_bf16 v[200:203], a[140:143], v[52:55], v[200:203]
    v_mfma_f32_16x16x32_bf16 v[204:207], a[196:199], v[52:55], v[204:207]
    v_mfma_f32_16x16x32_bf16 v[192:195], a[32:35], v[56:59], v[192:195]
    v_mfma_f32_16x16x32_bf16 v[196:199], a[88:91], v[56:59], v[196:199]
    ds_read_b128 v[112:115], v6 offset:8192
    v_mfma_f32_16x16x32_bf16 v[200:203], a[144:147], v[56:59], v[200:203]
    v_mfma_f32_16x16x32_bf16 v[204:207], a[200:203], v[56:59], v[204:207]
    v_mfma_f32_16x16x32_bf16 v[192:195], a[36:39], v[60:63], v[192:195]
    v_mfma_f32_16x16x32_bf16 v[196:199], a[92:95], v[60:63], v[196:199]
    ds_read_b128 v[116:119], v6 offset:9216
    v_mfma_f32_16x16x32_bf16 v[200:203], a[148:151], v[60:63], v[200:203]
    v_mfma_f32_16x16x32_bf16 v[204:207], a[204:207], v[60:63], v[204:207]
    v_mfma_f32_16x16x32_bf16 v[192:195], a[40:43], v[64:67], v[192:195]
    v_mfma_f32_16x16x32_bf16 v[196:199], a[96:99], v[64:67], v[196:199]
    ds_read_b128 v[120:123], v6 offset:10240
    v_mfma_f32_16x16x32_bf16 v[200:203], a[152:155], v[64:67], v[200:203]
    v_mfma_f32_16x16x32_bf16 v[204:207], a[208:211], v[64:67], v[204:207]
    v_mfma_f32_16x16x32_bf16 v[192:195], a[44:47], v[68:71], v[192:195]
    v_mfma_f32_16x16x32_bf16 v[196:199], a[100:103], v[68:71], v[196:199]
    ds_read_b128 v[124:127], v6 offset:11264
    v_mfma_f32_16x16x32_bf16 v[200:203], a[156:159], v[68:71], v[200:203]
    v_mfma_f32_16x16x32_bf16 v[204:207], a[212:215], v[68:71], v[204:207]
    v_mfma_f32_16x16x32_bf16 v[192:195], a[48:51], v[72:75], v[192:195]
    v_mfma_f32_16x16x32_bf16 v[196:199], a[104:107], v[72:75], v[196:199]
    ds_read_b128 v[128:131], v6 offset:12288
    v_mfma_f32_16x16x32_bf16 v[200:203], a[160:163], v[72:75], v[200:203]
    v_mfma_f32_16x16x32_bf16 v[204:207], a[216:219], v[72:75], v[204:207]
    v_mfma_f32_16x16x32_bf16 v[192:195], a[52:55], v[76:79], v[192:195]
    v_mfma_f32_16x16x32_bf16 v[196:199], a[108:111], v[76:79], v[196:199]
    ds_read_b128 v[132:135], v6 offset:13312
    v_mfma_f32_16x16x32_bf16 v[200:203], a[164:167], v[76:79], v[200:203]
    v_mfma_f32_16x16x32_bf16 v[204:207], a[220:223], v[76:79], v[204:207]
    s_nop 7
    v_cvt_pk_bf16_f32 v216, v192, v193
    v_cvt_pk_bf16_f32 v217, v194, v195
    v_cvt_pk_bf16_f32 v218, v196, v197
    v_cvt_pk_bf16_f32 v219, v198, v199
    global_store_dwordx4 v4, v[216:219], s[34:35] offset:1024 sc1
    v_cvt_pk_bf16_f32 v220, v200, v201
    v_cvt_pk_bf16_f32 v221, v202, v203
    v_cvt_pk_bf16_f32 v222, v204, v205
    v_cvt_pk_bf16_f32 v223, v206, v207
    global_store_dwordx4 v4, v[220:223], s[36:37] offset:1024 sc1
    s_waitcnt lgkmcnt(0)
    v_mfma_f32_16x16x32_bf16 v[192:195], a[0:3], v[80:83], 0
    v_mfma_f32_16x16x32_bf16 v[196:199], a[56:59], v[80:83], 0
    ds_read_b128 v[136:139], v6 offset:14336
    v_mfma_f32_16x16x32_bf16 v[200:203], a[112:115], v[80:83], 0
    v_mfma_f32_16x16x32_bf16 v[204:207], a[168:171], v[80:83], 0
    v_mfma_f32_16x16x32_bf16 v[192:195], a[4:7], v[84:87], v[192:195]
    v_mfma_f32_16x16x32_bf16 v[196:199], a[60:63], v[84:87], v[196:199]
    ds_read_b128 v[140:143], v6 offset:15360
    v_mfma_f32_16x16x32_bf16 v[200:203], a[116:119], v[84:87], v[200:203]
    v_mfma_f32_16x16x32_bf16 v[204:207], a[172:175], v[84:87], v[204:207]
    v_mfma_f32_16x16x32_bf16 v[192:195], a[8:11], v[88:91], v[192:195]
    v_mfma_f32_16x16x32_bf16 v[196:199], a[64:67], v[88:91], v[196:199]
    ds_read_b128 v[144:147], v6 offset:16384
    v_mfma_f32_16x16x32_bf16 v[200:203], a[120:123], v[88:91], v[200:203]
    v_mfma_f32_16x16x32_bf16 v[204:207], a[176:179], v[88:91], v[204:207]
    v_mfma_f32_16x16x32_bf16 v[192:195], a[12:15], v[92:95], v[192:195]
    v_mfma_f32_16x16x32_bf16 v[196:199], a[68:71], v[92:95], v[196:199]
    ds_read_b128 v[148:151], v6 offset:17408
    v_mfma_f32_16x16x32_bf16 v[200:203], a[124:127], v[92:95], v[200:203]
    v_mfma_f32_16x16x32_bf16 v[204:207], a[180:183], v[92:95], v[204:207]
    v_mfma_f32_16x16x32_bf16 v[192:195], a[16:19], v[96:99], v[192:195]
    v_mfma_f32_16x16x32_bf16 v[196:199], a[72:75], v[96:99], v[196:199]
    ds_read_b128 v[152:155], v6 offset:18432
    v_mfma_f32_16x16x32_bf16 v[200:203], a[128:131], v[96:99], v[200:203]
    v_mfma_f32_16x16x32_bf16 v[204:207], a[184:187], v[96:99], v[204:207]
    v_mfma_f32_16x16x32_bf16 v[192:195], a[20:23], v[100:103], v[192:195]
    v_mfma_f32_16x16x32_bf16 v[196:199], a[76:79], v[100:103], v[196:199]
    ds_read_b128 v[156:159], v6 offset:19456
    v_mfma_f32_16x16x32_bf16 v[200:203], a[132:135], v[100:103], v[200:203]
    v_mfma_f32_16x16x32_bf16 v[204:207], a[188:191], v[100:103], v[204:207]
    v_mfma_f32_16x16x32_bf16 v[192:195], a[24:27], v[104:107], v[192:195]
    v_mfma_f32_16x16x32_bf16 v[196:199], a[80:83], v[104:107], v[196:199]
    ds_read_b128 v[160:163], v6 offset:20480
    v_mfma_f32_16x16x32_bf16 v[200:203], a[136:139], v[104:107], v[200:203]
    v_mfma_f32_16x16x32_bf16 v[204:207], a[192:195], v[104:107], v[204:207]
    v_mfma_f32_16x16x32_bf16 v[192:195], a[28:31], v[108:111], v[192:195]
    v_mfma_f32_16x16x32_bf16 v[196:199], a[84:87], v[108:111], v[196:199]
    ds_read_b128 v[164:167], v6 offset:21504
    v_mfma_f32_16x16x32_bf16 v[200:203], a[140:143], v[108:111], v[200:203]
    v_mfma_f32_16x16x32_bf16 v[204:207], a[196:199], v[108:111], v[204:207]
    v_mfma_f32_16x16x32_bf16 v[192:195], a[32:35], v[112:115], v[192:195]
    v_mfma_f32_16x16x32_bf16 v[196:199], a[88:91], v[112:115], v[196:199]
    ds_read_b128 v[168:171], v6 offset:22528
    v_mfma_f32_16x16x32_bf16 v[200:203], a[144:147], v[112:115], v[200:203]
    v_mfma_f32_16x16x32_bf16 v[204:207], a[200:203], v[112:115], v[204:207]
    v_mfma_f32_16x16x32_bf16 v[192:195], a[36:39], v[116:119], v[192:195]
    v_mfma_f32_16x16x32_bf16 v[196:199], a[92:95], v[116:119], v[196:199]
    ds_read_b128 v[172:175], v6 offset:23552
    v_mfma_f32_16x16x32_bf16 v[200:203], a[148:151], v[116:119], v[200:203]
    v_mfma_f32_16x16x32_bf16 v[204:207], a[204:207], v[116:119], v[204:207]
    v_mfma_f32_16x16x32_bf16 v[192:195], a[40:43], v[120:123], v[192:195]
    v_mfma_f32_16x16x32_bf16 v[196:199], a[96:99], v[120:123], v[196:199]
    ds_read_b128 v[176:179], v6 offset:24576
    v_mfma_f32_16x16x32_bf16 v[200:203], a[152:155], v[120:123], v[200:203]
    v_mfma_f32_16x16x32_bf16 v[204:207], a[208:211], v[120:123], v[204:207]
    v_mfma_f32_16x16x32_bf16 v[192:195], a[44:47], v[124:127], v[192:195]
    v_mfma_f32_16x16x32_bf16 v[196:199], a[100:103], v[124:127], v[196:199]
    ds_read_b128 v[180:183], v6 offset:25600
    v_mfma_f32_16x16x32_bf16 v[200:203], a[156:159], v[124:127], v[200:203]
    v_mfma_f32_16x16x32_bf16 v[204:207], a[212:215], v[124:127], v[204:207]
    v_mfma_f32_16x16x32_bf16 v[192:195], a[48:51], v[128:131], v[192:195]
    v_mfma_f32_16x16x32_bf16 v[196:199], a[104:107], v[128:131], v[196:199]
    ds_read_b128 v[184:187], v6 offset:26624
    v_mfma_f32_16x16x32_bf16 v[200:203], a[160:163], v[128:131], v[200:203]
    v_mfma_f32_16x16x32_bf16 v[204:207], a[216:219], v[128:131], v[204:207]
    v_mfma_f32_16x16x32_bf16 v[192:195], a[52:55], v[132:135], v[192:195]
    v_mfma_f32_16x16x32_bf16 v[196:199], a[108:111], v[132:135], v[196:199]
    ds_read_b128 v[188:191], v6 offset:27648
    v_mfma_f32_16x16x32_bf16 v[200:203], a[164:167], v[132:135], v[200:203]
    v_mfma_f32_16x16x32_bf16 v[204:207], a[220:223], v[132:135], v[204:207]
    s_nop 7
    v_cvt_pk_bf16_f32 v208, v192, v193
    v_cvt_pk_bf16_f32 v209, v194, v195
    v_cvt_pk_bf16_f32 v210, v196, v197
    v_cvt_pk_bf16_f32 v211, v198, v199
    global_store_dwordx4 v4, v[208:211], s[34:35] offset:2048 sc1
    v_cvt_pk_bf16_f32 v212, v200, v201
    v_cvt_pk_bf16_f32 v213, v202, v203
    v_cvt_pk_bf16_f32 v214, v204, v205
    v_cvt_pk_bf16_f32 v215, v206, v207
    global_store_dwordx4 v4, v[212:215], s[36:37] offset:2048 sc1
    s_waitcnt lgkmcnt(0)
    s_waitcnt vmcnt(17)
    s_barrier
    v_mfma_f32_16x16x32_bf16 v[192:195], a[0:3], v[136:139], 0
    v_mfma_f32_16x16x32_bf16 v[196:199], a[56:59], v[136:139], 0
    ds_read_b128 v[24:27], v6 offset:28672
    v_mfma_f32_16x16x32_bf16 v[200:203], a[112:115], v[136:139], 0
    v_mfma_f32_16x16x32_bf16 v[204:207], a[168:171], v[136:139], 0
    v_mfma_f32_16x16x32_bf16 v[192:195], a[4:7], v[140:143], v[192:195]
    v_mfma_f32_16x16x32_bf16 v[196:199], a[60:63], v[140:143], v[196:199]
    ds_read_b128 v[28:31], v6 offset:29696
    v_mfma_f32_16x16x32_bf16 v[200:203], a[116:119], v[140:143], v[200:203]
    v_mfma_f32_16x16x32_bf16 v[204:207], a[172:175], v[140:143], v[204:207]
    v_mfma_f32_16x16x32_bf16 v[192:195], a[8:11], v[144:147], v[192:195]
    v_mfma_f32_16x16x32_bf16 v[196:199], a[64:67], v[144:147], v[196:199]
    ds_read_b128 v[32:35], v6 offset:30720
    v_mfma_f32_16x16x32_bf16 v[200:203], a[120:123], v[144:147], v[200:203]
    v_mfma_f32_16x16x32_bf16 v[204:207], a[176:179], v[144:147], v[204:207]
    v_mfma_f32_16x16x32_bf16 v[192:195], a[12:15], v[148:151], v[192:195]
    v_mfma_f32_16x16x32_bf16 v[196:199], a[68:71], v[148:151], v[196:199]
    ds_read_b128 v[36:39], v6 offset:31744
    v_mfma_f32_16x16x32_bf16 v[200:203], a[124:127], v[148:151], v[200:203]
    v_mfma_f32_16x16x32_bf16 v[204:207], a[180:183], v[148:151], v[204:207]
    v_mfma_f32_16x16x32_bf16 v[192:195], a[16:19], v[152:155], v[192:195]
    v_mfma_f32_16x16x32_bf16 v[196:199], a[72:75], v[152:155], v[196:199]
    ds_read_b128 v[40:43], v6 offset:32768
    v_mfma_f32_16x16x32_bf16 v[200:203], a[128:131], v[152:155], v[200:203]
    v_mfma_f32_16x16x32_bf16 v[204:207], a[184:187], v[152:155], v[204:207]
    v_mfma_f32_16x16x32_bf16 v[192:195], a[20:23], v[156:159], v[192:195]
    v_mfma_f32_16x16x32_bf16 v[196:199], a[76:79], v[156:159], v[196:199]
    ds_read_b128 v[44:47], v6 offset:33792
    v_mfma_f32_16x16x32_bf16 v[200:203], a[132:135], v[156:159], v[200:203]
    v_mfma_f32_16x16x32_bf16 v[204:207], a[188:191], v[156:159], v[204:207]
    v_mfma_f32_16x16x32_bf16 v[192:195], a[24:27], v[160:163], v[192:195]
    v_mfma_f32_16x16x32_bf16 v[196:199], a[80:83], v[160:163], v[196:199]
    ds_read_b128 v[48:51], v6 offset:34816
    v_mfma_f32_16x16x32_bf16 v[200:203], a[136:139], v[160:163], v[200:203]
    v_mfma_f32_16x16x32_bf16 v[204:207], a[192:195], v[160:163], v[204:207]
    v_mfma_f32_16x16x32_bf16 v[192:195], a[28:31], v[164:167], v[192:195]
    v_mfma_f32_16x16x32_bf16 v[196:199], a[84:87], v[164:167], v[196:199]
    ds_read_b128 v[52:55], v6 offset:35840
    v_mfma_f32_16x16x32_bf16 v[200:203], a[140:143], v[164:167], v[200:203]
    v_mfma_f32_16x16x32_bf16 v[204:207], a[196:199], v[164:167], v[204:207]
    v_mfma_f32_16x16x32_bf16 v[192:195], a[32:35], v[168:171], v[192:195]
    v_mfma_f32_16x16x32_bf16 v[196:199], a[88:91], v[168:171], v[196:199]
    ds_read_b128 v[56:59], v6 offset:36864
    v_mfma_f32_16x16x32_bf16 v[200:203], a[144:147], v[168:171], v[200:203]
    v_mfma_f32_16x16x32_bf16 v[204:207], a[200:203], v[168:171], v[204:207]
    v_mfma_f32_16x16x32_bf16 v[192:195], a[36:39], v[172:175], v[192:195]
    v_mfma_f32_16x16x32_bf16 v[196:199], a[92:95], v[172:175], v[196:199]
    ds_read_b128 v[60:63], v6 offset:37888
    v_mfma_f32_16x16x32_bf16 v[200:203], a[148:151], v[172:175], v[200:203]
    v_mfma_f32_16x16x32_bf16 v[204:207], a[204:207], v[172:175], v[204:207]
    v_mfma_f32_16x16x32_bf16 v[192:195], a[40:43], v[176:179], v[192:195]
    v_mfma_f32_16x16x32_bf16 v[196:199], a[96:99], v[176:179], v[196:199]
    ds_read_b128 v[64:67], v6 offset:38912
    v_mfma_f32_16x16x32_bf16 v[200:203], a[152:155], v[176:179], v[200:203]
    v_mfma_f32_16x16x32_bf16 v[204:207], a[208:211], v[176:179], v[204:207]
    v_mfma_f32_16x16x32_bf16 v[192:195], a[44:47], v[180:183], v[192:195]
    v_mfma_f32_16x16x32_bf16 v[196:199], a[100:103], v[180:183], v[196:199]
    ds_read_b128 v[68:71], v6 offset:39936
    v_mfma_f32_16x16x32_bf16 v[200:203], a[156:159], v[180:183], v[200:203]
    v_mfma_f32_16x16x32_bf16 v[204:207], a[212:215], v[180:183], v[204:207]
    v_mfma_f32_16x16x32_bf16 v[192:195], a[48:51], v[184:187], v[192:195]
    v_mfma_f32_16x16x32_bf16 v[196:199], a[104:107], v[184:187], v[196:199]
    ds_read_b128 v[72:75], v6 offset:40960
    v_mfma_f32_16x16x32_bf16 v[200:203], a[160:163], v[184:187], v[200:203]
    v_mfma_f32_16x16x32_bf16 v[204:207], a[216:219], v[184:187], v[204:207]
    v_mfma_f32_16x16x32_bf16 v[192:195], a[52:55], v[188:191], v[192:195]
    v_mfma_f32_16x16x32_bf16 v[196:199], a[108:111], v[188:191], v[196:199]
    ds_read_b128 v[76:79], v6 offset:41984
    v_mfma_f32_16x16x32_bf16 v[200:203], a[164:167], v[188:191], v[200:203]
    v_mfma_f32_16x16x32_bf16 v[204:207], a[220:223], v[188:191], v[204:207]
    s_nop 7
    v_cvt_pk_bf16_f32 v216, v192, v193
    v_cvt_pk_bf16_f32 v217, v194, v195
    v_cvt_pk_bf16_f32 v218, v196, v197
    v_cvt_pk_bf16_f32 v219, v198, v199
    global_store_dwordx4 v4, v[216:219], s[34:35] offset:3072 sc1
    v_cvt_pk_bf16_f32 v220, v200, v201
    v_cvt_pk_bf16_f32 v221, v202, v203
    v_cvt_pk_bf16_f32 v222, v204, v205
    v_cvt_pk_bf16_f32 v223, v206, v207
    global_store_dwordx4 v4, v[220:223], s[36:37] offset:3072 sc1
    s_waitcnt lgkmcnt(0)
    v_mfma_f32_16x16x32_bf16 v[192:195], a[0:3], v[24:27], 0
    v_mfma_f32_16x16x32_bf16 v[196:199], a[56:59], v[24:27], 0
    ds_read_b128 v[80:83], v6 offset:43008
    v_mfma_f32_16x16x32_bf16 v[200:203], a[112:115], v[24:27], 0
    v_mfma_f32_16x16x32_bf16 v[204:207], a[168:171], v[24:27], 0
    v_mfma_f32_16x16x32_bf16 v[192:195], a[4:7], v[28:31], v[192:195]
    v_mfma_f32_16x16x32_bf16 v[196:199], a[60:63], v[28:31], v[196:199]
    ds_read_b128 v[84:87], v6 offset:44032
    v_mfma_f32_16x16x32_bf16 v[200:203], a[116:119], v[28:31], v[200:203]
    v_mfma_f32_16x16x32_bf16 v[204:207], a[172:175], v[28:31], v[204:207]
    v_mfma_f32_16x16x32_bf16 v[192:195], a[8:11], v[32:35], v[192:195]
    v_mfma_f32_16x16x32_bf16 v[196:199], a[64:67], v[32:35], v[196:199]
    ds_read_b128 v[88:91], v6 offset:45056
    v_mfma_f32_16x16x32_bf16 v[200:203], a[120:123], v[32:35], v[200:203]
    v_mfma_f32_16x16x32_bf16 v[204:207], a[176:179], v[32:35], v[204:207]
    v_mfma_f32_16x16x32_bf16 v[192:195], a[12:15], v[36:39], v[192:195]
    v_mfma_f32_16x16x32_bf16 v[196:199], a[68:71], v[36:39], v[196:199]
    ds_read_b128 v[92:95], v6 offset:46080
    v_mfma_f32_16x16x32_bf16 v[200:203], a[124:127], v[36:39], v[200:203]
    v_mfma_f32_16x16x32_bf16 v[204:207], a[180:183], v[36:39], v[204:207]
    v_mfma_f32_16x16x32_bf16 v[192:195], a[16:19], v[40:43], v[192:195]
    v_mfma_f32_16x16x32_bf16 v[196:199], a[72:75], v[40:43], v[196:199]
    ds_read_b128 v[96:99], v6 offset:47104
    v_mfma_f32_16x16x32_bf16 v[200:203], a[128:131], v[40:43], v[200:203]
    v_mfma_f32_16x16x32_bf16 v[204:207], a[184:187], v[40:43], v[204:207]
    v_mfma_f32_16x16x32_bf16 v[192:195], a[20:23], v[44:47], v[192:195]
    v_mfma_f32_16x16x32_bf16 v[196:199], a[76:79], v[44:47], v[196:199]
    ds_read_b128 v[100:103], v6 offset:48128
    v_mfma_f32_16x16x32_bf16 v[200:203], a[132:135], v[44:47], v[200:203]
    v_mfma_f32_16x16x32_bf16 v[204:207], a[188:191], v[44:47], v[204:207]
    v_mfma_f32_16x16x32_bf16 v[192:195], a[24:27], v[48:51], v[192:195]
    v_mfma_f32_16x16x32_bf16 v[196:199], a[80:83], v[48:51], v[196:199]
    ds_read_b128 v[104:107], v6 offset:49152
    v_mfma_f32_16x16x32_bf16 v[200:203], a[136:139], v[48:51], v[200:203]
    v_mfma_f32_16x16x32_bf16 v[204:207], a[192:195], v[48:51], v[204:207]
    v_mfma_f32_16x16x32_bf16 v[192:195], a[28:31], v[52:55], v[192:195]
    v_mfma_f32_16x16x32_bf16 v[196:199], a[84:87], v[52:55], v[196:199]
    ds_read_b128 v[108:111], v6 offset:50176
    v_mfma_f32_16x16x32_bf16 v[200:203], a[140:143], v[52:55], v[200:203]
    v_mfma_f32_16x16x32_bf16 v[204:207], a[196:199], v[52:55], v[204:207]
    v_mfma_f32_16x16x32_bf16 v[192:195], a[32:35], v[56:59], v[192:195]
    v_mfma_f32_16x16x32_bf16 v[196:199], a[88:91], v[56:59], v[196:199]
    ds_read_b128 v[112:115], v6 offset:51200
    v_mfma_f32_16x16x32_bf16 v[200:203], a[144:147], v[56:59], v[200:203]
    v_mfma_f32_16x16x32_bf16 v[204:207], a[200:203], v[56:59], v[204:207]
    v_mfma_f32_16x16x32_bf16 v[192:195], a[36:39], v[60:63], v[192:195]
    v_mfma_f32_16x16x32_bf16 v[196:199], a[92:95], v[60:63], v[196:199]
    ds_read_b128 v[116:119], v6 offset:52224
    v_mfma_f32_16x16x32_bf16 v[200:203], a[148:151], v[60:63], v[200:203]
    v_mfma_f32_16x16x32_bf16 v[204:207], a[204:207], v[60:63], v[204:207]
    v_mfma_f32_16x16x32_bf16 v[192:195], a[40:43], v[64:67], v[192:195]
    v_mfma_f32_16x16x32_bf16 v[196:199], a[96:99], v[64:67], v[196:199]
    ds_read_b128 v[120:123], v6 offset:53248
    v_mfma_f32_16x16x32_bf16 v[200:203], a[152:155], v[64:67], v[200:203]
    v_mfma_f32_16x16x32_bf16 v[204:207], a[208:211], v[64:67], v[204:207]
    v_mfma_f32_16x16x32_bf16 v[192:195], a[44:47], v[68:71], v[192:195]
    v_mfma_f32_16x16x32_bf16 v[196:199], a[100:103], v[68:71], v[196:199]
    ds_read_b128 v[124:127], v6 offset:54272
    v_mfma_f32_16x16x32_bf16 v[200:203], a[156:159], v[68:71], v[200:203]
    v_mfma_f32_16x16x32_bf16 v[204:207], a[212:215], v[68:71], v[204:207]
    v_mfma_f32_16x16x32_bf16 v[192:195], a[48:51], v[72:75], v[192:195]
    v_mfma_f32_16x16x32_bf16 v[196:199], a[104:107], v[72:75], v[196:199]
    ds_read_b128 v[128:131], v6 offset:55296
    v_mfma_f32_16x16x32_bf16 v[200:203], a[160:163], v[72:75], v[200:203]
    v_mfma_f32_16x16x32_bf16 v[204:207], a[216:219], v[72:75], v[204:207]
    v_mfma_f32_16x16x32_bf16 v[192:195], a[52:55], v[76:79], v[192:195]
    v_mfma_f32_16x16x32_bf16 v[196:199], a[108:111], v[76:79], v[196:199]
    ds_read_b128 v[132:135], v6 offset:56320
    v_mfma_f32_16x16x32_bf16 v[200:203], a[164:167], v[76:79], v[200:203]
    v_mfma_f32_16x16x32_bf16 v[204:207], a[220:223], v[76:79], v[204:207]
    s_nop 7
    v_cvt_pk_bf16_f32 v208, v192, v193
    v_cvt_pk_bf16_f32 v209, v194, v195
    v_cvt_pk_bf16_f32 v210, v196, v197
    v_cvt_pk_bf16_f32 v211, v198, v199
    global_store_dwordx4 v5, v[208:211], s[34:35] offset:0 sc1
    v_cvt_pk_bf16_f32 v212, v200, v201
    v_cvt_pk_bf16_f32 v213, v202, v203
    v_cvt_pk_bf16_f32 v214, v204, v205
    v_cvt_pk_bf16_f32 v215, v206, v207
    global_store_dwordx4 v5, v[212:215], s[36:37] offset:0 sc1
    s_waitcnt lgkmcnt(0)
    s_waitcnt vmcnt(10)
    s_barrier
    v_mfma_f32_16x16x32_bf16 v[192:195], a[0:3], v[80:83], 0
    v_mfma_f32_16x16x32_bf16 v[196:199], a[56:59], v[80:83], 0
    ds_read_b128 v[136:139], v7 offset:0
    v_mfma_f32_16x16x32_bf16 v[200:203], a[112:115], v[80:83], 0
    v_mfma_f32_16x16x32_bf16 v[204:207], a[168:171], v[80:83], 0
    v_mfma_f32_16x16x32_bf16 v[192:195], a[4:7], v[84:87], v[192:195]
    v_mfma_f32_16x16x32_bf16 v[196:199], a[60:63], v[84:87], v[196:199]
    ds_read_b128 v[140:143], v7 offset:1024
    v_mfma_f32_16x16x32_bf16 v[200:203], a[116:119], v[84:87], v[200:203]
    v_mfma_f32_16x16x32_bf16 v[204:207], a[172:175], v[84:87], v[204:207]
    v_mfma_f32_16x16x32_bf16 v[192:195], a[8:11], v[88:91], v[192:195]
    v_mfma_f32_16x16x32_bf16 v[196:199], a[64:67], v[88:91], v[196:199]
    ds_read_b128 v[144:147], v7 offset:2048
    v_mfma_f32_16x16x32_bf16 v[200:203], a[120:123], v[88:91], v[200:203]
    v_mfma_f32_16x16x32_bf16 v[204:207], a[176:179], v[88:91], v[204:207]
    v_mfma_f32_16x16x32_bf16 v[192:195], a[12:15], v[92:95], v[192:195]
    v_mfma_f32_16x16x32_bf16 v[196:199], a[68:71], v[92:95], v[196:199]
    ds_read_b128 v[148:151], v7 offset:3072
    v_mfma_f32_16x16x32_bf16 v[200:203], a[124:127], v[92:95], v[200:203]
    v_mfma_f32_16x16x32_bf16 v[204:207], a[180:183], v[92:95], v[204:207]
    v_mfma_f32_16x16x32_bf16 v[192:195], a[16:19], v[96:99], v[192:195]
    v_mfma_f32_16x16x32_bf16 v[196:199], a[72:75], v[96:99], v[196:199]
    ds_read_b128 v[152:155], v7 offset:4096
    v_mfma_f32_16x16x32_bf16 v[200:203], a[128:131], v[96:99], v[200:203]
    v_mfma_f32_16x16x32_bf16 v[204:207], a[184:187], v[96:99], v[204:207]
    v_mfma_f32_16x16x32_bf16 v[192:195], a[20:23], v[100:103], v[192:195]
    v_mfma_f32_16x16x32_bf16 v[196:199], a[76:79], v[100:103], v[196:199]
    ds_read_b128 v[156:159], v7 offset:5120
    v_mfma_f32_16x16x32_bf16 v[200:203], a[132:135], v[100:103], v[200:203]
    v_mfma_f32_16x16x32_bf16 v[204:207], a[188:191], v[100:103], v[204:207]
    v_mfma_f32_16x16x32_bf16 v[192:195], a[24:27], v[104:107], v[192:195]
    v_mfma_f32_16x16x32_bf16 v[196:199], a[80:83], v[104:107], v[196:199]
    ds_read_b128 v[160:163], v7 offset:6144
    v_mfma_f32_16x16x32_bf16 v[200:203], a[136:139], v[104:107], v[200:203]
    v_mfma_f32_16x16x32_bf16 v[204:207], a[192:195], v[104:107], v[204:207]
    v_mfma_f32_16x16x32_bf16 v[192:195], a[28:31], v[108:111], v[192:195]
    v_mfma_f32_16x16x32_bf16 v[196:199], a[84:87], v[108:111], v[196:199]
    ds_read_b128 v[164:167], v7 offset:7168
    v_mfma_f32_16x16x32_bf16 v[200:203], a[140:143], v[108:111], v[200:203]
    v_mfma_f32_16x16x32_bf16 v[204:207], a[196:199], v[108:111], v[204:207]
    v_mfma_f32_16x16x32_bf16 v[192:195], a[32:35], v[112:115], v[192:195]
    v_mfma_f32_16x16x32_bf16 v[196:199], a[88:91], v[112:115], v[196:199]
    ds_read_b128 v[168:171], v7 offset:8192
    v_mfma_f32_16x16x32_bf16 v[200:203], a[144:147], v[112:115], v[200:203]
    v_mfma_f32_16x16x32_bf16 v[204:207], a[200:203], v[112:115], v[204:207]
    v_mfma_f32_16x16x32_bf16 v[192:195], a[36:39], v[116:119], v[192:195]
    v_mfma_f32_16x16x32_bf16 v[196:199], a[92:95], v[116:119], v[196:199]
    ds_read_b128 v[172:175], v7 offset:9216
    v_mfma_f32_16x16x32_bf16 v[200:203], a[148:151], v[116:119], v[200:203]
    v_mfma_f32_16x16x32_bf16 v[204:207], a[204:207], v[116:119], v[204:207]
    v_mfma_f32_16x16x32_bf16 v[192:195], a[40:43], v[120:123], v[192:195]
    v_mfma_f32_16x16x32_bf16 v[196:199], a[96:99], v[120:123], v[196:199]
    ds_read_b128 v[176:179], v7 offset:10240
    v_mfma_f32_16x16x32_bf16 v[200:203], a[152:155], v[120:123], v[200:203]
    v_mfma_f32_16x16x32_bf16 v[204:207], a[208:211], v[120:123], v[204:207]
    v_mfma_f32_16x16x32_bf16 v[192:195], a[44:47], v[124:127], v[192:195]
    v_mfma_f32_16x16x32_bf16 v[196:199], a[100:103], v[124:127], v[196:199]
    ds_read_b128 v[180:183], v7 offset:11264
    v_mfma_f32_16x16x32_bf16 v[200:203], a[156:159], v[124:127], v[200:203]
    v_mfma_f32_16x16x32_bf16 v[204:207], a[212:215], v[124:127], v[204:207]
    v_mfma_f32_16x16x32_bf16 v[192:195], a[48:51], v[128:131], v[192:195]
    v_mfma_f32_16x16x32_bf16 v[196:199], a[104:107], v[128:131], v[196:199]
    ds_read_b128 v[184:187], v7 offset:12288
    v_mfma_f32_16x16x32_bf16 v[200:203], a[160:163], v[128:131], v[200:203]
    v_mfma_f32_16x16x32_bf16 v[204:207], a[216:219], v[128:131], v[204:207]
    v_mfma_f32_16x16x32_bf16 v[192:195], a[52:55], v[132:135], v[192:195]
    v_mfma_f32_16x16x32_bf16 v[196:199], a[108:111], v[132:135], v[196:199]
    ds_read_b128 v[188:191], v7 offset:13312
    v_mfma_f32_16x16x32_bf16 v[200:203], a[164:167], v[132:135], v[200:203]
    v_mfma_f32_16x16x32_bf16 v[204:207], a[220:223], v[132:135], v[204:207]
    s_nop 7
    v_cvt_pk_bf16_f32 v216, v192, v193
    v_cvt_pk_bf16_f32 v217, v194, v195
    v_cvt_pk_bf16_f32 v218, v196, v197
    v_cvt_pk_bf16_f32 v219, v198, v199
    global_store_dwordx4 v5, v[216:219], s[34:35] offset:1024 sc1
    v_cvt_pk_bf16_f32 v220, v200, v201
    v_cvt_pk_bf16_f32 v221, v202, v203
    v_cvt_pk_bf16_f32 v222, v204, v205
    v_cvt_pk_bf16_f32 v223, v206, v207
    global_store_dwordx4 v5, v[220:223], s[36:37] offset:1024 sc1
    s_waitcnt lgkmcnt(0)
    v_mfma_f32_16x16x32_bf16 v[192:195], a[0:3], v[136:139], 0
    v_mfma_f32_16x16x32_bf16 v[196:199], a[56:59], v[136:139], 0
    ds_read_b128 v[24:27], v7 offset:14336
    v_mfma_f32_16x16x32_bf16 v[200:203], a[112:115], v[136:139], 0
    v_mfma_f32_16x16x32_bf16 v[204:207], a[168:171], v[136:139], 0
    v_mfma_f32_16x16x32_bf16 v[192:195], a[4:7], v[140:143], v[192:195]
    v_mfma_f32_16x16x32_bf16 v[196:199], a[60:63], v[140:143], v[196:199]
    ds_read_b128 v[28:31], v7 offset:15360
    v_mfma_f32_16x16x32_bf16 v[200:203], a[116:119], v[140:143], v[200:203]
    v_mfma_f32_16x16x32_bf16 v[204:207], a[172:175], v[140:143], v[204:207]
    v_mfma_f32_16x16x32_bf16 v[192:195], a[8:11], v[144:147], v[192:195]
    v_mfma_f32_16x16x32_bf16 v[196:199], a[64:67], v[144:147], v[196:199]
    ds_read_b128 v[32:35], v7 offset:16384
    v_mfma_f32_16x16x32_bf16 v[200:203], a[120:123], v[144:147], v[200:203]
    v_mfma_f32_16x16x32_bf16 v[204:207], a[176:179], v[144:147], v[204:207]
    v_mfma_f32_16x16x32_bf16 v[192:195], a[12:15], v[148:151], v[192:195]
    v_mfma_f32_16x16x32_bf16 v[196:199], a[68:71], v[148:151], v[196:199]
    ds_read_b128 v[36:39], v7 offset:17408
    v_mfma_f32_16x16x32_bf16 v[200:203], a[124:127], v[148:151], v[200:203]
    v_mfma_f32_16x16x32_bf16 v[204:207], a[180:183], v[148:151], v[204:207]
    v_mfma_f32_16x16x32_bf16 v[192:195], a[16:19], v[152:155], v[192:195]
    v_mfma_f32_16x16x32_bf16 v[196:199], a[72:75], v[152:155], v[196:199]
    ds_read_b128 v[40:43], v7 offset:18432
    v_mfma_f32_16x16x32_bf16 v[200:203], a[128:131], v[152:155], v[200:203]
    v_mfma_f32_16x16x32_bf16 v[204:207], a[184:187], v[152:155], v[204:207]
    v_mfma_f32_16x16x32_bf16 v[192:195], a[20:23], v[156:159], v[192:195]
    v_mfma_f32_16x16x32_bf16 v[196:199], a[76:79], v[156:159], v[196:199]
    ds_read_b128 v[44:47], v7 offset:19456
    v_mfma_f32_16x16x32_bf16 v[200:203], a[132:135], v[156:159], v[200:203]
    v_mfma_f32_16x16x32_bf16 v[204:207], a[188:191], v[156:159], v[204:207]
    v_mfma_f32_16x16x32_bf16 v[192:195], a[24:27], v[160:163], v[192:195]
    v_mfma_f32_16x16x32_bf16 v[196:199], a[80:83], v[160:163], v[196:199]
    ds_read_b128 v[48:51], v7 offset:20480
    v_mfma_f32_16x16x32_bf16 v[200:203], a[136:139], v[160:163], v[200:203]
    v_mfma_f32_16x16x32_bf16 v[204:207], a[192:195], v[160:163], v[204:207]
    v_mfma_f32_16x16x32_bf16 v[192:195], a[28:31], v[164:167], v[192:195]
    v_mfma_f32_16x16x32_bf16 v[196:199], a[84:87], v[164:167], v[196:199]
    ds_read_b128 v[52:55], v7 offset:21504
    v_mfma_f32_16x16x32_bf16 v[200:203], a[140:143], v[164:167], v[200:203]
    v_mfma_f32_16x16x32_bf16 v[204:207], a[196:199], v[164:167], v[204:207]
    v_mfma_f32_16x16x32_bf16 v[192:195], a[32:35], v[168:171], v[192:195]
    v_mfma_f32_16x16x32_bf16 v[196:199], a[88:91], v[168:171], v[196:199]
    ds_read_b128 v[56:59], v7 offset:22528
    v_mfma_f32_16x16x32_bf16 v[200:203], a[144:147], v[168:171], v[200:203]
    v_mfma_f32_16x16x32_bf16 v[204:207], a[200:203], v[168:171], v[204:207]
    v_mfma_f32_16x16x32_bf16 v[192:195], a[36:39], v[172:175], v[192:195]
    v_mfma_f32_16x16x32_bf16 v[196:199], a[92:95], v[172:175], v[196:199]
    ds_read_b128 v[60:63], v7 offset:23552
    v_mfma_f32_16x16x32_bf16 v[200:203], a[148:151], v[172:175], v[200:203]
    v_mfma_f32_16x16x32_bf16 v[204:207], a[204:207], v[172:175], v[204:207]
    v_mfma_f32_16x16x32_bf16 v[192:195], a[40:43], v[176:179], v[192:195]
    v_mfma_f32_16x16x32_bf16 v[196:199], a[96:99], v[176:179], v[196:199]
    ds_read_b128 v[64:67], v7 offset:24576
    v_mfma_f32_16x16x32_bf16 v[200:203], a[152:155], v[176:179], v[200:203]
    v_mfma_f32_16x16x32_bf16 v[204:207], a[208:211], v[176:179], v[204:207]
    v_mfma_f32_16x16x32_bf16 v[192:195], a[44:47], v[180:183], v[192:195]
    v_mfma_f32_16x16x32_bf16 v[196:199], a[100:103], v[180:183], v[196:199]
    ds_read_b128 v[68:71], v7 offset:25600
    v_mfma_f32_16x16x32_bf16 v[200:203], a[156:159], v[180:183], v[200:203]
    v_mfma_f32_16x16x32_bf16 v[204:207], a[212:215], v[180:183], v[204:207]
    v_mfma_f32_16x16x32_bf16 v[192:195], a[48:51], v[184:187], v[192:195]
    v_mfma_f32_16x16x32_bf16 v[196:199], a[104:107], v[184:187], v[196:199]
    ds_read_b128 v[72:75], v7 offset:26624
    v_mfma_f32_16x16x32_bf16 v[200:203], a[160:163], v[184:187], v[200:203]
    v_mfma_f32_16x16x32_bf16 v[204:207], a[216:219], v[184:187], v[204:207]
    v_mfma_f32_16x16x32_bf16 v[192:195], a[52:55], v[188:191], v[192:195]
    v_mfma_f32_16x16x32_bf16 v[196:199], a[108:111], v[188:191], v[196:199]
    ds_read_b128 v[76:79], v7 offset:27648
    v_mfma_f32_16x16x32_bf16 v[200:203], a[164:167], v[188:191], v[200:203]
    v_mfma_f32_16x16x32_bf16 v[204:207], a[220:223], v[188:191], v[204:207]
    s_nop 7
    v_cvt_pk_bf16_f32 v208, v192, v193
    v_cvt_pk_bf16_f32 v209, v194, v195
    v_cvt_pk_bf16_f32 v210, v196, v197
    v_cvt_pk_bf16_f32 v211, v198, v199
    global_store_dwordx4 v5, v[208:211], s[34:35] offset:2048 sc1
    v_cvt_pk_bf16_f32 v212, v200, v201
    v_cvt_pk_bf16_f32 v213, v202, v203
    v_cvt_pk_bf16_f32 v214, v204, v205
    v_cvt_pk_bf16_f32 v215, v206, v207
    global_store_dwordx4 v5, v[212:215], s[36:37] offset:2048 sc1
    s_waitcnt lgkmcnt(0)
    v_mfma_f32_16x16x32_bf16 v[192:195], a[0:3], v[24:27], 0
    v_mfma_f32_16x16x32_bf16 v[196:199], a[56:59], v[24:27], 0
    v_mfma_f32_16x16x32_bf16 v[200:203], a[112:115], v[24:27], 0
    v_mfma_f32_16x16x32_bf16 v[204:207], a[168:171], v[24:27], 0
    v_mfma_f32_16x16x32_bf16 v[192:195], a[4:7], v[28:31], v[192:195]
    v_mfma_f32_16x16x32_bf16 v[196:199], a[60:63], v[28:31], v[196:199]
    v_mfma_f32_16x16x32_bf16 v[200:203], a[116:119], v[28:31], v[200:203]
    v_mfma_f32_16x16x32_bf16 v[204:207], a[172:175], v[28:31], v[204:207]
    v_mfma_f32_16x16x32_bf16 v[192:195], a[8:11], v[32:35], v[192:195]
    v_mfma_f32_16x16x32_bf16 v[196:199], a[64:67], v[32:35], v[196:199]
    v_mfma_f32_16x16x32_bf16 v[200:203], a[120:123], v[32:35], v[200:203]
    v_mfma_f32_16x16x32_bf16 v[204:207], a[176:179], v[32:35], v[204:207]
    v_mfma_f32_16x16x32_bf16 v[192:195], a[12:15], v[36:39], v[192:195]
    v_mfma_f32_16x16x32_bf16 v[196:199], a[68:71], v[36:39], v[196:199]
    v_mfma_f32_16x16x32_bf16 v[200:203], a[124:127], v[36:39], v[200:203]
    v_mfma_f32_16x16x32_bf16 v[204:207], a[180:183], v[36:39], v[204:207]
    v_mfma_f32_16x16x32_bf16 v[192:195], a[16:19], v[40:43], v[192:195]
    v_mfma_f32_16x16x32_bf16 v[196:199], a[72:75], v[40:43], v[196:199]
    v_mfma_f32_16x16x32_bf16 v[200:203], a[128:131], v[40:43], v[200:203]
    v_mfma_f32_16x16x32_bf16 v[204:207], a[184:187], v[40:43], v[204:207]
    v_mfma_f32_16x16x32_bf16 v[192:195], a[20:23], v[44:47], v[192:195]
    v_mfma_f32_16x16x32_bf16 v[196:199], a[76:79], v[44:47], v[196:199]
    v_mfma_f32_16x16x32_bf16 v[200:203], a[132:135], v[44:47], v[200:203]
    v_mfma_f32_16x16x32_bf16 v[204:207], a[188:191], v[44:47], v[204:207]
    v_mfma_f32_16x16x32_bf16 v[192:195], a[24:27], v[48:51], v[192:195]
    v_mfma_f32_16x16x32_bf16 v[196:199], a[80:83], v[48:51], v[196:199]
    v_mfma_f32_16x16x32_bf16 v[200:203], a[136:139], v[48:51], v[200:203]
    v_mfma_f32_16x16x32_bf16 v[204:207], a[192:195], v[48:51], v[204:207]
    v_mfma_f32_16x16x32_bf16 v[192:195], a[28:31], v[52:55], v[192:195]
    v_mfma_f32_16x16x32_bf16 v[196:199], a[84:87], v[52:55], v[196:199]
    v_mfma_f32_16x16x32_bf16 v[200:203], a[140:143], v[52:55], v[200:203]
    v_mfma_f32_16x16x32_bf16 v[204:207], a[196:199], v[52:55], v[204:207]
    v_mfma_f32_16x16x32_bf16 v[192:195], a[32:35], v[56:59], v[192:195]
    v_mfma_f32_16x16x32_bf16 v[196:199], a[88:91], v[56:59], v[196:199]
    v_mfma_f32_16x16x32_bf16 v[200:203], a[144:147], v[56:59], v[200:203]
    v_mfma_f32_16x16x32_bf16 v[204:207], a[200:203], v[56:59], v[204:207]
    v_mfma_f32_16x16x32_bf16 v[192:195], a[36:39], v[60:63], v[192:195]
    v_mfma_f32_16x16x32_bf16 v[196:199], a[92:95], v[60:63], v[196:199]
    v_mfma_f32_16x16x32_bf16 v[200:203], a[148:151], v[60:63], v[200:203]
    v_mfma_f32_16x16x32_bf16 v[204:207], a[204:207], v[60:63], v[204:207]
    v_mfma_f32_16x16x32_bf16 v[192:195], a[40:43], v[64:67], v[192:195]
    v_mfma_f32_16x16x32_bf16 v[196:199], a[96:99], v[64:67], v[196:199]
    v_mfma_f32_16x16x32_bf16 v[200:203], a[152:155], v[64:67], v[200:203]
    v_mfma_f32_16x16x32_bf16 v[204:207], a[208:211], v[64:67], v[204:207]
    v_mfma_f32_16x16x32_bf16 v[192:195], a[44:47], v[68:71], v[192:195]
    v_mfma_f32_16x16x32_bf16 v[196:199], a[100:103], v[68:71], v[196:199]
    v_mfma_f32_16x16x32_bf16 v[200:203], a[156:159], v[68:71], v[200:203]
    v_mfma_f32_16x16x32_bf16 v[204:207], a[212:215], v[68:71], v[204:207]
    v_mfma_f32_16x16x32_bf16 v[192:195], a[48:51], v[72:75], v[192:195]
    v_mfma_f32_16x16x32_bf16 v[196:199], a[104:107], v[72:75], v[196:199]
    v_mfma_f32_16x16x32_bf16 v[200:203], a[160:163], v[72:75], v[200:203]
    v_mfma_f32_16x16x32_bf16 v[204:207], a[216:219], v[72:75], v[204:207]
    v_mfma_f32_16x16x32_bf16 v[192:195], a[52:55], v[76:79], v[192:195]
    v_mfma_f32_16x16x32_bf16 v[196:199], a[108:111], v[76:79], v[196:199]
    v_mfma_f32_16x16x32_bf16 v[200:203], a[164:167], v[76:79], v[200:203]
    v_mfma_f32_16x16x32_bf16 v[204:207], a[220:223], v[76:79], v[204:207]
    s_nop 7
    v_cvt_pk_bf16_f32 v216, v192, v193
    v_cvt_pk_bf16_f32 v217, v194, v195
    v_cvt_pk_bf16_f32 v218, v196, v197
    v_cvt_pk_bf16_f32 v219, v198, v199
    global_store_dwordx4 v5, v[216:219], s[34:35] offset:3072 sc1
    v_cvt_pk_bf16_f32 v220, v200, v201
    v_cvt_pk_bf16_f32 v221, v202, v203
    v_cvt_pk_bf16_f32 v222, v204, v205
    v_cvt_pk_bf16_f32 v223, v206, v207
    global_store_dwordx4 v5, v[220:223], s[36:37] offset:3072 sc1
    s_waitcnt vmcnt(0)
    s_barrier
    s_cmp_lg_u32 s23, 0
    s_cbranch_scc1 Lsig_101
    s_lshl_b32 s25, s73, 7
    s_add_u32 s25, s25, 0x7900000
    s_add_u32 s76, s4, s25
    s_addc_u32 s77, s5, 0
    s_mov_b64 exec, 1
    v_mov_b32 v22, 0
    v_mov_b32 v23, 1
    global_atomic_add v22, v23, s[76:77]
    s_mov_b64 exec, -1
Lsig_101:
Lnovo_100:
    s_cmp_ge_u32 s72, 168
    s_cbranch_scc1 Lnotr_102
    v_and_b32 v1, 63, v0
    s_lshl_b32 s25, s72, 2
    s_add_u32 s25, s25, s23
    s_mul_i32 s34, s23, 7168
    v_lshrrev_b32 v7, 4, v1
    v_bfe_u32 v5, v1, 2, 2
    v_and_b32 v19, 3, v1
    s_cmp_ge_u32 s25, 448
    s_cbranch_scc1 Ltr2_103
    s_mov_b32 s26, 0x1100000
    s_cmp_ge_u32 s25, 224
    s_cselect_b32 s28, s56, s54
    s_cselect_b32 s29, s57, s55
    s_cselect_b32 s26, 0x1300000, s26
    s_cselect_b32 s27, 224, 0
    s_sub_u32 s25, s25, s27
    s_lshr_b32 s27, s25, 4
    s_and_b32 s25, s25, 15
    s_mul_i32 s30, s27, 114688
    s_mul_i32 s31, s25, 224
    s_add_u32 s30, s30, s31
    s_add_u32 s28, s28, s30
    s_addc_u32 s29, s29, 0
    s_mov_b32 s35, 3584
    s_mul_i32 s30, s25, 98
    s_add_u32 s30, s30, s27
    s_lshl_b32 s30, s30, 10
    s_add_u32 s30, s30, s26
    s_mov_b32 s36, 14336
    v_lshrrev_b32 v8, 1, v7
    v_lshlrev_b32 v8, 4, v8
    v_and_b32 v9, 1, v7
    v_lshl_add_u32 v8, v9, 2, v8
    v_and_b32 v9, 1, v5
    v_add_u32 v8, v8, v9
    v_lshrrev_b32 v9, 1, v5
    v_lshl_add_u32 v8, v9, 3, v8
    v_add_u32 v9, 2, v8
    s_branch Ltrj_104
Ltr2_103:
    s_sub_u32 s25, s25, 448
    s_lshr_b32 s27, s25, 2
    s_and_b32 s25, s25, 3
    s_mul_i32 s30, s27, 28672
    s_mul_i32 s31, s25, 224
    s_add_u32 s30, s30, s31
    s_add_u32 s28, s58, s30
    s_addc_u32 s29, s59, 0
    s_mov_b32 s35, 896
    s_mul_i32 s30, s25, 392
    s_add_u32 s30, s30, s27
    s_lshl_b32 s30, s30, 10
    s_add_u32 s30, s30, 0x1500000
    s_mov_b32 s36, 57344
    v_lshl_add_u32 v8, v7, 2, v5
    v_add_u32 v9, 16, v8
Ltrj_104:
    s_add_u32 s32, s4, s30
    s_addc_u32 s33, s5, 0
    v_add_u32 v4, 0, v1
    v_mul_u32_u24 v10, 4682, v4
    v_lshrrev_b32 v10, 16, v10
    v_mul_u32_u24 v11, 14, v10
    v_sub_u32 v4, v4, v11
    v_mul_u32_u24 v10, s35, v10
    v_lshl_add_u32 v4, v4, 4, v10
    s_add_u32 m0, s34, 0
    s_nop 0
    global_load_lds_dwordx4 v4, s[28:29]
    v_add_u32 v4, 64, v1
    v_mul_u32_u24 v10, 4682, v4
    v_lshrrev_b32 v10, 16, v10
    v_mul_u32_u24 v11, 14, v10
    v_sub_u32 v4, v4, v11
    v_mul_u32_u24 v10, s35, v10
    v_lshl_add_u32 v4, v4, 4, v10
    s_add_u32 m0, s34, 1024
    s_nop 0
    global_load_lds_dwordx4 v4, s[28:29]
    v_add_u32 v4, 128, v1
    v_mul_u32_u24 v10, 4682, v4
    v_lshrrev_b32 v10, 16, v10
    v_mul_u32_u24 v11, 14, v10
    v_sub_u32 v4, v4, v11
    v_mul_u32_u24 v10, s35, v10
    v_lshl_add_u32 v4, v4, 4, v10
    s_add_u32 m0, s34, 2048
    s_nop 0
    global_load_lds_dwordx4 v4, s[28:29]
    v_add_u32 v4, 192, v1
    v_mul_u32_u24 v10, 4682, v4
    v_lshrrev_b32 v10, 16, v10
    v_mul_u32_u24 v11, 14, v10
    v_sub_u32 v4, v4, v11
    v_mul_u32_u24 v10, s35, v10
    v_lshl_add_u32 v4, v4, 4, v10
    s_add_u32 m0, s34, 3072
    s_nop 0
    global_load_lds_dwordx4 v4, s[28:29]
    v_add_u32 v4, 256, v1
    v_mul_u32_u24 v10, 4682, v4
    v_lshrrev_b32 v10, 16, v10
    v_mul_u32_u24 v11, 14, v10
    v_sub_u32 v4, v4, v11
    v_mul_u32_u24 v10, s35, v10
    v_lshl_add_u32 v4, v4, 4, v10
    s_add_u32 m0, s34, 4096
    s_nop 0
    global_load_lds_dwordx4 v4, s[28:29]
    v_add_u32 v4, 320, v1
    v_mul_u32_u24 v10, 4682, v4
    v_lshrrev_b32 v10, 16, v10
    v_mul_u32_u24 v11, 14, v10
    v_sub_u32 v4, v4, v11
    v_mul_u32_u24 v10, s35, v10
    v_lshl_add_u32 v4, v4, 4, v10
    s_add_u32 m0, s34, 5120
    s_nop 0
    global_load_lds_dwordx4 v4, s[28:29]
    v_add_u32 v4, 384, v1
    v_mul_u32_u24 v10, 4682, v4
    v_lshrrev_b32 v10, 16, v10
    v_mul_u32_u24 v11, 14, v10
    v_sub_u32 v4, v4, v11
    v_mul_u32_u24 v10, s35, v10
    v_lshl_add_u32 v4, v4, 4, v10
    s_add_u32 m0, s34, 6144
    s_nop 0
    global_load_lds_dwordx4 v4, s[28:29]
    v_mul_u32_u24 v8, 224, v8
    v_lshl_add_u32 v8, v19, 3, v8
    v_add_u32 v8, s34, v8
    v_mul_u32_u24 v9, 224, v9
    v_lshl_add_u32 v9, v19, 3, v9
    v_add_u32 v9, s34, v9
    v_lshlrev_b32 v4, 4, v1
    s_waitcnt vmcnt(0)
    ds_read_b64_tr_b16 v[32:33], v8 offset:0
    ds_read_b64_tr_b16 v[34:35], v9 offset:0
    ds_read_b64_tr_b16 v[36:37], v8 offset:32
    ds_read_b64_tr_b16 v[38:39], v9 offset:32
    ds_read_b64_tr_b16 v[40:41], v8 offset:64
    ds_read_b64_tr_b16 v[42:43], v9 offset:64
    ds_read_b64_tr_b16 v[44:45], v8 offset:96
    ds_read_b64_tr_b16 v[46:47], v9 offset:96
    ds_read_b64_tr_b16 v[48:49], v8 offset:128
    ds_read_b64_tr_b16 v[50:51], v9 offset:128
    ds_read_b64_tr_b16 v[52:53], v8 offset:160
    ds_read_b64_tr_b16 v[54:55], v9 offset:160
    ds_read_b64_tr_b16 v[56:57], v8 offset:192
    ds_read_b64_tr_b16 v[58:59], v9 offset:192
    s_waitcnt lgkmcnt(0)
    global_store_dwordx4 v4, v[32:35], s[32:33] sc1
    v_add_u32 v4, s36, v4
    global_store_dwordx4 v4, v[36:39], s[32:33] sc1
    v_add_u32 v4, s36, v4
    global_store_dwordx4 v4, v[40:43], s[32:33] sc1
    v_add_u32 v4, s36, v4
    global_store_dwordx4 v4, v[44:47], s[32:33] sc1
    v_add_u32 v4, s36, v4
    global_store_dwordx4 v4, v[48:51], s[32:33] sc1
    v_add_u32 v4, s36, v4
    global_store_dwordx4 v4, v[52:55], s[32:33] sc1
    v_add_u32 v4, s36, v4
    global_store_dwordx4 v4, v[56:59], s[32:33] sc1
    v_add_u32 v4, s36, v4
    s_waitcnt vmcnt(0)
    s_barrier
    s_cmp_lg_u32 s23, 0
    s_cbranch_scc1 Lsig_105
    s_add_u32 s76, s4, 0x7900800
    s_addc_u32 s77, s5, 0
    s_mov_b64 exec, 1
    v_mov_b32 v22, 0
    v_mov_b32 v23, 1
    global_atomic_add v22, v23, s[76:77]
    s_mov_b64 exec, -1
Lsig_105:
Lnotr_102:
    v_and_b32 v1, 63, v0
    v_lshlrev_b32 v2, 4, v1
    v_lshlrev_b32 v3, 4, v1
    v_add_u32 v3, 4096, v3
    v_lshlrev_b32 v4, 4, v1
    v_add_u32 v4, 8192, v4
    v_lshlrev_b32 v5, 4, v1
    v_add_u32 v5, 12288, v5
    v_and_b32 v14, 3, v1
    v_bfe_u32 v15, v1, 2, 1
    v_lshl_add_u32 v14, v15, 3, v14
    v_lshrrev_b32 v15, 4, v1
    v_lshl_add_u32 v14, v15, 4, v14
    v_lshlrev_b32 v14, 4, v14
    v_bfe_u32 v15, v1, 3, 1
    v_mul_u32_u24 v15, 14336, v15
    v_add_u32 v14, v14, v15
    v_add_u32 v6, 0, v2
    v_add_u32 v9, 0, v14
    v_add_u32 v7, 57344, v2
    v_add_u32 v10, 57344, v14
    v_add_u32 v8, 114688, v2
    v_add_u32 v11, 114688, v14
    s_mul_i32 s39, s23, 7168
    v_add_u32 v12, s39, v2
    v_add_u32 v13, 4096, v12
    s_lshl_b32 s28, s73, 4
    s_lshl_b32 s29, s23, 2
    s_add_u32 s28, s28, s29
    s_mul_i32 s25, s74, 229376
    s_add_u32 s25, s25, 0x400000
    s_add_u32 s30, s4, s25
    s_addc_u32 s31, s5, 0
    s_mul_i32 s25, s28, 229376
    s_lshl_b32 s26, s74, 13
    s_add_u32 s25, s25, s26
    s_add_u32 s25, s25, 0x2000000
    s_add_u32 s34, s4, s25
    s_addc_u32 s35, s5, 0
    v_mov_b32 v16, v2
    v_add_u32 v17, 229376, v2
    v_add_u32 v18, 458752, v2
    v_add_u32 v19, 688128, v2
    s_barrier
    s_add_u32 m0, s39, 0
    s_nop 0
    global_load_lds_dwordx4 v12, s[30:31] offset:0 sc1
    s_add_u32 m0, s39, 0
    s_nop 0
    global_load_lds_dwordx4 v12, s[30:31] offset:1024 sc1
    s_add_u32 m0, s39, 0
    s_nop 0
    global_load_lds_dwordx4 v12, s[30:31] offset:2048 sc1
    s_add_u32 m0, s39, 0
    s_nop 0
    global_load_lds_dwordx4 v12, s[30:31] offset:3072 sc1
    s_add_u32 m0, s39, 4096
    s_nop 0
    global_load_lds_dwordx4 v13, s[30:31] offset:0 sc1
    s_add_u32 m0, s39, 4096
    s_nop 0
    global_load_lds_dwordx4 v13, s[30:31] offset:1024 sc1
    s_add_u32 m0, s39, 4096
    s_nop 0
    global_load_lds_dwordx4 v13, s[30:31] offset:2048 sc1
    s_add_u32 s30, s30, 0x7000
    s_addc_u32 s31, s31, 0
    s_add_u32 m0, s39, 28672
    s_nop 0
    global_load_lds_dwordx4 v12, s[30:31] offset:0 sc1
    s_add_u32 m0, s39, 28672
    s_nop 0
    global_load_lds_dwordx4 v12, s[30:31] offset:1024 sc1
    s_add_u32 m0, s39, 28672
    s_nop 0
    global_load_lds_dwordx4 v12, s[30:31] offset:2048 sc1
    s_add_u32 m0, s39, 28672
    s_nop 0
    global_load_lds_dwordx4 v12, s[30:31] offset:3072 sc1
    s_add_u32 m0, s39, 32768
    s_nop 0
    global_load_lds_dwordx4 v13, s[30:31] offset:0 sc1
    s_add_u32 m0, s39, 32768
    s_nop 0
    global_load_lds_dwordx4 v13, s[30:31] offset:1024 sc1
    s_add_u32 m0, s39, 32768
    s_nop 0
    global_load_lds_dwordx4 v13, s[30:31] offset:2048 sc1
    s_add_u32 s30, s30, 0x7000
    s_addc_u32 s31, s31, 0
    s_add_u32 m0, s39, 57344
    s_nop 0
    global_load_lds_dwordx4 v12, s[30:31] offset:0 sc1
    s_add_u32 m0, s39, 57344
    s_nop 0
    global_load_lds_dwordx4 v12, s[30:31] offset:1024 sc1
    s_add_u32 m0, s39, 57344
    s_nop 0
    global_load_lds_dwordx4 v12, s[30:31] offset:2048 sc1
    s_add_u32 m0, s39, 57344
    s_nop 0
    global_load_lds_dwordx4 v12, s[30:31] offset:3072 sc1
    s_add_u32 m0, s39, 61440
    s_nop 0
    global_load_lds_dwordx4 v13, s[30:31] offset:0 sc1
    s_add_u32 m0, s39, 61440
    s_nop 0
    global_load_lds_dwordx4 v13, s[30:31] offset:1024 sc1
    s_add_u32 m0, s39, 61440
    s_nop 0
    global_load_lds_dwordx4 v13, s[30:31] offset:2048 sc1
    s_add_u32 s30, s30, 0x7000
    s_addc_u32 s31, s31, 0
    s_waitcnt vmcnt(14)
    s_barrier
    ds_read_b128 v[24:27], v9 offset:0
    ds_read_b128 v[28:31], v9 offset:1024
    ds_read_b128 v[32:35], v9 offset:2048
    ds_read_b128 v[36:39], v9 offset:3072
    ds_read_b128 v[40:43], v9 offset:4096
    ds_read_b128 v[44:47], v9 offset:5120
    ds_read_b128 v[48:51], v9 offset:6144
    ds_read_b128 v[52:55], v9 offset:7168
    ds_read_b128 v[56:59], v9 offset:8192
    ds_read_b128 v[60:63], v9 offset:9216
    ds_read_b128 v[64:67], v9 offset:10240
    ds_read_b128 v[68:71], v9 offset:11264
    ds_read_b128 v[72:75], v9 offset:12288
    ds_read_b128 v[76:79], v9 offset:13312
    s_waitcnt lgkmcnt(0)
    v_mfma_f32_16x16x32_bf16 v[192:195], v[24:27], a[0:3], 0
    v_mfma_f32_16x16x32_bf16 v[196:199], v[24:27], a[56:59], 0
    ds_read_b128 v[80:83], v9 offset:64
    v_mfma_f32_16x16x32_bf16 v[200:203], v[24:27], a[112:115], 0
    v_mfma_f32_16x16x32_bf16 v[204:207], v[24:27], a[168:171], 0
    s_add_u32 m0, s39, 86016
    s_nop 0
    global_load_lds_dwordx4 v12, s[30:31] offset:0 sc1
    s_add_u32 m0, s39, 86016
    s_nop 0
    global_load_lds_dwordx4 v12, s[30:31] offset:1024 sc1
    v_mfma_f32_16x16x32_bf16 v[192:195], v[28:31], a[4:7], v[192:195]
    v_mfma_f32_16x16x32_bf16 v[196:199], v[28:31], a[60:63], v[196:199]
    ds_read_b128 v[84:87], v9 offset:1088
    v_mfma_f32_16x16x32_bf16 v[200:203], v[28:31], a[116:119], v[200:203]
    v_mfma_f32_16x16x32_bf16 v[204:207], v[28:31], a[172:175], v[204:207]
    s_add_u32 m0, s39, 86016
    s_nop 0
    global_load_lds_dwordx4 v12, s[30:31] offset:2048 sc1
    s_add_u32 m0, s39, 86016
    s_nop 0
    global_load_lds_dwordx4 v12, s[30:31] offset:3072 sc1
    v_mfma_f32_16x16x32_bf16 v[192:195], v[32:35], a[8:11], v[192:195]
    v_mfma_f32_16x16x32_bf16 v[196:199], v[32:35], a[64:67], v[196:199]
    ds_read_b128 v[88:91], v9 offset:2112
    v_mfma_f32_16x16x32_bf16 v[200:203], v[32:35], a[120:123], v[200:203]
    v_mfma_f32_16x16x32_bf16 v[204:207], v[32:35], a[176:179], v[204:207]
    s_add_u32 m0, s39, 90112
    s_nop 0
    global_load_lds_dwordx4 v13, s[30:31] offset:0 sc1
    s_add_u32 m0, s39, 90112
    s_nop 0
    global_load_lds_dwordx4 v13, s[30:31] offset:1024 sc1
    v_mfma_f32_16x16x32_bf16 v[192:195], v[36:39], a[12:15], v[192:195]
    v_mfma_f32_16x16x32_bf16 v[196:199], v[36:39], a[68:71], v[196:199]
    ds_read_b128 v[92:95], v9 offset:3136
    v_mfma_f32_16x16x32_bf16 v[200:203], v[36:39], a[124:127], v[200:203]
    v_mfma_f32_16x16x32_bf16 v[204:207], v[36:39], a[180:183], v[204:207]
    s_add_u32 m0, s39, 90112
    s_nop 0
    global_load_lds_dwordx4 v13, s[30:31] offset:2048 sc1
    s_add_u32 s30, s30, 0x7000
    s_addc_u32 s31, s31, 0
    v_mfma_f32_16x16x32_bf16 v[192:195], v[40:43], a[16:19], v[192:195]
    v_mfma_f32_16x16x32_bf16 v[196:199], v[40:43], a[72:75], v[196:199]
    ds_read_b128 v[96:99], v9 offset:4160
    v_mfma_f32_16x16x32_bf16 v[200:203], v[40:43], a[128:131], v[200:203]
    v_mfma_f32_16x16x32_bf16 v[204:207], v[40:43], a[184:187], v[204:207]
    v_mfma_f32_16x16x32_bf16 v[192:195], v[44:47], a[20:23], v[192:195]
    v_mfma_f32_16x16x32_bf16 v[196:199], v[44:47], a[76:79], v[196:199]
    ds_read_b128 v[100:103], v9 offset:5184
    v_mfma_f32_16x16x32_bf16 v[200:203], v[44:47], a[132:135], v[200:203]
    v_mfma_f32_16x16x32_bf16 v[204:207], v[44:47], a[188:191], v[204:207]
    v_mfma_f32_16x16x32_bf16 v[192:195], v[48:51], a[24:27], v[192:195]
    v_mfma_f32_16x16x32_bf16 v[196:199], v[48:51], a[80:83], v[196:199]
    ds_read_b128 v[104:107], v9 offset:6208
    v_mfma_f32_16x16x32_bf16 v[200:203], v[48:51], a[136:139], v[200:203]
    v_mfma_f32_16x16x32_bf16 v[204:207], v[48:51], a[192:195], v[204:207]
    v_mfma_f32_16x16x32_bf16 v[192:195], v[52:55], a[28:31], v[192:195]
    v_mfma_f32_16x16x32_bf16 v[196:199], v[52:55], a[84:87], v[196:199]
    ds_read_b128 v[108:111], v9 offset:7232
    v_mfma_f32_16x16x32_bf16 v[200:203], v[52:55], a[140:143], v[200:203]
    v_mfma_f32_16x16x32_bf16 v[204:207], v[52:55], a[196:199], v[204:207]
    v_mfma_f32_16x16x32_bf16 v[192:195], v[56:59], a[32:35], v[192:195]
    v_mfma_f32_16x16x32_bf16 v[196:199], v[56:59], a[88:91], v[196:199]
    ds_read_b128 v[112:115], v9 offset:8256
    v_mfma_f32_16x16x32_bf16 v[200:203], v[56:59], a[144:147], v[200:203]
    v_mfma_f32_16x16x32_bf16 v[204:207], v[56:59], a[200:203], v[204:207]
    v_mfma_f32_16x16x32_bf16 v[192:195], v[60:63], a[36:39], v[192:195]
    v_mfma_f32_16x16x32_bf16 v[196:199], v[60:63], a[92:95], v[196:199]
    ds_read_b128 v[116:119], v9 offset:9280
    v_mfma_f32_16x16x32_bf16 v[200:203], v[60:63], a[148:151], v[200:203]
    v_mfma_f32_16x16x32_bf16 v[204:207], v[60:63], a[204:207], v[204:207]
    v_mfma_f32_16x16x32_bf16 v[192:195], v[64:67], a[40:43], v[192:195]
    v_mfma_f32_16x16x32_bf16 v[196:199], v[64:67], a[96:99], v[196:199]
    ds_read_b128 v[120:123], v9 offset:10304
    v_mfma_f32_16x16x32_bf16 v[200:203], v[64:67], a[152:155], v[200:203]
    v_mfma_f32_16x16x32_bf16 v[204:207], v[64:67], a[208:211], v[204:207]
    v_mfma_f32_16x16x32_bf16 v[192:195], v[68:71], a[44:47], v[192:195]
    v_mfma_f32_16x16x32_bf16 v[196:199], v[68:71], a[100:103], v[196:199]
    ds_read_b128 v[124:127], v9 offset:11328
    v_mfma_f32_16x16x32_bf16 v[200:203], v[68:71], a[156:159], v[200:203]
    v_mfma_f32_16x16x32_bf16 v[204:207], v[68:71], a[212:215], v[204:207]
    v_mfma_f32_16x16x32_bf16 v[192:195], v[72:75], a[48:51], v[192:195]
    v_mfma_f32_16x16x32_bf16 v[196:199], v[72:75], a[104:107], v[196:199]
    ds_read_b128 v[128:131], v9 offset:12352
    v_mfma_f32_16x16x32_bf16 v[200:203], v[72:75], a[160:163], v[200:203]
    v_mfma_f32_16x16x32_bf16 v[204:207], v[72:75], a[216:219], v[204:207]
    v_mfma_f32_16x16x32_bf16 v[192:195], v[76:79], a[52:55], v[192:195]
    v_mfma_f32_16x16x32_bf16 v[196:199], v[76:79], a[108:111], v[196:199]
    ds_read_b128 v[132:135], v9 offset:13376
    v_mfma_f32_16x16x32_bf16 v[200:203], v[76:79], a[164:167], v[200:203]
    v_mfma_f32_16x16x32_bf16 v[204:207], v[76:79], a[220:223], v[204:207]
    s_waitcnt lgkmcnt(0)
    s_waitcnt vmcnt(14)
    s_barrier
    v_mfma_f32_16x16x32_bf16 v[208:211], v[80:83], a[0:3], 0
    v_mfma_f32_16x16x32_bf16 v[212:215], v[80:83], a[56:59], 0
    ds_read_b128 v[136:139], v9 offset:28672
    v_mfma_f32_16x16x32_bf16 v[216:219], v[80:83], a[112:115], 0
    v_mfma_f32_16x16x32_bf16 v[220:223], v[80:83], a[168:171], 0
    v_mfma_f32_16x16x32_bf16 v[208:211], v[84:87], a[4:7], v[208:211]
    v_mfma_f32_16x16x32_bf16 v[212:215], v[84:87], a[60:63], v[212:215]
    ds_read_b128 v[140:143], v9 offset:29696
    v_mfma_f32_16x16x32_bf16 v[216:219], v[84:87], a[116:119], v[216:219]
    v_mfma_f32_16x16x32_bf16 v[220:223], v[84:87], a[172:175], v[220:223]
    v_mfma_f32_16x16x32_bf16 v[208:211], v[88:91], a[8:11], v[208:211]
    v_mfma_f32_16x16x32_bf16 v[212:215], v[88:91], a[64:67], v[212:215]
    ds_read_b128 v[144:147], v9 offset:30720
    v_mfma_f32_16x16x32_bf16 v[216:219], v[88:91], a[120:123], v[216:219]
    v_mfma_f32_16x16x32_bf16 v[220:223], v[88:91], a[176:179], v[220:223]
    v_mfma_f32_16x16x32_bf16 v[208:211], v[92:95], a[12:15], v[208:211]
    v_mfma_f32_16x16x32_bf16 v[212:215], v[92:95], a[68:71], v[212:215]
    ds_read_b128 v[148:151], v9 offset:31744
    v_mfma_f32_16x16x32_bf16 v[216:219], v[92:95], a[124:127], v[216:219]
    v_mfma_f32_16x16x32_bf16 v[220:223], v[92:95], a[180:183], v[220:223]
    v_mfma_f32_16x16x32_bf16 v[208:211], v[96:99], a[16:19], v[208:211]
    v_mfma_f32_16x16x32_bf16 v[212:215], v[96:99], a[72:75], v[212:215]
    ds_read_b128 v[152:155], v9 offset:32768
    v_mfma_f32_16x16x32_bf16 v[216:219], v[96:99], a[128:131], v[216:219]
    v_mfma_f32_16x16x32_bf16 v[220:223], v[96:99], a[184:187], v[220:223]
    v_mfma_f32_16x16x32_bf16 v[208:211], v[100:103], a[20:23], v[208:211]
    v_mfma_f32_16x16x32_bf16 v[212:215], v[100:103], a[76:79], v[212:215]
    ds_read_b128 v[156:159], v9 offset:33792
    v_mfma_f32_16x16x32_bf16 v[216:219], v[100:103], a[132:135], v[216:219]
    v_mfma_f32_16x16x32_bf16 v[220:223], v[100:103], a[188:191], v[220:223]
    v_mfma_f32_16x16x32_bf16 v[208:211], v[104:107], a[24:27], v[208:211]
    v_mfma_f32_16x16x32_bf16 v[212:215], v[104:107], a[80:83], v[212:215]
    ds_read_b128 v[160:163], v9 offset:34816
    v_mfma_f32_16x16x32_bf16 v[216:219], v[104:107], a[136:139], v[216:219]
    v_mfma_f32_16x16x32_bf16 v[220:223], v[104:107], a[192:195], v[220:223]
    v_mfma_f32_16x16x32_bf16 v[208:211], v[108:111], a[28:31], v[208:211]
    v_mfma_f32_16x16x32_bf16 v[212:215], v[108:111], a[84:87], v[212:215]
    ds_read_b128 v[164:167], v9 offset:35840
    v_mfma_f32_16x16x32_bf16 v[216:219], v[108:111], a[140:143], v[216:219]
    v_mfma_f32_16x16x32_bf16 v[220:223], v[108:111], a[196:199], v[220:223]
    v_mfma_f32_16x16x32_bf16 v[208:211], v[112:115], a[32:35], v[208:211]
    v_mfma_f32_16x16x32_bf16 v[212:215], v[112:115], a[88:91], v[212:215]
    ds_read_b128 v[168:171], v9 offset:36864
    v_mfma_f32_16x16x32_bf16 v[216:219], v[112:115], a[144:147], v[216:219]
    v_mfma_f32_16x16x32_bf16 v[220:223], v[112:115], a[200:203], v[220:223]
    v_mfma_f32_16x16x32_bf16 v[208:211], v[116:119], a[36:39], v[208:211]
    v_mfma_f32_16x16x32_bf16 v[212:215], v[116:119], a[92:95], v[212:215]
    ds_read_b128 v[172:175], v9 offset:37888
    v_mfma_f32_16x16x32_bf16 v[216:219], v[116:119], a[148:151], v[216:219]
    v_mfma_f32_16x16x32_bf16 v[220:223], v[116:119], a[204:207], v[220:223]
    v_mfma_f32_16x16x32_bf16 v[208:211], v[120:123], a[40:43], v[208:211]
    v_mfma_f32_16x16x32_bf16 v[212:215], v[120:123], a[96:99], v[212:215]
    ds_read_b128 v[176:179], v9 offset:38912
    v_mfma_f32_16x16x32_bf16 v[216:219], v[120:123], a[152:155], v[216:219]
    v_mfma_f32_16x16x32_bf16 v[220:223], v[120:123], a[208:211], v[220:223]
    v_mfma_f32_16x16x32_bf16 v[208:211], v[124:127], a[44:47], v[208:211]
    v_mfma_f32_16x16x32_bf16 v[212:215], v[124:127], a[100:103], v[212:215]
    ds_read_b128 v[180:183], v9 offset:39936
    v_mfma_f32_16x16x32_bf16 v[216:219], v[124:127], a[156:159], v[216:219]
    v_mfma_f32_16x16x32_bf16 v[220:223], v[124:127], a[212:215], v[220:223]
    v_mfma_f32_16x16x32_bf16 v[208:211], v[128:131], a[48:51], v[208:211]
    v_mfma_f32_16x16x32_bf16 v[212:215], v[128:131], a[104:107], v[212:215]
    ds_read_b128 v[184:187], v9 offset:40960
    v_mfma_f32_16x16x32_bf16 v[216:219], v[128:131], a[160:163], v[216:219]
    v_mfma_f32_16x16x32_bf16 v[220:223], v[128:131], a[216:219], v[220:223]
    v_mfma_f32_16x16x32_bf16 v[208:211], v[132:135], a[52:55], v[208:211]
    v_mfma_f32_16x16x32_bf16 v[212:215], v[132:135], a[108:111], v[212:215]
    ds_read_b128 v[188:191], v9 offset:41984
    v_mfma_f32_16x16x32_bf16 v[216:219], v[132:135], a[164:167], v[216:219]
    v_mfma_f32_16x16x32_bf16 v[220:223], v[132:135], a[220:223], v[220:223]
    s_nop 7
    v_cvt_pk_bf16_f32 v224, v192, v193
    v_cvt_pk_bf16_f32 v225, v194, v195
    v_cvt_pk_bf16_f32 v226, v208, v209
    v_cvt_pk_bf16_f32 v227, v210, v211
    global_store_dwordx4 v16, v[224:227], s[34:35] offset:0 sc1
    v_cvt_pk_bf16_f32 v228, v196, v197
    v_cvt_pk_bf16_f32 v229, v198, v199
    v_cvt_pk_bf16_f32 v230, v212, v213
    v_cvt_pk_bf16_f32 v231, v214, v215
    global_store_dwordx4 v17, v[228:231], s[34:35] offset:0 sc1
    v_cvt_pk_bf16_f32 v232, v200, v201
    v_cvt_pk_bf16_f32 v233, v202, v203
    v_cvt_pk_bf16_f32 v234, v216, v217
    v_cvt_pk_bf16_f32 v235, v218, v219
    global_store_dwordx4 v18, v[232:235], s[34:35] offset:0 sc1
    v_cvt_pk_bf16_f32 v236, v204, v205
    v_cvt_pk_bf16_f32 v237, v206, v207
    v_cvt_pk_bf16_f32 v238, v220, v221
    v_cvt_pk_bf16_f32 v239, v222, v223
    global_store_dwordx4 v19, v[236:239], s[34:35] offset:0 sc1
    s_waitcnt lgkmcnt(0)
    v_mfma_f32_16x16x32_bf16 v[192:195], v[136:139], a[0:3], 0
    v_mfma_f32_16x16x32_bf16 v[196:199], v[136:139], a[56:59], 0
    ds_read_b128 v[24:27], v9 offset:28736
    v_mfma_f32_16x16x32_bf16 v[200:203], v[136:139], a[112:115], 0
    v_mfma_f32_16x16x32_bf16 v[204:207], v[136:139], a[168:171], 0
    s_add_u32 m0, s39, 114688
    s_nop 0
    global_load_lds_dwordx4 v12, s[30:31] offset:0 sc1
    s_add_u32 m0, s39, 114688
    s_nop 0
    global_load_lds_dwordx4 v12, s[30:31] offset:1024 sc1
    v_mfma_f32_16x16x32_bf16 v[192:195], v[140:143], a[4:7], v[192:195]
    v_mfma_f32_16x16x32_bf16 v[196:199], v[140:143], a[60:63], v[196:199]
    ds_read_b128 v[28:31], v9 offset:29760
    v_mfma_f32_16x16x32_bf16 v[200:203], v[140:143], a[116:119], v[200:203]
    v_mfma_f32_16x16x32_bf16 v[204:207], v[140:143], a[172:175], v[204:207]
    s_add_u32 m0, s39, 114688
    s_nop 0
    global_load_lds_dwordx4 v12, s[30:31] offset:2048 sc1
    s_add_u32 m0, s39, 114688
    s_nop 0
    global_load_lds_dwordx4 v12, s[30:31] offset:3072 sc1
    v_mfma_f32_16x16x32_bf16 v[192:195], v[144:147], a[8:11], v[192:195]
    v_mfma_f32_16x16x32_bf16 v[196:199], v[144:147], a[64:67], v[196:199]
    ds_read_b128 v[32:35], v9 offset:30784
    v_mfma_f32_16x16x32_bf16 v[200:203], v[144:147], a[120:123], v[200:203]
    v_mfma_f32_16x16x32_bf16 v[204:207], v[144:147], a[176:179], v[204:207]
    s_add_u32 m0, s39, 118784
    s_nop 0
    global_load_lds_dwordx4 v13, s[30:31] offset:0 sc1
    s_add_u32 m0, s39, 118784
    s_nop 0
    global_load_lds_dwordx4 v13, s[30:31] offset:1024 sc1
    v_mfma_f32_16x16x32_bf16 v[192:195], v[148:151], a[12:15], v[192:195]
    v_mfma_f32_16x16x32_bf16 v[196:199], v[148:151], a[68:71], v[196:199]
    ds_read_b128 v[36:39], v9 offset:31808
    v_mfma_f32_16x16x32_bf16 v[200:203], v[148:151], a[124:127], v[200:203]
    v_mfma_f32_16x16x32_bf16 v[204:207], v[148:151], a[180:183], v[204:207]
    s_add_u32 m0, s39, 118784
    s_nop 0
    global_load_lds_dwordx4 v13, s[30:31] offset:2048 sc1
    s_add_u32 s30, s30, 0x7000
    s_addc_u32 s31, s31, 0
    v_mfma_f32_16x16x32_bf16 v[192:195], v[152:155], a[16:19], v[192:195]
    v_mfma_f32_16x16x32_bf16 v[196:199], v[152:155], a[72:75], v[196:199]
    ds_read_b128 v[40:43], v9 offset:32832
    v_mfma_f32_16x16x32_bf16 v[200:203], v[152:155], a[128:131], v[200:203]
    v_mfma_f32_16x16x32_bf16 v[204:207], v[152:155], a[184:187], v[204:207]
    v_mfma_f32_16x16x32_bf16 v[192:195], v[156:159], a[20:23], v[192:195]
    v_mfma_f32_16x16x32_bf16 v[196:199], v[156:159], a[76:79], v[196:199]
    ds_read_b128 v[44:47], v9 offset:33856
    v_mfma_f32_16x16x32_bf16 v[200:203], v[156:159], a[132:135], v[200:203]
    v_mfma_f32_16x16x32_bf16 v[204:207], v[156:159], a[188:191], v[204:207]
    v_mfma_f32_16x16x32_bf16 v[192:195], v[160:163], a[24:27], v[192:195]
    v_mfma_f32_16x16x32_bf16 v[196:199], v[160:163], a[80:83], v[196:199]
    ds_read_b128 v[48:51], v9 offset:34880
    v_mfma_f32_16x16x32_bf16 v[200:203], v[160:163], a[136:139], v[200:203]
    v_mfma_f32_16x16x32_bf16 v[204:207], v[160:163], a[192:195], v[204:207]
    v_mfma_f32_16x16x32_bf16 v[192:195], v[164:167], a[28:31], v[192:195]
    v_mfma_f32_16x16x32_bf16 v[196:199], v[164:167], a[84:87], v[196:199]
    ds_read_b128 v[52:55], v9 offset:35904
    v_mfma_f32_16x16x32_bf16 v[200:203], v[164:167], a[140:143], v[200:203]
    v_mfma_f32_16x16x32_bf16 v[204:207], v[164:167], a[196:199], v[204:207]
    v_mfma_f32_16x16x32_bf16 v[192:195], v[168:171], a[32:35], v[192:195]
    v_mfma_f32_16x16x32_bf16 v[196:199], v[168:171], a[88:91], v[196:199]
    ds_read_b128 v[56:59], v9 offset:36928
    v_mfma_f32_16x16x32_bf16 v[200:203], v[168:171], a[144:147], v[200:203]
    v_mfma_f32_16x16x32_bf16 v[204:207], v[168:171], a[200:203], v[204:207]
    v_mfma_f32_16x16x32_bf16 v[192:195], v[172:175], a[36:39], v[192:195]
    v_mfma_f32_16x16x32_bf16 v[196:199], v[172:175], a[92:95], v[196:199]
    ds_read_b128 v[60:63], v9 offset:37952
    v_mfma_f32_16x16x32_bf16 v[200:203], v[172:175], a[148:151], v[200:203]
    v_mfma_f32_16x16x32_bf16 v[204:207], v[172:175], a[204:207], v[204:207]
    v_mfma_f32_16x16x32_bf16 v[192:195], v[176:179], a[40:43], v[192:195]
    v_mfma_f32_16x16x32_bf16 v[196:199], v[176:179], a[96:99], v[196:199]
    ds_read_b128 v[64:67], v9 offset:38976
    v_mfma_f32_16x16x32_bf16 v[200:203], v[176:179], a[152:155], v[200:203]
    v_mfma_f32_16x16x32_bf16 v[204:207], v[176:179], a[208:211], v[204:207]
    v_mfma_f32_16x16x32_bf16 v[192:195], v[180:183], a[44:47], v[192:195]
    v_mfma_f32_16x16x32_bf16 v[196:199], v[180:183], a[100:103], v[196:199]
    ds_read_b128 v[68:71], v9 offset:40000
    v_mfma_f32_16x16x32_bf16 v[200:203], v[180:183], a[156:159], v[200:203]
    v_mfma_f32_16x16x32_bf16 v[204:207], v[180:183], a[212:215], v[204:207]
    v_mfma_f32_16x16x32_bf16 v[192:195], v[184:187], a[48:51], v[192:195]
    v_mfma_f32_16x16x32_bf16 v[196:199], v[184:187], a[104:107], v[196:199]
    ds_read_b128 v[72:75], v9 offset:41024
    v_mfma_f32_16x16x32_bf16 v[200:203], v[184:187], a[160:163], v[200:203]
    v_mfma_f32_16x16x32_bf16 v[204:207], v[184:187], a[216:219], v[204:207]
    v_mfma_f32_16x16x32_bf16 v[192:195], v[188:191], a[52:55], v[192:195]
    v_mfma_f32_16x16x32_bf16 v[196:199], v[188:191], a[108:111], v[196:199]
    ds_read_b128 v[76:79], v9 offset:42048
    v_mfma_f32_16x16x32_bf16 v[200:203], v[188:191], a[164:167], v[200:203]
    v_mfma_f32_16x16x32_bf16 v[204:207], v[188:191], a[220:223], v[204:207]
    s_waitcnt lgkmcnt(0)
    s_waitcnt vmcnt(18)
    s_barrier
    v_mfma_f32_16x16x32_bf16 v[208:211], v[24:27], a[0:3], 0
    v_mfma_f32_16x16x32_bf16 v[212:215], v[24:27], a[56:59], 0
    ds_read_b128 v[80:83], v10 offset:0
    v_mfma_f32_16x16x32_bf16 v[216:219], v[24:27], a[112:115], 0
    v_mfma_f32_16x16x32_bf16 v[220:223], v[24:27], a[168:171], 0
    v_mfma_f32_16x16x32_bf16 v[208:211], v[28:31], a[4:7], v[208:211]
    v_mfma_f32_16x16x32_bf16 v[212:215], v[28:31], a[60:63], v[212:215]
    ds_read_b128 v[84:87], v10 offset:1024
    v_mfma_f32_16x16x32_bf16 v[216:219], v[28:31], a[116:119], v[216:219]
    v_mfma_f32_16x16x32_bf16 v[220:223], v[28:31], a[172:175], v[220:223]
    v_mfma_f32_16x16x32_bf16 v[208:211], v[32:35], a[8:11], v[208:211]
    v_mfma_f32_16x16x32_bf16 v[212:215], v[32:35], a[64:67], v[212:215]
    ds_read_b128 v[88:91], v10 offset:2048
    v_mfma_f32_16x16x32_bf16 v[216:219], v[32:35], a[120:123], v[216:219]
    v_mfma_f32_16x16x32_bf16 v[220:223], v[32:35], a[176:179], v[220:223]
    v_mfma_f32_16x16x32_bf16 v[208:211], v[36:39], a[12:15], v[208:211]
    v_mfma_f32_16x16x32_bf16 v[212:215], v[36:39], a[68:71], v[212:215]
    ds_read_b128 v[92:95], v10 offset:3072
    v_mfma_f32_16x16x32_bf16 v[216:219], v[36:39], a[124:127], v[216:219]
    v_mfma_f32_16x16x32_bf16 v[220:223], v[36:39], a[180:183], v[220:223]
    v_mfma_f32_16x16x32_bf16 v[208:211], v[40:43], a[16:19], v[208:211]
    v_mfma_f32_16x16x32_bf16 v[212:215], v[40:43], a[72:75], v[212:215]
    ds_read_b128 v[96:99], v10 offset:4096
    v_mfma_f32_16x16x32_bf16 v[216:219], v[40:43], a[128:131], v[216:219]
    v_mfma_f32_16x16x32_bf16 v[220:223], v[40:43], a[184:187], v[220:223]
    v_mfma_f32_16x16x32_bf16 v[208:211], v[44:47], a[20:23], v[208:211]
    v_mfma_f32_16x16x32_bf16 v[212:215], v[44:47], a[76:79], v[212:215]
    ds_read_b128 v[100:103], v10 offset:5120
    v_mfma_f32_16x16x32_bf16 v[216:219], v[44:47], a[132:135], v[216:219]
    v_mfma_f32_16x16x32_bf16 v[220:223], v[44:47], a[188:191], v[220:223]
    v_mfma_f32_16x16x32_bf16 v[208:211], v[48:51], a[24:27], v[208:211]
    v_mfma_f32_16x16x32_bf16 v[212:215], v[48:51], a[80:83], v[212:215]
    ds_read_b128 v[104:107], v10 offset:6144
    v_mfma_f32_16x16x32_bf16 v[216:219], v[48:51], a[136:139], v[216:219]
    v_mfma_f32_16x16x32_bf16 v[220:223], v[48:51], a[192:195], v[220:223]
    v_mfma_f32_16x16x32_bf16 v[208:211], v[52:55], a[28:31], v[208:211]
    v_mfma_f32_16x16x32_bf16 v[212:215], v[52:55], a[84:87], v[212:215]
    ds_read_b128 v[108:111], v10 offset:7168
    v_mfma_f32_16x16x32_bf16 v[216:219], v[52:55], a[140:143], v[216:219]
    v_mfma_f32_16x16x32_bf16 v[220:223], v[52:55], a[196:199], v[220:223]
    v_mfma_f32_16x16x32_bf16 v[208:211], v[56:59], a[32:35], v[208:211]
    v_mfma_f32_16x16x32_bf16 v[212:215], v[56:59], a[88:91], v[212:215]
    ds_read_b128 v[112:115], v10 offset:8192
    v_mfma_f32_16x16x32_bf16 v[216:219], v[56:59], a[144:147], v[216:219]
    v_mfma_f32_16x16x32_bf16 v[220:223], v[56:59], a[200:203], v[220:223]
    v_mfma_f32_16x16x32_bf16 v[208:211], v[60:63], a[36:39], v[208:211]
    v_mfma_f32_16x16x32_bf16 v[212:215], v[60:63], a[92:95], v[212:215]
    ds_read_b128 v[116:119], v10 offset:9216
    v_mfma_f32_16x16x32_bf16 v[216:219], v[60:63], a[148:151], v[216:219]
    v_mfma_f32_16x16x32_bf16 v[220:223], v[60:63], a[204:207], v[220:223]
    v_mfma_f32_16x16x32_bf16 v[208:211], v[64:67], a[40:43], v[208:211]
    v_mfma_f32_16x16x32_bf16 v[212:215], v[64:67], a[96:99], v[212:215]
    ds_read_b128 v[120:123], v10 offset:10240
    v_mfma_f32_16x16x32_bf16 v[216:219], v[64:67], a[152:155], v[216:219]
    v_mfma_f32_16x16x32_bf16 v[220:223], v[64:67], a[208:211], v[220:223]
    v_mfma_f32_16x16x32_bf16 v[208:211], v[68:71], a[44:47], v[208:211]
    v_mfma_f32_16x16x32_bf16 v[212:215], v[68:71], a[100:103], v[212:215]
    ds_read_b128 v[124:127], v10 offset:11264
    v_mfma_f32_16x16x32_bf16 v[216:219], v[68:71], a[156:159], v[216:219]
    v_mfma_f32_16x16x32_bf16 v[220:223], v[68:71], a[212:215], v[220:223]
    v_mfma_f32_16x16x32_bf16 v[208:211], v[72:75], a[48:51], v[208:211]
    v_mfma_f32_16x16x32_bf16 v[212:215], v[72:75], a[104:107], v[212:215]
    ds_read_b128 v[128:131], v10 offset:12288
    v_mfma_f32_16x16x32_bf16 v[216:219], v[72:75], a[160:163], v[216:219]
    v_mfma_f32_16x16x32_bf16 v[220:223], v[72:75], a[216:219], v[220:223]
    v_mfma_f32_16x16x32_bf16 v[208:211], v[76:79], a[52:55], v[208:211]
    v_mfma_f32_16x16x32_bf16 v[212:215], v[76:79], a[108:111], v[212:215]
    ds_read_b128 v[132:135], v10 offset:13312
    v_mfma_f32_16x16x32_bf16 v[216:219], v[76:79], a[164:167], v[216:219]
    v_mfma_f32_16x16x32_bf16 v[220:223], v[76:79], a[220:223], v[220:223]
    s_nop 7
    v_cvt_pk_bf16_f32 v240, v192, v193
    v_cvt_pk_bf16_f32 v241, v194, v195
    v_cvt_pk_bf16_f32 v242, v208, v209
    v_cvt_pk_bf16_f32 v243, v210, v211
    global_store_dwordx4 v16, v[240:243], s[34:35] offset:1024 sc1
    v_cvt_pk_bf16_f32 v244, v196, v197
    v_cvt_pk_bf16_f32 v245, v198, v199
    v_cvt_pk_bf16_f32 v246, v212, v213
    v_cvt_pk_bf16_f32 v247, v214, v215
    global_store_dwordx4 v17, v[244:247], s[34:35] offset:1024 sc1
    v_cvt_pk_bf16_f32 v248, v200, v201
    v_cvt_pk_bf16_f32 v249, v202, v203
    v_cvt_pk_bf16_f32 v250, v216, v217
    v_cvt_pk_bf16_f32 v251, v218, v219
    global_store_dwordx4 v18, v[248:251], s[34:35] offset:1024 sc1
    v_cvt_pk_bf16_f32 v252, v204, v205
    v_cvt_pk_bf16_f32 v253, v206, v207
    v_cvt_pk_bf16_f32 v254, v220, v221
    v_cvt_pk_bf16_f32 v255, v222, v223
    global_store_dwordx4 v19, v[252:255], s[34:35] offset:1024 sc1
    s_waitcnt lgkmcnt(0)
    v_mfma_f32_16x16x32_bf16 v[192:195], v[80:83], a[0:3], 0
    v_mfma_f32_16x16x32_bf16 v[196:199], v[80:83], a[56:59], 0
    ds_read_b128 v[136:139], v10 offset:64
    v_mfma_f32_16x16x32_bf16 v[200:203], v[80:83], a[112:115], 0
    v_mfma_f32_16x16x32_bf16 v[204:207], v[80:83], a[168:171], 0
    s_add_u32 m0, s39, 0
    s_nop 0
    global_load_lds_dwordx4 v12, s[30:31] offset:0 sc1
    s_add_u32 m0, s39, 0
    s_nop 0
    global_load_lds_dwordx4 v12, s[30:31] offset:1024 sc1
    v_mfma_f32_16x16x32_bf16 v[192:195], v[84:87], a[4:7], v[192:195]
    v_mfma_f32_16x16x32_bf16 v[196:199], v[84:87], a[60:63], v[196:199]
    ds_read_b128 v[140:143], v10 offset:1088
    v_mfma_f32_16x16x32_bf16 v[200:203], v[84:87], a[116:119], v[200:203]
    v_mfma_f32_16x16x32_bf16 v[204:207], v[84:87], a[172:175], v[204:207]
    s_add_u32 m0, s39, 0
    s_nop 0
    global_load_lds_dwordx4 v12, s[30:31] offset:2048 sc1
    s_add_u32 m0, s39, 0
    s_nop 0
    global_load_lds_dwordx4 v12, s[30:31] offset:3072 sc1
    v_mfma_f32_16x16x32_bf16 v[192:195], v[88:91], a[8:11], v[192:195]
    v_mfma_f32_16x16x32_bf16 v[196:199], v[88:91], a[64:67], v[196:199]
    ds_read_b128 v[144:147], v10 offset:2112
    v_mfma_f32_16x16x32_bf16 v[200:203], v[88:91], a[120:123], v[200:203]
    v_mfma_f32_16x16x32_bf16 v[204:207], v[88:91], a[176:179], v[204:207]
    s_add_u32 m0, s39, 4096
    s_nop 0
    global_load_lds_dwordx4 v13, s[30:31] offset:0 sc1
    s_add_u32 m0, s39, 4096
    s_nop 0
    global_load_lds_dwordx4 v13, s[30:31] offset:1024 sc1
    v_mfma_f32_16x16x32_bf16 v[192:195], v[92:95], a[12:15], v[192:195]
    v_mfma_f32_16x16x32_bf16 v[196:199], v[92:95], a[68:71], v[196:199]
    ds_read_b128 v[148:151], v10 offset:3136
    v_mfma_f32_16x16x32_bf16 v[200:203], v[92:95], a[124:127], v[200:203]
    v_mfma_f32_16x16x32_bf16 v[204:207], v[92:95], a[180:183], v[204:207]
    s_add_u32 m0, s39, 4096
    s_nop 0
    global_load_lds_dwordx4 v13, s[30:31] offset:2048 sc1
    s_add_u32 s30, s30, 0x7000
    s_addc_u32 s31, s31, 0
    v_mfma_f32_16x16x32_bf16 v[192:195], v[96:99], a[16:19], v[192:195]
    v_mfma_f32_16x16x32_bf16 v[196:199], v[96:99], a[72:75], v[196:199]
    ds_read_b128 v[152:155], v10 offset:4160
    v_mfma_f32_16x16x32_bf16 v[200:203], v[96:99], a[128:131], v[200:203]
    v_mfma_f32_16x16x32_bf16 v[204:207], v[96:99], a[184:187], v[204:207]
    v_mfma_f32_16x16x32_bf16 v[192:195], v[100:103], a[20:23], v[192:195]
    v_mfma_f32_16x16x32_bf16 v[196:199], v[100:103], a[76:79], v[196:199]
    ds_read_b128 v[156:159], v10 offset:5184
    v_mfma_f32_16x16x32_bf16 v[200:203], v[100:103], a[132:135], v[200:203]
    v_mfma_f32_16x16x32_bf16 v[204:207], v[100:103], a[188:191], v[204:207]
    v_mfma_f32_16x16x32_bf16 v[192:195], v[104:107], a[24:27], v[192:195]
    v_mfma_f32_16x16x32_bf16 v[196:199], v[104:107], a[80:83], v[196:199]
    ds_read_b128 v[160:163], v10 offset:6208
    v_mfma_f32_16x16x32_bf16 v[200:203], v[104:107], a[136:139], v[200:203]
    v_mfma_f32_16x16x32_bf16 v[204:207], v[104:107], a[192:195], v[204:207]
    v_mfma_f32_16x16x32_bf16 v[192:195], v[108:111], a[28:31], v[192:195]
    v_mfma_f32_16x16x32_bf16 v[196:199], v[108:111], a[84:87], v[196:199]
    ds_read_b128 v[164:167], v10 offset:7232
    v_mfma_f32_16x16x32_bf16 v[200:203], v[108:111], a[140:143], v[200:203]
    v_mfma_f32_16x16x32_bf16 v[204:207], v[108:111], a[196:199], v[204:207]
    v_mfma_f32_16x16x32_bf16 v[192:195], v[112:115], a[32:35], v[192:195]
    v_mfma_f32_16x16x32_bf16 v[196:199], v[112:115], a[88:91], v[196:199]
    ds_read_b128 v[168:171], v10 offset:8256
    v_mfma_f32_16x16x32_bf16 v[200:203], v[112:115], a[144:147], v[200:203]
    v_mfma_f32_16x16x32_bf16 v[204:207], v[112:115], a[200:203], v[204:207]
    v_mfma_f32_16x16x32_bf16 v[192:195], v[116:119], a[36:39], v[192:195]
    v_mfma_f32_16x16x32_bf16 v[196:199], v[116:119], a[92:95], v[196:199]
    ds_read_b128 v[172:175], v10 offset:9280
    v_mfma_f32_16x16x32_bf16 v[200:203], v[116:119], a[148:151], v[200:203]
    v_mfma_f32_16x16x32_bf16 v[204:207], v[116:119], a[204:207], v[204:207]
    v_mfma_f32_16x16x32_bf16 v[192:195], v[120:123], a[40:43], v[192:195]
    v_mfma_f32_16x16x32_bf16 v[196:199], v[120:123], a[96:99], v[196:199]
    ds_read_b128 v[176:179], v10 offset:10304
    v_mfma_f32_16x16x32_bf16 v[200:203], v[120:123], a[152:155], v[200:203]
    v_mfma_f32_16x16x32_bf16 v[204:207], v[120:123], a[208:211], v[204:207]
    v_mfma_f32_16x16x32_bf16 v[192:195], v[124:127], a[44:47], v[192:195]
    v_mfma_f32_16x16x32_bf16 v[196:199], v[124:127], a[100:103], v[196:199]
    ds_read_b128 v[180:183], v10 offset:11328
    v_mfma_f32_16x16x32_bf16 v[200:203], v[124:127], a[156:159], v[200:203]
    v_mfma_f32_16x16x32_bf16 v[204:207], v[124:127], a[212:215], v[204:207]
    v_mfma_f32_16x16x32_bf16 v[192:195], v[128:131], a[48:51], v[192:195]
    v_mfma_f32_16x16x32_bf16 v[196:199], v[128:131], a[104:107], v[196:199]
    ds_read_b128 v[184:187], v10 offset:12352
    v_mfma_f32_16x16x32_bf16 v[200:203], v[128:131], a[160:163], v[200:203]
    v_mfma_f32_16x16x32_bf16 v[204:207], v[128:131], a[216:219], v[204:207]
    v_mfma_f32_16x16x32_bf16 v[192:195], v[132:135], a[52:55], v[192:195]
    v_mfma_f32_16x16x32_bf16 v[196:199], v[132:135], a[108:111], v[196:199]
    ds_read_b128 v[188:191], v10 offset:13376
    v_mfma_f32_16x16x32_bf16 v[200:203], v[132:135], a[164:167], v[200:203]
    v_mfma_f32_16x16x32_bf16 v[204:207], v[132:135], a[220:223], v[204:207]
    s_waitcnt lgkmcnt(0)
    s_waitcnt vmcnt(22)
    s_barrier
    v_mfma_f32_16x16x32_bf16 v[208:211], v[136:139], a[0:3], 0
    v_mfma_f32_16x16x32_bf16 v[212:215], v[136:139], a[56:59], 0
    ds_read_b128 v[24:27], v10 offset:28672
    v_mfma_f32_16x16x32_bf16 v[216:219], v[136:139], a[112:115], 0
    v_mfma_f32_16x16x32_bf16 v[220:223], v[136:139], a[168:171], 0
    v_mfma_f32_16x16x32_bf16 v[208:211], v[140:143], a[4:7], v[208:211]
    v_mfma_f32_16x16x32_bf16 v[212:215], v[140:143], a[60:63], v[212:215]
    ds_read_b128 v[28:31], v10 offset:29696
    v_mfma_f32_16x16x32_bf16 v[216:219], v[140:143], a[116:119], v[216:219]
    v_mfma_f32_16x16x32_bf16 v[220:223], v[140:143], a[172:175], v[220:223]
    v_mfma_f32_16x16x32_bf16 v[208:211], v[144:147], a[8:11], v[208:211]
    v_mfma_f32_16x16x32_bf16 v[212:215], v[144:147], a[64:67], v[212:215]
    ds_read_b128 v[32:35], v10 offset:30720
    v_mfma_f32_16x16x32_bf16 v[216:219], v[144:147], a[120:123], v[216:219]
    v_mfma_f32_16x16x32_bf16 v[220:223], v[144:147], a[176:179], v[220:223]
    v_mfma_f32_16x16x32_bf16 v[208:211], v[148:151], a[12:15], v[208:211]
    v_mfma_f32_16x16x32_bf16 v[212:215], v[148:151], a[68:71], v[212:215]
    ds_read_b128 v[36:39], v10 offset:31744
    v_mfma_f32_16x16x32_bf16 v[216:219], v[148:151], a[124:127], v[216:219]
    v_mfma_f32_16x16x32_bf16 v[220:223], v[148:151], a[180:183], v[220:223]
    v_mfma_f32_16x16x32_bf16 v[208:211], v[152:155], a[16:19], v[208:211]
    v_mfma_f32_16x16x32_bf16 v[212:215], v[152:155], a[72:75], v[212:215]
    ds_read_b128 v[40:43], v10 offset:32768
    v_mfma_f32_16x16x32_bf16 v[216:219], v[152:155], a[128:131], v[216:219]
    v_mfma_f32_16x16x32_bf16 v[220:223], v[152:155], a[184:187], v[220:223]
    v_mfma_f32_16x16x32_bf16 v[208:211], v[156:159], a[20:23], v[208:211]
    v_mfma_f32_16x16x32_bf16 v[212:215], v[156:159], a[76:79], v[212:215]
    ds_read_b128 v[44:47], v10 offset:33792
    v_mfma_f32_16x16x32_bf16 v[216:219], v[156:159], a[132:135], v[216:219]
    v_mfma_f32_16x16x32_bf16 v[220:223], v[156:159], a[188:191], v[220:223]
    v_mfma_f32_16x16x32_bf16 v[208:211], v[160:163], a[24:27], v[208:211]
    v_mfma_f32_16x16x32_bf16 v[212:215], v[160:163], a[80:83], v[212:215]
    ds_read_b128 v[48:51], v10 offset:34816
    v_mfma_f32_16x16x32_bf16 v[216:219], v[160:163], a[136:139], v[216:219]
    v_mfma_f32_16x16x32_bf16 v[220:223], v[160:163], a[192:195], v[220:223]
    v_mfma_f32_16x16x32_bf16 v[208:211], v[164:167], a[28:31], v[208:211]
    v_mfma_f32_16x16x32_bf16 v[212:215], v[164:167], a[84:87], v[212:215]
    ds_read_b128 v[52:55], v10 offset:35840
    v_mfma_f32_16x16x32_bf16 v[216:219], v[164:167], a[140:143], v[216:219]
    v_mfma_f32_16x16x32_bf16 v[220:223], v[164:167], a[196:199], v[220:223]
    v_mfma_f32_16x16x32_bf16 v[208:211], v[168:171], a[32:35], v[208:211]
    v_mfma_f32_16x16x32_bf16 v[212:215], v[168:171], a[88:91], v[212:215]
    ds_read_b128 v[56:59], v10 offset:36864
    v_mfma_f32_16x16x32_bf16 v[216:219], v[168:171], a[144:147], v[216:219]
    v_mfma_f32_16x16x32_bf16 v[220:223], v[168:171], a[200:203], v[220:223]
    v_mfma_f32_16x16x32_bf16 v[208:211], v[172:175], a[36:39], v[208:211]
    v_mfma_f32_16x16x32_bf16 v[212:215], v[172:175], a[92:95], v[212:215]
    ds_read_b128 v[60:63], v10 offset:37888
    v_mfma_f32_16x16x32_bf16 v[216:219], v[172:175], a[148:151], v[216:219]
    v_mfma_f32_16x16x32_bf16 v[220:223], v[172:175], a[204:207], v[220:223]
    v_mfma_f32_16x16x32_bf16 v[208:211], v[176:179], a[40:43], v[208:211]
    v_mfma_f32_16x16x32_bf16 v[212:215], v[176:179], a[96:99], v[212:215]
    ds_read_b128 v[64:67], v10 offset:38912
    v_mfma_f32_16x16x32_bf16 v[216:219], v[176:179], a[152:155], v[216:219]
    v_mfma_f32_16x16x32_bf16 v[220:223], v[176:179], a[208:211], v[220:223]
    v_mfma_f32_16x16x32_bf16 v[208:211], v[180:183], a[44:47], v[208:211]
    v_mfma_f32_16x16x32_bf16 v[212:215], v[180:183], a[100:103], v[212:215]
    ds_read_b128 v[68:71], v10 offset:39936
    v_mfma_f32_16x16x32_bf16 v[216:219], v[180:183], a[156:159], v[216:219]
    v_mfma_f32_16x16x32_bf16 v[220:223], v[180:183], a[212:215], v[220:223]
    v_mfma_f32_16x16x32_bf16 v[208:211], v[184:187], a[48:51], v[208:211]
    v_mfma_f32_16x16x32_bf16 v[212:215], v[184:187], a[104:107], v[212:215]
    ds_read_b128 v[72:75], v10 offset:40960
    v_mfma_f32_16x16x32_bf16 v[216:219], v[184:187], a[160:163], v[216:219]
    v_mfma_f32_16x16x32_bf16 v[220:223], v[184:187], a[216:219], v[220:223]
    v_mfma_f32_16x16x32_bf16 v[208:211], v[188:191], a[52:55], v[208:211]
    v_mfma_f32_16x16x32_bf16 v[212:215], v[188:191], a[108:111], v[212:215]
    ds_read_b128 v[76:79], v10 offset:41984
    v_mfma_f32_16x16x32_bf16 v[216:219], v[188:191], a[164:167], v[216:219]
    v_mfma_f32_16x16x32_bf16 v[220:223], v[188:191], a[220:223], v[220:223]
    s_nop 7
    v_cvt_pk_bf16_f32 v224, v192, v193
    v_cvt_pk_bf16_f32 v225, v194, v195
    v_cvt_pk_bf16_f32 v226, v208, v209
    v_cvt_pk_bf16_f32 v227, v210, v211
    global_store_dwordx4 v16, v[224:227], s[34:35] offset:2048 sc1
    v_cvt_pk_bf16_f32 v228, v196, v197
    v_cvt_pk_bf16_f32 v229, v198, v199
    v_cvt_pk_bf16_f32 v230, v212, v213
    v_cvt_pk_bf16_f32 v231, v214, v215
    global_store_dwordx4 v17, v[228:231], s[34:35] offset:2048 sc1
    v_cvt_pk_bf16_f32 v232, v200, v201
    v_cvt_pk_bf16_f32 v233, v202, v203
    v_cvt_pk_bf16_f32 v234, v216, v217
    v_cvt_pk_bf16_f32 v235, v218, v219
    global_store_dwordx4 v18, v[232:235], s[34:35] offset:2048 sc1
    v_cvt_pk_bf16_f32 v236, v204, v205
    v_cvt_pk_bf16_f32 v237, v206, v207
    v_cvt_pk_bf16_f32 v238, v220, v221
    v_cvt_pk_bf16_f32 v239, v222, v223
    global_store_dwordx4 v19, v[236:239], s[34:35] offset:2048 sc1
    s_waitcnt lgkmcnt(0)
    v_mfma_f32_16x16x32_bf16 v[192:195], v[24:27], a[0:3], 0
    v_mfma_f32_16x16x32_bf16 v[196:199], v[24:27], a[56:59], 0
    ds_read_b128 v[80:83], v10 offset:28736
    v_mfma_f32_16x16x32_bf16 v[200:203], v[24:27], a[112:115], 0
    v_mfma_f32_16x16x32_bf16 v[204:207], v[24:27], a[168:171], 0
    s_add_u32 m0, s39, 28672
    s_nop 0
    global_load_lds_dwordx4 v12, s[30:31] offset:0 sc1
    s_add_u32 m0, s39, 28672
    s_nop 0
    global_load_lds_dwordx4 v12, s[30:31] offset:1024 sc1
    v_mfma_f32_16x16x32_bf16 v[192:195], v[28:31], a[4:7], v[192:195]
    v_mfma_f32_16x16x32_bf16 v[196:199], v[28:31], a[60:63], v[196:199]
    ds_read_b128 v[84:87], v10 offset:29760
    v_mfma_f32_16x16x32_bf16 v[200:203], v[28:31], a[116:119], v[200:203]
    v_mfma_f32_16x16x32_bf16 v[204:207], v[28:31], a[172:175], v[204:207]
    s_add_u32 m0, s39, 28672
    s_nop 0
    global_load_lds_dwordx4 v12, s[30:31] offset:2048 sc1
    s_add_u32 m0, s39, 28672
    s_nop 0
    global_load_lds_dwordx4 v12, s[30:31] offset:3072 sc1
    v_mfma_f32_16x16x32_bf16 v[192:195], v[32:35], a[8:11], v[192:195]
    v_mfma_f32_16x16x32_bf16 v[196:199], v[32:35], a[64:67], v[196:199]
    ds_read_b128 v[88:91], v10 offset:30784
    v_mfma_f32_16x16x32_bf16 v[200:203], v[32:35], a[120:123], v[200:203]
    v_mfma_f32_16x16x32_bf16 v[204:207], v[32:35], a[176:179], v[204:207]
    s_add_u32 m0, s39, 32768
    s_nop 0
    global_load_lds_dwordx4 v13, s[30:31] offset:0 sc1
    s_add_u32 m0, s39, 32768
    s_nop 0
    global_load_lds_dwordx4 v13, s[30:31] offset:1024 sc1
    v_mfma_f32_16x16x32_bf16 v[192:195], v[36:39], a[12:15], v[192:195]
    v_mfma_f32_16x16x32_bf16 v[196:199], v[36:39], a[68:71], v[196:199]
    ds_read_b128 v[92:95], v10 offset:31808
    v_mfma_f32_16x16x32_bf16 v[200:203], v[36:39], a[124:127], v[200:203]
    v_mfma_f32_16x16x32_bf16 v[204:207], v[36:39], a[180:183], v[204:207]
    s_add_u32 m0, s39, 32768
    s_nop 0
    global_load_lds_dwordx4 v13, s[30:31] offset:2048 sc1
    s_add_u32 s30, s30, 0x7000
    s_addc_u32 s31, s31, 0
    v_mfma_f32_16x16x32_bf16 v[192:195], v[40:43], a[16:19], v[192:195]
    v_mfma_f32_16x16x32_bf16 v[196:199], v[40:43], a[72:75], v[196:199]
    ds_read_b128 v[96:99], v10 offset:32832
    v_mfma_f32_16x16x32_bf16 v[200:203], v[40:43], a[128:131], v[200:203]
    v_mfma_f32_16x16x32_bf16 v[204:207], v[40:43], a[184:187], v[204:207]
    v_mfma_f32_16x16x32_bf16 v[192:195], v[44:47], a[20:23], v[192:195]
    v_mfma_f32_16x16x32_bf16 v[196:199], v[44:47], a[76:79], v[196:199]
    ds_read_b128 v[100:103], v10 offset:33856
    v_mfma_f32_16x16x32_bf16 v[200:203], v[44:47], a[132:135], v[200:203]
    v_mfma_f32_16x16x32_bf16 v[204:207], v[44:47], a[188:191], v[204:207]
    v_mfma_f32_16x16x32_bf16 v[192:195], v[48:51], a[24:27], v[192:195]
    v_mfma_f32_16x16x32_bf16 v[196:199], v[48:51], a[80:83], v[196:199]
    ds_read_b128 v[104:107], v10 offset:34880
    v_mfma_f32_16x16x32_bf16 v[200:203], v[48:51], a[136:139], v[200:203]
    v_mfma_f32_16x16x32_bf16 v[204:207], v[48:51], a[192:195], v[204:207]
    v_mfma_f32_16x16x32_bf16 v[192:195], v[52:55], a[28:31], v[192:195]
    v_mfma_f32_16x16x32_bf16 v[196:199], v[52:55], a[84:87], v[196:199]
    ds_read_b128 v[108:111], v10 offset:35904
    v_mfma_f32_16x16x32_bf16 v[200:203], v[52:55], a[140:143], v[200:203]
    v_mfma_f32_16x16x32_bf16 v[204:207], v[52:55], a[196:199], v[204:207]
    v_mfma_f32_16x16x32_bf16 v[192:195], v[56:59], a[32:35], v[192:195]
    v_mfma_f32_16x16x32_bf16 v[196:199], v[56:59], a[88:91], v[196:199]
    ds_read_b128 v[112:115], v10 offset:36928
    v_mfma_f32_16x16x32_bf16 v[200:203], v[56:59], a[144:147], v[200:203]
    v_mfma_f32_16x16x32_bf16 v[204:207], v[56:59], a[200:203], v[204:207]
    v_mfma_f32_16x16x32_bf16 v[192:195], v[60:63], a[36:39], v[192:195]
    v_mfma_f32_16x16x32_bf16 v[196:199], v[60:63], a[92:95], v[196:199]
    ds_read_b128 v[116:119], v10 offset:37952
    v_mfma_f32_16x16x32_bf16 v[200:203], v[60:63], a[148:151], v[200:203]
    v_mfma_f32_16x16x32_bf16 v[204:207], v[60:63], a[204:207], v[204:207]
    v_mfma_f32_16x16x32_bf16 v[192:195], v[64:67], a[40:43], v[192:195]
    v_mfma_f32_16x16x32_bf16 v[196:199], v[64:67], a[96:99], v[196:199]
    ds_read_b128 v[120:123], v10 offset:38976
    v_mfma_f32_16x16x32_bf16 v[200:203], v[64:67], a[152:155], v[200:203]
    v_mfma_f32_16x16x32_bf16 v[204:207], v[64:67], a[208:211], v[204:207]
    v_mfma_f32_16x16x32_bf16 v[192:195], v[68:71], a[44:47], v[192:195]
    v_mfma_f32_16x16x32_bf16 v[196:199], v[68:71], a[100:103], v[196:199]
    ds_read_b128 v[124:127], v10 offset:40000
    v_mfma_f32_16x16x32_bf16 v[200:203], v[68:71], a[156:159], v[200:203]
    v_mfma_f32_16x16x32_bf16 v[204:207], v[68:71], a[212:215], v[204:207]
    v_mfma_f32_16x16x32_bf16 v[192:195], v[72:75], a[48:51], v[192:195]
    v_mfma_f32_16x16x32_bf16 v[196:199], v[72:75], a[104:107], v[196:199]
    ds_read_b128 v[128:131], v10 offset:41024
    v_mfma_f32_16x16x32_bf16 v[200:203], v[72:75], a[160:163], v[200:203]
    v_mfma_f32_16x16x32_bf16 v[204:207], v[72:75], a[216:219], v[204:207]
    v_mfma_f32_16x16x32_bf16 v[192:195], v[76:79], a[52:55], v[192:195]
    v_mfma_f32_16x16x32_bf16 v[196:199], v[76:79], a[108:111], v[196:199]
    ds_read_b128 v[132:135], v10 offset:42048
    v_mfma_f32_16x16x32_bf16 v[200:203], v[76:79], a[164:167], v[200:203]
    v_mfma_f32_16x16x32_bf16 v[204:207], v[76:79], a[220:223], v[204:207]
    s_waitcnt lgkmcnt(0)
    s_waitcnt vmcnt(22)
    s_barrier
    v_mfma_f32_16x16x32_bf16 v[208:211], v[80:83], a[0:3], 0
    v_mfma_f32_16x16x32_bf16 v[212:215], v[80:83], a[56:59], 0
    ds_read_b128 v[136:139], v11 offset:0
    v_mfma_f32_16x16x32_bf16 v[216:219], v[80:83], a[112:115], 0
    v_mfma_f32_16x16x32_bf16 v[220:223], v[80:83], a[168:171], 0
    v_mfma_f32_16x16x32_bf16 v[208:211], v[84:87], a[4:7], v[208:211]
    v_mfma_f32_16x16x32_bf16 v[212:215], v[84:87], a[60:63], v[212:215]
    ds_read_b128 v[140:143], v11 offset:1024
    v_mfma_f32_16x16x32_bf16 v[216:219], v[84:87], a[116:119], v[216:219]
    v_mfma_f32_16x16x32_bf16 v[220:223], v[84:87], a[172:175], v[220:223]
    v_mfma_f32_16x16x32_bf16 v[208:211], v[88:91], a[8:11], v[208:211]
    v_mfma_f32_16x16x32_bf16 v[212:215], v[88:91], a[64:67], v[212:215]
    ds_read_b128 v[144:147], v11 offset:2048
    v_mfma_f32_16x16x32_bf16 v[216:219], v[88:91], a[120:123], v[216:219]
    v_mfma_f32_16x16x32_bf16 v[220:223], v[88:91], a[176:179], v[220:223]
    v_mfma_f32_16x16x32_bf16 v[208:211], v[92:95], a[12:15], v[208:211]
    v_mfma_f32_16x16x32_bf16 v[212:215], v[92:95], a[68:71], v[212:215]
    ds_read_b128 v[148:151], v11 offset:3072
    v_mfma_f32_16x16x32_bf16 v[216:219], v[92:95], a[124:127], v[216:219]
    v_mfma_f32_16x16x32_bf16 v[220:223], v[92:95], a[180:183], v[220:223]
    v_mfma_f32_16x16x32_bf16 v[208:211], v[96:99], a[16:19], v[208:211]
    v_mfma_f32_16x16x32_bf16 v[212:215], v[96:99], a[72:75], v[212:215]
    ds_read_b128 v[152:155], v11 offset:4096
    v_mfma_f32_16x16x32_bf16 v[216:219], v[96:99], a[128:131], v[216:219]
    v_mfma_f32_16x16x32_bf16 v[220:223], v[96:99], a[184:187], v[220:223]
    v_mfma_f32_16x16x32_bf16 v[208:211], v[100:103], a[20:23], v[208:211]
    v_mfma_f32_16x16x32_bf16 v[212:215], v[100:103], a[76:79], v[212:215]
    ds_read_b128 v[156:159], v11 offset:5120
    v_mfma_f32_16x16x32_bf16 v[216:219], v[100:103], a[132:135], v[216:219]
    v_mfma_f32_16x16x32_bf16 v[220:223], v[100:103], a[188:191], v[220:223]
    v_mfma_f32_16x16x32_bf16 v[208:211], v[104:107], a[24:27], v[208:211]
    v_mfma_f32_16x16x32_bf16 v[212:215], v[104:107], a[80:83], v[212:215]
    ds_read_b128 v[160:163], v11 offset:6144
    v_mfma_f32_16x16x32_bf16 v[216:219], v[104:107], a[136:139], v[216:219]
    v_mfma_f32_16x16x32_bf16 v[220:223], v[104:107], a[192:195], v[220:223]
    v_mfma_f32_16x16x32_bf16 v[208:211], v[108:111], a[28:31], v[208:211]
    v_mfma_f32_16x16x32_bf16 v[212:215], v[108:111], a[84:87], v[212:215]
    ds_read_b128 v[164:167], v11 offset:7168
    v_mfma_f32_16x16x32_bf16 v[216:219], v[108:111], a[140:143], v[216:219]
    v_mfma_f32_16x16x32_bf16 v[220:223], v[108:111], a[196:199], v[220:223]
    v_mfma_f32_16x16x32_bf16 v[208:211], v[112:115], a[32:35], v[208:211]
    v_mfma_f32_16x16x32_bf16 v[212:215], v[112:115], a[88:91], v[212:215]
    ds_read_b128 v[168:171], v11 offset:8192
    v_mfma_f32_16x16x32_bf16 v[216:219], v[112:115], a[144:147], v[216:219]
    v_mfma_f32_16x16x32_bf16 v[220:223], v[112:115], a[200:203], v[220:223]
    v_mfma_f32_16x16x32_bf16 v[208:211], v[116:119], a[36:39], v[208:211]
    v_mfma_f32_16x16x32_bf16 v[212:215], v[116:119], a[92:95], v[212:215]
    ds_read_b128 v[172:175], v11 offset:9216
    v_mfma_f32_16x16x32_bf16 v[216:219], v[116:119], a[148:151], v[216:219]
    v_mfma_f32_16x16x32_bf16 v[220:223], v[116:119], a[204:207], v[220:223]
    v_mfma_f32_16x16x32_bf16 v[208:211], v[120:123], a[40:43], v[208:211]
    v_mfma_f32_16x16x32_bf16 v[212:215], v[120:123], a[96:99], v[212:215]
    ds_read_b128 v[176:179], v11 offset:10240
    v_mfma_f32_16x16x32_bf16 v[216:219], v[120:123], a[152:155], v[216:219]
    v_mfma_f32_16x16x32_bf16 v[220:223], v[120:123], a[208:211], v[220:223]
    v_mfma_f32_16x16x32_bf16 v[208:211], v[124:127], a[44:47], v[208:211]
    v_mfma_f32_16x16x32_bf16 v[212:215], v[124:127], a[100:103], v[212:215]
    ds_read_b128 v[180:183], v11 offset:11264
    v_mfma_f32_16x16x32_bf16 v[216:219], v[124:127], a[156:159], v[216:219]
    v_mfma_f32_16x16x32_bf16 v[220:223], v[124:127], a[212:215], v[220:223]
    v_mfma_f32_16x16x32_bf16 v[208:211], v[128:131], a[48:51], v[208:211]
    v_mfma_f32_16x16x32_bf16 v[212:215], v[128:131], a[104:107], v[212:215]
    ds_read_b128 v[184:187], v11 offset:12288
    v_mfma_f32_16x16x32_bf16 v[216:219], v[128:131], a[160:163], v[216:219]
    v_mfma_f32_16x16x32_bf16 v[220:223], v[128:131], a[216:219], v[220:223]
    v_mfma_f32_16x16x32_bf16 v[208:211], v[132:135], a[52:55], v[208:211]
    v_mfma_f32_16x16x32_bf16 v[212:215], v[132:135], a[108:111], v[212:215]
    ds_read_b128 v[188:191], v11 offset:13312
    v_mfma_f32_16x16x32_bf16 v[216:219], v[132:135], a[164:167], v[216:219]
    v_mfma_f32_16x16x32_bf16 v[220:223], v[132:135], a[220:223], v[220:223]
    s_nop 7
    v_cvt_pk_bf16_f32 v240, v192, v193
    v_cvt_pk_bf16_f32 v241, v194, v195
    v_cvt_pk_bf16_f32 v242, v208, v209
    v_cvt_pk_bf16_f32 v243, v210, v211
    global_store_dwordx4 v16, v[240:243], s[34:35] offset:3072 sc1
    v_cvt_pk_bf16_f32 v244, v196, v197
    v_cvt_pk_bf16_f32 v245, v198, v199
    v_cvt_pk_bf16_f32 v246, v212, v213
    v_cvt_pk_bf16_f32 v247, v214, v215
    global_store_dwordx4 v17, v[244:247], s[34:35] offset:3072 sc1
    v_cvt_pk_bf16_f32 v248, v200, v201
    v_cvt_pk_bf16_f32 v249, v202, v203
    v_cvt_pk_bf16_f32 v250, v216, v217
    v_cvt_pk_bf16_f32 v251, v218, v219
    global_store_dwordx4 v18, v[248:251], s[34:35] offset:3072 sc1
    v_cvt_pk_bf16_f32 v252, v204, v205
    v_cvt_pk_bf16_f32 v253, v206, v207
    v_cvt_pk_bf16_f32 v254, v220, v221
    v_cvt_pk_bf16_f32 v255, v222, v223
    global_store_dwordx4 v19, v[252:255], s[34:35] offset:3072 sc1
    s_add_u32 s34, s34, 0x1000
    s_addc_u32 s35, s35, 0
    s_waitcnt lgkmcnt(0)
    v_mfma_f32_16x16x32_bf16 v[192:195], v[136:139], a[0:3], 0
    v_mfma_f32_16x16x32_bf16 v[196:199], v[136:139], a[56:59], 0
    ds_read_b128 v[24:27], v11 offset:64
    v_mfma_f32_16x16x32_bf16 v[200:203], v[136:139], a[112:115], 0
    v_mfma_f32_16x16x32_bf16 v[204:207], v[136:139], a[168:171], 0
    s_add_u32 m0, s39, 57344
    s_nop 0
    global_load_lds_dwordx4 v12, s[30:31] offset:0 sc1
    s_add_u32 m0, s39, 57344
    s_nop 0
    global_load_lds_dwordx4 v12, s[30:31] offset:1024 sc1
    v_mfma_f32_16x16x32_bf16 v[192:195], v[140:143], a[4:7], v[192:195]
    v_mfma_f32_16x16x32_bf16 v[196:199], v[140:143], a[60:63], v[196:199]
    ds_read_b128 v[28:31], v11 offset:1088
    v_mfma_f32_16x16x32_bf16 v[200:203], v[140:143], a[116:119], v[200:203]
    v_mfma_f32_16x16x32_bf16 v[204:207], v[140:143], a[172:175], v[204:207]
    s_add_u32 m0, s39, 57344
    s_nop 0
    global_load_lds_dwordx4 v12, s[30:31] offset:2048 sc1
    s_add_u32 m0, s39, 57344
    s_nop 0
    global_load_lds_dwordx4 v12, s[30:31] offset:3072 sc1
    v_mfma_f32_16x16x32_bf16 v[192:195], v[144:147], a[8:11], v[192:195]
    v_mfma_f32_16x16x32_bf16 v[196:199], v[144:147], a[64:67], v[196:199]
    ds_read_b128 v[32:35], v11 offset:2112
    v_mfma_f32_16x16x32_bf16 v[200:203], v[144:147], a[120:123], v[200:203]
    v_mfma_f32_16x16x32_bf16 v[204:207], v[144:147], a[176:179], v[204:207]
    s_add_u32 m0, s39, 61440
    s_nop 0
    global_load_lds_dwordx4 v13, s[30:31] offset:0 sc1
    s_add_u32 m0, s39, 61440
    s_nop 0
    global_load_lds_dwordx4 v13, s[30:31] offset:1024 sc1
    v_mfma_f32_16x16x32_bf16 v[192:195], v[148:151], a[12:15], v[192:195]
    v_mfma_f32_16x16x32_bf16 v[196:199], v[148:151], a[68:71], v[196:199]
    ds_read_b128 v[36:39], v11 offset:3136
    v_mfma_f32_16x16x32_bf16 v[200:203], v[148:151], a[124:127], v[200:203]
    v_mfma_f32_16x16x32_bf16 v[204:207], v[148:151], a[180:183], v[204:207]
    s_add_u32 m0, s39, 61440
    s_nop 0
    global_load_lds_dwordx4 v13, s[30:31] offset:2048 sc1
    s_add_u32 s30, s30, 0x7000
    s_addc_u32 s31, s31, 0
    v_mfma_f32_16x16x32_bf16 v[192:195], v[152:155], a[16:19], v[192:195]
    v_mfma_f32_16x16x32_bf16 v[196:199], v[152:155], a[72:75], v[196:199]
    ds_read_b128 v[40:43], v11 offset:4160
    v_mfma_f32_16x16x32_bf16 v[200:203], v[152:155], a[128:131], v[200:203]
    v_mfma_f32_16x16x32_bf16 v[204:207], v[152:155], a[184:187], v[204:207]
    v_mfma_f32_16x16x32_bf16 v[192:195], v[156:159], a[20:23], v[192:195]
    v_mfma_f32_16x16x32_bf16 v[196:199], v[156:159], a[76:79], v[196:199]
    ds_read_b128 v[44:47], v11 offset:5184
    v_mfma_f32_16x16x32_bf16 v[200:203], v[156:159], a[132:135], v[200:203]
    v_mfma_f32_16x16x32_bf16 v[204:207], v[156:159], a[188:191], v[204:207]
    v_mfma_f32_16x16x32_bf16 v[192:195], v[160:163], a[24:27], v[192:195]
    v_mfma_f32_16x16x32_bf16 v[196:199], v[160:163], a[80:83], v[196:199]
    ds_read_b128 v[48:51], v11 offset:6208
    v_mfma_f32_16x16x32_bf16 v[200:203], v[160:163], a[136:139], v[200:203]
    v_mfma_f32_16x16x32_bf16 v[204:207], v[160:163], a[192:195], v[204:207]
    v_mfma_f32_16x16x32_bf16 v[192:195], v[164:167], a[28:31], v[192:195]
    v_mfma_f32_16x16x32_bf16 v[196:199], v[164:167], a[84:87], v[196:199]
    ds_read_b128 v[52:55], v11 offset:7232
    v_mfma_f32_16x16x32_bf16 v[200:203], v[164:167], a[140:143], v[200:203]
    v_mfma_f32_16x16x32_bf16 v[204:207], v[164:167], a[196:199], v[204:207]
    v_mfma_f32_16x16x32_bf16 v[192:195], v[168:171], a[32:35], v[192:195]
    v_mfma_f32_16x16x32_bf16 v[196:199], v[168:171], a[88:91], v[196:199]
    ds_read_b128 v[56:59], v11 offset:8256
    v_mfma_f32_16x16x32_bf16 v[200:203], v[168:171], a[144:147], v[200:203]
    v_mfma_f32_16x16x32_bf16 v[204:207], v[168:171], a[200:203], v[204:207]
    v_mfma_f32_16x16x32_bf16 v[192:195], v[172:175], a[36:39], v[192:195]
    v_mfma_f32_16x16x32_bf16 v[196:199], v[172:175], a[92:95], v[196:199]
    ds_read_b128 v[60:63], v11 offset:9280
    v_mfma_f32_16x16x32_bf16 v[200:203], v[172:175], a[148:151], v[200:203]
    v_mfma_f32_16x16x32_bf16 v[204:207], v[172:175], a[204:207], v[204:207]
    v_mfma_f32_16x16x32_bf16 v[192:195], v[176:179], a[40:43], v[192:195]
    v_mfma_f32_16x16x32_bf16 v[196:199], v[176:179], a[96:99], v[196:199]
    ds_read_b128 v[64:67], v11 offset:10304
    v_mfma_f32_16x16x32_bf16 v[200:203], v[176:179], a[152:155], v[200:203]
    v_mfma_f32_16x16x32_bf16 v[204:207], v[176:179], a[208:211], v[204:207]
    v_mfma_f32_16x16x32_bf16 v[192:195], v[180:183], a[44:47], v[192:195]
    v_mfma_f32_16x16x32_bf16 v[196:199], v[180:183], a[100:103], v[196:199]
    ds_read_b128 v[68:71], v11 offset:11328
    v_mfma_f32_16x16x32_bf16 v[200:203], v[180:183], a[156:159], v[200:203]
    v_mfma_f32_16x16x32_bf16 v[204:207], v[180:183], a[212:215], v[204:207]
    v_mfma_f32_16x16x32_bf16 v[192:195], v[184:187], a[48:51], v[192:195]
    v_mfma_f32_16x16x32_bf16 v[196:199], v[184:187], a[104:107], v[196:199]
    ds_read_b128 v[72:75], v11 offset:12352
    v_mfma_f32_16x16x32_bf16 v[200:203], v[184:187], a[160:163], v[200:203]
    v_mfma_f32_16x16x32_bf16 v[204:207], v[184:187], a[216:219], v[204:207]
    v_mfma_f32_16x16x32_bf16 v[192:195], v[188:191], a[52:55], v[192:195]
    v_mfma_f32_16x16x32_bf16 v[196:199], v[188:191], a[108:111], v[196:199]
    ds_read_b128 v[76:79], v11 offset:13376
    v_mfma_f32_16x16x32_bf16 v[200:203], v[188:191], a[164:167], v[200:203]
    v_mfma_f32_16x16x32_bf16 v[204:207], v[188:191], a[220:223], v[204:207]
    s_waitcnt lgkmcnt(0)
    s_waitcnt vmcnt(22)
    s_barrier
    v_mfma_f32_16x16x32_bf16 v[208:211], v[24:27], a[0:3], 0
    v_mfma_f32_16x16x32_bf16 v[212:215], v[24:27], a[56:59], 0
    ds_read_b128 v[80:83], v9 offset:0
    v_mfma_f32_16x16x32_bf16 v[216:219], v[24:27], a[112:115], 0
    v_mfma_f32_16x16x32_bf16 v[220:223], v[24:27], a[168:171], 0
    v_mfma_f32_16x16x32_bf16 v[208:211], v[28:31], a[4:7], v[208:211]
    v_mfma_f32_16x16x32_bf16 v[212:215], v[28:31], a[60:63], v[212:215]
    ds_read_b128 v[84:87], v9 offset:1024
    v_mfma_f32_16x16x32_bf16 v[216:219], v[28:31], a[116:119], v[216:219]
    v_mfma_f32_16x16x32_bf16 v[220:223], v[28:31], a[172:175], v[220:223]
    v_mfma_f32_16x16x32_bf16 v[208:211], v[32:35], a[8:11], v[208:211]
    v_mfma_f32_16x16x32_bf16 v[212:215], v[32:35], a[64:67], v[212:215]
    ds_read_b128 v[88:91], v9 offset:2048
    v_mfma_f32_16x16x32_bf16 v[216:219], v[32:35], a[120:123], v[216:219]
    v_mfma_f32_16x16x32_bf16 v[220:223], v[32:35], a[176:179], v[220:223]
    v_mfma_f32_16x16x32_bf16 v[208:211], v[36:39], a[12:15], v[208:211]
    v_mfma_f32_16x16x32_bf16 v[212:215], v[36:39], a[68:71], v[212:215]
    ds_read_b128 v[92:95], v9 offset:3072
    v_mfma_f32_16x16x32_bf16 v[216:219], v[36:39], a[124:127], v[216:219]
    v_mfma_f32_16x16x32_bf16 v[220:223], v[36:39], a[180:183], v[220:223]
    v_mfma_f32_16x16x32_bf16 v[208:211], v[40:43], a[16:19], v[208:211]
    v_mfma_f32_16x16x32_bf16 v[212:215], v[40:43], a[72:75], v[212:215]
    ds_read_b128 v[96:99], v9 offset:4096
    v_mfma_f32_16x16x32_bf16 v[216:219], v[40:43], a[128:131], v[216:219]
    v_mfma_f32_16x16x32_bf16 v[220:223], v[40:43], a[184:187], v[220:223]
    v_mfma_f32_16x16x32_bf16 v[208:211], v[44:47], a[20:23], v[208:211]
    v_mfma_f32_16x16x32_bf16 v[212:215], v[44:47], a[76:79], v[212:215]
    ds_read_b128 v[100:103], v9 offset:5120
    v_mfma_f32_16x16x32_bf16 v[216:219], v[44:47], a[132:135], v[216:219]
    v_mfma_f32_16x16x32_bf16 v[220:223], v[44:47], a[188:191], v[220:223]
    v_mfma_f32_16x16x32_bf16 v[208:211], v[48:51], a[24:27], v[208:211]
    v_mfma_f32_16x16x32_bf16 v[212:215], v[48:51], a[80:83], v[212:215]
    ds_read_b128 v[104:107], v9 offset:6144
    v_mfma_f32_16x16x32_bf16 v[216:219], v[48:51], a[136:139], v[216:219]
    v_mfma_f32_16x16x32_bf16 v[220:223], v[48:51], a[192:195], v[220:223]
    v_mfma_f32_16x16x32_bf16 v[208:211], v[52:55], a[28:31], v[208:211]
    v_mfma_f32_16x16x32_bf16 v[212:215], v[52:55], a[84:87], v[212:215]
    ds_read_b128 v[108:111], v9 offset:7168
    v_mfma_f32_16x16x32_bf16 v[216:219], v[52:55], a[140:143], v[216:219]
    v_mfma_f32_16x16x32_bf16 v[220:223], v[52:55], a[196:199], v[220:223]
    v_mfma_f32_16x16x32_bf16 v[208:211], v[56:59], a[32:35], v[208:211]
    v_mfma_f32_16x16x32_bf16 v[212:215], v[56:59], a[88:91], v[212:215]
    ds_read_b128 v[112:115], v9 offset:8192
    v_mfma_f32_16x16x32_bf16 v[216:219], v[56:59], a[144:147], v[216:219]
    v_mfma_f32_16x16x32_bf16 v[220:223], v[56:59], a[200:203], v[220:223]
    v_mfma_f32_16x16x32_bf16 v[208:211], v[60:63], a[36:39], v[208:211]
    v_mfma_f32_16x16x32_bf16 v[212:215], v[60:63], a[92:95], v[212:215]
    ds_read_b128 v[116:119], v9 offset:9216
    v_mfma_f32_16x16x32_bf16 v[216:219], v[60:63], a[148:151], v[216:219]
    v_mfma_f32_16x16x32_bf16 v[220:223], v[60:63], a[204:207], v[220:223]
    v_mfma_f32_16x16x32_bf16 v[208:211], v[64:67], a[40:43], v[208:211]
    v_mfma_f32_16x16x32_bf16 v[212:215], v[64:67], a[96:99], v[212:215]
    ds_read_b128 v[120:123], v9 offset:10240
    v_mfma_f32_16x16x32_bf16 v[216:219], v[64:67], a[152:155], v[216:219]
    v_mfma_f32_16x16x32_bf16 v[220:223], v[64:67], a[208:211], v[220:223]
    v_mfma_f32_16x16x32_bf16 v[208:211], v[68:71], a[44:47], v[208:211]
    v_mfma_f32_16x16x32_bf16 v[212:215], v[68:71], a[100:103], v[212:215]
    ds_read_b128 v[124:127], v9 offset:11264
    v_mfma_f32_16x16x32_bf16 v[216:219], v[68:71], a[156:159], v[216:219]
    v_mfma_f32_16x16x32_bf16 v[220:223], v[68:71], a[212:215], v[220:223]
    v_mfma_f32_16x16x32_bf16 v[208:211], v[72:75], a[48:51], v[208:211]
    v_mfma_f32_16x16x32_bf16 v[212:215], v[72:75], a[104:107], v[212:215]
    ds_read_b128 v[128:131], v9 offset:12288
    v_mfma_f32_16x16x32_bf16 v[216:219], v[72:75], a[160:163], v[216:219]
    v_mfma_f32_16x16x32_bf16 v[220:223], v[72:75], a[216:219], v[220:223]
    v_mfma_f32_16x16x32_bf16 v[208:211], v[76:79], a[52:55], v[208:211]
    v_mfma_f32_16x16x32_bf16 v[212:215], v[76:79], a[108:111], v[212:215]
    ds_read_b128 v[132:135], v9 offset:13312
    v_mfma_f32_16x16x32_bf16 v[216:219], v[76:79], a[164:167], v[216:219]
    v_mfma_f32_16x16x32_bf16 v[220:223], v[76:79], a[220:223], v[220:223]
    s_nop 7
    v_cvt_pk_bf16_f32 v224, v192, v193
    v_cvt_pk_bf16_f32 v225, v194, v195
    v_cvt_pk_bf16_f32 v226, v208, v209
    v_cvt_pk_bf16_f32 v227, v210, v211
    global_store_dwordx4 v16, v[224:227], s[34:35] offset:0 sc1
    v_cvt_pk_bf16_f32 v228, v196, v197
    v_cvt_pk_bf16_f32 v229, v198, v199
    v_cvt_pk_bf16_f32 v230, v212, v213
    v_cvt_pk_bf16_f32 v231, v214, v215
    global_store_dwordx4 v17, v[228:231], s[34:35] offset:0 sc1
    v_cvt_pk_bf16_f32 v232, v200, v201
    v_cvt_pk_bf16_f32 v233, v202, v203
    v_cvt_pk_bf16_f32 v234, v216, v217
    v_cvt_pk_bf16_f32 v235, v218, v219
    global_store_dwordx4 v18, v[232:235], s[34:35] offset:0 sc1
    v_cvt_pk_bf16_f32 v236, v204, v205
    v_cvt_pk_bf16_f32 v237, v206, v207
    v_cvt_pk_bf16_f32 v238, v220, v221
    v_cvt_pk_bf16_f32 v239, v222, v223
    global_store_dwordx4 v19, v[236:239], s[34:35] offset:0 sc1
    s_waitcnt lgkmcnt(0)
    v_mfma_f32_16x16x32_bf16 v[192:195], v[80:83], a[0:3], 0
    v_mfma_f32_16x16x32_bf16 v[196:199], v[80:83], a[56:59], 0
    ds_read_b128 v[136:139], v9 offset:64
    v_mfma_f32_16x16x32_bf16 v[200:203], v[80:83], a[112:115], 0
    v_mfma_f32_16x16x32_bf16 v[204:207], v[80:83], a[168:171], 0
    v_mfma_f32_16x16x32_bf16 v[192:195], v[84:87], a[4:7], v[192:195]
    v_mfma_f32_16x16x32_bf16 v[196:199], v[84:87], a[60:63], v[196:199]
    ds_read_b128 v[140:143], v9 offset:1088
    v_mfma_f32_16x16x32_bf16 v[200:203], v[84:87], a[116:119], v[200:203]
    v_mfma_f32_16x16x32_bf16 v[204:207], v[84:87], a[172:175], v[204:207]
    v_mfma_f32_16x16x32_bf16 v[192:195], v[88:91], a[8:11], v[192:195]
    v_mfma_f32_16x16x32_bf16 v[196:199], v[88:91], a[64:67], v[196:199]
    ds_read_b128 v[144:147], v9 offset:2112
    v_mfma_f32_16x16x32_bf16 v[200:203], v[88:91], a[120:123], v[200:203]
    v_mfma_f32_16x16x32_bf16 v[204:207], v[88:91], a[176:179], v[204:207]
    v_mfma_f32_16x16x32_bf16 v[192:195], v[92:95], a[12:15], v[192:195]
    v_mfma_f32_16x16x32_bf16 v[196:199], v[92:95], a[68:71], v[196:199]
    ds_read_b128 v[148:151], v9 offset:3136
    v_mfma_f32_16x16x32_bf16 v[200:203], v[92:95], a[124:127], v[200:203]
    v_mfma_f32_16x16x32_bf16 v[204:207], v[92:95], a[180:183], v[204:207]
    v_mfma_f32_16x16x32_bf16 v[192:195], v[96:99], a[16:19], v[192:195]
    v_mfma_f32_16x16x32_bf16 v[196:199], v[96:99], a[72:75], v[196:199]
    ds_read_b128 v[152:155], v9 offset:4160
    v_mfma_f32_16x16x32_bf16 v[200:203], v[96:99], a[128:131], v[200:203]
    v_mfma_f32_16x16x32_bf16 v[204:207], v[96:99], a[184:187], v[204:207]
    v_mfma_f32_16x16x32_bf16 v[192:195], v[100:103], a[20:23], v[192:195]
    v_mfma_f32_16x16x32_bf16 v[196:199], v[100:103], a[76:79], v[196:199]
    ds_read_b128 v[156:159], v9 offset:5184
    v_mfma_f32_16x16x32_bf16 v[200:203], v[100:103], a[132:135], v[200:203]
    v_mfma_f32_16x16x32_bf16 v[204:207], v[100:103], a[188:191], v[204:207]
    v_mfma_f32_16x16x32_bf16 v[192:195], v[104:107], a[24:27], v[192:195]
    v_mfma_f32_16x16x32_bf16 v[196:199], v[104:107], a[80:83], v[196:199]
    ds_read_b128 v[160:163], v9 offset:6208
    v_mfma_f32_16x16x32_bf16 v[200:203], v[104:107], a[136:139], v[200:203]
    v_mfma_f32_16x16x32_bf16 v[204:207], v[104:107], a[192:195], v[204:207]
    v_mfma_f32_16x16x32_bf16 v[192:195], v[108:111], a[28:31], v[192:195]
    v_mfma_f32_16x16x32_bf16 v[196:199], v[108:111], a[84:87], v[196:199]
    ds_read_b128 v[164:167], v9 offset:7232
    v_mfma_f32_16x16x32_bf16 v[200:203], v[108:111], a[140:143], v[200:203]
    v_mfma_f32_16x16x32_bf16 v[204:207], v[108:111], a[196:199], v[204:207]
    v_mfma_f32_16x16x32_bf16 v[192:195], v[112:115], a[32:35], v[192:195]
    v_mfma_f32_16x16x32_bf16 v[196:199], v[112:115], a[88:91], v[196:199]
    ds_read_b128 v[168:171], v9 offset:8256
    v_mfma_f32_16x16x32_bf16 v[200:203], v[112:115], a[144:147], v[200:203]
    v_mfma_f32_16x16x32_bf16 v[204:207], v[112:115], a[200:203], v[204:207]
    v_mfma_f32_16x16x32_bf16 v[192:195], v[116:119], a[36:39], v[192:195]
    v_mfma_f32_16x16x32_bf16 v[196:199], v[116:119], a[92:95], v[196:199]
    ds_read_b128 v[172:175], v9 offset:9280
    v_mfma_f32_16x16x32_bf16 v[200:203], v[116:119], a[148:151], v[200:203]
    v_mfma_f32_16x16x32_bf16 v[204:207], v[116:119], a[204:207], v[204:207]
    v_mfma_f32_16x16x32_bf16 v[192:195], v[120:123], a[40:43], v[192:195]
    v_mfma_f32_16x16x32_bf16 v[196:199], v[120:123], a[96:99], v[196:199]
    ds_read_b128 v[176:179], v9 offset:10304
    v_mfma_f32_16x16x32_bf16 v[200:203], v[120:123], a[152:155], v[200:203]
    v_mfma_f32_16x16x32_bf16 v[204:207], v[120:123], a[208:211], v[204:207]
    v_mfma_f32_16x16x32_bf16 v[192:195], v[124:127], a[44:47], v[192:195]
    v_mfma_f32_16x16x32_bf16 v[196:199], v[124:127], a[100:103], v[196:199]
    ds_read_b128 v[180:183], v9 offset:11328
    v_mfma_f32_16x16x32_bf16 v[200:203], v[124:127], a[156:159], v[200:203]
    v_mfma_f32_16x16x32_bf16 v[204:207], v[124:127], a[212:215], v[204:207]
    v_mfma_f32_16x16x32_bf16 v[192:195], v[128:131], a[48:51], v[192:195]
    v_mfma_f32_16x16x32_bf16 v[196:199], v[128:131], a[104:107], v[196:199]
    ds_read_b128 v[184:187], v9 offset:12352
    v_mfma_f32_16x16x32_bf16 v[200:203], v[128:131], a[160:163], v[200:203]
    v_mfma_f32_16x16x32_bf16 v[204:207], v[128:131], a[216:219], v[204:207]
    v_mfma_f32_16x16x32_bf16 v[192:195], v[132:135], a[52:55], v[192:195]
    v_mfma_f32_16x16x32_bf16 v[196:199], v[132:135], a[108:111], v[196:199]
    ds_read_b128 v[188:191], v9 offset:13376
    v_mfma_f32_16x16x32_bf16 v[200:203], v[132:135], a[164:167], v[200:203]
    v_mfma_f32_16x16x32_bf16 v[204:207], v[132:135], a[220:223], v[204:207]
    s_waitcnt lgkmcnt(0)
    s_waitcnt vmcnt(15)
    s_barrier
    v_mfma_f32_16x16x32_bf16 v[208:211], v[136:139], a[0:3], 0
    v_mfma_f32_16x16x32_bf16 v[212:215], v[136:139], a[56:59], 0
    ds_read_b128 v[24:27], v9 offset:28672
    v_mfma_f32_16x16x32_bf16 v[216:219], v[136:139], a[112:115], 0
    v_mfma_f32_16x16x32_bf16 v[220:223], v[136:139], a[168:171], 0
    v_mfma_f32_16x16x32_bf16 v[208:211], v[140:143], a[4:7], v[208:211]
    v_mfma_f32_16x16x32_bf16 v[212:215], v[140:143], a[60:63], v[212:215]
    ds_read_b128 v[28:31], v9 offset:29696
    v_mfma_f32_16x16x32_bf16 v[216:219], v[140:143], a[116:119], v[216:219]
    v_mfma_f32_16x16x32_bf16 v[220:223], v[140:143], a[172:175], v[220:223]
    v_mfma_f32_16x16x32_bf16 v[208:211], v[144:147], a[8:11], v[208:211]
    v_mfma_f32_16x16x32_bf16 v[212:215], v[144:147], a[64:67], v[212:215]
    ds_read_b128 v[32:35], v9 offset:30720
    v_mfma_f32_16x16x32_bf16 v[216:219], v[144:147], a[120:123], v[216:219]
    v_mfma_f32_16x16x32_bf16 v[220:223], v[144:147], a[176:179], v[220:223]
    v_mfma_f32_16x16x32_bf16 v[208:211], v[148:151], a[12:15], v[208:211]
    v_mfma_f32_16x16x32_bf16 v[212:215], v[148:151], a[68:71], v[212:215]
    ds_read_b128 v[36:39], v9 offset:31744
    v_mfma_f32_16x16x32_bf16 v[216:219], v[148:151], a[124:127], v[216:219]
    v_mfma_f32_16x16x32_bf16 v[220:223], v[148:151], a[180:183], v[220:223]
    v_mfma_f32_16x16x32_bf16 v[208:211], v[152:155], a[16:19], v[208:211]
    v_mfma_f32_16x16x32_bf16 v[212:215], v[152:155], a[72:75], v[212:215]
    ds_read_b128 v[40:43], v9 offset:32768
    v_mfma_f32_16x16x32_bf16 v[216:219], v[152:155], a[128:131], v[216:219]
    v_mfma_f32_16x16x32_bf16 v[220:223], v[152:155], a[184:187], v[220:223]
    v_mfma_f32_16x16x32_bf16 v[208:211], v[156:159], a[20:23], v[208:211]
    v_mfma_f32_16x16x32_bf16 v[212:215], v[156:159], a[76:79], v[212:215]
    ds_read_b128 v[44:47], v9 offset:33792
    v_mfma_f32_16x16x32_bf16 v[216:219], v[156:159], a[132:135], v[216:219]
    v_mfma_f32_16x16x32_bf16 v[220:223], v[156:159], a[188:191], v[220:223]
    v_mfma_f32_16x16x32_bf16 v[208:211], v[160:163], a[24:27], v[208:211]
    v_mfma_f32_16x16x32_bf16 v[212:215], v[160:163], a[80:83], v[212:215]
    ds_read_b128 v[48:51], v9 offset:34816
    v_mfma_f32_16x16x32_bf16 v[216:219], v[160:163], a[136:139], v[216:219]
    v_mfma_f32_16x16x32_bf16 v[220:223], v[160:163], a[192:195], v[220:223]
    v_mfma_f32_16x16x32_bf16 v[208:211], v[164:167], a[28:31], v[208:211]
    v_mfma_f32_16x16x32_bf16 v[212:215], v[164:167], a[84:87], v[212:215]
    ds_read_b128 v[52:55], v9 offset:35840
    v_mfma_f32_16x16x32_bf16 v[216:219], v[164:167], a[140:143], v[216:219]
    v_mfma_f32_16x16x32_bf16 v[220:223], v[164:167], a[196:199], v[220:223]
    v_mfma_f32_16x16x32_bf16 v[208:211], v[168:171], a[32:35], v[208:211]
    v_mfma_f32_16x16x32_bf16 v[212:215], v[168:171], a[88:91], v[212:215]
    ds_read_b128 v[56:59], v9 offset:36864
    v_mfma_f32_16x16x32_bf16 v[216:219], v[168:171], a[144:147], v[216:219]
    v_mfma_f32_16x16x32_bf16 v[220:223], v[168:171], a[200:203], v[220:223]
    v_mfma_f32_16x16x32_bf16 v[208:211], v[172:175], a[36:39], v[208:211]
    v_mfma_f32_16x16x32_bf16 v[212:215], v[172:175], a[92:95], v[212:215]
    ds_read_b128 v[60:63], v9 offset:37888
    v_mfma_f32_16x16x32_bf16 v[216:219], v[172:175], a[148:151], v[216:219]
    v_mfma_f32_16x16x32_bf16 v[220:223], v[172:175], a[204:207], v[220:223]
    v_mfma_f32_16x16x32_bf16 v[208:211], v[176:179], a[40:43], v[208:211]
    v_mfma_f32_16x16x32_bf16 v[212:215], v[176:179], a[96:99], v[212:215]
    ds_read_b128 v[64:67], v9 offset:38912
    v_mfma_f32_16x16x32_bf16 v[216:219], v[176:179], a[152:155], v[216:219]
    v_mfma_f32_16x16x32_bf16 v[220:223], v[176:179], a[208:211], v[220:223]
    v_mfma_f32_16x16x32_bf16 v[208:211], v[180:183], a[44:47], v[208:211]
    v_mfma_f32_16x16x32_bf16 v[212:215], v[180:183], a[100:103], v[212:215]
    ds_read_b128 v[68:71], v9 offset:39936
    v_mfma_f32_16x16x32_bf16 v[216:219], v[180:183], a[156:159], v[216:219]
    v_mfma_f32_16x16x32_bf16 v[220:223], v[180:183], a[212:215], v[220:223]
    v_mfma_f32_16x16x32_bf16 v[208:211], v[184:187], a[48:51], v[208:211]
    v_mfma_f32_16x16x32_bf16 v[212:215], v[184:187], a[104:107], v[212:215]
    ds_read_b128 v[72:75], v9 offset:40960
    v_mfma_f32_16x16x32_bf16 v[216:219], v[184:187], a[160:163], v[216:219]
    v_mfma_f32_16x16x32_bf16 v[220:223], v[184:187], a[216:219], v[220:223]
    v_mfma_f32_16x16x32_bf16 v[208:211], v[188:191], a[52:55], v[208:211]
    v_mfma_f32_16x16x32_bf16 v[212:215], v[188:191], a[108:111], v[212:215]
    ds_read_b128 v[76:79], v9 offset:41984
    v_mfma_f32_16x16x32_bf16 v[216:219], v[188:191], a[164:167], v[216:219]
    v_mfma_f32_16x16x32_bf16 v[220:223], v[188:191], a[220:223], v[220:223]
    s_nop 7
    v_cvt_pk_bf16_f32 v240, v192, v193
    v_cvt_pk_bf16_f32 v241, v194, v195
    v_cvt_pk_bf16_f32 v242, v208, v209
    v_cvt_pk_bf16_f32 v243, v210, v211
    global_store_dwordx4 v16, v[240:243], s[34:35] offset:1024 sc1
    v_cvt_pk_bf16_f32 v244, v196, v197
    v_cvt_pk_bf16_f32 v245, v198, v199
    v_cvt_pk_bf16_f32 v246, v212, v213
    v_cvt_pk_bf16_f32 v247, v214, v215
    global_store_dwordx4 v17, v[244:247], s[34:35] offset:1024 sc1
    v_cvt_pk_bf16_f32 v248, v200, v201
    v_cvt_pk_bf16_f32 v249, v202, v203
    v_cvt_pk_bf16_f32 v250, v216, v217
    v_cvt_pk_bf16_f32 v251, v218, v219
    global_store_dwordx4 v18, v[248:251], s[34:35] offset:1024 sc1
    v_cvt_pk_bf16_f32 v252, v204, v205
    v_cvt_pk_bf16_f32 v253, v206, v207
    v_cvt_pk_bf16_f32 v254, v220, v221
    v_cvt_pk_bf16_f32 v255, v222, v223
    global_store_dwordx4 v19, v[252:255], s[34:35] offset:1024 sc1
    s_waitcnt lgkmcnt(0)
    v_mfma_f32_16x16x32_bf16 v[192:195], v[24:27], a[0:3], 0
    v_mfma_f32_16x16x32_bf16 v[196:199], v[24:27], a[56:59], 0
    ds_read_b128 v[80:83], v9 offset:28736
    v_mfma_f32_16x16x32_bf16 v[200:203], v[24:27], a[112:115], 0
    v_mfma_f32_16x16x32_bf16 v[204:207], v[24:27], a[168:171], 0
    v_mfma_f32_16x16x32_bf16 v[192:195], v[28:31], a[4:7], v[192:195]
    v_mfma_f32_16x16x32_bf16 v[196:199], v[28:31], a[60:63], v[196:199]
    ds_read_b128 v[84:87], v9 offset:29760
    v_mfma_f32_16x16x32_bf16 v[200:203], v[28:31], a[116:119], v[200:203]
    v_mfma_f32_16x16x32_bf16 v[204:207], v[28:31], a[172:175], v[204:207]
    v_mfma_f32_16x16x32_bf16 v[192:195], v[32:35], a[8:11], v[192:195]
    v_mfma_f32_16x16x32_bf16 v[196:199], v[32:35], a[64:67], v[196:199]
    ds_read_b128 v[88:91], v9 offset:30784
    v_mfma_f32_16x16x32_bf16 v[200:203], v[32:35], a[120:123], v[200:203]
    v_mfma_f32_16x16x32_bf16 v[204:207], v[32:35], a[176:179], v[204:207]
    v_mfma_f32_16x16x32_bf16 v[192:195], v[36:39], a[12:15], v[192:195]
    v_mfma_f32_16x16x32_bf16 v[196:199], v[36:39], a[68:71], v[196:199]
    ds_read_b128 v[92:95], v9 offset:31808
    v_mfma_f32_16x16x32_bf16 v[200:203], v[36:39], a[124:127], v[200:203]
    v_mfma_f32_16x16x32_bf16 v[204:207], v[36:39], a[180:183], v[204:207]
    v_mfma_f32_16x16x32_bf16 v[192:195], v[40:43], a[16:19], v[192:195]
    v_mfma_f32_16x16x32_bf16 v[196:199], v[40:43], a[72:75], v[196:199]
    ds_read_b128 v[96:99], v9 offset:32832
    v_mfma_f32_16x16x32_bf16 v[200:203], v[40:43], a[128:131], v[200:203]
    v_mfma_f32_16x16x32_bf16 v[204:207], v[40:43], a[184:187], v[204:207]
    v_mfma_f32_16x16x32_bf16 v[192:195], v[44:47], a[20:23], v[192:195]
    v_mfma_f32_16x16x32_bf16 v[196:199], v[44:47], a[76:79], v[196:199]
    ds_read_b128 v[100:103], v9 offset:33856
    v_mfma_f32_16x16x32_bf16 v[200:203], v[44:47], a[132:135], v[200:203]
    v_mfma_f32_16x16x32_bf16 v[204:207], v[44:47], a[188:191], v[204:207]
    v_mfma_f32_16x16x32_bf16 v[192:195], v[48:51], a[24:27], v[192:195]
    v_mfma_f32_16x16x32_bf16 v[196:199], v[48:51], a[80:83], v[196:199]
    ds_read_b128 v[104:107], v9 offset:34880
    v_mfma_f32_16x16x32_bf16 v[200:203], v[48:51], a[136:139], v[200:203]
    v_mfma_f32_16x16x32_bf16 v[204:207], v[48:51], a[192:195], v[204:207]
    v_mfma_f32_16x16x32_bf16 v[192:195], v[52:55], a[28:31], v[192:195]
    v_mfma_f32_16x16x32_bf16 v[196:199], v[52:55], a[84:87], v[196:199]
    ds_read_b128 v[108:111], v9 offset:35904
    v_mfma_f32_16x16x32_bf16 v[200:203], v[52:55], a[140:143], v[200:203]
    v_mfma_f32_16x16x32_bf16 v[204:207], v[52:55], a[196:199], v[204:207]
    v_mfma_f32_16x16x32_bf16 v[192:195], v[56:59], a[32:35], v[192:195]
    v_mfma_f32_16x16x32_bf16 v[196:199], v[56:59], a[88:91], v[196:199]
    ds_read_b128 v[112:115], v9 offset:36928
    v_mfma_f32_16x16x32_bf16 v[200:203], v[56:59], a[144:147], v[200:203]
    v_mfma_f32_16x16x32_bf16 v[204:207], v[56:59], a[200:203], v[204:207]
    v_mfma_f32_16x16x32_bf16 v[192:195], v[60:63], a[36:39], v[192:195]
    v_mfma_f32_16x16x32_bf16 v[196:199], v[60:63], a[92:95], v[196:199]
    ds_read_b128 v[116:119], v9 offset:37952
    v_mfma_f32_16x16x32_bf16 v[200:203], v[60:63], a[148:151], v[200:203]
    v_mfma_f32_16x16x32_bf16 v[204:207], v[60:63], a[204:207], v[204:207]
    v_mfma_f32_16x16x32_bf16 v[192:195], v[64:67], a[40:43], v[192:195]
    v_mfma_f32_16x16x32_bf16 v[196:199], v[64:67], a[96:99], v[196:199]
    ds_read_b128 v[120:123], v9 offset:38976
    v_mfma_f32_16x16x32_bf16 v[200:203], v[64:67], a[152:155], v[200:203]
    v_mfma_f32_16x16x32_bf16 v[204:207], v[64:67], a[208:211], v[204:207]
    v_mfma_f32_16x16x32_bf16 v[192:195], v[68:71], a[44:47], v[192:195]
    v_mfma_f32_16x16x32_bf16 v[196:199], v[68:71], a[100:103], v[196:199]
    ds_read_b128 v[124:127], v9 offset:40000
    v_mfma_f32_16x16x32_bf16 v[200:203], v[68:71], a[156:159], v[200:203]
    v_mfma_f32_16x16x32_bf16 v[204:207], v[68:71], a[212:215], v[204:207]
    v_mfma_f32_16x16x32_bf16 v[192:195], v[72:75], a[48:51], v[192:195]
    v_mfma_f32_16x16x32_bf16 v[196:199], v[72:75], a[104:107], v[196:199]
    ds_read_b128 v[128:131], v9 offset:41024
    v_mfma_f32_16x16x32_bf16 v[200:203], v[72:75], a[160:163], v[200:203]
    v_mfma_f32_16x16x32_bf16 v[204:207], v[72:75], a[216:219], v[204:207]
    v_mfma_f32_16x16x32_bf16 v[192:195], v[76:79], a[52:55], v[192:195]
    v_mfma_f32_16x16x32_bf16 v[196:199], v[76:79], a[108:111], v[196:199]
    ds_read_b128 v[132:135], v9 offset:42048
    v_mfma_f32_16x16x32_bf16 v[200:203], v[76:79], a[164:167], v[200:203]
    v_mfma_f32_16x16x32_bf16 v[204:207], v[76:79], a[220:223], v[204:207]
    s_waitcnt lgkmcnt(0)
    s_waitcnt vmcnt(8)
    s_barrier
    v_mfma_f32_16x16x32_bf16 v[208:211], v[80:83], a[0:3], 0
    v_mfma_f32_16x16x32_bf16 v[212:215], v[80:83], a[56:59], 0
    ds_read_b128 v[136:139], v10 offset:0
    v_mfma_f32_16x16x32_bf16 v[216:219], v[80:83], a[112:115], 0
    v_mfma_f32_16x16x32_bf16 v[220:223], v[80:83], a[168:171], 0
    v_mfma_f32_16x16x32_bf16 v[208:211], v[84:87], a[4:7], v[208:211]
    v_mfma_f32_16x16x32_bf16 v[212:215], v[84:87], a[60:63], v[212:215]
    ds_read_b128 v[140:143], v10 offset:1024
    v_mfma_f32_16x16x32_bf16 v[216:219], v[84:87], a[116:119], v[216:219]
    v_mfma_f32_16x16x32_bf16 v[220:223], v[84:87], a[172:175], v[220:223]
    v_mfma_f32_16x16x32_bf16 v[208:211], v[88:91], a[8:11], v[208:211]
    v_mfma_f32_16x16x32_bf16 v[212:215], v[88:91], a[64:67], v[212:215]
    ds_read_b128 v[144:147], v10 offset:2048
    v_mfma_f32_16x16x32_bf16 v[216:219], v[88:91], a[120:123], v[216:219]
    v_mfma_f32_16x16x32_bf16 v[220:223], v[88:91], a[176:179], v[220:223]
    v_mfma_f32_16x16x32_bf16 v[208:211], v[92:95], a[12:15], v[208:211]
    v_mfma_f32_16x16x32_bf16 v[212:215], v[92:95], a[68:71], v[212:215]
    ds_read_b128 v[148:151], v10 offset:3072
    v_mfma_f32_16x16x32_bf16 v[216:219], v[92:95], a[124:127], v[216:219]
    v_mfma_f32_16x16x32_bf16 v[220:223], v[92:95], a[180:183], v[220:223]
    v_mfma_f32_16x16x32_bf16 v[208:211], v[96:99], a[16:19], v[208:211]
    v_mfma_f32_16x16x32_bf16 v[212:215], v[96:99], a[72:75], v[212:215]
    ds_read_b128 v[152:155], v10 offset:4096
    v_mfma_f32_16x16x32_bf16 v[216:219], v[96:99], a[128:131], v[216:219]
    v_mfma_f32_16x16x32_bf16 v[220:223], v[96:99], a[184:187], v[220:223]
    v_mfma_f32_16x16x32_bf16 v[208:211], v[100:103], a[20:23], v[208:211]
    v_mfma_f32_16x16x32_bf16 v[212:215], v[100:103], a[76:79], v[212:215]
    ds_read_b128 v[156:159], v10 offset:5120
    v_mfma_f32_16x16x32_bf16 v[216:219], v[100:103], a[132:135], v[216:219]
    v_mfma_f32_16x16x32_bf16 v[220:223], v[100:103], a[188:191], v[220:223]
    v_mfma_f32_16x16x32_bf16 v[208:211], v[104:107], a[24:27], v[208:211]
    v_mfma_f32_16x16x32_bf16 v[212:215], v[104:107], a[80:83], v[212:215]
    ds_read_b128 v[160:163], v10 offset:6144
    v_mfma_f32_16x16x32_bf16 v[216:219], v[104:107], a[136:139], v[216:219]
    v_mfma_f32_16x16x32_bf16 v[220:223], v[104:107], a[192:195], v[220:223]
    v_mfma_f32_16x16x32_bf16 v[208:211], v[108:111], a[28:31], v[208:211]
    v_mfma_f32_16x16x32_bf16 v[212:215], v[108:111], a[84:87], v[212:215]
    ds_read_b128 v[164:167], v10 offset:7168
    v_mfma_f32_16x16x32_bf16 v[216:219], v[108:111], a[140:143], v[216:219]
    v_mfma_f32_16x16x32_bf16 v[220:223], v[108:111], a[196:199], v[220:223]
    v_mfma_f32_16x16x32_bf16 v[208:211], v[112:115], a[32:35], v[208:211]
    v_mfma_f32_16x16x32_bf16 v[212:215], v[112:115], a[88:91], v[212:215]
    ds_read_b128 v[168:171], v10 offset:8192
    v_mfma_f32_16x16x32_bf16 v[216:219], v[112:115], a[144:147], v[216:219]
    v_mfma_f32_16x16x32_bf16 v[220:223], v[112:115], a[200:203], v[220:223]
    v_mfma_f32_16x16x32_bf16 v[208:211], v[116:119], a[36:39], v[208:211]
    v_mfma_f32_16x16x32_bf16 v[212:215], v[116:119], a[92:95], v[212:215]
    ds_read_b128 v[172:175], v10 offset:9216
    v_mfma_f32_16x16x32_bf16 v[216:219], v[116:119], a[148:151], v[216:219]
    v_mfma_f32_16x16x32_bf16 v[220:223], v[116:119], a[204:207], v[220:223]
    v_mfma_f32_16x16x32_bf16 v[208:211], v[120:123], a[40:43], v[208:211]
    v_mfma_f32_16x16x32_bf16 v[212:215], v[120:123], a[96:99], v[212:215]
    ds_read_b128 v[176:179], v10 offset:10240
    v_mfma_f32_16x16x32_bf16 v[216:219], v[120:123], a[152:155], v[216:219]
    v_mfma_f32_16x16x32_bf16 v[220:223], v[120:123], a[208:211], v[220:223]
    v_mfma_f32_16x16x32_bf16 v[208:211], v[124:127], a[44:47], v[208:211]
    v_mfma_f32_16x16x32_bf16 v[212:215], v[124:127], a[100:103], v[212:215]
    ds_read_b128 v[180:183], v10 offset:11264
    v_mfma_f32_16x16x32_bf16 v[216:219], v[124:127], a[156:159], v[216:219]
    v_mfma_f32_16x16x32_bf16 v[220:223], v[124:127], a[212:215], v[220:223]
    v_mfma_f32_16x16x32_bf16 v[208:211], v[128:131], a[48:51], v[208:211]
    v_mfma_f32_16x16x32_bf16 v[212:215], v[128:131], a[104:107], v[212:215]
    ds_read_b128 v[184:187], v10 offset:12288
    v_mfma_f32_16x16x32_bf16 v[216:219], v[128:131], a[160:163], v[216:219]
    v_mfma_f32_16x16x32_bf16 v[220:223], v[128:131], a[216:219], v[220:223]
    v_mfma_f32_16x16x32_bf16 v[208:211], v[132:135], a[52:55], v[208:211]
    v_mfma_f32_16x16x32_bf16 v[212:215], v[132:135], a[108:111], v[212:215]
    ds_read_b128 v[188:191], v10 offset:13312
    v_mfma_f32_16x16x32_bf16 v[216:219], v[132:135], a[164:167], v[216:219]
    v_mfma_f32_16x16x32_bf16 v[220:223], v[132:135], a[220:223], v[220:223]
    s_nop 7
    v_cvt_pk_bf16_f32 v224, v192, v193
    v_cvt_pk_bf16_f32 v225, v194, v195
    v_cvt_pk_bf16_f32 v226, v208, v209
    v_cvt_pk_bf16_f32 v227, v210, v211
    global_store_dwordx4 v16, v[224:227], s[34:35] offset:2048 sc1
    v_cvt_pk_bf16_f32 v228, v196, v197
    v_cvt_pk_bf16_f32 v229, v198, v199
    v_cvt_pk_bf16_f32 v230, v212, v213
    v_cvt_pk_bf16_f32 v231, v214, v215
    global_store_dwordx4 v17, v[228:231], s[34:35] offset:2048 sc1
    v_cvt_pk_bf16_f32 v232, v200, v201
    v_cvt_pk_bf16_f32 v233, v202, v203
    v_cvt_pk_bf16_f32 v234, v216, v217
    v_cvt_pk_bf16_f32 v235, v218, v219
    global_store_dwordx4 v18, v[232:235], s[34:35] offset:2048 sc1
    v_cvt_pk_bf16_f32 v236, v204, v205
    v_cvt_pk_bf16_f32 v237, v206, v207
    v_cvt_pk_bf16_f32 v238, v220, v221
    v_cvt_pk_bf16_f32 v239, v222, v223
    global_store_dwordx4 v19, v[236:239], s[34:35] offset:2048 sc1
    s_waitcnt lgkmcnt(0)
    v_mfma_f32_16x16x32_bf16 v[192:195], v[136:139], a[0:3], 0
    v_mfma_f32_16x16x32_bf16 v[196:199], v[136:139], a[56:59], 0
    ds_read_b128 v[24:27], v10 offset:64
    v_mfma_f32_16x16x32_bf16 v[200:203], v[136:139], a[112:115], 0
    v_mfma_f32_16x16x32_bf16 v[204:207], v[136:139], a[168:171], 0
    v_mfma_f32_16x16x32_bf16 v[192:195], v[140:143], a[4:7], v[192:195]
    v_mfma_f32_16x16x32_bf16 v[196:199], v[140:143], a[60:63], v[196:199]
    ds_read_b128 v[28:31], v10 offset:1088
    v_mfma_f32_16x16x32_bf16 v[200:203], v[140:143], a[116:119], v[200:203]
    v_mfma_f32_16x16x32_bf16 v[204:207], v[140:143], a[172:175], v[204:207]
    v_mfma_f32_16x16x32_bf16 v[192:195], v[144:147], a[8:11], v[192:195]
    v_mfma_f32_16x16x32_bf16 v[196:199], v[144:147], a[64:67], v[196:199]
    ds_read_b128 v[32:35], v10 offset:2112
    v_mfma_f32_16x16x32_bf16 v[200:203], v[144:147], a[120:123], v[200:203]
    v_mfma_f32_16x16x32_bf16 v[204:207], v[144:147], a[176:179], v[204:207]
    v_mfma_f32_16x16x32_bf16 v[192:195], v[148:151], a[12:15], v[192:195]
    v_mfma_f32_16x16x32_bf16 v[196:199], v[148:151], a[68:71], v[196:199]
    ds_read_b128 v[36:39], v10 offset:3136
    v_mfma_f32_16x16x32_bf16 v[200:203], v[148:151], a[124:127], v[200:203]
    v_mfma_f32_16x16x32_bf16 v[204:207], v[148:151], a[180:183], v[204:207]
    v_mfma_f32_16x16x32_bf16 v[192:195], v[152:155], a[16:19], v[192:195]
    v_mfma_f32_16x16x32_bf16 v[196:199], v[152:155], a[72:75], v[196:199]
    ds_read_b128 v[40:43], v10 offset:4160
    v_mfma_f32_16x16x32_bf16 v[200:203], v[152:155], a[128:131], v[200:203]
    v_mfma_f32_16x16x32_bf16 v[204:207], v[152:155], a[184:187], v[204:207]
    v_mfma_f32_16x16x32_bf16 v[192:195], v[156:159], a[20:23], v[192:195]
    v_mfma_f32_16x16x32_bf16 v[196:199], v[156:159], a[76:79], v[196:199]
    ds_read_b128 v[44:47], v10 offset:5184
    v_mfma_f32_16x16x32_bf16 v[200:203], v[156:159], a[132:135], v[200:203]
    v_mfma_f32_16x16x32_bf16 v[204:207], v[156:159], a[188:191], v[204:207]
    v_mfma_f32_16x16x32_bf16 v[192:195], v[160:163], a[24:27], v[192:195]
    v_mfma_f32_16x16x32_bf16 v[196:199], v[160:163], a[80:83], v[196:199]
    ds_read_b128 v[48:51], v10 offset:6208
    v_mfma_f32_16x16x32_bf16 v[200:203], v[160:163], a[136:139], v[200:203]
    v_mfma_f32_16x16x32_bf16 v[204:207], v[160:163], a[192:195], v[204:207]
    v_mfma_f32_16x16x32_bf16 v[192:195], v[164:167], a[28:31], v[192:195]
    v_mfma_f32_16x16x32_bf16 v[196:199], v[164:167], a[84:87], v[196:199]
    ds_read_b128 v[52:55], v10 offset:7232
    v_mfma_f32_16x16x32_bf16 v[200:203], v[164:167], a[140:143], v[200:203]
    v_mfma_f32_16x16x32_bf16 v[204:207], v[164:167], a[196:199], v[204:207]
    v_mfma_f32_16x16x32_bf16 v[192:195], v[168:171], a[32:35], v[192:195]
    v_mfma_f32_16x16x32_bf16 v[196:199], v[168:171], a[88:91], v[196:199]
    ds_read_b128 v[56:59], v10 offset:8256
    v_mfma_f32_16x16x32_bf16 v[200:203], v[168:171], a[144:147], v[200:203]
    v_mfma_f32_16x16x32_bf16 v[204:207], v[168:171], a[200:203], v[204:207]
    v_mfma_f32_16x16x32_bf16 v[192:195], v[172:175], a[36:39], v[192:195]
    v_mfma_f32_16x16x32_bf16 v[196:199], v[172:175], a[92:95], v[196:199]
    ds_read_b128 v[60:63], v10 offset:9280
    v_mfma_f32_16x16x32_bf16 v[200:203], v[172:175], a[148:151], v[200:203]
    v_mfma_f32_16x16x32_bf16 v[204:207], v[172:175], a[204:207], v[204:207]
    v_mfma_f32_16x16x32_bf16 v[192:195], v[176:179], a[40:43], v[192:195]
    v_mfma_f32_16x16x32_bf16 v[196:199], v[176:179], a[96:99], v[196:199]
    ds_read_b128 v[64:67], v10 offset:10304
    v_mfma_f32_16x16x32_bf16 v[200:203], v[176:179], a[152:155], v[200:203]
    v_mfma_f32_16x16x32_bf16 v[204:207], v[176:179], a[208:211], v[204:207]
    v_mfma_f32_16x16x32_bf16 v[192:195], v[180:183], a[44:47], v[192:195]
    v_mfma_f32_16x16x32_bf16 v[196:199], v[180:183], a[100:103], v[196:199]
    ds_read_b128 v[68:71], v10 offset:11328
    v_mfma_f32_16x16x32_bf16 v[200:203], v[180:183], a[156:159], v[200:203]
    v_mfma_f32_16x16x32_bf16 v[204:207], v[180:183], a[212:215], v[204:207]
    v_mfma_f32_16x16x32_bf16 v[192:195], v[184:187], a[48:51], v[192:195]
    v_mfma_f32_16x16x32_bf16 v[196:199], v[184:187], a[104:107], v[196:199]
    ds_read_b128 v[72:75], v10 offset:12352
    v_mfma_f32_16x16x32_bf16 v[200:203], v[184:187], a[160:163], v[200:203]
    v_mfma_f32_16x16x32_bf16 v[204:207], v[184:187], a[216:219], v[204:207]
    v_mfma_f32_16x16x32_bf16 v[192:195], v[188:191], a[52:55], v[192:195]
    v_mfma_f32_16x16x32_bf16 v[196:199], v[188:191], a[108:111], v[196:199]
    ds_read_b128 v[76:79], v10 offset:13376
    v_mfma_f32_16x16x32_bf16 v[200:203], v[188:191], a[164:167], v[200:203]
    v_mfma_f32_16x16x32_bf16 v[204:207], v[188:191], a[220:223], v[204:207]
    s_waitcnt lgkmcnt(0)
    v_mfma_f32_16x16x32_bf16 v[208:211], v[24:27], a[0:3], 0
    v_mfma_f32_16x16x32_bf16 v[212:215], v[24:27], a[56:59], 0
    v_mfma_f32_16x16x32_bf16 v[216:219], v[24:27], a[112:115], 0
    v_mfma_f32_16x16x32_bf16 v[220:223], v[24:27], a[168:171], 0
    v_mfma_f32_16x16x32_bf16 v[208:211], v[28:31], a[4:7], v[208:211]
    v_mfma_f32_16x16x32_bf16 v[212:215], v[28:31], a[60:63], v[212:215]
    v_mfma_f32_16x16x32_bf16 v[216:219], v[28:31], a[116:119], v[216:219]
    v_mfma_f32_16x16x32_bf16 v[220:223], v[28:31], a[172:175], v[220:223]
    v_mfma_f32_16x16x32_bf16 v[208:211], v[32:35], a[8:11], v[208:211]
    v_mfma_f32_16x16x32_bf16 v[212:215], v[32:35], a[64:67], v[212:215]
    v_mfma_f32_16x16x32_bf16 v[216:219], v[32:35], a[120:123], v[216:219]
    v_mfma_f32_16x16x32_bf16 v[220:223], v[32:35], a[176:179], v[220:223]
    v_mfma_f32_16x16x32_bf16 v[208:211], v[36:39], a[12:15], v[208:211]
    v_mfma_f32_16x16x32_bf16 v[212:215], v[36:39], a[68:71], v[212:215]
    v_mfma_f32_16x16x32_bf16 v[216:219], v[36:39], a[124:127], v[216:219]
    v_mfma_f32_16x16x32_bf16 v[220:223], v[36:39], a[180:183], v[220:223]
    v_mfma_f32_16x16x32_bf16 v[208:211], v[40:43], a[16:19], v[208:211]
    v_mfma_f32_16x16x32_bf16 v[212:215], v[40:43], a[72:75], v[212:215]
    v_mfma_f32_16x16x32_bf16 v[216:219], v[40:43], a[128:131], v[216:219]
    v_mfma_f32_16x16x32_bf16 v[220:223], v[40:43], a[184:187], v[220:223]
    v_mfma_f32_16x16x32_bf16 v[208:211], v[44:47], a[20:23], v[208:211]
    v_mfma_f32_16x16x32_bf16 v[212:215], v[44:47], a[76:79], v[212:215]
    v_mfma_f32_16x16x32_bf16 v[216:219], v[44:47], a[132:135], v[216:219]
    v_mfma_f32_16x16x32_bf16 v[220:223], v[44:47], a[188:191], v[220:223]
    v_mfma_f32_16x16x32_bf16 v[208:211], v[48:51], a[24:27], v[208:211]
    v_mfma_f32_16x16x32_bf16 v[212:215], v[48:51], a[80:83], v[212:215]
    v_mfma_f32_16x16x32_bf16 v[216:219], v[48:51], a[136:139], v[216:219]
    v_mfma_f32_16x16x32_bf16 v[220:223], v[48:51], a[192:195], v[220:223]
    v_mfma_f32_16x16x32_bf16 v[208:211], v[52:55], a[28:31], v[208:211]
    v_mfma_f32_16x16x32_bf16 v[212:215], v[52:55], a[84:87], v[212:215]
    v_mfma_f32_16x16x32_bf16 v[216:219], v[52:55], a[140:143], v[216:219]
    v_mfma_f32_16x16x32_bf16 v[220:223], v[52:55], a[196:199], v[220:223]
    v_mfma_f32_16x16x32_bf16 v[208:211], v[56:59], a[32:35], v[208:211]
    v_mfma_f32_16x16x32_bf16 v[212:215], v[56:59], a[88:91], v[212:215]
    v_mfma_f32_16x16x32_bf16 v[216:219], v[56:59], a[144:147], v[216:219]
    v_mfma_f32_16x16x32_bf16 v[220:223], v[56:59], a[200:203], v[220:223]
    v_mfma_f32_16x16x32_bf16 v[208:211], v[60:63], a[36:39], v[208:211]
    v_mfma_f32_16x16x32_bf16 v[212:215], v[60:63], a[92:95], v[212:215]
    v_mfma_f32_16x16x32_bf16 v[216:219], v[60:63], a[148:151], v[216:219]
    v_mfma_f32_16x16x32_bf16 v[220:223], v[60:63], a[204:207], v[220:223]
    v_mfma_f32_16x16x32_bf16 v[208:211], v[64:67], a[40:43], v[208:211]
    v_mfma_f32_16x16x32_bf16 v[212:215], v[64:67], a[96:99], v[212:215]
    v_mfma_f32_16x16x32_bf16 v[216:219], v[64:67], a[152:155], v[216:219]
    v_mfma_f32_16x16x32_bf16 v[220:223], v[64:67], a[208:211], v[220:223]
    v_mfma_f32_16x16x32_bf16 v[208:211], v[68:71], a[44:47], v[208:211]
    v_mfma_f32_16x16x32_bf16 v[212:215], v[68:71], a[100:103], v[212:215]
    v_mfma_f32_16x16x32_bf16 v[216:219], v[68:71], a[156:159], v[216:219]
    v_mfma_f32_16x16x32_bf16 v[220:223], v[68:71], a[212:215], v[220:223]
    v_mfma_f32_16x16x32_bf16 v[208:211], v[72:75], a[48:51], v[208:211]
    v_mfma_f32_16x16x32_bf16 v[212:215], v[72:75], a[104:107], v[212:215]
    v_mfma_f32_16x16x32_bf16 v[216:219], v[72:75], a[160:163], v[216:219]
    v_mfma_f32_16x16x32_bf16 v[220:223], v[72:75], a[216:219], v[220:223]
    v_mfma_f32_16x16x32_bf16 v[208:211], v[76:79], a[52:55], v[208:211]
    v_mfma_f32_16x16x32_bf16 v[212:215], v[76:79], a[108:111], v[212:215]
    v_mfma_f32_16x16x32_bf16 v[216:219], v[76:79], a[164:167], v[216:219]
    v_mfma_f32_16x16x32_bf16 v[220:223], v[76:79], a[220:223], v[220:223]
    s_nop 7
    v_cvt_pk_bf16_f32 v240, v192, v193
    v_cvt_pk_bf16_f32 v241, v194, v195
    v_cvt_pk_bf16_f32 v242, v208, v209
    v_cvt_pk_bf16_f32 v243, v210, v211
    global_store_dwordx4 v16, v[240:243], s[34:35] offset:3072 sc1
    v_cvt_pk_bf16_f32 v244, v196, v197
    v_cvt_pk_bf16_f32 v245, v198, v199
    v_cvt_pk_bf16_f32 v246, v212, v213
    v_cvt_pk_bf16_f32 v247, v214, v215
    global_store_dwordx4 v17, v[244:247], s[34:35] offset:3072 sc1
    v_cvt_pk_bf16_f32 v248, v200, v201
    v_cvt_pk_bf16_f32 v249, v202, v203
    v_cvt_pk_bf16_f32 v250, v216, v217
    v_cvt_pk_bf16_f32 v251, v218, v219
    global_store_dwordx4 v18, v[248:251], s[34:35] offset:3072 sc1
    v_cvt_pk_bf16_f32 v252, v204, v205
    v_cvt_pk_bf16_f32 v253, v206, v207
    v_cvt_pk_bf16_f32 v254, v220, v221
    v_cvt_pk_bf16_f32 v255, v222, v223
    global_store_dwordx4 v19, v[252:255], s[34:35] offset:3072 sc1
    s_add_u32 s34, s34, 0x1000
    s_addc_u32 s35, s35, 0
    s_waitcnt vmcnt(0)
    s_cmp_lg_u32 s23, 0
    s_cbranch_scc1 Lwo_106
    s_add_u32 s76, s4, 0x7900800
    s_addc_u32 s77, s5, 0
    v_mbcnt_lo_u32_b32 v8, -1, 0
    v_mbcnt_hi_u32_b32 v8, -1, v8
    v_lshlrev_b32 v8, 2, v8
    s_mov_b32 s78, 1048576
    s_mov_b32 exec_lo, 0x1
    s_mov_b32 exec_hi, 0x0
Lwf_107:
    global_load_dword v9, v8, s[76:77] sc1
    s_sub_u32 s78, s78, 1
    s_cmp_eq_u32 s78, 0
    s_cbranch_scc1 Lexit_1
    s_waitcnt vmcnt(0)
    v_cmp_ne_u32 vcc, 168, v9
    s_cbranch_vccz Lwfd_108
    s_sleep 8
    s_branch Lwf_107
Lwfd_108:
    s_mov_b64 exec, -1
Lwo_106:
    s_barrier
    v_and_b32 v1, 63, v0
    v_lshlrev_b32 v2, 4, v1
    v_lshlrev_b32 v3, 4, v1
    v_add_u32 v3, 4096, v3
    v_lshlrev_b32 v4, 4, v1
    v_add_u32 v4, 8192, v4
    v_lshlrev_b32 v5, 4, v1
    v_add_u32 v5, 12288, v5
    v_and_b32 v14, 3, v1
    v_bfe_u32 v15, v1, 2, 1
    v_lshl_add_u32 v14, v15, 3, v14
    v_lshrrev_b32 v15, 4, v1
    v_lshl_add_u32 v14, v15, 4, v14
    v_lshlrev_b32 v14, 4, v14
    v_bfe_u32 v15, v1, 3, 1
    v_mul_u32_u24 v15, 14336, v15
    v_add_u32 v14, v14, v15
    v_add_u32 v6, 0, v2
    v_add_u32 v9, 0, v14
    v_add_u32 v7, 57344, v2
    v_add_u32 v10, 57344, v14
    v_add_u32 v8, 114688, v2
    v_add_u32 v11, 114688, v14
    s_mul_i32 s39, s23, 7168
    v_add_u32 v12, s39, v2
    v_add_u32 v13, 4096, v12
    s_lshl_b32 s28, s73, 4
    s_lshl_b32 s29, s23, 2
    s_add_u32 s28, s28, s29
    s_mul_i32 s25, s74, 57344
    s_add_u32 s26, s25, 0x1100000
    s_add_u32 s30, s4, s26
    s_addc_u32 s31, s5, 0
    s_add_u32 s26, s25, 0x1300000
    s_add_u32 s32, s4, s26
    s_addc_u32 s33, s5, 0
    s_mul_i32 s25, s28, 57344
    s_lshl_b32 s26, s74, 11
    s_add_u32 s25, s25, s26
    s_add_u32 s25, s25, 0x1700000
    s_add_u32 s34, s4, s25
    s_addc_u32 s35, s5, 0
    s_mov_b32 s38, 0x3fb8aa3b
    v_mov_b32 v16, v2
    v_add_u32 v17, 57344, v2
    v_add_u32 v18, 114688, v2
    v_add_u32 v19, 172032, v2
    s_barrier
    s_add_u32 m0, s39, 0
    s_nop 0
    global_load_lds_dwordx4 v12, s[30:31] offset:0 sc1
    s_add_u32 m0, s39, 0
    s_nop 0
    global_load_lds_dwordx4 v12, s[30:31] offset:1024 sc1
    s_add_u32 m0, s39, 0
    s_nop 0
    global_load_lds_dwordx4 v12, s[30:31] offset:2048 sc1
    s_add_u32 m0, s39, 0
    s_nop 0
    global_load_lds_dwordx4 v12, s[30:31] offset:3072 sc1
    s_add_u32 m0, s39, 4096
    s_nop 0
    global_load_lds_dwordx4 v13, s[30:31] offset:0 sc1
    s_add_u32 m0, s39, 4096
    s_nop 0
    global_load_lds_dwordx4 v13, s[30:31] offset:1024 sc1
    s_add_u32 m0, s39, 4096
    s_nop 0
    global_load_lds_dwordx4 v13, s[30:31] offset:2048 sc1
    s_add_u32 s30, s30, 0x7000
    s_addc_u32 s31, s31, 0
    s_add_u32 m0, s39, 28672
    s_nop 0
    global_load_lds_dwordx4 v12, s[32:33] offset:0 sc1
    s_add_u32 m0, s39, 28672
    s_nop 0
    global_load_lds_dwordx4 v12, s[32:33] offset:1024 sc1
    s_add_u32 m0, s39, 28672
    s_nop 0
    global_load_lds_dwordx4 v12, s[32:33] offset:2048 sc1
    s_add_u32 m0, s39, 28672
    s_nop 0
    global_load_lds_dwordx4 v12, s[32:33] offset:3072 sc1
    s_add_u32 m0, s39, 32768
    s_nop 0
    global_load_lds_dwordx4 v13, s[32:33] offset:0 sc1
    s_add_u32 m0, s39, 32768
    s_nop 0
    global_load_lds_dwordx4 v13, s[32:33] offset:1024 sc1
    s_add_u32 m0, s39, 32768
    s_nop 0
    global_load_lds_dwordx4 v13, s[32:33] offset:2048 sc1
    s_add_u32 s32, s32, 0x7000
    s_addc_u32 s33, s33, 0
    s_add_u32 m0, s39, 57344
    s_nop 0
    global_load_lds_dwordx4 v12, s[30:31] offset:0 sc1
    s_add_u32 m0, s39, 57344
    s_nop 0
    global_load_lds_dwordx4 v12, s[30:31] offset:1024 sc1
    s_add_u32 m0, s39, 57344
    s_nop 0
    global_load_lds_dwordx4 v12, s[30:31] offset:2048 sc1
    s_add_u32 m0, s39, 57344
    s_nop 0
    global_load_lds_dwordx4 v12, s[30:31] offset:3072 sc1
    s_add_u32 m0, s39, 61440
    s_nop 0
    global_load_lds_dwordx4 v13, s[30:31] offset:0 sc1
    s_add_u32 m0, s39, 61440
    s_nop 0
    global_load_lds_dwordx4 v13, s[30:31] offset:1024 sc1
    s_add_u32 m0, s39, 61440
    s_nop 0
    global_load_lds_dwordx4 v13, s[30:31] offset:2048 sc1
    s_add_u32 s30, s30, 0x7000
    s_addc_u32 s31, s31, 0
    s_waitcnt vmcnt(14)
    s_barrier
    ds_read_b128 v[24:27], v6 offset:0
    ds_read_b128 v[28:31], v6 offset:1024
    ds_read_b128 v[32:35], v6 offset:2048
    ds_read_b128 v[36:39], v6 offset:3072
    ds_read_b128 v[40:43], v6 offset:4096
    ds_read_b128 v[44:47], v6 offset:5120
    ds_read_b128 v[48:51], v6 offset:6144
    ds_read_b128 v[52:55], v6 offset:7168
    ds_read_b128 v[56:59], v6 offset:8192
    ds_read_b128 v[60:63], v6 offset:9216
    ds_read_b128 v[64:67], v6 offset:10240
    ds_read_b128 v[68:71], v6 offset:11264
    ds_read_b128 v[72:75], v6 offset:12288
    ds_read_b128 v[76:79], v6 offset:13312
    s_waitcnt lgkmcnt(0)
    v_mfma_f32_16x16x32_bf16 v[192:195], v[24:27], a[0:3], 0
    v_mfma_f32_16x16x32_bf16 v[196:199], v[24:27], a[56:59], 0
    ds_read_b128 v[80:83], v6 offset:14336
    v_mfma_f32_16x16x32_bf16 v[200:203], v[24:27], a[112:115], 0
    v_mfma_f32_16x16x32_bf16 v[204:207], v[24:27], a[168:171], 0
    s_add_u32 m0, s39, 86016
    s_nop 0
    global_load_lds_dwordx4 v12, s[32:33] offset:0 sc1
    s_add_u32 m0, s39, 86016
    s_nop 0
    global_load_lds_dwordx4 v12, s[32:33] offset:1024 sc1
    v_mfma_f32_16x16x32_bf16 v[192:195], v[28:31], a[4:7], v[192:195]
    v_mfma_f32_16x16x32_bf16 v[196:199], v[28:31], a[60:63], v[196:199]
    ds_read_b128 v[84:87], v6 offset:15360
    v_mfma_f32_16x16x32_bf16 v[200:203], v[28:31], a[116:119], v[200:203]
    v_mfma_f32_16x16x32_bf16 v[204:207], v[28:31], a[172:175], v[204:207]
    s_add_u32 m0, s39, 86016
    s_nop 0
    global_load_lds_dwordx4 v12, s[32:33] offset:2048 sc1
    s_add_u32 m0, s39, 86016
    s_nop 0
    global_load_lds_dwordx4 v12, s[32:33] offset:3072 sc1
    v_mfma_f32_16x16x32_bf16 v[192:195], v[32:35], a[8:11], v[192:195]
    v_mfma_f32_16x16x32_bf16 v[196:199], v[32:35], a[64:67], v[196:199]
    ds_read_b128 v[88:91], v6 offset:16384
    v_mfma_f32_16x16x32_bf16 v[200:203], v[32:35], a[120:123], v[200:203]
    v_mfma_f32_16x16x32_bf16 v[204:207], v[32:35], a[176:179], v[204:207]
    s_add_u32 m0, s39, 90112
    s_nop 0
    global_load_lds_dwordx4 v13, s[32:33] offset:0 sc1
    s_add_u32 m0, s39, 90112
    s_nop 0
    global_load_lds_dwordx4 v13, s[32:33] offset:1024 sc1
    v_mfma_f32_16x16x32_bf16 v[192:195], v[36:39], a[12:15], v[192:195]
    v_mfma_f32_16x16x32_bf16 v[196:199], v[36:39], a[68:71], v[196:199]
    ds_read_b128 v[92:95], v6 offset:17408
    v_mfma_f32_16x16x32_bf16 v[200:203], v[36:39], a[124:127], v[200:203]
    v_mfma_f32_16x16x32_bf16 v[204:207], v[36:39], a[180:183], v[204:207]
    s_add_u32 m0, s39, 90112
    s_nop 0
    global_load_lds_dwordx4 v13, s[32:33] offset:2048 sc1
    s_add_u32 s32, s32, 0x7000
    s_addc_u32 s33, s33, 0
    v_mfma_f32_16x16x32_bf16 v[192:195], v[40:43], a[16:19], v[192:195]
    v_mfma_f32_16x16x32_bf16 v[196:199], v[40:43], a[72:75], v[196:199]
    ds_read_b128 v[96:99], v6 offset:18432
    v_mfma_f32_16x16x32_bf16 v[200:203], v[40:43], a[128:131], v[200:203]
    v_mfma_f32_16x16x32_bf16 v[204:207], v[40:43], a[184:187], v[204:207]
    v_mfma_f32_16x16x32_bf16 v[192:195], v[44:47], a[20:23], v[192:195]
    v_mfma_f32_16x16x32_bf16 v[196:199], v[44:47], a[76:79], v[196:199]
    ds_read_b128 v[100:103], v6 offset:19456
    v_mfma_f32_16x16x32_bf16 v[200:203], v[44:47], a[132:135], v[200:203]
    v_mfma_f32_16x16x32_bf16 v[204:207], v[44:47], a[188:191], v[204:207]
    v_mfma_f32_16x16x32_bf16 v[192:195], v[48:51], a[24:27], v[192:195]
    v_mfma_f32_16x16x32_bf16 v[196:199], v[48:51], a[80:83], v[196:199]
    ds_read_b128 v[104:107], v6 offset:20480
    v_mfma_f32_16x16x32_bf16 v[200:203], v[48:51], a[136:139], v[200:203]
    v_mfma_f32_16x16x32_bf16 v[204:207], v[48:51], a[192:195], v[204:207]
    v_mfma_f32_16x16x32_bf16 v[192:195], v[52:55], a[28:31], v[192:195]
    v_mfma_f32_16x16x32_bf16 v[196:199], v[52:55], a[84:87], v[196:199]
    ds_read_b128 v[108:111], v6 offset:21504
    v_mfma_f32_16x16x32_bf16 v[200:203], v[52:55], a[140:143], v[200:203]
    v_mfma_f32_16x16x32_bf16 v[204:207], v[52:55], a[196:199], v[204:207]
    v_mfma_f32_16x16x32_bf16 v[192:195], v[56:59], a[32:35], v[192:195]
    v_mfma_f32_16x16x32_bf16 v[196:199], v[56:59], a[88:91], v[196:199]
    ds_read_b128 v[112:115], v6 offset:22528
    v_mfma_f32_16x16x32_bf16 v[200:203], v[56:59], a[144:147], v[200:203]
    v_mfma_f32_16x16x32_bf16 v[204:207], v[56:59], a[200:203], v[204:207]
    v_mfma_f32_16x16x32_bf16 v[192:195], v[60:63], a[36:39], v[192:195]
    v_mfma_f32_16x16x32_bf16 v[196:199], v[60:63], a[92:95], v[196:199]
    ds_read_b128 v[116:119], v6 offset:23552
    v_mfma_f32_16x16x32_bf16 v[200:203], v[60:63], a[148:151], v[200:203]
    v_mfma_f32_16x16x32_bf16 v[204:207], v[60:63], a[204:207], v[204:207]
    v_mfma_f32_16x16x32_bf16 v[192:195], v[64:67], a[40:43], v[192:195]
    v_mfma_f32_16x16x32_bf16 v[196:199], v[64:67], a[96:99], v[196:199]
    ds_read_b128 v[120:123], v6 offset:24576
    v_mfma_f32_16x16x32_bf16 v[200:203], v[64:67], a[152:155], v[200:203]
    v_mfma_f32_16x16x32_bf16 v[204:207], v[64:67], a[208:211], v[204:207]
    v_mfma_f32_16x16x32_bf16 v[192:195], v[68:71], a[44:47], v[192:195]
    v_mfma_f32_16x16x32_bf16 v[196:199], v[68:71], a[100:103], v[196:199]
    ds_read_b128 v[124:127], v6 offset:25600
    v_mfma_f32_16x16x32_bf16 v[200:203], v[68:71], a[156:159], v[200:203]
    v_mfma_f32_16x16x32_bf16 v[204:207], v[68:71], a[212:215], v[204:207]
    v_mfma_f32_16x16x32_bf16 v[192:195], v[72:75], a[48:51], v[192:195]
    v_mfma_f32_16x16x32_bf16 v[196:199], v[72:75], a[104:107], v[196:199]
    ds_read_b128 v[128:131], v6 offset:26624
    v_mfma_f32_16x16x32_bf16 v[200:203], v[72:75], a[160:163], v[200:203]
    v_mfma_f32_16x16x32_bf16 v[204:207], v[72:75], a[216:219], v[204:207]
    v_mfma_f32_16x16x32_bf16 v[192:195], v[76:79], a[52:55], v[192:195]
    v_mfma_f32_16x16x32_bf16 v[196:199], v[76:79], a[108:111], v[196:199]
    ds_read_b128 v[132:135], v6 offset:27648
    v_mfma_f32_16x16x32_bf16 v[200:203], v[76:79], a[164:167], v[200:203]
    v_mfma_f32_16x16x32_bf16 v[204:207], v[76:79], a[220:223], v[204:207]
    s_waitcnt lgkmcnt(0)
    s_waitcnt vmcnt(14)
    s_barrier
    v_mfma_f32_16x16x32_bf16 v[208:211], v[80:83], a[0:3], 0
    v_mfma_f32_16x16x32_bf16 v[212:215], v[80:83], a[56:59], 0
    ds_read_b128 v[136:139], v6 offset:28672
    v_mfma_f32_16x16x32_bf16 v[216:219], v[80:83], a[112:115], 0
    v_mfma_f32_16x16x32_bf16 v[220:223], v[80:83], a[168:171], 0
    v_mfma_f32_16x16x32_bf16 v[208:211], v[84:87], a[4:7], v[208:211]
    v_mfma_f32_16x16x32_bf16 v[212:215], v[84:87], a[60:63], v[212:215]
    ds_read_b128 v[140:143], v6 offset:29696
    v_mfma_f32_16x16x32_bf16 v[216:219], v[84:87], a[116:119], v[216:219]
    v_mfma_f32_16x16x32_bf16 v[220:223], v[84:87], a[172:175], v[220:223]
    v_mfma_f32_16x16x32_bf16 v[208:211], v[88:91], a[8:11], v[208:211]
    v_mfma_f32_16x16x32_bf16 v[212:215], v[88:91], a[64:67], v[212:215]
    ds_read_b128 v[144:147], v6 offset:30720
    v_mfma_f32_16x16x32_bf16 v[216:219], v[88:91], a[120:123], v[216:219]
    v_mfma_f32_16x16x32_bf16 v[220:223], v[88:91], a[176:179], v[220:223]
    v_mfma_f32_16x16x32_bf16 v[208:211], v[92:95], a[12:15], v[208:211]
    v_mfma_f32_16x16x32_bf16 v[212:215], v[92:95], a[68:71], v[212:215]
    ds_read_b128 v[148:151], v6 offset:31744
    v_mfma_f32_16x16x32_bf16 v[216:219], v[92:95], a[124:127], v[216:219]
    v_mfma_f32_16x16x32_bf16 v[220:223], v[92:95], a[180:183], v[220:223]
    v_mfma_f32_16x16x32_bf16 v[208:211], v[96:99], a[16:19], v[208:211]
    v_mfma_f32_16x16x32_bf16 v[212:215], v[96:99], a[72:75], v[212:215]
    ds_read_b128 v[152:155], v6 offset:32768
    v_mfma_f32_16x16x32_bf16 v[216:219], v[96:99], a[128:131], v[216:219]
    v_mfma_f32_16x16x32_bf16 v[220:223], v[96:99], a[184:187], v[220:223]
    v_mfma_f32_16x16x32_bf16 v[208:211], v[100:103], a[20:23], v[208:211]
    v_mfma_f32_16x16x32_bf16 v[212:215], v[100:103], a[76:79], v[212:215]
    ds_read_b128 v[156:159], v6 offset:33792
    v_mfma_f32_16x16x32_bf16 v[216:219], v[100:103], a[132:135], v[216:219]
    v_mfma_f32_16x16x32_bf16 v[220:223], v[100:103], a[188:191], v[220:223]
    v_mfma_f32_16x16x32_bf16 v[208:211], v[104:107], a[24:27], v[208:211]
    v_mfma_f32_16x16x32_bf16 v[212:215], v[104:107], a[80:83], v[212:215]
    ds_read_b128 v[160:163], v6 offset:34816
    v_mfma_f32_16x16x32_bf16 v[216:219], v[104:107], a[136:139], v[216:219]
    v_mfma_f32_16x16x32_bf16 v[220:223], v[104:107], a[192:195], v[220:223]
    v_mfma_f32_16x16x32_bf16 v[208:211], v[108:111], a[28:31], v[208:211]
    v_mfma_f32_16x16x32_bf16 v[212:215], v[108:111], a[84:87], v[212:215]
    ds_read_b128 v[164:167], v6 offset:35840
    v_mfma_f32_16x16x32_bf16 v[216:219], v[108:111], a[140:143], v[216:219]
    v_mfma_f32_16x16x32_bf16 v[220:223], v[108:111], a[196:199], v[220:223]
    v_mfma_f32_16x16x32_bf16 v[208:211], v[112:115], a[32:35], v[208:211]
    v_mfma_f32_16x16x32_bf16 v[212:215], v[112:115], a[88:91], v[212:215]
    ds_read_b128 v[168:171], v6 offset:36864
    v_mfma_f32_16x16x32_bf16 v[216:219], v[112:115], a[144:147], v[216:219]
    v_mfma_f32_16x16x32_bf16 v[220:223], v[112:115], a[200:203], v[220:223]
    v_mfma_f32_16x16x32_bf16 v[208:211], v[116:119], a[36:39], v[208:211]
    v_mfma_f32_16x16x32_bf16 v[212:215], v[116:119], a[92:95], v[212:215]
    ds_read_b128 v[172:175], v6 offset:37888
    v_mfma_f32_16x16x32_bf16 v[216:219], v[116:119], a[148:151], v[216:219]
    v_mfma_f32_16x16x32_bf16 v[220:223], v[116:119], a[204:207], v[220:223]
    v_mfma_f32_16x16x32_bf16 v[208:211], v[120:123], a[40:43], v[208:211]
    v_mfma_f32_16x16x32_bf16 v[212:215], v[120:123], a[96:99], v[212:215]
    ds_read_b128 v[176:179], v6 offset:38912
    v_mfma_f32_16x16x32_bf16 v[216:219], v[120:123], a[152:155], v[216:219]
    v_mfma_f32_16x16x32_bf16 v[220:223], v[120:123], a[208:211], v[220:223]
    v_mfma_f32_16x16x32_bf16 v[208:211], v[124:127], a[44:47], v[208:211]
    v_mfma_f32_16x16x32_bf16 v[212:215], v[124:127], a[100:103], v[212:215]
    ds_read_b128 v[180:183], v6 offset:39936
    v_mfma_f32_16x16x32_bf16 v[216:219], v[124:127], a[156:159], v[216:219]
    v_mfma_f32_16x16x32_bf16 v[220:223], v[124:127], a[212:215], v[220:223]
    v_mfma_f32_16x16x32_bf16 v[208:211], v[128:131], a[48:51], v[208:211]
    v_mfma_f32_16x16x32_bf16 v[212:215], v[128:131], a[104:107], v[212:215]
    ds_read_b128 v[184:187], v6 offset:40960
    v_mfma_f32_16x16x32_bf16 v[216:219], v[128:131], a[160:163], v[216:219]
    v_mfma_f32_16x16x32_bf16 v[220:223], v[128:131], a[216:219], v[220:223]
    v_mfma_f32_16x16x32_bf16 v[208:211], v[132:135], a[52:55], v[208:211]
    v_mfma_f32_16x16x32_bf16 v[212:215], v[132:135], a[108:111], v[212:215]
    ds_read_b128 v[188:191], v6 offset:41984
    v_mfma_f32_16x16x32_bf16 v[216:219], v[132:135], a[164:167], v[216:219]
    v_mfma_f32_16x16x32_bf16 v[220:223], v[132:135], a[220:223], v[220:223]
    s_waitcnt lgkmcnt(0)
    v_mfma_f32_16x16x32_bf16 v[224:227], v[136:139], a[0:3], 0
    v_mfma_f32_16x16x32_bf16 v[228:231], v[136:139], a[56:59], 0
    ds_read_b128 v[24:27], v6 offset:43008
    v_mfma_f32_16x16x32_bf16 v[232:235], v[136:139], a[112:115], 0
    v_mfma_f32_16x16x32_bf16 v[236:239], v[136:139], a[168:171], 0
    v_mfma_f32_16x16x32_bf16 v[224:227], v[140:143], a[4:7], v[224:227]
    v_mfma_f32_16x16x32_bf16 v[228:231], v[140:143], a[60:63], v[228:231]
    ds_read_b128 v[28:31], v6 offset:44032
    v_mfma_f32_16x16x32_bf16 v[232:235], v[140:143], a[116:119], v[232:235]
    v_mfma_f32_16x16x32_bf16 v[236:239], v[140:143], a[172:175], v[236:239]
    v_mfma_f32_16x16x32_bf16 v[224:227], v[144:147], a[8:11], v[224:227]
    v_mfma_f32_16x16x32_bf16 v[228:231], v[144:147], a[64:67], v[228:231]
    ds_read_b128 v[32:35], v6 offset:45056
    v_mfma_f32_16x16x32_bf16 v[232:235], v[144:147], a[120:123], v[232:235]
    v_mfma_f32_16x16x32_bf16 v[236:239], v[144:147], a[176:179], v[236:239]
    v_mfma_f32_16x16x32_bf16 v[224:227], v[148:151], a[12:15], v[224:227]
    v_mfma_f32_16x16x32_bf16 v[228:231], v[148:151], a[68:71], v[228:231]
    ds_read_b128 v[36:39], v6 offset:46080
    v_mfma_f32_16x16x32_bf16 v[232:235], v[148:151], a[124:127], v[232:235]
    v_mfma_f32_16x16x32_bf16 v[236:239], v[148:151], a[180:183], v[236:239]
    v_mfma_f32_16x16x32_bf16 v[224:227], v[152:155], a[16:19], v[224:227]
    v_mfma_f32_16x16x32_bf16 v[228:231], v[152:155], a[72:75], v[228:231]
    ds_read_b128 v[40:43], v6 offset:47104
    v_mfma_f32_16x16x32_bf16 v[232:235], v[152:155], a[128:131], v[232:235]
    v_mfma_f32_16x16x32_bf16 v[236:239], v[152:155], a[184:187], v[236:239]
    v_mfma_f32_16x16x32_bf16 v[224:227], v[156:159], a[20:23], v[224:227]
    v_mfma_f32_16x16x32_bf16 v[228:231], v[156:159], a[76:79], v[228:231]
    ds_read_b128 v[44:47], v6 offset:48128
    v_mfma_f32_16x16x32_bf16 v[232:235], v[156:159], a[132:135], v[232:235]
    v_mfma_f32_16x16x32_bf16 v[236:239], v[156:159], a[188:191], v[236:239]
    v_mfma_f32_16x16x32_bf16 v[224:227], v[160:163], a[24:27], v[224:227]
    v_mfma_f32_16x16x32_bf16 v[228:231], v[160:163], a[80:83], v[228:231]
    ds_read_b128 v[48:51], v6 offset:49152
    v_mfma_f32_16x16x32_bf16 v[232:235], v[160:163], a[136:139], v[232:235]
    v_mfma_f32_16x16x32_bf16 v[236:239], v[160:163], a[192:195], v[236:239]
    v_mfma_f32_16x16x32_bf16 v[224:227], v[164:167], a[28:31], v[224:227]
    v_mfma_f32_16x16x32_bf16 v[228:231], v[164:167], a[84:87], v[228:231]
    ds_read_b128 v[52:55], v6 offset:50176
    v_mfma_f32_16x16x32_bf16 v[232:235], v[164:167], a[140:143], v[232:235]
    v_mfma_f32_16x16x32_bf16 v[236:239], v[164:167], a[196:199], v[236:239]
    v_mfma_f32_16x16x32_bf16 v[224:227], v[168:171], a[32:35], v[224:227]
    v_mfma_f32_16x16x32_bf16 v[228:231], v[168:171], a[88:91], v[228:231]
    ds_read_b128 v[56:59], v6 offset:51200
    v_mfma_f32_16x16x32_bf16 v[232:235], v[168:171], a[144:147], v[232:235]
    v_mfma_f32_16x16x32_bf16 v[236:239], v[168:171], a[200:203], v[236:239]
    v_mfma_f32_16x16x32_bf16 v[224:227], v[172:175], a[36:39], v[224:227]
    v_mfma_f32_16x16x32_bf16 v[228:231], v[172:175], a[92:95], v[228:231]
    ds_read_b128 v[60:63], v6 offset:52224
    v_mfma_f32_16x16x32_bf16 v[232:235], v[172:175], a[148:151], v[232:235]
    v_mfma_f32_16x16x32_bf16 v[236:239], v[172:175], a[204:207], v[236:239]
    v_mfma_f32_16x16x32_bf16 v[224:227], v[176:179], a[40:43], v[224:227]
    v_mfma_f32_16x16x32_bf16 v[228:231], v[176:179], a[96:99], v[228:231]
    ds_read_b128 v[64:67], v6 offset:53248
    v_mfma_f32_16x16x32_bf16 v[232:235], v[176:179], a[152:155], v[232:235]
    v_mfma_f32_16x16x32_bf16 v[236:239], v[176:179], a[208:211], v[236:239]
    v_mfma_f32_16x16x32_bf16 v[224:227], v[180:183], a[44:47], v[224:227]
    v_mfma_f32_16x16x32_bf16 v[228:231], v[180:183], a[100:103], v[228:231]
    ds_read_b128 v[68:71], v6 offset:54272
    v_mfma_f32_16x16x32_bf16 v[232:235], v[180:183], a[156:159], v[232:235]
    v_mfma_f32_16x16x32_bf16 v[236:239], v[180:183], a[212:215], v[236:239]
    v_mfma_f32_16x16x32_bf16 v[224:227], v[184:187], a[48:51], v[224:227]
    v_mfma_f32_16x16x32_bf16 v[228:231], v[184:187], a[104:107], v[228:231]
    ds_read_b128 v[72:75], v6 offset:55296
    v_mfma_f32_16x16x32_bf16 v[232:235], v[184:187], a[160:163], v[232:235]
    v_mfma_f32_16x16x32_bf16 v[236:239], v[184:187], a[216:219], v[236:239]
    v_mfma_f32_16x16x32_bf16 v[224:227], v[188:191], a[52:55], v[224:227]
    v_mfma_f32_16x16x32_bf16 v[228:231], v[188:191], a[108:111], v[228:231]
    ds_read_b128 v[76:79], v6 offset:56320
    v_mfma_f32_16x16x32_bf16 v[232:235], v[188:191], a[164:167], v[232:235]
    v_mfma_f32_16x16x32_bf16 v[236:239], v[188:191], a[220:223], v[236:239]
    s_waitcnt lgkmcnt(0)
    s_waitcnt vmcnt(7)
    s_barrier
    v_mfma_f32_16x16x32_bf16 v[240:243], v[24:27], a[0:3], 0
    v_mfma_f32_16x16x32_bf16 v[244:247], v[24:27], a[56:59], 0
    ds_read_b128 v[80:83], v7 offset:0
    v_mfma_f32_16x16x32_bf16 v[248:251], v[24:27], a[112:115], 0
    v_mfma_f32_16x16x32_bf16 v[252:255], v[24:27], a[168:171], 0
    v_mfma_f32_16x16x32_bf16 v[240:243], v[28:31], a[4:7], v[240:243]
    v_mfma_f32_16x16x32_bf16 v[244:247], v[28:31], a[60:63], v[244:247]
    ds_read_b128 v[84:87], v7 offset:1024
    v_mfma_f32_16x16x32_bf16 v[248:251], v[28:31], a[116:119], v[248:251]
    v_mfma_f32_16x16x32_bf16 v[252:255], v[28:31], a[172:175], v[252:255]
    v_mfma_f32_16x16x32_bf16 v[240:243], v[32:35], a[8:11], v[240:243]
    v_mfma_f32_16x16x32_bf16 v[244:247], v[32:35], a[64:67], v[244:247]
    ds_read_b128 v[88:91], v7 offset:2048
    v_mfma_f32_16x16x32_bf16 v[248:251], v[32:35], a[120:123], v[248:251]
    v_mfma_f32_16x16x32_bf16 v[252:255], v[32:35], a[176:179], v[252:255]
    v_mfma_f32_16x16x32_bf16 v[240:243], v[36:39], a[12:15], v[240:243]
    v_mfma_f32_16x16x32_bf16 v[244:247], v[36:39], a[68:71], v[244:247]
    ds_read_b128 v[92:95], v7 offset:3072
    v_mfma_f32_16x16x32_bf16 v[248:251], v[36:39], a[124:127], v[248:251]
    v_mfma_f32_16x16x32_bf16 v[252:255], v[36:39], a[180:183], v[252:255]
    v_mfma_f32_16x16x32_bf16 v[240:243], v[40:43], a[16:19], v[240:243]
    v_mfma_f32_16x16x32_bf16 v[244:247], v[40:43], a[72:75], v[244:247]
    ds_read_b128 v[96:99], v7 offset:4096
    v_mfma_f32_16x16x32_bf16 v[248:251], v[40:43], a[128:131], v[248:251]
    v_mfma_f32_16x16x32_bf16 v[252:255], v[40:43], a[184:187], v[252:255]
    v_mfma_f32_16x16x32_bf16 v[240:243], v[44:47], a[20:23], v[240:243]
    v_mfma_f32_16x16x32_bf16 v[244:247], v[44:47], a[76:79], v[244:247]
    ds_read_b128 v[100:103], v7 offset:5120
    v_mfma_f32_16x16x32_bf16 v[248:251], v[44:47], a[132:135], v[248:251]
    v_mfma_f32_16x16x32_bf16 v[252:255], v[44:47], a[188:191], v[252:255]
    v_mfma_f32_16x16x32_bf16 v[240:243], v[48:51], a[24:27], v[240:243]
    v_mfma_f32_16x16x32_bf16 v[244:247], v[48:51], a[80:83], v[244:247]
    ds_read_b128 v[104:107], v7 offset:6144
    v_mfma_f32_16x16x32_bf16 v[248:251], v[48:51], a[136:139], v[248:251]
    v_mfma_f32_16x16x32_bf16 v[252:255], v[48:51], a[192:195], v[252:255]
    v_mfma_f32_16x16x32_bf16 v[240:243], v[52:55], a[28:31], v[240:243]
    v_mfma_f32_16x16x32_bf16 v[244:247], v[52:55], a[84:87], v[244:247]
    ds_read_b128 v[108:111], v7 offset:7168
    v_mfma_f32_16x16x32_bf16 v[248:251], v[52:55], a[140:143], v[248:251]
    v_mfma_f32_16x16x32_bf16 v[252:255], v[52:55], a[196:199], v[252:255]
    v_mfma_f32_16x16x32_bf16 v[240:243], v[56:59], a[32:35], v[240:243]
    v_mfma_f32_16x16x32_bf16 v[244:247], v[56:59], a[88:91], v[244:247]
    ds_read_b128 v[112:115], v7 offset:8192
    v_mfma_f32_16x16x32_bf16 v[248:251], v[56:59], a[144:147], v[248:251]
    v_mfma_f32_16x16x32_bf16 v[252:255], v[56:59], a[200:203], v[252:255]
    v_mfma_f32_16x16x32_bf16 v[240:243], v[60:63], a[36:39], v[240:243]
    v_mfma_f32_16x16x32_bf16 v[244:247], v[60:63], a[92:95], v[244:247]
    ds_read_b128 v[116:119], v7 offset:9216
    v_mfma_f32_16x16x32_bf16 v[248:251], v[60:63], a[148:151], v[248:251]
    v_mfma_f32_16x16x32_bf16 v[252:255], v[60:63], a[204:207], v[252:255]
    v_mfma_f32_16x16x32_bf16 v[240:243], v[64:67], a[40:43], v[240:243]
    v_mfma_f32_16x16x32_bf16 v[244:247], v[64:67], a[96:99], v[244:247]
    ds_read_b128 v[120:123], v7 offset:10240
    v_mfma_f32_16x16x32_bf16 v[248:251], v[64:67], a[152:155], v[248:251]
    v_mfma_f32_16x16x32_bf16 v[252:255], v[64:67], a[208:211], v[252:255]
    v_mfma_f32_16x16x32_bf16 v[240:243], v[68:71], a[44:47], v[240:243]
    v_mfma_f32_16x16x32_bf16 v[244:247], v[68:71], a[100:103], v[244:247]
    ds_read_b128 v[124:127], v7 offset:11264
    v_mfma_f32_16x16x32_bf16 v[248:251], v[68:71], a[156:159], v[248:251]
    v_mfma_f32_16x16x32_bf16 v[252:255], v[68:71], a[212:215], v[252:255]
    v_mfma_f32_16x16x32_bf16 v[240:243], v[72:75], a[48:51], v[240:243]
    v_mfma_f32_16x16x32_bf16 v[244:247], v[72:75], a[104:107], v[244:247]
    ds_read_b128 v[128:131], v7 offset:12288
    v_mfma_f32_16x16x32_bf16 v[248:251], v[72:75], a[160:163], v[248:251]
    v_mfma_f32_16x16x32_bf16 v[252:255], v[72:75], a[216:219], v[252:255]
    v_mfma_f32_16x16x32_bf16 v[240:243], v[76:79], a[52:55], v[240:243]
    v_mfma_f32_16x16x32_bf16 v[244:247], v[76:79], a[108:111], v[244:247]
    ds_read_b128 v[132:135], v7 offset:13312
    v_mfma_f32_16x16x32_bf16 v[248:251], v[76:79], a[164:167], v[248:251]
    v_mfma_f32_16x16x32_bf16 v[252:255], v[76:79], a[220:223], v[252:255]
    s_nop 7
    v_mul_f32 v20, s38, v192
    v_exp_f32 v20, -v20
    v_mul_f32 v224, v224, v192
    v_add_f32 v20, 1.0, v20
    v_rcp_f32 v20, v20
    s_nop 0
    v_mul_f32 v224, v224, v20
    v_mul_f32 v21, s38, v193
    v_exp_f32 v21, -v21
    v_mul_f32 v225, v225, v193
    v_add_f32 v21, 1.0, v21
    v_rcp_f32 v21, v21
    s_nop 0
    v_mul_f32 v225, v225, v21
    v_mul_f32 v22, s38, v194
    v_exp_f32 v22, -v22
    v_mul_f32 v226, v226, v194
    v_add_f32 v22, 1.0, v22
    v_rcp_f32 v22, v22
    s_nop 0
    v_mul_f32 v226, v226, v22
    v_mul_f32 v23, s38, v195
    v_exp_f32 v23, -v23
    v_mul_f32 v227, v227, v195
    v_add_f32 v23, 1.0, v23
    v_rcp_f32 v23, v23
    s_nop 0
    v_mul_f32 v227, v227, v23
    v_mul_f32 v20, s38, v208
    v_exp_f32 v20, -v20
    v_mul_f32 v240, v240, v208
    v_add_f32 v20, 1.0, v20
    v_rcp_f32 v20, v20
    s_nop 0
    v_mul_f32 v240, v240, v20
    v_mul_f32 v21, s38, v209
    v_exp_f32 v21, -v21
    v_mul_f32 v241, v241, v209
    v_add_f32 v21, 1.0, v21
    v_rcp_f32 v21, v21
    s_nop 0
    v_mul_f32 v241, v241, v21
    v_mul_f32 v22, s38, v210
    v_exp_f32 v22, -v22
    v_mul_f32 v242, v242, v210
    v_add_f32 v22, 1.0, v22
    v_rcp_f32 v22, v22
    s_nop 0
    v_mul_f32 v242, v242, v22
    v_mul_f32 v23, s38, v211
    v_exp_f32 v23, -v23
    v_mul_f32 v243, v243, v211
    v_add_f32 v23, 1.0, v23
    v_rcp_f32 v23, v23
    s_nop 0
    v_mul_f32 v243, v243, v23
    v_cvt_pk_bf16_f32 v192, v224, v225
    v_cvt_pk_bf16_f32 v193, v226, v227
    v_cvt_pk_bf16_f32 v194, v240, v241
    v_cvt_pk_bf16_f32 v195, v242, v243
    global_store_dwordx4 v16, v[192:195], s[34:35] offset:0 sc1
    v_mul_f32 v20, s38, v196
    v_exp_f32 v20, -v20
    v_mul_f32 v228, v228, v196
    v_add_f32 v20, 1.0, v20
    v_rcp_f32 v20, v20
    s_nop 0
    v_mul_f32 v228, v228, v20
    v_mul_f32 v21, s38, v197
    v_exp_f32 v21, -v21
    v_mul_f32 v229, v229, v197
    v_add_f32 v21, 1.0, v21
    v_rcp_f32 v21, v21
    s_nop 0
    v_mul_f32 v229, v229, v21
    v_mul_f32 v22, s38, v198
    v_exp_f32 v22, -v22
    v_mul_f32 v230, v230, v198
    v_add_f32 v22, 1.0, v22
    v_rcp_f32 v22, v22
    s_nop 0
    v_mul_f32 v230, v230, v22
    v_mul_f32 v23, s38, v199
    v_exp_f32 v23, -v23
    v_mul_f32 v231, v231, v199
    v_add_f32 v23, 1.0, v23
    v_rcp_f32 v23, v23
    s_nop 0
    v_mul_f32 v231, v231, v23
    v_mul_f32 v20, s38, v212
    v_exp_f32 v20, -v20
    v_mul_f32 v244, v244, v212
    v_add_f32 v20, 1.0, v20
    v_rcp_f32 v20, v20
    s_nop 0
    v_mul_f32 v244, v244, v20
    v_mul_f32 v21, s38, v213
    v_exp_f32 v21, -v21
    v_mul_f32 v245, v245, v213
    v_add_f32 v21, 1.0, v21
    v_rcp_f32 v21, v21
    s_nop 0
    v_mul_f32 v245, v245, v21
    v_mul_f32 v22, s38, v214
    v_exp_f32 v22, -v22
    v_mul_f32 v246, v246, v214
    v_add_f32 v22, 1.0, v22
    v_rcp_f32 v22, v22
    s_nop 0
    v_mul_f32 v246, v246, v22
    v_mul_f32 v23, s38, v215
    v_exp_f32 v23, -v23
    v_mul_f32 v247, v247, v215
    v_add_f32 v23, 1.0, v23
    v_rcp_f32 v23, v23
    s_nop 0
    v_mul_f32 v247, v247, v23
    v_cvt_pk_bf16_f32 v196, v228, v229
    v_cvt_pk_bf16_f32 v197, v230, v231
    v_cvt_pk_bf16_f32 v198, v244, v245
    v_cvt_pk_bf16_f32 v199, v246, v247
    global_store_dwordx4 v17, v[196:199], s[34:35] offset:0 sc1
    v_mul_f32 v20, s38, v200
    v_exp_f32 v20, -v20
    v_mul_f32 v232, v232, v200
    v_add_f32 v20, 1.0, v20
    v_rcp_f32 v20, v20
    s_nop 0
    v_mul_f32 v232, v232, v20
    v_mul_f32 v21, s38, v201
    v_exp_f32 v21, -v21
    v_mul_f32 v233, v233, v201
    v_add_f32 v21, 1.0, v21
    v_rcp_f32 v21, v21
    s_nop 0
    v_mul_f32 v233, v233, v21
    v_mul_f32 v22, s38, v202
    v_exp_f32 v22, -v22
    v_mul_f32 v234, v234, v202
    v_add_f32 v22, 1.0, v22
    v_rcp_f32 v22, v22
    s_nop 0
    v_mul_f32 v234, v234, v22
    v_mul_f32 v23, s38, v203
    v_exp_f32 v23, -v23
    v_mul_f32 v235, v235, v203
    v_add_f32 v23, 1.0, v23
    v_rcp_f32 v23, v23
    s_nop 0
    v_mul_f32 v235, v235, v23
    v_mul_f32 v20, s38, v216
    v_exp_f32 v20, -v20
    v_mul_f32 v248, v248, v216
    v_add_f32 v20, 1.0, v20
    v_rcp_f32 v20, v20
    s_nop 0
    v_mul_f32 v248, v248, v20
    v_mul_f32 v21, s38, v217
    v_exp_f32 v21, -v21
    v_mul_f32 v249, v249, v217
    v_add_f32 v21, 1.0, v21
    v_rcp_f32 v21, v21
    s_nop 0
    v_mul_f32 v249, v249, v21
    v_mul_f32 v22, s38, v218
    v_exp_f32 v22, -v22
    v_mul_f32 v250, v250, v218
    v_add_f32 v22, 1.0, v22
    v_rcp_f32 v22, v22
    s_nop 0
    v_mul_f32 v250, v250, v22
    v_mul_f32 v23, s38, v219
    v_exp_f32 v23, -v23
    v_mul_f32 v251, v251, v219
    v_add_f32 v23, 1.0, v23
    v_rcp_f32 v23, v23
    s_nop 0
    v_mul_f32 v251, v251, v23
    v_cvt_pk_bf16_f32 v200, v232, v233
    v_cvt_pk_bf16_f32 v201, v234, v235
    v_cvt_pk_bf16_f32 v202, v248, v249
    v_cvt_pk_bf16_f32 v203, v250, v251
    global_store_dwordx4 v18, v[200:203], s[34:35] offset:0 sc1
    v_mul_f32 v20, s38, v204
    v_exp_f32 v20, -v20
    v_mul_f32 v236, v236, v204
    v_add_f32 v20, 1.0, v20
    v_rcp_f32 v20, v20
    s_nop 0
    v_mul_f32 v236, v236, v20
    v_mul_f32 v21, s38, v205
    v_exp_f32 v21, -v21
    v_mul_f32 v237, v237, v205
    v_add_f32 v21, 1.0, v21
    v_rcp_f32 v21, v21
    s_nop 0
    v_mul_f32 v237, v237, v21
    v_mul_f32 v22, s38, v206
    v_exp_f32 v22, -v22
    v_mul_f32 v238, v238, v206
    v_add_f32 v22, 1.0, v22
    v_rcp_f32 v22, v22
    s_nop 0
    v_mul_f32 v238, v238, v22
    v_mul_f32 v23, s38, v207
    v_exp_f32 v23, -v23
    v_mul_f32 v239, v239, v207
    v_add_f32 v23, 1.0, v23
    v_rcp_f32 v23, v23
    s_nop 0
    v_mul_f32 v239, v239, v23
    v_mul_f32 v20, s38, v220
    v_exp_f32 v20, -v20
    v_mul_f32 v252, v252, v220
    v_add_f32 v20, 1.0, v20
    v_rcp_f32 v20, v20
    s_nop 0
    v_mul_f32 v252, v252, v20
    v_mul_f32 v21, s38, v221
    v_exp_f32 v21, -v21
    v_mul_f32 v253, v253, v221
    v_add_f32 v21, 1.0, v21
    v_rcp_f32 v21, v21
    s_nop 0
    v_mul_f32 v253, v253, v21
    v_mul_f32 v22, s38, v222
    v_exp_f32 v22, -v22
    v_mul_f32 v254, v254, v222
    v_add_f32 v22, 1.0, v22
    v_rcp_f32 v22, v22
    s_nop 0
    v_mul_f32 v254, v254, v22
    v_mul_f32 v23, s38, v223
    v_exp_f32 v23, -v23
    v_mul_f32 v255, v255, v223
    v_add_f32 v23, 1.0, v23
    v_rcp_f32 v23, v23
    s_nop 0
    v_mul_f32 v255, v255, v23
    v_cvt_pk_bf16_f32 v204, v236, v237
    v_cvt_pk_bf16_f32 v205, v238, v239
    v_cvt_pk_bf16_f32 v206, v252, v253
    v_cvt_pk_bf16_f32 v207, v254, v255
    global_store_dwordx4 v19, v[204:207], s[34:35] offset:0 sc1
    s_nop 1
    s_waitcnt lgkmcnt(0)
    v_mfma_f32_16x16x32_bf16 v[192:195], v[80:83], a[0:3], 0
    v_mfma_f32_16x16x32_bf16 v[196:199], v[80:83], a[56:59], 0
    ds_read_b128 v[136:139], v7 offset:14336
    v_mfma_f32_16x16x32_bf16 v[200:203], v[80:83], a[112:115], 0
    v_mfma_f32_16x16x32_bf16 v[204:207], v[80:83], a[168:171], 0
    v_mfma_f32_16x16x32_bf16 v[192:195], v[84:87], a[4:7], v[192:195]
    v_mfma_f32_16x16x32_bf16 v[196:199], v[84:87], a[60:63], v[196:199]
    ds_read_b128 v[140:143], v7 offset:15360
    v_mfma_f32_16x16x32_bf16 v[200:203], v[84:87], a[116:119], v[200:203]
    v_mfma_f32_16x16x32_bf16 v[204:207], v[84:87], a[172:175], v[204:207]
    v_mfma_f32_16x16x32_bf16 v[192:195], v[88:91], a[8:11], v[192:195]
    v_mfma_f32_16x16x32_bf16 v[196:199], v[88:91], a[64:67], v[196:199]
    ds_read_b128 v[144:147], v7 offset:16384
    v_mfma_f32_16x16x32_bf16 v[200:203], v[88:91], a[120:123], v[200:203]
    v_mfma_f32_16x16x32_bf16 v[204:207], v[88:91], a[176:179], v[204:207]
    v_mfma_f32_16x16x32_bf16 v[192:195], v[92:95], a[12:15], v[192:195]
    v_mfma_f32_16x16x32_bf16 v[196:199], v[92:95], a[68:71], v[196:199]
    ds_read_b128 v[148:151], v7 offset:17408
    v_mfma_f32_16x16x32_bf16 v[200:203], v[92:95], a[124:127], v[200:203]
    v_mfma_f32_16x16x32_bf16 v[204:207], v[92:95], a[180:183], v[204:207]
    v_mfma_f32_16x16x32_bf16 v[192:195], v[96:99], a[16:19], v[192:195]
    v_mfma_f32_16x16x32_bf16 v[196:199], v[96:99], a[72:75], v[196:199]
    ds_read_b128 v[152:155], v7 offset:18432
    v_mfma_f32_16x16x32_bf16 v[200:203], v[96:99], a[128:131], v[200:203]
    v_mfma_f32_16x16x32_bf16 v[204:207], v[96:99], a[184:187], v[204:207]
    v_mfma_f32_16x16x32_bf16 v[192:195], v[100:103], a[20:23], v[192:195]
    v_mfma_f32_16x16x32_bf16 v[196:199], v[100:103], a[76:79], v[196:199]
    ds_read_b128 v[156:159], v7 offset:19456
    v_mfma_f32_16x16x32_bf16 v[200:203], v[100:103], a[132:135], v[200:203]
    v_mfma_f32_16x16x32_bf16 v[204:207], v[100:103], a[188:191], v[204:207]
    v_mfma_f32_16x16x32_bf16 v[192:195], v[104:107], a[24:27], v[192:195]
    v_mfma_f32_16x16x32_bf16 v[196:199], v[104:107], a[80:83], v[196:199]
    ds_read_b128 v[160:163], v7 offset:20480
    v_mfma_f32_16x16x32_bf16 v[200:203], v[104:107], a[136:139], v[200:203]
    v_mfma_f32_16x16x32_bf16 v[204:207], v[104:107], a[192:195], v[204:207]
    v_mfma_f32_16x16x32_bf16 v[192:195], v[108:111], a[28:31], v[192:195]
    v_mfma_f32_16x16x32_bf16 v[196:199], v[108:111], a[84:87], v[196:199]
    ds_read_b128 v[164:167], v7 offset:21504
    v_mfma_f32_16x16x32_bf16 v[200:203], v[108:111], a[140:143], v[200:203]
    v_mfma_f32_16x16x32_bf16 v[204:207], v[108:111], a[196:199], v[204:207]
    v_mfma_f32_16x16x32_bf16 v[192:195], v[112:115], a[32:35], v[192:195]
    v_mfma_f32_16x16x32_bf16 v[196:199], v[112:115], a[88:91], v[196:199]
    ds_read_b128 v[168:171], v7 offset:22528
    v_mfma_f32_16x16x32_bf16 v[200:203], v[112:115], a[144:147], v[200:203]
    v_mfma_f32_16x16x32_bf16 v[204:207], v[112:115], a[200:203], v[204:207]
    v_mfma_f32_16x16x32_bf16 v[192:195], v[116:119], a[36:39], v[192:195]
    v_mfma_f32_16x16x32_bf16 v[196:199], v[116:119], a[92:95], v[196:199]
    ds_read_b128 v[172:175], v7 offset:23552
    v_mfma_f32_16x16x32_bf16 v[200:203], v[116:119], a[148:151], v[200:203]
    v_mfma_f32_16x16x32_bf16 v[204:207], v[116:119], a[204:207], v[204:207]
    v_mfma_f32_16x16x32_bf16 v[192:195], v[120:123], a[40:43], v[192:195]
    v_mfma_f32_16x16x32_bf16 v[196:199], v[120:123], a[96:99], v[196:199]
    ds_read_b128 v[176:179], v7 offset:24576
    v_mfma_f32_16x16x32_bf16 v[200:203], v[120:123], a[152:155], v[200:203]
    v_mfma_f32_16x16x32_bf16 v[204:207], v[120:123], a[208:211], v[204:207]
    v_mfma_f32_16x16x32_bf16 v[192:195], v[124:127], a[44:47], v[192:195]
    v_mfma_f32_16x16x32_bf16 v[196:199], v[124:127], a[100:103], v[196:199]
    ds_read_b128 v[180:183], v7 offset:25600
    v_mfma_f32_16x16x32_bf16 v[200:203], v[124:127], a[156:159], v[200:203]
    v_mfma_f32_16x16x32_bf16 v[204:207], v[124:127], a[212:215], v[204:207]
    v_mfma_f32_16x16x32_bf16 v[192:195], v[128:131], a[48:51], v[192:195]
    v_mfma_f32_16x16x32_bf16 v[196:199], v[128:131], a[104:107], v[196:199]
    ds_read_b128 v[184:187], v7 offset:26624
    v_mfma_f32_16x16x32_bf16 v[200:203], v[128:131], a[160:163], v[200:203]
    v_mfma_f32_16x16x32_bf16 v[204:207], v[128:131], a[216:219], v[204:207]
    v_mfma_f32_16x16x32_bf16 v[192:195], v[132:135], a[52:55], v[192:195]
    v_mfma_f32_16x16x32_bf16 v[196:199], v[132:135], a[108:111], v[196:199]
    ds_read_b128 v[188:191], v7 offset:27648
    v_mfma_f32_16x16x32_bf16 v[200:203], v[132:135], a[164:167], v[200:203]
    v_mfma_f32_16x16x32_bf16 v[204:207], v[132:135], a[220:223], v[204:207]
    s_waitcnt lgkmcnt(0)
    s_waitcnt vmcnt(4)
    s_barrier
    v_mfma_f32_16x16x32_bf16 v[208:211], v[136:139], a[0:3], 0
    v_mfma_f32_16x16x32_bf16 v[212:215], v[136:139], a[56:59], 0
    ds_read_b128 v[24:27], v7 offset:28672
    v_mfma_f32_16x16x32_bf16 v[216:219], v[136:139], a[112:115], 0
    v_mfma_f32_16x16x32_bf16 v[220:223], v[136:139], a[168:171], 0
    v_mfma_f32_16x16x32_bf16 v[208:211], v[140:143], a[4:7], v[208:211]
    v_mfma_f32_16x16x32_bf16 v[212:215], v[140:143], a[60:63], v[212:215]
    ds_read_b128 v[28:31], v7 offset:29696
    v_mfma_f32_16x16x32_bf16 v[216:219], v[140:143], a[116:119], v[216:219]
    v_mfma_f32_16x16x32_bf16 v[220:223], v[140:143], a[172:175], v[220:223]
    v_mfma_f32_16x16x32_bf16 v[208:211], v[144:147], a[8:11], v[208:211]
    v_mfma_f32_16x16x32_bf16 v[212:215], v[144:147], a[64:67], v[212:215]
    ds_read_b128 v[32:35], v7 offset:30720
    v_mfma_f32_16x16x32_bf16 v[216:219], v[144:147], a[120:123], v[216:219]
    v_mfma_f32_16x16x32_bf16 v[220:223], v[144:147], a[176:179], v[220:223]
    v_mfma_f32_16x16x32_bf16 v[208:211], v[148:151], a[12:15], v[208:211]
    v_mfma_f32_16x16x32_bf16 v[212:215], v[148:151], a[68:71], v[212:215]
    ds_read_b128 v[36:39], v7 offset:31744
    v_mfma_f32_16x16x32_bf16 v[216:219], v[148:151], a[124:127], v[216:219]
    v_mfma_f32_16x16x32_bf16 v[220:223], v[148:151], a[180:183], v[220:223]
    v_mfma_f32_16x16x32_bf16 v[208:211], v[152:155], a[16:19], v[208:211]
    v_mfma_f32_16x16x32_bf16 v[212:215], v[152:155], a[72:75], v[212:215]
    ds_read_b128 v[40:43], v7 offset:32768
    v_mfma_f32_16x16x32_bf16 v[216:219], v[152:155], a[128:131], v[216:219]
    v_mfma_f32_16x16x32_bf16 v[220:223], v[152:155], a[184:187], v[220:223]
    v_mfma_f32_16x16x32_bf16 v[208:211], v[156:159], a[20:23], v[208:211]
    v_mfma_f32_16x16x32_bf16 v[212:215], v[156:159], a[76:79], v[212:215]
    ds_read_b128 v[44:47], v7 offset:33792
    v_mfma_f32_16x16x32_bf16 v[216:219], v[156:159], a[132:135], v[216:219]
    v_mfma_f32_16x16x32_bf16 v[220:223], v[156:159], a[188:191], v[220:223]
    v_mfma_f32_16x16x32_bf16 v[208:211], v[160:163], a[24:27], v[208:211]
    v_mfma_f32_16x16x32_bf16 v[212:215], v[160:163], a[80:83], v[212:215]
    ds_read_b128 v[48:51], v7 offset:34816
    v_mfma_f32_16x16x32_bf16 v[216:219], v[160:163], a[136:139], v[216:219]
    v_mfma_f32_16x16x32_bf16 v[220:223], v[160:163], a[192:195], v[220:223]
    v_mfma_f32_16x16x32_bf16 v[208:211], v[164:167], a[28:31], v[208:211]
    v_mfma_f32_16x16x32_bf16 v[212:215], v[164:167], a[84:87], v[212:215]
    ds_read_b128 v[52:55], v7 offset:35840
    v_mfma_f32_16x16x32_bf16 v[216:219], v[164:167], a[140:143], v[216:219]
    v_mfma_f32_16x16x32_bf16 v[220:223], v[164:167], a[196:199], v[220:223]
    v_mfma_f32_16x16x32_bf16 v[208:211], v[168:171], a[32:35], v[208:211]
    v_mfma_f32_16x16x32_bf16 v[212:215], v[168:171], a[88:91], v[212:215]
    ds_read_b128 v[56:59], v7 offset:36864
    v_mfma_f32_16x16x32_bf16 v[216:219], v[168:171], a[144:147], v[216:219]
    v_mfma_f32_16x16x32_bf16 v[220:223], v[168:171], a[200:203], v[220:223]
    v_mfma_f32_16x16x32_bf16 v[208:211], v[172:175], a[36:39], v[208:211]
    v_mfma_f32_16x16x32_bf16 v[212:215], v[172:175], a[92:95], v[212:215]
    ds_read_b128 v[60:63], v7 offset:37888
    v_mfma_f32_16x16x32_bf16 v[216:219], v[172:175], a[148:151], v[216:219]
    v_mfma_f32_16x16x32_bf16 v[220:223], v[172:175], a[204:207], v[220:223]
    v_mfma_f32_16x16x32_bf16 v[208:211], v[176:179], a[40:43], v[208:211]
    v_mfma_f32_16x16x32_bf16 v[212:215], v[176:179], a[96:99], v[212:215]
    ds_read_b128 v[64:67], v7 offset:38912
    v_mfma_f32_16x16x32_bf16 v[216:219], v[176:179], a[152:155], v[216:219]
    v_mfma_f32_16x16x32_bf16 v[220:223], v[176:179], a[208:211], v[220:223]
    v_mfma_f32_16x16x32_bf16 v[208:211], v[180:183], a[44:47], v[208:211]
    v_mfma_f32_16x16x32_bf16 v[212:215], v[180:183], a[100:103], v[212:215]
    ds_read_b128 v[68:71], v7 offset:39936
    v_mfma_f32_16x16x32_bf16 v[216:219], v[180:183], a[156:159], v[216:219]
    v_mfma_f32_16x16x32_bf16 v[220:223], v[180:183], a[212:215], v[220:223]
    v_mfma_f32_16x16x32_bf16 v[208:211], v[184:187], a[48:51], v[208:211]
    v_mfma_f32_16x16x32_bf16 v[212:215], v[184:187], a[104:107], v[212:215]
    ds_read_b128 v[72:75], v7 offset:40960
    v_mfma_f32_16x16x32_bf16 v[216:219], v[184:187], a[160:163], v[216:219]
    v_mfma_f32_16x16x32_bf16 v[220:223], v[184:187], a[216:219], v[220:223]
    v_mfma_f32_16x16x32_bf16 v[208:211], v[188:191], a[52:55], v[208:211]
    v_mfma_f32_16x16x32_bf16 v[212:215], v[188:191], a[108:111], v[212:215]
    ds_read_b128 v[76:79], v7 offset:41984
    v_mfma_f32_16x16x32_bf16 v[216:219], v[188:191], a[164:167], v[216:219]
    v_mfma_f32_16x16x32_bf16 v[220:223], v[188:191], a[220:223], v[220:223]
    s_waitcnt lgkmcnt(0)
    v_mfma_f32_16x16x32_bf16 v[224:227], v[24:27], a[0:3], 0
    v_mfma_f32_16x16x32_bf16 v[228:231], v[24:27], a[56:59], 0
    ds_read_b128 v[80:83], v7 offset:43008
    v_mfma_f32_16x16x32_bf16 v[232:235], v[24:27], a[112:115], 0
    v_mfma_f32_16x16x32_bf16 v[236:239], v[24:27], a[168:171], 0
    v_mfma_f32_16x16x32_bf16 v[224:227], v[28:31], a[4:7], v[224:227]
    v_mfma_f32_16x16x32_bf16 v[228:231], v[28:31], a[60:63], v[228:231]
    ds_read_b128 v[84:87], v7 offset:44032
    v_mfma_f32_16x16x32_bf16 v[232:235], v[28:31], a[116:119], v[232:235]
    v_mfma_f32_16x16x32_bf16 v[236:239], v[28:31], a[172:175], v[236:239]
    v_mfma_f32_16x16x32_bf16 v[224:227], v[32:35], a[8:11], v[224:227]
    v_mfma_f32_16x16x32_bf16 v[228:231], v[32:35], a[64:67], v[228:231]
    ds_read_b128 v[88:91], v7 offset:45056
    v_mfma_f32_16x16x32_bf16 v[232:235], v[32:35], a[120:123], v[232:235]
    v_mfma_f32_16x16x32_bf16 v[236:239], v[32:35], a[176:179], v[236:239]
    v_mfma_f32_16x16x32_bf16 v[224:227], v[36:39], a[12:15], v[224:227]
    v_mfma_f32_16x16x32_bf16 v[228:231], v[36:39], a[68:71], v[228:231]
    ds_read_b128 v[92:95], v7 offset:46080
    v_mfma_f32_16x16x32_bf16 v[232:235], v[36:39], a[124:127], v[232:235]
    v_mfma_f32_16x16x32_bf16 v[236:239], v[36:39], a[180:183], v[236:239]
    v_mfma_f32_16x16x32_bf16 v[224:227], v[40:43], a[16:19], v[224:227]
    v_mfma_f32_16x16x32_bf16 v[228:231], v[40:43], a[72:75], v[228:231]
    ds_read_b128 v[96:99], v7 offset:47104
    v_mfma_f32_16x16x32_bf16 v[232:235], v[40:43], a[128:131], v[232:235]
    v_mfma_f32_16x16x32_bf16 v[236:239], v[40:43], a[184:187], v[236:239]
    v_mfma_f32_16x16x32_bf16 v[224:227], v[44:47], a[20:23], v[224:227]
    v_mfma_f32_16x16x32_bf16 v[228:231], v[44:47], a[76:79], v[228:231]
    ds_read_b128 v[100:103], v7 offset:48128
    v_mfma_f32_16x16x32_bf16 v[232:235], v[44:47], a[132:135], v[232:235]
    v_mfma_f32_16x16x32_bf16 v[236:239], v[44:47], a[188:191], v[236:239]
    v_mfma_f32_16x16x32_bf16 v[224:227], v[48:51], a[24:27], v[224:227]
    v_mfma_f32_16x16x32_bf16 v[228:231], v[48:51], a[80:83], v[228:231]
    ds_read_b128 v[104:107], v7 offset:49152
    v_mfma_f32_16x16x32_bf16 v[232:235], v[48:51], a[136:139], v[232:235]
    v_mfma_f32_16x16x32_bf16 v[236:239], v[48:51], a[192:195], v[236:239]
    v_mfma_f32_16x16x32_bf16 v[224:227], v[52:55], a[28:31], v[224:227]
    v_mfma_f32_16x16x32_bf16 v[228:231], v[52:55], a[84:87], v[228:231]
    ds_read_b128 v[108:111], v7 offset:50176
    v_mfma_f32_16x16x32_bf16 v[232:235], v[52:55], a[140:143], v[232:235]
    v_mfma_f32_16x16x32_bf16 v[236:239], v[52:55], a[196:199], v[236:239]
    v_mfma_f32_16x16x32_bf16 v[224:227], v[56:59], a[32:35], v[224:227]
    v_mfma_f32_16x16x32_bf16 v[228:231], v[56:59], a[88:91], v[228:231]
    ds_read_b128 v[112:115], v7 offset:51200
    v_mfma_f32_16x16x32_bf16 v[232:235], v[56:59], a[144:147], v[232:235]
    v_mfma_f32_16x16x32_bf16 v[236:239], v[56:59], a[200:203], v[236:239]
    v_mfma_f32_16x16x32_bf16 v[224:227], v[60:63], a[36:39], v[224:227]
    v_mfma_f32_16x16x32_bf16 v[228:231], v[60:63], a[92:95], v[228:231]
    ds_read_b128 v[116:119], v7 offset:52224
    v_mfma_f32_16x16x32_bf16 v[232:235], v[60:63], a[148:151], v[232:235]
    v_mfma_f32_16x16x32_bf16 v[236:239], v[60:63], a[204:207], v[236:239]
    v_mfma_f32_16x16x32_bf16 v[224:227], v[64:67], a[40:43], v[224:227]
    v_mfma_f32_16x16x32_bf16 v[228:231], v[64:67], a[96:99], v[228:231]
    ds_read_b128 v[120:123], v7 offset:53248
    v_mfma_f32_16x16x32_bf16 v[232:235], v[64:67], a[152:155], v[232:235]
    v_mfma_f32_16x16x32_bf16 v[236:239], v[64:67], a[208:211], v[236:239]
    v_mfma_f32_16x16x32_bf16 v[224:227], v[68:71], a[44:47], v[224:227]
    v_mfma_f32_16x16x32_bf16 v[228:231], v[68:71], a[100:103], v[228:231]
    ds_read_b128 v[124:127], v7 offset:54272
    v_mfma_f32_16x16x32_bf16 v[232:235], v[68:71], a[156:159], v[232:235]
    v_mfma_f32_16x16x32_bf16 v[236:239], v[68:71], a[212:215], v[236:239]
    v_mfma_f32_16x16x32_bf16 v[224:227], v[72:75], a[48:51], v[224:227]
    v_mfma_f32_16x16x32_bf16 v[228:231], v[72:75], a[104:107], v[228:231]
    ds_read_b128 v[128:131], v7 offset:55296
    v_mfma_f32_16x16x32_bf16 v[232:235], v[72:75], a[160:163], v[232:235]
    v_mfma_f32_16x16x32_bf16 v[236:239], v[72:75], a[216:219], v[236:239]
    v_mfma_f32_16x16x32_bf16 v[224:227], v[76:79], a[52:55], v[224:227]
    v_mfma_f32_16x16x32_bf16 v[228:231], v[76:79], a[108:111], v[228:231]
    ds_read_b128 v[132:135], v7 offset:56320
    v_mfma_f32_16x16x32_bf16 v[232:235], v[76:79], a[164:167], v[232:235]
    v_mfma_f32_16x16x32_bf16 v[236:239], v[76:79], a[220:223], v[236:239]
    s_waitcnt lgkmcnt(0)
    v_mfma_f32_16x16x32_bf16 v[240:243], v[80:83], a[0:3], 0
    v_mfma_f32_16x16x32_bf16 v[244:247], v[80:83], a[56:59], 0
    v_mfma_f32_16x16x32_bf16 v[248:251], v[80:83], a[112:115], 0
    v_mfma_f32_16x16x32_bf16 v[252:255], v[80:83], a[168:171], 0
    v_mfma_f32_16x16x32_bf16 v[240:243], v[84:87], a[4:7], v[240:243]
    v_mfma_f32_16x16x32_bf16 v[244:247], v[84:87], a[60:63], v[244:247]
    v_mfma_f32_16x16x32_bf16 v[248:251], v[84:87], a[116:119], v[248:251]
    v_mfma_f32_16x16x32_bf16 v[252:255], v[84:87], a[172:175], v[252:255]
    v_mfma_f32_16x16x32_bf16 v[240:243], v[88:91], a[8:11], v[240:243]
    v_mfma_f32_16x16x32_bf16 v[244:247], v[88:91], a[64:67], v[244:247]
    v_mfma_f32_16x16x32_bf16 v[248:251], v[88:91], a[120:123], v[248:251]
    v_mfma_f32_16x16x32_bf16 v[252:255], v[88:91], a[176:179], v[252:255]
    v_mfma_f32_16x16x32_bf16 v[240:243], v[92:95], a[12:15], v[240:243]
    v_mfma_f32_16x16x32_bf16 v[244:247], v[92:95], a[68:71], v[244:247]
    v_mfma_f32_16x16x32_bf16 v[248:251], v[92:95], a[124:127], v[248:251]
    v_mfma_f32_16x16x32_bf16 v[252:255], v[92:95], a[180:183], v[252:255]
    v_mfma_f32_16x16x32_bf16 v[240:243], v[96:99], a[16:19], v[240:243]
    v_mfma_f32_16x16x32_bf16 v[244:247], v[96:99], a[72:75], v[244:247]
    v_mfma_f32_16x16x32_bf16 v[248:251], v[96:99], a[128:131], v[248:251]
    v_mfma_f32_16x16x32_bf16 v[252:255], v[96:99], a[184:187], v[252:255]
    v_mfma_f32_16x16x32_bf16 v[240:243], v[100:103], a[20:23], v[240:243]
    v_mfma_f32_16x16x32_bf16 v[244:247], v[100:103], a[76:79], v[244:247]
    v_mfma_f32_16x16x32_bf16 v[248:251], v[100:103], a[132:135], v[248:251]
    v_mfma_f32_16x16x32_bf16 v[252:255], v[100:103], a[188:191], v[252:255]
    v_mfma_f32_16x16x32_bf16 v[240:243], v[104:107], a[24:27], v[240:243]
    v_mfma_f32_16x16x32_bf16 v[244:247], v[104:107], a[80:83], v[244:247]
    v_mfma_f32_16x16x32_bf16 v[248:251], v[104:107], a[136:139], v[248:251]
    v_mfma_f32_16x16x32_bf16 v[252:255], v[104:107], a[192:195], v[252:255]
    v_mfma_f32_16x16x32_bf16 v[240:243], v[108:111], a[28:31], v[240:243]
    v_mfma_f32_16x16x32_bf16 v[244:247], v[108:111], a[84:87], v[244:247]
    v_mfma_f32_16x16x32_bf16 v[248:251], v[108:111], a[140:143], v[248:251]
    v_mfma_f32_16x16x32_bf16 v[252:255], v[108:111], a[196:199], v[252:255]
    v_mfma_f32_16x16x32_bf16 v[240:243], v[112:115], a[32:35], v[240:243]
    v_mfma_f32_16x16x32_bf16 v[244:247], v[112:115], a[88:91], v[244:247]
    v_mfma_f32_16x16x32_bf16 v[248:251], v[112:115], a[144:147], v[248:251]
    v_mfma_f32_16x16x32_bf16 v[252:255], v[112:115], a[200:203], v[252:255]
    v_mfma_f32_16x16x32_bf16 v[240:243], v[116:119], a[36:39], v[240:243]
    v_mfma_f32_16x16x32_bf16 v[244:247], v[116:119], a[92:95], v[244:247]
    v_mfma_f32_16x16x32_bf16 v[248:251], v[116:119], a[148:151], v[248:251]
    v_mfma_f32_16x16x32_bf16 v[252:255], v[116:119], a[204:207], v[252:255]
    v_mfma_f32_16x16x32_bf16 v[240:243], v[120:123], a[40:43], v[240:243]
    v_mfma_f32_16x16x32_bf16 v[244:247], v[120:123], a[96:99], v[244:247]
    v_mfma_f32_16x16x32_bf16 v[248:251], v[120:123], a[152:155], v[248:251]
    v_mfma_f32_16x16x32_bf16 v[252:255], v[120:123], a[208:211], v[252:255]
    v_mfma_f32_16x16x32_bf16 v[240:243], v[124:127], a[44:47], v[240:243]
    v_mfma_f32_16x16x32_bf16 v[244:247], v[124:127], a[100:103], v[244:247]
    v_mfma_f32_16x16x32_bf16 v[248:251], v[124:127], a[156:159], v[248:251]
    v_mfma_f32_16x16x32_bf16 v[252:255], v[124:127], a[212:215], v[252:255]
    v_mfma_f32_16x16x32_bf16 v[240:243], v[128:131], a[48:51], v[240:243]
    v_mfma_f32_16x16x32_bf16 v[244:247], v[128:131], a[104:107], v[244:247]
    v_mfma_f32_16x16x32_bf16 v[248:251], v[128:131], a[160:163], v[248:251]
    v_mfma_f32_16x16x32_bf16 v[252:255], v[128:131], a[216:219], v[252:255]
    v_mfma_f32_16x16x32_bf16 v[240:243], v[132:135], a[52:55], v[240:243]
    v_mfma_f32_16x16x32_bf16 v[244:247], v[132:135], a[108:111], v[244:247]
    v_mfma_f32_16x16x32_bf16 v[248:251], v[132:135], a[164:167], v[248:251]
    v_mfma_f32_16x16x32_bf16 v[252:255], v[132:135], a[220:223], v[252:255]
    s_nop 7
    v_mul_f32 v20, s38, v192
    v_exp_f32 v20, -v20
    v_mul_f32 v224, v224, v192
    v_add_f32 v20, 1.0, v20
    v_rcp_f32 v20, v20
    s_nop 0
    v_mul_f32 v224, v224, v20
    v_mul_f32 v21, s38, v193
    v_exp_f32 v21, -v21
    v_mul_f32 v225, v225, v193
    v_add_f32 v21, 1.0, v21
    v_rcp_f32 v21, v21
    s_nop 0
    v_mul_f32 v225, v225, v21
    v_mul_f32 v22, s38, v194
    v_exp_f32 v22, -v22
    v_mul_f32 v226, v226, v194
    v_add_f32 v22, 1.0, v22
    v_rcp_f32 v22, v22
    s_nop 0
    v_mul_f32 v226, v226, v22
    v_mul_f32 v23, s38, v195
    v_exp_f32 v23, -v23
    v_mul_f32 v227, v227, v195
    v_add_f32 v23, 1.0, v23
    v_rcp_f32 v23, v23
    s_nop 0
    v_mul_f32 v227, v227, v23
    v_mul_f32 v20, s38, v208
    v_exp_f32 v20, -v20
    v_mul_f32 v240, v240, v208
    v_add_f32 v20, 1.0, v20
    v_rcp_f32 v20, v20
    s_nop 0
    v_mul_f32 v240, v240, v20
    v_mul_f32 v21, s38, v209
    v_exp_f32 v21, -v21
    v_mul_f32 v241, v241, v209
    v_add_f32 v21, 1.0, v21
    v_rcp_f32 v21, v21
    s_nop 0
    v_mul_f32 v241, v241, v21
    v_mul_f32 v22, s38, v210
    v_exp_f32 v22, -v22
    v_mul_f32 v242, v242, v210
    v_add_f32 v22, 1.0, v22
    v_rcp_f32 v22, v22
    s_nop 0
    v_mul_f32 v242, v242, v22
    v_mul_f32 v23, s38, v211
    v_exp_f32 v23, -v23
    v_mul_f32 v243, v243, v211
    v_add_f32 v23, 1.0, v23
    v_rcp_f32 v23, v23
    s_nop 0
    v_mul_f32 v243, v243, v23
    v_cvt_pk_bf16_f32 v192, v224, v225
    v_cvt_pk_bf16_f32 v193, v226, v227
    v_cvt_pk_bf16_f32 v194, v240, v241
    v_cvt_pk_bf16_f32 v195, v242, v243
    global_store_dwordx4 v16, v[192:195], s[34:35] offset:1024 sc1
    v_mul_f32 v20, s38, v196
    v_exp_f32 v20, -v20
    v_mul_f32 v228, v228, v196
    v_add_f32 v20, 1.0, v20
    v_rcp_f32 v20, v20
    s_nop 0
    v_mul_f32 v228, v228, v20
    v_mul_f32 v21, s38, v197
    v_exp_f32 v21, -v21
    v_mul_f32 v229, v229, v197
    v_add_f32 v21, 1.0, v21
    v_rcp_f32 v21, v21
    s_nop 0
    v_mul_f32 v229, v229, v21
    v_mul_f32 v22, s38, v198
    v_exp_f32 v22, -v22
    v_mul_f32 v230, v230, v198
    v_add_f32 v22, 1.0, v22
    v_rcp_f32 v22, v22
    s_nop 0
    v_mul_f32 v230, v230, v22
    v_mul_f32 v23, s38, v199
    v_exp_f32 v23, -v23
    v_mul_f32 v231, v231, v199
    v_add_f32 v23, 1.0, v23
    v_rcp_f32 v23, v23
    s_nop 0
    v_mul_f32 v231, v231, v23
    v_mul_f32 v20, s38, v212
    v_exp_f32 v20, -v20
    v_mul_f32 v244, v244, v212
    v_add_f32 v20, 1.0, v20
    v_rcp_f32 v20, v20
    s_nop 0
    v_mul_f32 v244, v244, v20
    v_mul_f32 v21, s38, v213
    v_exp_f32 v21, -v21
    v_mul_f32 v245, v245, v213
    v_add_f32 v21, 1.0, v21
    v_rcp_f32 v21, v21
    s_nop 0
    v_mul_f32 v245, v245, v21
    v_mul_f32 v22, s38, v214
    v_exp_f32 v22, -v22
    v_mul_f32 v246, v246, v214
    v_add_f32 v22, 1.0, v22
    v_rcp_f32 v22, v22
    s_nop 0
    v_mul_f32 v246, v246, v22
    v_mul_f32 v23, s38, v215
    v_exp_f32 v23, -v23
    v_mul_f32 v247, v247, v215
    v_add_f32 v23, 1.0, v23
    v_rcp_f32 v23, v23
    s_nop 0
    v_mul_f32 v247, v247, v23
    v_cvt_pk_bf16_f32 v196, v228, v229
    v_cvt_pk_bf16_f32 v197, v230, v231
    v_cvt_pk_bf16_f32 v198, v244, v245
    v_cvt_pk_bf16_f32 v199, v246, v247
    global_store_dwordx4 v17, v[196:199], s[34:35] offset:1024 sc1
    v_mul_f32 v20, s38, v200
    v_exp_f32 v20, -v20
    v_mul_f32 v232, v232, v200
    v_add_f32 v20, 1.0, v20
    v_rcp_f32 v20, v20
    s_nop 0
    v_mul_f32 v232, v232, v20
    v_mul_f32 v21, s38, v201
    v_exp_f32 v21, -v21
    v_mul_f32 v233, v233, v201
    v_add_f32 v21, 1.0, v21
    v_rcp_f32 v21, v21
    s_nop 0
    v_mul_f32 v233, v233, v21
    v_mul_f32 v22, s38, v202
    v_exp_f32 v22, -v22
    v_mul_f32 v234, v234, v202
    v_add_f32 v22, 1.0, v22
    v_rcp_f32 v22, v22
    s_nop 0
    v_mul_f32 v234, v234, v22
    v_mul_f32 v23, s38, v203
    v_exp_f32 v23, -v23
    v_mul_f32 v235, v235, v203
    v_add_f32 v23, 1.0, v23
    v_rcp_f32 v23, v23
    s_nop 0
    v_mul_f32 v235, v235, v23
    v_mul_f32 v20, s38, v216
    v_exp_f32 v20, -v20
    v_mul_f32 v248, v248, v216
    v_add_f32 v20, 1.0, v20
    v_rcp_f32 v20, v20
    s_nop 0
    v_mul_f32 v248, v248, v20
    v_mul_f32 v21, s38, v217
    v_exp_f32 v21, -v21
    v_mul_f32 v249, v249, v217
    v_add_f32 v21, 1.0, v21
    v_rcp_f32 v21, v21
    s_nop 0
    v_mul_f32 v249, v249, v21
    v_mul_f32 v22, s38, v218
    v_exp_f32 v22, -v22
    v_mul_f32 v250, v250, v218
    v_add_f32 v22, 1.0, v22
    v_rcp_f32 v22, v22
    s_nop 0
    v_mul_f32 v250, v250, v22
    v_mul_f32 v23, s38, v219
    v_exp_f32 v23, -v23
    v_mul_f32 v251, v251, v219
    v_add_f32 v23, 1.0, v23
    v_rcp_f32 v23, v23
    s_nop 0
    v_mul_f32 v251, v251, v23
    v_cvt_pk_bf16_f32 v200, v232, v233
    v_cvt_pk_bf16_f32 v201, v234, v235
    v_cvt_pk_bf16_f32 v202, v248, v249
    v_cvt_pk_bf16_f32 v203, v250, v251
    global_store_dwordx4 v18, v[200:203], s[34:35] offset:1024 sc1
    v_mul_f32 v20, s38, v204
    v_exp_f32 v20, -v20
    v_mul_f32 v236, v236, v204
    v_add_f32 v20, 1.0, v20
    v_rcp_f32 v20, v20
    s_nop 0
    v_mul_f32 v236, v236, v20
    v_mul_f32 v21, s38, v205
    v_exp_f32 v21, -v21
    v_mul_f32 v237, v237, v205
    v_add_f32 v21, 1.0, v21
    v_rcp_f32 v21, v21
    s_nop 0
    v_mul_f32 v237, v237, v21
    v_mul_f32 v22, s38, v206
    v_exp_f32 v22, -v22
    v_mul_f32 v238, v238, v206
    v_add_f32 v22, 1.0, v22
    v_rcp_f32 v22, v22
    s_nop 0
    v_mul_f32 v238, v238, v22
    v_mul_f32 v23, s38, v207
    v_exp_f32 v23, -v23
    v_mul_f32 v239, v239, v207
    v_add_f32 v23, 1.0, v23
    v_rcp_f32 v23, v23
    s_nop 0
    v_mul_f32 v239, v239, v23
    v_mul_f32 v20, s38, v220
    v_exp_f32 v20, -v20
    v_mul_f32 v252, v252, v220
    v_add_f32 v20, 1.0, v20
    v_rcp_f32 v20, v20
    s_nop 0
    v_mul_f32 v252, v252, v20
    v_mul_f32 v21, s38, v221
    v_exp_f32 v21, -v21
    v_mul_f32 v253, v253, v221
    v_add_f32 v21, 1.0, v21
    v_rcp_f32 v21, v21
    s_nop 0
    v_mul_f32 v253, v253, v21
    v_mul_f32 v22, s38, v222
    v_exp_f32 v22, -v22
    v_mul_f32 v254, v254, v222
    v_add_f32 v22, 1.0, v22
    v_rcp_f32 v22, v22
    s_nop 0
    v_mul_f32 v254, v254, v22
    v_mul_f32 v23, s38, v223
    v_exp_f32 v23, -v23
    v_mul_f32 v255, v255, v223
    v_add_f32 v23, 1.0, v23
    v_rcp_f32 v23, v23
    s_nop 0
    v_mul_f32 v255, v255, v23
    v_cvt_pk_bf16_f32 v204, v236, v237
    v_cvt_pk_bf16_f32 v205, v238, v239
    v_cvt_pk_bf16_f32 v206, v252, v253
    v_cvt_pk_bf16_f32 v207, v254, v255
    global_store_dwordx4 v19, v[204:207], s[34:35] offset:1024 sc1
    s_nop 1
    s_waitcnt vmcnt(0)
    s_barrier
    s_cmp_lg_u32 s23, 0
    s_cbranch_scc1 Lsig_109
    s_lshl_b32 s25, s73, 7
    s_add_u32 s25, s25, 0x7900400
    s_add_u32 s76, s4, s25
    s_addc_u32 s77, s5, 0
    s_mov_b64 exec, 1
    v_mov_b32 v22, 0
    v_mov_b32 v23, 1
    global_atomic_add v22, v23, s[76:77]
    s_mov_b64 exec, -1
Lsig_109:
    s_cmp_lt_u32 s72, 64
    s_cbranch_scc1 Lf2_110
    s_sub_u32 s71, s72, 106
    s_cmp_ge_u32 s72, 106
    s_cbranch_scc1 Lxa_111
    s_sub_u32 s25, s72, 64
    s_mul_i32 s20, s25, 4682
    s_lshr_b32 s20, s20, 16
    s_mul_i32 s26, s20, 14
    s_sub_u32 s22, s25, s26
    s_add_u32 s22, s22, 16
    s_mov_b32 s46, 1
    s_barrier
    s_branch Lushadow_50
Lf2_110:
    s_lshr_b32 s73, s72, 3
    s_waitcnt vmcnt(0)
    s_cmp_lg_u32 s23, 0
    s_cbranch_scc1 Lwo_112
    s_lshl_b32 s25, s73, 7
    s_add_u32 s25, s25, 0x7900400
    s_add_u32 s76, s4, s25
    s_addc_u32 s77, s5, 0
    v_mbcnt_lo_u32_b32 v8, -1, 0
    v_mbcnt_hi_u32_b32 v8, -1, v8
    v_lshlrev_b32 v8, 2, v8
    s_mov_b32 s78, 1048576
    s_mov_b32 exec_lo, 0x1
    s_mov_b32 exec_hi, 0x0
Lwf_113:
    global_load_dword v9, v8, s[76:77] sc1
    s_sub_u32 s78, s78, 1
    s_cmp_eq_u32 s78, 0
    s_cbranch_scc1 Lexit_1
    s_waitcnt vmcnt(0)
    v_cmp_ne_u32 vcc, 28, v9
    s_cbranch_vccz Lwfd_114
    s_sleep 8
    s_branch Lwf_113
Lwfd_114:
    s_mov_b64 exec, -1
Lwo_112:
    s_barrier
    v_and_b32 v1, 63, v0
    v_lshlrev_b32 v2, 4, v1
    v_add_u32 v4, 0, v2
    v_add_u32 v5, 57344, v2
    v_add_u32 v6, 114688, v2
    v_add_u32 v7, 172032, v2
    v_add_u32 v8, 229376, v2
    v_add_u32 v9, 286720, v2
    v_add_u32 v10, 344064, v2
    s_mul_i32 s25, s23, 401408
    s_add_u32 s25, s25, 0x1500000
    s_add_u32 s26, s4, s25
    s_addc_u32 s27, s5, 0
    s_mul_i32 s25, s72, 114688
    s_add_u32 s25, s25, 0x1700000
    s_add_u32 s28, s4, s25
    s_addc_u32 s29, s5, 0
    global_load_dwordx4 v[16:19], v4, s[26:27] offset:0 sc1
    global_load_dwordx4 v[20:23], v5, s[26:27] offset:0 sc1
    global_load_dwordx4 v[24:27], v6, s[26:27] offset:0 sc1
    global_load_dwordx4 v[28:31], v7, s[26:27] offset:0 sc1
    global_load_dwordx4 v[32:35], v8, s[26:27] offset:0 sc1
    global_load_dwordx4 v[36:39], v9, s[26:27] offset:0 sc1
    global_load_dwordx4 v[40:43], v10, s[26:27] offset:0 sc1
    global_load_dwordx4 v[44:47], v4, s[28:29] offset:0 sc1
    global_load_dwordx4 v[48:51], v5, s[28:29] offset:0 sc1
    global_load_dwordx4 v[52:55], v4, s[26:27] offset:1024 sc1
    global_load_dwordx4 v[56:59], v5, s[26:27] offset:1024 sc1
    global_load_dwordx4 v[60:63], v6, s[26:27] offset:1024 sc1
    global_load_dwordx4 v[64:67], v7, s[26:27] offset:1024 sc1
    global_load_dwordx4 v[68:71], v8, s[26:27] offset:1024 sc1
    global_load_dwordx4 v[72:75], v9, s[26:27] offset:1024 sc1
    global_load_dwordx4 v[76:79], v10, s[26:27] offset:1024 sc1
    global_load_dwordx4 v[80:83], v4, s[28:29] offset:1024 sc1
    global_load_dwordx4 v[84:87], v5, s[28:29] offset:1024 sc1
    global_load_dwordx4 v[88:91], v4, s[26:27] offset:2048 sc1
    global_load_dwordx4 v[92:95], v5, s[26:27] offset:2048 sc1
    global_load_dwordx4 v[96:99], v6, s[26:27] offset:2048 sc1
    global_load_dwordx4 v[100:103], v7, s[26:27] offset:2048 sc1
    global_load_dwordx4 v[104:107], v8, s[26:27] offset:2048 sc1
    global_load_dwordx4 v[108:111], v9, s[26:27] offset:2048 sc1
    global_load_dwordx4 v[112:115], v10, s[26:27] offset:2048 sc1
    global_load_dwordx4 v[116:119], v4, s[28:29] offset:2048 sc1
    global_load_dwordx4 v[120:123], v5, s[28:29] offset:2048 sc1
    global_load_dwordx4 v[124:127], v4, s[26:27] offset:3072 sc1
    global_load_dwordx4 v[128:131], v5, s[26:27] offset:3072 sc1
    global_load_dwordx4 v[132:135], v6, s[26:27] offset:3072 sc1
    global_load_dwordx4 v[136:139], v7, s[26:27] offset:3072 sc1
    global_load_dwordx4 v[140:143], v8, s[26:27] offset:3072 sc1
    global_load_dwordx4 v[144:147], v9, s[26:27] offset:3072 sc1
    global_load_dwordx4 v[148:151], v10, s[26:27] offset:3072 sc1
    global_load_dwordx4 v[152:155], v4, s[28:29] offset:3072 sc1
    global_load_dwordx4 v[156:159], v5, s[28:29] offset:3072 sc1
    s_add_u32 s26, s26, 0x1000
    s_addc_u32 s27, s27, 0
    s_add_u32 s28, s28, 0x1000
    s_addc_u32 s29, s29, 0
    global_load_dwordx4 v[160:163], v4, s[26:27] offset:0 sc1
    global_load_dwordx4 v[164:167], v5, s[26:27] offset:0 sc1
    global_load_dwordx4 v[168:171], v6, s[26:27] offset:0 sc1
    global_load_dwordx4 v[172:175], v7, s[26:27] offset:0 sc1
    global_load_dwordx4 v[176:179], v8, s[26:27] offset:0 sc1
    global_load_dwordx4 v[180:183], v9, s[26:27] offset:0 sc1
    global_load_dwordx4 v[184:187], v10, s[26:27] offset:0 sc1
    global_load_dwordx4 v[188:191], v4, s[28:29] offset:0 sc1
    global_load_dwordx4 v[192:195], v5, s[28:29] offset:0 sc1
    s_waitcnt vmcnt(36)
    v_mfma_f32_16x16x32_bf16 a[0:3], v[16:19], v[44:47], 0
    v_mfma_f32_16x16x32_bf16 a[4:7], v[16:19], v[48:51], 0
    v_mfma_f32_16x16x32_bf16 a[8:11], v[20:23], v[44:47], 0
    v_mfma_f32_16x16x32_bf16 a[12:15], v[20:23], v[48:51], 0
    v_mfma_f32_16x16x32_bf16 a[16:19], v[24:27], v[44:47], 0
    v_mfma_f32_16x16x32_bf16 a[20:23], v[24:27], v[48:51], 0
    v_mfma_f32_16x16x32_bf16 a[24:27], v[28:31], v[44:47], 0
    v_mfma_f32_16x16x32_bf16 a[28:31], v[28:31], v[48:51], 0
    v_mfma_f32_16x16x32_bf16 a[32:35], v[32:35], v[44:47], 0
    v_mfma_f32_16x16x32_bf16 a[36:39], v[32:35], v[48:51], 0
    v_mfma_f32_16x16x32_bf16 a[40:43], v[36:39], v[44:47], 0
    v_mfma_f32_16x16x32_bf16 a[44:47], v[36:39], v[48:51], 0
    v_mfma_f32_16x16x32_bf16 a[48:51], v[40:43], v[44:47], 0
    v_mfma_f32_16x16x32_bf16 a[52:55], v[40:43], v[48:51], 0
    global_load_dwordx4 v[196:199], v4, s[26:27] offset:1024 sc1
    global_load_dwordx4 v[200:203], v5, s[26:27] offset:1024 sc1
    global_load_dwordx4 v[204:207], v6, s[26:27] offset:1024 sc1
    global_load_dwordx4 v[208:211], v7, s[26:27] offset:1024 sc1
    global_load_dwordx4 v[212:215], v8, s[26:27] offset:1024 sc1
    global_load_dwordx4 v[216:219], v9, s[26:27] offset:1024 sc1
    global_load_dwordx4 v[220:223], v10, s[26:27] offset:1024 sc1
    global_load_dwordx4 v[224:227], v4, s[28:29] offset:1024 sc1
    global_load_dwordx4 v[228:231], v5, s[28:29] offset:1024 sc1
    s_waitcnt vmcnt(36)
    v_mfma_f32_16x16x32_bf16 a[0:3], v[52:55], v[80:83], a[0:3]
    v_mfma_f32_16x16x32_bf16 a[4:7], v[52:55], v[84:87], a[4:7]
    v_mfma_f32_16x16x32_bf16 a[8:11], v[56:59], v[80:83], a[8:11]
    v_mfma_f32_16x16x32_bf16 a[12:15], v[56:59], v[84:87], a[12:15]
    v_mfma_f32_16x16x32_bf16 a[16:19], v[60:63], v[80:83], a[16:19]
    v_mfma_f32_16x16x32_bf16 a[20:23], v[60:63], v[84:87], a[20:23]
    v_mfma_f32_16x16x32_bf16 a[24:27], v[64:67], v[80:83], a[24:27]
    v_mfma_f32_16x16x32_bf16 a[28:31], v[64:67], v[84:87], a[28:31]
    v_mfma_f32_16x16x32_bf16 a[32:35], v[68:71], v[80:83], a[32:35]
    v_mfma_f32_16x16x32_bf16 a[36:39], v[68:71], v[84:87], a[36:39]
    v_mfma_f32_16x16x32_bf16 a[40:43], v[72:75], v[80:83], a[40:43]
    v_mfma_f32_16x16x32_bf16 a[44:47], v[72:75], v[84:87], a[44:47]
    v_mfma_f32_16x16x32_bf16 a[48:51], v[76:79], v[80:83], a[48:51]
    v_mfma_f32_16x16x32_bf16 a[52:55], v[76:79], v[84:87], a[52:55]
    global_load_dwordx4 v[16:19], v4, s[26:27] offset:2048 sc1
    global_load_dwordx4 v[20:23], v5, s[26:27] offset:2048 sc1
    global_load_dwordx4 v[24:27], v6, s[26:27] offset:2048 sc1
    global_load_dwordx4 v[28:31], v7, s[26:27] offset:2048 sc1
    global_load_dwordx4 v[32:35], v8, s[26:27] offset:2048 sc1
    global_load_dwordx4 v[36:39], v9, s[26:27] offset:2048 sc1
    global_load_dwordx4 v[40:43], v10, s[26:27] offset:2048 sc1
    global_load_dwordx4 v[44:47], v4, s[28:29] offset:2048 sc1
    global_load_dwordx4 v[48:51], v5, s[28:29] offset:2048 sc1
    s_waitcnt vmcnt(36)
    v_mfma_f32_16x16x32_bf16 a[0:3], v[88:91], v[116:119], a[0:3]
    v_mfma_f32_16x16x32_bf16 a[4:7], v[88:91], v[120:123], a[4:7]
    v_mfma_f32_16x16x32_bf16 a[8:11], v[92:95], v[116:119], a[8:11]
    v_mfma_f32_16x16x32_bf16 a[12:15], v[92:95], v[120:123], a[12:15]
    v_mfma_f32_16x16x32_bf16 a[16:19], v[96:99], v[116:119], a[16:19]
    v_mfma_f32_16x16x32_bf16 a[20:23], v[96:99], v[120:123], a[20:23]
    v_mfma_f32_16x16x32_bf16 a[24:27], v[100:103], v[116:119], a[24:27]
    v_mfma_f32_16x16x32_bf16 a[28:31], v[100:103], v[120:123], a[28:31]
    v_mfma_f32_16x16x32_bf16 a[32:35], v[104:107], v[116:119], a[32:35]
    v_mfma_f32_16x16x32_bf16 a[36:39], v[104:107], v[120:123], a[36:39]
    v_mfma_f32_16x16x32_bf16 a[40:43], v[108:111], v[116:119], a[40:43]
    v_mfma_f32_16x16x32_bf16 a[44:47], v[108:111], v[120:123], a[44:47]
    v_mfma_f32_16x16x32_bf16 a[48:51], v[112:115], v[116:119], a[48:51]
    v_mfma_f32_16x16x32_bf16 a[52:55], v[112:115], v[120:123], a[52:55]
    global_load_dwordx4 v[52:55], v4, s[26:27] offset:3072 sc1
    global_load_dwordx4 v[56:59], v5, s[26:27] offset:3072 sc1
    global_load_dwordx4 v[60:63], v6, s[26:27] offset:3072 sc1
    global_load_dwordx4 v[64:67], v7, s[26:27] offset:3072 sc1
    global_load_dwordx4 v[68:71], v8, s[26:27] offset:3072 sc1
    global_load_dwordx4 v[72:75], v9, s[26:27] offset:3072 sc1
    global_load_dwordx4 v[76:79], v10, s[26:27] offset:3072 sc1
    global_load_dwordx4 v[80:83], v4, s[28:29] offset:3072 sc1
    global_load_dwordx4 v[84:87], v5, s[28:29] offset:3072 sc1
    s_add_u32 s26, s26, 0x1000
    s_addc_u32 s27, s27, 0
    s_add_u32 s28, s28, 0x1000
    s_addc_u32 s29, s29, 0
    s_waitcnt vmcnt(36)
    v_mfma_f32_16x16x32_bf16 a[0:3], v[124:127], v[152:155], a[0:3]
    v_mfma_f32_16x16x32_bf16 a[4:7], v[124:127], v[156:159], a[4:7]
    v_mfma_f32_16x16x32_bf16 a[8:11], v[128:131], v[152:155], a[8:11]
    v_mfma_f32_16x16x32_bf16 a[12:15], v[128:131], v[156:159], a[12:15]
    v_mfma_f32_16x16x32_bf16 a[16:19], v[132:135], v[152:155], a[16:19]
    v_mfma_f32_16x16x32_bf16 a[20:23], v[132:135], v[156:159], a[20:23]
    v_mfma_f32_16x16x32_bf16 a[24:27], v[136:139], v[152:155], a[24:27]
    v_mfma_f32_16x16x32_bf16 a[28:31], v[136:139], v[156:159], a[28:31]
    v_mfma_f32_16x16x32_bf16 a[32:35], v[140:143], v[152:155], a[32:35]
    v_mfma_f32_16x16x32_bf16 a[36:39], v[140:143], v[156:159], a[36:39]
    v_mfma_f32_16x16x32_bf16 a[40:43], v[144:147], v[152:155], a[40:43]
    v_mfma_f32_16x16x32_bf16 a[44:47], v[144:147], v[156:159], a[44:47]
    v_mfma_f32_16x16x32_bf16 a[48:51], v[148:151], v[152:155], a[48:51]
    v_mfma_f32_16x16x32_bf16 a[52:55], v[148:151], v[156:159], a[52:55]
    global_load_dwordx4 v[88:91], v4, s[26:27] offset:0 sc1
    global_load_dwordx4 v[92:95], v5, s[26:27] offset:0 sc1
    global_load_dwordx4 v[96:99], v6, s[26:27] offset:0 sc1
    global_load_dwordx4 v[100:103], v7, s[26:27] offset:0 sc1
    global_load_dwordx4 v[104:107], v8, s[26:27] offset:0 sc1
    global_load_dwordx4 v[108:111], v9, s[26:27] offset:0 sc1
    global_load_dwordx4 v[112:115], v10, s[26:27] offset:0 sc1
    global_load_dwordx4 v[116:119], v4, s[28:29] offset:0 sc1
    global_load_dwordx4 v[120:123], v5, s[28:29] offset:0 sc1
    s_waitcnt vmcnt(36)
    v_mfma_f32_16x16x32_bf16 a[0:3], v[160:163], v[188:191], a[0:3]
    v_mfma_f32_16x16x32_bf16 a[4:7], v[160:163], v[192:195], a[4:7]
    v_mfma_f32_16x16x32_bf16 a[8:11], v[164:167], v[188:191], a[8:11]
    v_mfma_f32_16x16x32_bf16 a[12:15], v[164:167], v[192:195], a[12:15]
    v_mfma_f32_16x16x32_bf16 a[16:19], v[168:171], v[188:191], a[16:19]
    v_mfma_f32_16x16x32_bf16 a[20:23], v[168:171], v[192:195], a[20:23]
    v_mfma_f32_16x16x32_bf16 a[24:27], v[172:175], v[188:191], a[24:27]
    v_mfma_f32_16x16x32_bf16 a[28:31], v[172:175], v[192:195], a[28:31]
    v_mfma_f32_16x16x32_bf16 a[32:35], v[176:179], v[188:191], a[32:35]
    v_mfma_f32_16x16x32_bf16 a[36:39], v[176:179], v[192:195], a[36:39]
    v_mfma_f32_16x16x32_bf16 a[40:43], v[180:183], v[188:191], a[40:43]
    v_mfma_f32_16x16x32_bf16 a[44:47], v[180:183], v[192:195], a[44:47]
    v_mfma_f32_16x16x32_bf16 a[48:51], v[184:187], v[188:191], a[48:51]
    v_mfma_f32_16x16x32_bf16 a[52:55], v[184:187], v[192:195], a[52:55]
    global_load_dwordx4 v[124:127], v4, s[26:27] offset:1024 sc1
    global_load_dwordx4 v[128:131], v5, s[26:27] offset:1024 sc1
    global_load_dwordx4 v[132:135], v6, s[26:27] offset:1024 sc1
    global_load_dwordx4 v[136:139], v7, s[26:27] offset:1024 sc1
    global_load_dwordx4 v[140:143], v8, s[26:27] offset:1024 sc1
    global_load_dwordx4 v[144:147], v9, s[26:27] offset:1024 sc1
    global_load_dwordx4 v[148:151], v10, s[26:27] offset:1024 sc1
    global_load_dwordx4 v[152:155], v4, s[28:29] offset:1024 sc1
    global_load_dwordx4 v[156:159], v5, s[28:29] offset:1024 sc1
    s_waitcnt vmcnt(36)
    v_mfma_f32_16x16x32_bf16 a[0:3], v[196:199], v[224:227], a[0:3]
    v_mfma_f32_16x16x32_bf16 a[4:7], v[196:199], v[228:231], a[4:7]
    v_mfma_f32_16x16x32_bf16 a[8:11], v[200:203], v[224:227], a[8:11]
    v_mfma_f32_16x16x32_bf16 a[12:15], v[200:203], v[228:231], a[12:15]
    v_mfma_f32_16x16x32_bf16 a[16:19], v[204:207], v[224:227], a[16:19]
    v_mfma_f32_16x16x32_bf16 a[20:23], v[204:207], v[228:231], a[20:23]
    v_mfma_f32_16x16x32_bf16 a[24:27], v[208:211], v[224:227], a[24:27]
    v_mfma_f32_16x16x32_bf16 a[28:31], v[208:211], v[228:231], a[28:31]
    v_mfma_f32_16x16x32_bf16 a[32:35], v[212:215], v[224:227], a[32:35]
    v_mfma_f32_16x16x32_bf16 a[36:39], v[212:215], v[228:231], a[36:39]
    v_mfma_f32_16x16x32_bf16 a[40:43], v[216:219], v[224:227], a[40:43]
    v_mfma_f32_16x16x32_bf16 a[44:47], v[216:219], v[228:231], a[44:47]
    v_mfma_f32_16x16x32_bf16 a[48:51], v[220:223], v[224:227], a[48:51]
    v_mfma_f32_16x16x32_bf16 a[52:55], v[220:223], v[228:231], a[52:55]
    global_load_dwordx4 v[160:163], v4, s[26:27] offset:2048 sc1
    global_load_dwordx4 v[164:167], v5, s[26:27] offset:2048 sc1
    global_load_dwordx4 v[168:171], v6, s[26:27] offset:2048 sc1
    global_load_dwordx4 v[172:175], v7, s[26:27] offset:2048 sc1
    global_load_dwordx4 v[176:179], v8, s[26:27] offset:2048 sc1
    global_load_dwordx4 v[180:183], v9, s[26:27] offset:2048 sc1
    global_load_dwordx4 v[184:187], v10, s[26:27] offset:2048 sc1
    global_load_dwordx4 v[188:191], v4, s[28:29] offset:2048 sc1
    global_load_dwordx4 v[192:195], v5, s[28:29] offset:2048 sc1
    s_waitcnt vmcnt(36)
    v_mfma_f32_16x16x32_bf16 a[0:3], v[16:19], v[44:47], a[0:3]
    v_mfma_f32_16x16x32_bf16 a[4:7], v[16:19], v[48:51], a[4:7]
    v_mfma_f32_16x16x32_bf16 a[8:11], v[20:23], v[44:47], a[8:11]
    v_mfma_f32_16x16x32_bf16 a[12:15], v[20:23], v[48:51], a[12:15]
    v_mfma_f32_16x16x32_bf16 a[16:19], v[24:27], v[44:47], a[16:19]
    v_mfma_f32_16x16x32_bf16 a[20:23], v[24:27], v[48:51], a[20:23]
    v_mfma_f32_16x16x32_bf16 a[24:27], v[28:31], v[44:47], a[24:27]
    v_mfma_f32_16x16x32_bf16 a[28:31], v[28:31], v[48:51], a[28:31]
    v_mfma_f32_16x16x32_bf16 a[32:35], v[32:35], v[44:47], a[32:35]
    v_mfma_f32_16x16x32_bf16 a[36:39], v[32:35], v[48:51], a[36:39]
    v_mfma_f32_16x16x32_bf16 a[40:43], v[36:39], v[44:47], a[40:43]
    v_mfma_f32_16x16x32_bf16 a[44:47], v[36:39], v[48:51], a[44:47]
    v_mfma_f32_16x16x32_bf16 a[48:51], v[40:43], v[44:47], a[48:51]
    v_mfma_f32_16x16x32_bf16 a[52:55], v[40:43], v[48:51], a[52:55]
    global_load_dwordx4 v[196:199], v4, s[26:27] offset:3072 sc1
    global_load_dwordx4 v[200:203], v5, s[26:27] offset:3072 sc1
    global_load_dwordx4 v[204:207], v6, s[26:27] offset:3072 sc1
    global_load_dwordx4 v[208:211], v7, s[26:27] offset:3072 sc1
    global_load_dwordx4 v[212:215], v8, s[26:27] offset:3072 sc1
    global_load_dwordx4 v[216:219], v9, s[26:27] offset:3072 sc1
    global_load_dwordx4 v[220:223], v10, s[26:27] offset:3072 sc1
    global_load_dwordx4 v[224:227], v4, s[28:29] offset:3072 sc1
    global_load_dwordx4 v[228:231], v5, s[28:29] offset:3072 sc1
    s_add_u32 s26, s26, 0x1000
    s_addc_u32 s27, s27, 0
    s_add_u32 s28, s28, 0x1000
    s_addc_u32 s29, s29, 0
    s_waitcnt vmcnt(36)
    v_mfma_f32_16x16x32_bf16 a[0:3], v[52:55], v[80:83], a[0:3]
    v_mfma_f32_16x16x32_bf16 a[4:7], v[52:55], v[84:87], a[4:7]
    v_mfma_f32_16x16x32_bf16 a[8:11], v[56:59], v[80:83], a[8:11]
    v_mfma_f32_16x16x32_bf16 a[12:15], v[56:59], v[84:87], a[12:15]
    v_mfma_f32_16x16x32_bf16 a[16:19], v[60:63], v[80:83], a[16:19]
    v_mfma_f32_16x16x32_bf16 a[20:23], v[60:63], v[84:87], a[20:23]
    v_mfma_f32_16x16x32_bf16 a[24:27], v[64:67], v[80:83], a[24:27]
    v_mfma_f32_16x16x32_bf16 a[28:31], v[64:67], v[84:87], a[28:31]
    v_mfma_f32_16x16x32_bf16 a[32:35], v[68:71], v[80:83], a[32:35]
    v_mfma_f32_16x16x32_bf16 a[36:39], v[68:71], v[84:87], a[36:39]
    v_mfma_f32_16x16x32_bf16 a[40:43], v[72:75], v[80:83], a[40:43]
    v_mfma_f32_16x16x32_bf16 a[44:47], v[72:75], v[84:87], a[44:47]
    v_mfma_f32_16x16x32_bf16 a[48:51], v[76:79], v[80:83], a[48:51]
    v_mfma_f32_16x16x32_bf16 a[52:55], v[76:79], v[84:87], a[52:55]
    global_load_dwordx4 v[16:19], v4, s[26:27] offset:0 sc1
    global_load_dwordx4 v[20:23], v5, s[26:27] offset:0 sc1
    global_load_dwordx4 v[24:27], v6, s[26:27] offset:0 sc1
    global_load_dwordx4 v[28:31], v7, s[26:27] offset:0 sc1
    global_load_dwordx4 v[32:35], v8, s[26:27] offset:0 sc1
    global_load_dwordx4 v[36:39], v9, s[26:27] offset:0 sc1
    global_load_dwordx4 v[40:43], v10, s[26:27] offset:0 sc1
    global_load_dwordx4 v[44:47], v4, s[28:29] offset:0 sc1
    global_load_dwordx4 v[48:51], v5, s[28:29] offset:0 sc1
    s_waitcnt vmcnt(36)
    v_mfma_f32_16x16x32_bf16 a[0:3], v[88:91], v[116:119], a[0:3]
    v_mfma_f32_16x16x32_bf16 a[4:7], v[88:91], v[120:123], a[4:7]
    v_mfma_f32_16x16x32_bf16 a[8:11], v[92:95], v[116:119], a[8:11]
    v_mfma_f32_16x16x32_bf16 a[12:15], v[92:95], v[120:123], a[12:15]
    v_mfma_f32_16x16x32_bf16 a[16:19], v[96:99], v[116:119], a[16:19]
    v_mfma_f32_16x16x32_bf16 a[20:23], v[96:99], v[120:123], a[20:23]
    v_mfma_f32_16x16x32_bf16 a[24:27], v[100:103], v[116:119], a[24:27]
    v_mfma_f32_16x16x32_bf16 a[28:31], v[100:103], v[120:123], a[28:31]
    v_mfma_f32_16x16x32_bf16 a[32:35], v[104:107], v[116:119], a[32:35]
    v_mfma_f32_16x16x32_bf16 a[36:39], v[104:107], v[120:123], a[36:39]
    v_mfma_f32_16x16x32_bf16 a[40:43], v[108:111], v[116:119], a[40:43]
    v_mfma_f32_16x16x32_bf16 a[44:47], v[108:111], v[120:123], a[44:47]
    v_mfma_f32_16x16x32_bf16 a[48:51], v[112:115], v[116:119], a[48:51]
    v_mfma_f32_16x16x32_bf16 a[52:55], v[112:115], v[120:123], a[52:55]
    global_load_dwordx4 v[52:55], v4, s[26:27] offset:1024 sc1
    global_load_dwordx4 v[56:59], v5, s[26:27] offset:1024 sc1
    global_load_dwordx4 v[60:63], v6, s[26:27] offset:1024 sc1
    global_load_dwordx4 v[64:67], v7, s[26:27] offset:1024 sc1
    global_load_dwordx4 v[68:71], v8, s[26:27] offset:1024 sc1
    global_load_dwordx4 v[72:75], v9, s[26:27] offset:1024 sc1
    global_load_dwordx4 v[76:79], v10, s[26:27] offset:1024 sc1
    global_load_dwordx4 v[80:83], v4, s[28:29] offset:1024 sc1
    global_load_dwordx4 v[84:87], v5, s[28:29] offset:1024 sc1
    s_waitcnt vmcnt(36)
    v_mfma_f32_16x16x32_bf16 a[0:3], v[124:127], v[152:155], a[0:3]
    v_mfma_f32_16x16x32_bf16 a[4:7], v[124:127], v[156:159], a[4:7]
    v_mfma_f32_16x16x32_bf16 a[8:11], v[128:131], v[152:155], a[8:11]
    v_mfma_f32_16x16x32_bf16 a[12:15], v[128:131], v[156:159], a[12:15]
    v_mfma_f32_16x16x32_bf16 a[16:19], v[132:135], v[152:155], a[16:19]
    v_mfma_f32_16x16x32_bf16 a[20:23], v[132:135], v[156:159], a[20:23]
    v_mfma_f32_16x16x32_bf16 a[24:27], v[136:139], v[152:155], a[24:27]
    v_mfma_f32_16x16x32_bf16 a[28:31], v[136:139], v[156:159], a[28:31]
    v_mfma_f32_16x16x32_bf16 a[32:35], v[140:143], v[152:155], a[32:35]
    v_mfma_f32_16x16x32_bf16 a[36:39], v[140:143], v[156:159], a[36:39]
    v_mfma_f32_16x16x32_bf16 a[40:43], v[144:147], v[152:155], a[40:43]
    v_mfma_f32_16x16x32_bf16 a[44:47], v[144:147], v[156:159], a[44:47]
    v_mfma_f32_16x16x32_bf16 a[48:51], v[148:151], v[152:155], a[48:51]
    v_mfma_f32_16x16x32_bf16 a[52:55], v[148:151], v[156:159], a[52:55]
    global_load_dwordx4 v[88:91], v4, s[26:27] offset:2048 sc1
    global_load_dwordx4 v[92:95], v5, s[26:27] offset:2048 sc1
    global_load_dwordx4 v[96:99], v6, s[26:27] offset:2048 sc1
    global_load_dwordx4 v[100:103], v7, s[26:27] offset:2048 sc1
    global_load_dwordx4 v[104:107], v8, s[26:27] offset:2048 sc1
    global_load_dwordx4 v[108:111], v9, s[26:27] offset:2048 sc1
    global_load_dwordx4 v[112:115], v10, s[26:27] offset:2048 sc1
    global_load_dwordx4 v[116:119], v4, s[28:29] offset:2048 sc1
    global_load_dwordx4 v[120:123], v5, s[28:29] offset:2048 sc1
    s_waitcnt vmcnt(36)
    v_mfma_f32_16x16x32_bf16 a[0:3], v[160:163], v[188:191], a[0:3]
    v_mfma_f32_16x16x32_bf16 a[4:7], v[160:163], v[192:195], a[4:7]
    v_mfma_f32_16x16x32_bf16 a[8:11], v[164:167], v[188:191], a[8:11]
    v_mfma_f32_16x16x32_bf16 a[12:15], v[164:167], v[192:195], a[12:15]
    v_mfma_f32_16x16x32_bf16 a[16:19], v[168:171], v[188:191], a[16:19]
    v_mfma_f32_16x16x32_bf16 a[20:23], v[168:171], v[192:195], a[20:23]
    v_mfma_f32_16x16x32_bf16 a[24:27], v[172:175], v[188:191], a[24:27]
    v_mfma_f32_16x16x32_bf16 a[28:31], v[172:175], v[192:195], a[28:31]
    v_mfma_f32_16x16x32_bf16 a[32:35], v[176:179], v[188:191], a[32:35]
    v_mfma_f32_16x16x32_bf16 a[36:39], v[176:179], v[192:195], a[36:39]
    v_mfma_f32_16x16x32_bf16 a[40:43], v[180:183], v[188:191], a[40:43]
    v_mfma_f32_16x16x32_bf16 a[44:47], v[180:183], v[192:195], a[44:47]
    v_mfma_f32_16x16x32_bf16 a[48:51], v[184:187], v[188:191], a[48:51]
    v_mfma_f32_16x16x32_bf16 a[52:55], v[184:187], v[192:195], a[52:55]
    global_load_dwordx4 v[124:127], v4, s[26:27] offset:3072 sc1
    global_load_dwordx4 v[128:131], v5, s[26:27] offset:3072 sc1
    global_load_dwordx4 v[132:135], v6, s[26:27] offset:3072 sc1
    global_load_dwordx4 v[136:139], v7, s[26:27] offset:3072 sc1
    global_load_dwordx4 v[140:143], v8, s[26:27] offset:3072 sc1
    global_load_dwordx4 v[144:147], v9, s[26:27] offset:3072 sc1
    global_load_dwordx4 v[148:151], v10, s[26:27] offset:3072 sc1
    global_load_dwordx4 v[152:155], v4, s[28:29] offset:3072 sc1
    global_load_dwordx4 v[156:159], v5, s[28:29] offset:3072 sc1
    s_add_u32 s26, s26, 0x1000
    s_addc_u32 s27, s27, 0
    s_add_u32 s28, s28, 0x1000
    s_addc_u32 s29, s29, 0
    s_waitcnt vmcnt(36)
    v_mfma_f32_16x16x32_bf16 a[0:3], v[196:199], v[224:227], a[0:3]
    v_mfma_f32_16x16x32_bf16 a[4:7], v[196:199], v[228:231], a[4:7]
    v_mfma_f32_16x16x32_bf16 a[8:11], v[200:203], v[224:227], a[8:11]
    v_mfma_f32_16x16x32_bf16 a[12:15], v[200:203], v[228:231], a[12:15]
    v_mfma_f32_16x16x32_bf16 a[16:19], v[204:207], v[224:227], a[16:19]
    v_mfma_f32_16x16x32_bf16 a[20:23], v[204:207], v[228:231], a[20:23]
    v_mfma_f32_16x16x32_bf16 a[24:27], v[208:211], v[224:227], a[24:27]
    v_mfma_f32_16x16x32_bf16 a[28:31], v[208:211], v[228:231], a[28:31]
    v_mfma_f32_16x16x32_bf16 a[32:35], v[212:215], v[224:227], a[32:35]
    v_mfma_f32_16x16x32_bf16 a[36:39], v[212:215], v[228:231], a[36:39]
    v_mfma_f32_16x16x32_bf16 a[40:43], v[216:219], v[224:227], a[40:43]
    v_mfma_f32_16x16x32_bf16 a[44:47], v[216:219], v[228:231], a[44:47]
    v_mfma_f32_16x16x32_bf16 a[48:51], v[220:223], v[224:227], a[48:51]
    v_mfma_f32_16x16x32_bf16 a[52:55], v[220:223], v[228:231], a[52:55]
    global_load_dwordx4 v[160:163], v4, s[26:27] offset:0 sc1
    global_load_dwordx4 v[164:167], v5, s[26:27] offset:0 sc1
    global_load_dwordx4 v[168:171], v6, s[26:27] offset:0 sc1
    global_load_dwordx4 v[172:175], v7, s[26:27] offset:0 sc1
    global_load_dwordx4 v[176:179], v8, s[26:27] offset:0 sc1
    global_load_dwordx4 v[180:183], v9, s[26:27] offset:0 sc1
    global_load_dwordx4 v[184:187], v10, s[26:27] offset:0 sc1
    global_load_dwordx4 v[188:191], v4, s[28:29] offset:0 sc1
    global_load_dwordx4 v[192:195], v5, s[28:29] offset:0 sc1
    s_waitcnt vmcnt(36)
    v_mfma_f32_16x16x32_bf16 a[0:3], v[16:19], v[44:47], a[0:3]
    v_mfma_f32_16x16x32_bf16 a[4:7], v[16:19], v[48:51], a[4:7]
    v_mfma_f32_16x16x32_bf16 a[8:11], v[20:23], v[44:47], a[8:11]
    v_mfma_f32_16x16x32_bf16 a[12:15], v[20:23], v[48:51], a[12:15]
    v_mfma_f32_16x16x32_bf16 a[16:19], v[24:27], v[44:47], a[16:19]
    v_mfma_f32_16x16x32_bf16 a[20:23], v[24:27], v[48:51], a[20:23]
    v_mfma_f32_16x16x32_bf16 a[24:27], v[28:31], v[44:47], a[24:27]
    v_mfma_f32_16x16x32_bf16 a[28:31], v[28:31], v[48:51], a[28:31]
    v_mfma_f32_16x16x32_bf16 a[32:35], v[32:35], v[44:47], a[32:35]
    v_mfma_f32_16x16x32_bf16 a[36:39], v[32:35], v[48:51], a[36:39]
    v_mfma_f32_16x16x32_bf16 a[40:43], v[36:39], v[44:47], a[40:43]
    v_mfma_f32_16x16x32_bf16 a[44:47], v[36:39], v[48:51], a[44:47]
    v_mfma_f32_16x16x32_bf16 a[48:51], v[40:43], v[44:47], a[48:51]
    v_mfma_f32_16x16x32_bf16 a[52:55], v[40:43], v[48:51], a[52:55]
    global_load_dwordx4 v[196:199], v4, s[26:27] offset:1024 sc1
    global_load_dwordx4 v[200:203], v5, s[26:27] offset:1024 sc1
    global_load_dwordx4 v[204:207], v6, s[26:27] offset:1024 sc1
    global_load_dwordx4 v[208:211], v7, s[26:27] offset:1024 sc1
    global_load_dwordx4 v[212:215], v8, s[26:27] offset:1024 sc1
    global_load_dwordx4 v[216:219], v9, s[26:27] offset:1024 sc1
    global_load_dwordx4 v[220:223], v10, s[26:27] offset:1024 sc1
    global_load_dwordx4 v[224:227], v4, s[28:29] offset:1024 sc1
    global_load_dwordx4 v[228:231], v5, s[28:29] offset:1024 sc1
    s_waitcnt vmcnt(36)
    v_mfma_f32_16x16x32_bf16 a[0:3], v[52:55], v[80:83], a[0:3]
    v_mfma_f32_16x16x32_bf16 a[4:7], v[52:55], v[84:87], a[4:7]
    v_mfma_f32_16x16x32_bf16 a[8:11], v[56:59], v[80:83], a[8:11]
    v_mfma_f32_16x16x32_bf16 a[12:15], v[56:59], v[84:87], a[12:15]
    v_mfma_f32_16x16x32_bf16 a[16:19], v[60:63], v[80:83], a[16:19]
    v_mfma_f32_16x16x32_bf16 a[20:23], v[60:63], v[84:87], a[20:23]
    v_mfma_f32_16x16x32_bf16 a[24:27], v[64:67], v[80:83], a[24:27]
    v_mfma_f32_16x16x32_bf16 a[28:31], v[64:67], v[84:87], a[28:31]
    v_mfma_f32_16x16x32_bf16 a[32:35], v[68:71], v[80:83], a[32:35]
    v_mfma_f32_16x16x32_bf16 a[36:39], v[68:71], v[84:87], a[36:39]
    v_mfma_f32_16x16x32_bf16 a[40:43], v[72:75], v[80:83], a[40:43]
    v_mfma_f32_16x16x32_bf16 a[44:47], v[72:75], v[84:87], a[44:47]
    v_mfma_f32_16x16x32_bf16 a[48:51], v[76:79], v[80:83], a[48:51]
    v_mfma_f32_16x16x32_bf16 a[52:55], v[76:79], v[84:87], a[52:55]
    global_load_dwordx4 v[16:19], v4, s[26:27] offset:2048 sc1
    global_load_dwordx4 v[20:23], v5, s[26:27] offset:2048 sc1
    global_load_dwordx4 v[24:27], v6, s[26:27] offset:2048 sc1
    global_load_dwordx4 v[28:31], v7, s[26:27] offset:2048 sc1
    global_load_dwordx4 v[32:35], v8, s[26:27] offset:2048 sc1
    global_load_dwordx4 v[36:39], v9, s[26:27] offset:2048 sc1
    global_load_dwordx4 v[40:43], v10, s[26:27] offset:2048 sc1
    global_load_dwordx4 v[44:47], v4, s[28:29] offset:2048 sc1
    global_load_dwordx4 v[48:51], v5, s[28:29] offset:2048 sc1
    s_waitcnt vmcnt(36)
    v_mfma_f32_16x16x32_bf16 a[0:3], v[88:91], v[116:119], a[0:3]
    v_mfma_f32_16x16x32_bf16 a[4:7], v[88:91], v[120:123], a[4:7]
    v_mfma_f32_16x16x32_bf16 a[8:11], v[92:95], v[116:119], a[8:11]
    v_mfma_f32_16x16x32_bf16 a[12:15], v[92:95], v[120:123], a[12:15]
    v_mfma_f32_16x16x32_bf16 a[16:19], v[96:99], v[116:119], a[16:19]
    v_mfma_f32_16x16x32_bf16 a[20:23], v[96:99], v[120:123], a[20:23]
    v_mfma_f32_16x16x32_bf16 a[24:27], v[100:103], v[116:119], a[24:27]
    v_mfma_f32_16x16x32_bf16 a[28:31], v[100:103], v[120:123], a[28:31]
    v_mfma_f32_16x16x32_bf16 a[32:35], v[104:107], v[116:119], a[32:35]
    v_mfma_f32_16x16x32_bf16 a[36:39], v[104:107], v[120:123], a[36:39]
    v_mfma_f32_16x16x32_bf16 a[40:43], v[108:111], v[116:119], a[40:43]
    v_mfma_f32_16x16x32_bf16 a[44:47], v[108:111], v[120:123], a[44:47]
    v_mfma_f32_16x16x32_bf16 a[48:51], v[112:115], v[116:119], a[48:51]
    v_mfma_f32_16x16x32_bf16 a[52:55], v[112:115], v[120:123], a[52:55]
    global_load_dwordx4 v[52:55], v4, s[26:27] offset:3072 sc1
    global_load_dwordx4 v[56:59], v5, s[26:27] offset:3072 sc1
    global_load_dwordx4 v[60:63], v6, s[26:27] offset:3072 sc1
    global_load_dwordx4 v[64:67], v7, s[26:27] offset:3072 sc1
    global_load_dwordx4 v[68:71], v8, s[26:27] offset:3072 sc1
    global_load_dwordx4 v[72:75], v9, s[26:27] offset:3072 sc1
    global_load_dwordx4 v[76:79], v10, s[26:27] offset:3072 sc1
    global_load_dwordx4 v[80:83], v4, s[28:29] offset:3072 sc1
    global_load_dwordx4 v[84:87], v5, s[28:29] offset:3072 sc1
    s_add_u32 s26, s26, 0x1000
    s_addc_u32 s27, s27, 0
    s_add_u32 s28, s28, 0x1000
    s_addc_u32 s29, s29, 0
    s_waitcnt vmcnt(36)
    v_mfma_f32_16x16x32_bf16 a[0:3], v[124:127], v[152:155], a[0:3]
    v_mfma_f32_16x16x32_bf16 a[4:7], v[124:127], v[156:159], a[4:7]
    v_mfma_f32_16x16x32_bf16 a[8:11], v[128:131], v[152:155], a[8:11]
    v_mfma_f32_16x16x32_bf16 a[12:15], v[128:131], v[156:159], a[12:15]
    v_mfma_f32_16x16x32_bf16 a[16:19], v[132:135], v[152:155], a[16:19]
    v_mfma_f32_16x16x32_bf16 a[20:23], v[132:135], v[156:159], a[20:23]
    v_mfma_f32_16x16x32_bf16 a[24:27], v[136:139], v[152:155], a[24:27]
    v_mfma_f32_16x16x32_bf16 a[28:31], v[136:139], v[156:159], a[28:31]
    v_mfma_f32_16x16x32_bf16 a[32:35], v[140:143], v[152:155], a[32:35]
    v_mfma_f32_16x16x32_bf16 a[36:39], v[140:143], v[156:159], a[36:39]
    v_mfma_f32_16x16x32_bf16 a[40:43], v[144:147], v[152:155], a[40:43]
    v_mfma_f32_16x16x32_bf16 a[44:47], v[144:147], v[156:159], a[44:47]
    v_mfma_f32_16x16x32_bf16 a[48:51], v[148:151], v[152:155], a[48:51]
    v_mfma_f32_16x16x32_bf16 a[52:55], v[148:151], v[156:159], a[52:55]
    global_load_dwordx4 v[88:91], v4, s[26:27] offset:0 sc1
    global_load_dwordx4 v[92:95], v5, s[26:27] offset:0 sc1
    global_load_dwordx4 v[96:99], v6, s[26:27] offset:0 sc1
    global_load_dwordx4 v[100:103], v7, s[26:27] offset:0 sc1
    global_load_dwordx4 v[104:107], v8, s[26:27] offset:0 sc1
    global_load_dwordx4 v[108:111], v9, s[26:27] offset:0 sc1
    global_load_dwordx4 v[112:115], v10, s[26:27] offset:0 sc1
    global_load_dwordx4 v[116:119], v4, s[28:29] offset:0 sc1
    global_load_dwordx4 v[120:123], v5, s[28:29] offset:0 sc1
    s_waitcnt vmcnt(36)
    v_mfma_f32_16x16x32_bf16 a[0:3], v[160:163], v[188:191], a[0:3]
    v_mfma_f32_16x16x32_bf16 a[4:7], v[160:163], v[192:195], a[4:7]
    v_mfma_f32_16x16x32_bf16 a[8:11], v[164:167], v[188:191], a[8:11]
    v_mfma_f32_16x16x32_bf16 a[12:15], v[164:167], v[192:195], a[12:15]
    v_mfma_f32_16x16x32_bf16 a[16:19], v[168:171], v[188:191], a[16:19]
    v_mfma_f32_16x16x32_bf16 a[20:23], v[168:171], v[192:195], a[20:23]
    v_mfma_f32_16x16x32_bf16 a[24:27], v[172:175], v[188:191], a[24:27]
    v_mfma_f32_16x16x32_bf16 a[28:31], v[172:175], v[192:195], a[28:31]
    v_mfma_f32_16x16x32_bf16 a[32:35], v[176:179], v[188:191], a[32:35]
    v_mfma_f32_16x16x32_bf16 a[36:39], v[176:179], v[192:195], a[36:39]
    v_mfma_f32_16x16x32_bf16 a[40:43], v[180:183], v[188:191], a[40:43]
    v_mfma_f32_16x16x32_bf16 a[44:47], v[180:183], v[192:195], a[44:47]
    v_mfma_f32_16x16x32_bf16 a[48:51], v[184:187], v[188:191], a[48:51]
    v_mfma_f32_16x16x32_bf16 a[52:55], v[184:187], v[192:195], a[52:55]
    global_load_dwordx4 v[124:127], v4, s[26:27] offset:1024 sc1
    global_load_dwordx4 v[128:131], v5, s[26:27] offset:1024 sc1
    global_load_dwordx4 v[132:135], v6, s[26:27] offset:1024 sc1
    global_load_dwordx4 v[136:139], v7, s[26:27] offset:1024 sc1
    global_load_dwordx4 v[140:143], v8, s[26:27] offset:1024 sc1
    global_load_dwordx4 v[144:147], v9, s[26:27] offset:1024 sc1
    global_load_dwordx4 v[148:151], v10, s[26:27] offset:1024 sc1
    global_load_dwordx4 v[152:155], v4, s[28:29] offset:1024 sc1
    global_load_dwordx4 v[156:159], v5, s[28:29] offset:1024 sc1
    s_waitcnt vmcnt(36)
    v_mfma_f32_16x16x32_bf16 a[0:3], v[196:199], v[224:227], a[0:3]
    v_mfma_f32_16x16x32_bf16 a[4:7], v[196:199], v[228:231], a[4:7]
    v_mfma_f32_16x16x32_bf16 a[8:11], v[200:203], v[224:227], a[8:11]
    v_mfma_f32_16x16x32_bf16 a[12:15], v[200:203], v[228:231], a[12:15]
    v_mfma_f32_16x16x32_bf16 a[16:19], v[204:207], v[224:227], a[16:19]
    v_mfma_f32_16x16x32_bf16 a[20:23], v[204:207], v[228:231], a[20:23]
    v_mfma_f32_16x16x32_bf16 a[24:27], v[208:211], v[224:227], a[24:27]
    v_mfma_f32_16x16x32_bf16 a[28:31], v[208:211], v[228:231], a[28:31]
    v_mfma_f32_16x16x32_bf16 a[32:35], v[212:215], v[224:227], a[32:35]
    v_mfma_f32_16x16x32_bf16 a[36:39], v[212:215], v[228:231], a[36:39]
    v_mfma_f32_16x16x32_bf16 a[40:43], v[216:219], v[224:227], a[40:43]
    v_mfma_f32_16x16x32_bf16 a[44:47], v[216:219], v[228:231], a[44:47]
    v_mfma_f32_16x16x32_bf16 a[48:51], v[220:223], v[224:227], a[48:51]
    v_mfma_f32_16x16x32_bf16 a[52:55], v[220:223], v[228:231], a[52:55]
    global_load_dwordx4 v[160:163], v4, s[26:27] offset:2048 sc1
    global_load_dwordx4 v[164:167], v5, s[26:27] offset:2048 sc1
    global_load_dwordx4 v[168:171], v6, s[26:27] offset:2048 sc1
    global_load_dwordx4 v[172:175], v7, s[26:27] offset:2048 sc1
    global_load_dwordx4 v[176:179], v8, s[26:27] offset:2048 sc1
    global_load_dwordx4 v[180:183], v9, s[26:27] offset:2048 sc1
    global_load_dwordx4 v[184:187], v10, s[26:27] offset:2048 sc1
    global_load_dwordx4 v[188:191], v4, s[28:29] offset:2048 sc1
    global_load_dwordx4 v[192:195], v5, s[28:29] offset:2048 sc1
    s_waitcnt vmcnt(36)
    v_mfma_f32_16x16x32_bf16 a[0:3], v[16:19], v[44:47], a[0:3]
    v_mfma_f32_16x16x32_bf16 a[4:7], v[16:19], v[48:51], a[4:7]
    v_mfma_f32_16x16x32_bf16 a[8:11], v[20:23], v[44:47], a[8:11]
    v_mfma_f32_16x16x32_bf16 a[12:15], v[20:23], v[48:51], a[12:15]
    v_mfma_f32_16x16x32_bf16 a[16:19], v[24:27], v[44:47], a[16:19]
    v_mfma_f32_16x16x32_bf16 a[20:23], v[24:27], v[48:51], a[20:23]
    v_mfma_f32_16x16x32_bf16 a[24:27], v[28:31], v[44:47], a[24:27]
    v_mfma_f32_16x16x32_bf16 a[28:31], v[28:31], v[48:51], a[28:31]
    v_mfma_f32_16x16x32_bf16 a[32:35], v[32:35], v[44:47], a[32:35]
    v_mfma_f32_16x16x32_bf16 a[36:39], v[32:35], v[48:51], a[36:39]
    v_mfma_f32_16x16x32_bf16 a[40:43], v[36:39], v[44:47], a[40:43]
    v_mfma_f32_16x16x32_bf16 a[44:47], v[36:39], v[48:51], a[44:47]
    v_mfma_f32_16x16x32_bf16 a[48:51], v[40:43], v[44:47], a[48:51]
    v_mfma_f32_16x16x32_bf16 a[52:55], v[40:43], v[48:51], a[52:55]
    global_load_dwordx4 v[196:199], v4, s[26:27] offset:3072 sc1
    global_load_dwordx4 v[200:203], v5, s[26:27] offset:3072 sc1
    global_load_dwordx4 v[204:207], v6, s[26:27] offset:3072 sc1
    global_load_dwordx4 v[208:211], v7, s[26:27] offset:3072 sc1
    global_load_dwordx4 v[212:215], v8, s[26:27] offset:3072 sc1
    global_load_dwordx4 v[216:219], v9, s[26:27] offset:3072 sc1
    global_load_dwordx4 v[220:223], v10, s[26:27] offset:3072 sc1
    global_load_dwordx4 v[224:227], v4, s[28:29] offset:3072 sc1
    global_load_dwordx4 v[228:231], v5, s[28:29] offset:3072 sc1
    s_add_u32 s26, s26, 0x1000
    s_addc_u32 s27, s27, 0
    s_add_u32 s28, s28, 0x1000
    s_addc_u32 s29, s29, 0
    s_waitcnt vmcnt(36)
    v_mfma_f32_16x16x32_bf16 a[0:3], v[52:55], v[80:83], a[0:3]
    v_mfma_f32_16x16x32_bf16 a[4:7], v[52:55], v[84:87], a[4:7]
    v_mfma_f32_16x16x32_bf16 a[8:11], v[56:59], v[80:83], a[8:11]
    v_mfma_f32_16x16x32_bf16 a[12:15], v[56:59], v[84:87], a[12:15]
    v_mfma_f32_16x16x32_bf16 a[16:19], v[60:63], v[80:83], a[16:19]
    v_mfma_f32_16x16x32_bf16 a[20:23], v[60:63], v[84:87], a[20:23]
    v_mfma_f32_16x16x32_bf16 a[24:27], v[64:67], v[80:83], a[24:27]
    v_mfma_f32_16x16x32_bf16 a[28:31], v[64:67], v[84:87], a[28:31]
    v_mfma_f32_16x16x32_bf16 a[32:35], v[68:71], v[80:83], a[32:35]
    v_mfma_f32_16x16x32_bf16 a[36:39], v[68:71], v[84:87], a[36:39]
    v_mfma_f32_16x16x32_bf16 a[40:43], v[72:75], v[80:83], a[40:43]
    v_mfma_f32_16x16x32_bf16 a[44:47], v[72:75], v[84:87], a[44:47]
    v_mfma_f32_16x16x32_bf16 a[48:51], v[76:79], v[80:83], a[48:51]
    v_mfma_f32_16x16x32_bf16 a[52:55], v[76:79], v[84:87], a[52:55]
    global_load_dwordx4 v[16:19], v4, s[26:27] offset:0 sc1
    global_load_dwordx4 v[20:23], v5, s[26:27] offset:0 sc1
    global_load_dwordx4 v[24:27], v6, s[26:27] offset:0 sc1
    global_load_dwordx4 v[28:31], v7, s[26:27] offset:0 sc1
    global_load_dwordx4 v[32:35], v8, s[26:27] offset:0 sc1
    global_load_dwordx4 v[36:39], v9, s[26:27] offset:0 sc1
    global_load_dwordx4 v[40:43], v10, s[26:27] offset:0 sc1
    global_load_dwordx4 v[44:47], v4, s[28:29] offset:0 sc1
    global_load_dwordx4 v[48:51], v5, s[28:29] offset:0 sc1
    s_waitcnt vmcnt(36)
    v_mfma_f32_16x16x32_bf16 a[0:3], v[88:91], v[116:119], a[0:3]
    v_mfma_f32_16x16x32_bf16 a[4:7], v[88:91], v[120:123], a[4:7]
    v_mfma_f32_16x16x32_bf16 a[8:11], v[92:95], v[116:119], a[8:11]
    v_mfma_f32_16x16x32_bf16 a[12:15], v[92:95], v[120:123], a[12:15]
    v_mfma_f32_16x16x32_bf16 a[16:19], v[96:99], v[116:119], a[16:19]
    v_mfma_f32_16x16x32_bf16 a[20:23], v[96:99], v[120:123], a[20:23]
    v_mfma_f32_16x16x32_bf16 a[24:27], v[100:103], v[116:119], a[24:27]
    v_mfma_f32_16x16x32_bf16 a[28:31], v[100:103], v[120:123], a[28:31]
    v_mfma_f32_16x16x32_bf16 a[32:35], v[104:107], v[116:119], a[32:35]
    v_mfma_f32_16x16x32_bf16 a[36:39], v[104:107], v[120:123], a[36:39]
    v_mfma_f32_16x16x32_bf16 a[40:43], v[108:111], v[116:119], a[40:43]
    v_mfma_f32_16x16x32_bf16 a[44:47], v[108:111], v[120:123], a[44:47]
    v_mfma_f32_16x16x32_bf16 a[48:51], v[112:115], v[116:119], a[48:51]
    v_mfma_f32_16x16x32_bf16 a[52:55], v[112:115], v[120:123], a[52:55]
    global_load_dwordx4 v[52:55], v4, s[26:27] offset:1024 sc1
    global_load_dwordx4 v[56:59], v5, s[26:27] offset:1024 sc1
    global_load_dwordx4 v[60:63], v6, s[26:27] offset:1024 sc1
    global_load_dwordx4 v[64:67], v7, s[26:27] offset:1024 sc1
    global_load_dwordx4 v[68:71], v8, s[26:27] offset:1024 sc1
    global_load_dwordx4 v[72:75], v9, s[26:27] offset:1024 sc1
    global_load_dwordx4 v[76:79], v10, s[26:27] offset:1024 sc1
    global_load_dwordx4 v[80:83], v4, s[28:29] offset:1024 sc1
    global_load_dwordx4 v[84:87], v5, s[28:29] offset:1024 sc1
    s_waitcnt vmcnt(36)
    v_mfma_f32_16x16x32_bf16 a[0:3], v[124:127], v[152:155], a[0:3]
    v_mfma_f32_16x16x32_bf16 a[4:7], v[124:127], v[156:159], a[4:7]
    v_mfma_f32_16x16x32_bf16 a[8:11], v[128:131], v[152:155], a[8:11]
    v_mfma_f32_16x16x32_bf16 a[12:15], v[128:131], v[156:159], a[12:15]
    v_mfma_f32_16x16x32_bf16 a[16:19], v[132:135], v[152:155], a[16:19]
    v_mfma_f32_16x16x32_bf16 a[20:23], v[132:135], v[156:159], a[20:23]
    v_mfma_f32_16x16x32_bf16 a[24:27], v[136:139], v[152:155], a[24:27]
    v_mfma_f32_16x16x32_bf16 a[28:31], v[136:139], v[156:159], a[28:31]
    v_mfma_f32_16x16x32_bf16 a[32:35], v[140:143], v[152:155], a[32:35]
    v_mfma_f32_16x16x32_bf16 a[36:39], v[140:143], v[156:159], a[36:39]
    v_mfma_f32_16x16x32_bf16 a[40:43], v[144:147], v[152:155], a[40:43]
    v_mfma_f32_16x16x32_bf16 a[44:47], v[144:147], v[156:159], a[44:47]
    v_mfma_f32_16x16x32_bf16 a[48:51], v[148:151], v[152:155], a[48:51]
    v_mfma_f32_16x16x32_bf16 a[52:55], v[148:151], v[156:159], a[52:55]
    global_load_dwordx4 v[88:91], v4, s[26:27] offset:2048 sc1
    global_load_dwordx4 v[92:95], v5, s[26:27] offset:2048 sc1
    global_load_dwordx4 v[96:99], v6, s[26:27] offset:2048 sc1
    global_load_dwordx4 v[100:103], v7, s[26:27] offset:2048 sc1
    global_load_dwordx4 v[104:107], v8, s[26:27] offset:2048 sc1
    global_load_dwordx4 v[108:111], v9, s[26:27] offset:2048 sc1
    global_load_dwordx4 v[112:115], v10, s[26:27] offset:2048 sc1
    global_load_dwordx4 v[116:119], v4, s[28:29] offset:2048 sc1
    global_load_dwordx4 v[120:123], v5, s[28:29] offset:2048 sc1
    s_waitcnt vmcnt(36)
    v_mfma_f32_16x16x32_bf16 a[0:3], v[160:163], v[188:191], a[0:3]
    v_mfma_f32_16x16x32_bf16 a[4:7], v[160:163], v[192:195], a[4:7]
    v_mfma_f32_16x16x32_bf16 a[8:11], v[164:167], v[188:191], a[8:11]
    v_mfma_f32_16x16x32_bf16 a[12:15], v[164:167], v[192:195], a[12:15]
    v_mfma_f32_16x16x32_bf16 a[16:19], v[168:171], v[188:191], a[16:19]
    v_mfma_f32_16x16x32_bf16 a[20:23], v[168:171], v[192:195], a[20:23]
    v_mfma_f32_16x16x32_bf16 a[24:27], v[172:175], v[188:191], a[24:27]
    v_mfma_f32_16x16x32_bf16 a[28:31], v[172:175], v[192:195], a[28:31]
    v_mfma_f32_16x16x32_bf16 a[32:35], v[176:179], v[188:191], a[32:35]
    v_mfma_f32_16x16x32_bf16 a[36:39], v[176:179], v[192:195], a[36:39]
    v_mfma_f32_16x16x32_bf16 a[40:43], v[180:183], v[188:191], a[40:43]
    v_mfma_f32_16x16x32_bf16 a[44:47], v[180:183], v[192:195], a[44:47]
    v_mfma_f32_16x16x32_bf16 a[48:51], v[184:187], v[188:191], a[48:51]
    v_mfma_f32_16x16x32_bf16 a[52:55], v[184:187], v[192:195], a[52:55]
    global_load_dwordx4 v[124:127], v4, s[26:27] offset:3072 sc1
    global_load_dwordx4 v[128:131], v5, s[26:27] offset:3072 sc1
    global_load_dwordx4 v[132:135], v6, s[26:27] offset:3072 sc1
    global_load_dwordx4 v[136:139], v7, s[26:27] offset:3072 sc1
    global_load_dwordx4 v[140:143], v8, s[26:27] offset:3072 sc1
    global_load_dwordx4 v[144:147], v9, s[26:27] offset:3072 sc1
    global_load_dwordx4 v[148:151], v10, s[26:27] offset:3072 sc1
    global_load_dwordx4 v[152:155], v4, s[28:29] offset:3072 sc1
    global_load_dwordx4 v[156:159], v5, s[28:29] offset:3072 sc1
    s_add_u32 s26, s26, 0x1000
    s_addc_u32 s27, s27, 0
    s_add_u32 s28, s28, 0x1000
    s_addc_u32 s29, s29, 0
    s_waitcnt vmcnt(36)
    v_mfma_f32_16x16x32_bf16 a[0:3], v[196:199], v[224:227], a[0:3]
    v_mfma_f32_16x16x32_bf16 a[4:7], v[196:199], v[228:231], a[4:7]
    v_mfma_f32_16x16x32_bf16 a[8:11], v[200:203], v[224:227], a[8:11]
    v_mfma_f32_16x16x32_bf16 a[12:15], v[200:203], v[228:231], a[12:15]
    v_mfma_f32_16x16x32_bf16 a[16:19], v[204:207], v[224:227], a[16:19]
    v_mfma_f32_16x16x32_bf16 a[20:23], v[204:207], v[228:231], a[20:23]
    v_mfma_f32_16x16x32_bf16 a[24:27], v[208:211], v[224:227], a[24:27]
    v_mfma_f32_16x16x32_bf16 a[28:31], v[208:211], v[228:231], a[28:31]
    v_mfma_f32_16x16x32_bf16 a[32:35], v[212:215], v[224:227], a[32:35]
    v_mfma_f32_16x16x32_bf16 a[36:39], v[212:215], v[228:231], a[36:39]
    v_mfma_f32_16x16x32_bf16 a[40:43], v[216:219], v[224:227], a[40:43]
    v_mfma_f32_16x16x32_bf16 a[44:47], v[216:219], v[228:231], a[44:47]
    v_mfma_f32_16x16x32_bf16 a[48:51], v[220:223], v[224:227], a[48:51]
    v_mfma_f32_16x16x32_bf16 a[52:55], v[220:223], v[228:231], a[52:55]
    global_load_dwordx4 v[160:163], v4, s[26:27] offset:0 sc1
    global_load_dwordx4 v[164:167], v5, s[26:27] offset:0 sc1
    global_load_dwordx4 v[168:171], v6, s[26:27] offset:0 sc1
    global_load_dwordx4 v[172:175], v7, s[26:27] offset:0 sc1
    global_load_dwordx4 v[176:179], v8, s[26:27] offset:0 sc1
    global_load_dwordx4 v[180:183], v9, s[26:27] offset:0 sc1
    global_load_dwordx4 v[184:187], v10, s[26:27] offset:0 sc1
    global_load_dwordx4 v[188:191], v4, s[28:29] offset:0 sc1
    global_load_dwordx4 v[192:195], v5, s[28:29] offset:0 sc1
    s_waitcnt vmcnt(36)
    v_mfma_f32_16x16x32_bf16 a[0:3], v[16:19], v[44:47], a[0:3]
    v_mfma_f32_16x16x32_bf16 a[4:7], v[16:19], v[48:51], a[4:7]
    v_mfma_f32_16x16x32_bf16 a[8:11], v[20:23], v[44:47], a[8:11]
    v_mfma_f32_16x16x32_bf16 a[12:15], v[20:23], v[48:51], a[12:15]
    v_mfma_f32_16x16x32_bf16 a[16:19], v[24:27], v[44:47], a[16:19]
    v_mfma_f32_16x16x32_bf16 a[20:23], v[24:27], v[48:51], a[20:23]
    v_mfma_f32_16x16x32_bf16 a[24:27], v[28:31], v[44:47], a[24:27]
    v_mfma_f32_16x16x32_bf16 a[28:31], v[28:31], v[48:51], a[28:31]
    v_mfma_f32_16x16x32_bf16 a[32:35], v[32:35], v[44:47], a[32:35]
    v_mfma_f32_16x16x32_bf16 a[36:39], v[32:35], v[48:51], a[36:39]
    v_mfma_f32_16x16x32_bf16 a[40:43], v[36:39], v[44:47], a[40:43]
    v_mfma_f32_16x16x32_bf16 a[44:47], v[36:39], v[48:51], a[44:47]
    v_mfma_f32_16x16x32_bf16 a[48:51], v[40:43], v[44:47], a[48:51]
    v_mfma_f32_16x16x32_bf16 a[52:55], v[40:43], v[48:51], a[52:55]
    global_load_dwordx4 v[196:199], v4, s[26:27] offset:1024 sc1
    global_load_dwordx4 v[200:203], v5, s[26:27] offset:1024 sc1
    global_load_dwordx4 v[204:207], v6, s[26:27] offset:1024 sc1
    global_load_dwordx4 v[208:211], v7, s[26:27] offset:1024 sc1
    global_load_dwordx4 v[212:215], v8, s[26:27] offset:1024 sc1
    global_load_dwordx4 v[216:219], v9, s[26:27] offset:1024 sc1
    global_load_dwordx4 v[220:223], v10, s[26:27] offset:1024 sc1
    global_load_dwordx4 v[224:227], v4, s[28:29] offset:1024 sc1
    global_load_dwordx4 v[228:231], v5, s[28:29] offset:1024 sc1
    s_waitcnt vmcnt(36)
    v_mfma_f32_16x16x32_bf16 a[0:3], v[52:55], v[80:83], a[0:3]
    v_mfma_f32_16x16x32_bf16 a[4:7], v[52:55], v[84:87], a[4:7]
    v_mfma_f32_16x16x32_bf16 a[8:11], v[56:59], v[80:83], a[8:11]
    v_mfma_f32_16x16x32_bf16 a[12:15], v[56:59], v[84:87], a[12:15]
    v_mfma_f32_16x16x32_bf16 a[16:19], v[60:63], v[80:83], a[16:19]
    v_mfma_f32_16x16x32_bf16 a[20:23], v[60:63], v[84:87], a[20:23]
    v_mfma_f32_16x16x32_bf16 a[24:27], v[64:67], v[80:83], a[24:27]
    v_mfma_f32_16x16x32_bf16 a[28:31], v[64:67], v[84:87], a[28:31]
    v_mfma_f32_16x16x32_bf16 a[32:35], v[68:71], v[80:83], a[32:35]
    v_mfma_f32_16x16x32_bf16 a[36:39], v[68:71], v[84:87], a[36:39]
    v_mfma_f32_16x16x32_bf16 a[40:43], v[72:75], v[80:83], a[40:43]
    v_mfma_f32_16x16x32_bf16 a[44:47], v[72:75], v[84:87], a[44:47]
    v_mfma_f32_16x16x32_bf16 a[48:51], v[76:79], v[80:83], a[48:51]
    v_mfma_f32_16x16x32_bf16 a[52:55], v[76:79], v[84:87], a[52:55]
    global_load_dwordx4 v[16:19], v4, s[26:27] offset:2048 sc1
    global_load_dwordx4 v[20:23], v5, s[26:27] offset:2048 sc1
    global_load_dwordx4 v[24:27], v6, s[26:27] offset:2048 sc1
    global_load_dwordx4 v[28:31], v7, s[26:27] offset:2048 sc1
    global_load_dwordx4 v[32:35], v8, s[26:27] offset:2048 sc1
    global_load_dwordx4 v[36:39], v9, s[26:27] offset:2048 sc1
    global_load_dwordx4 v[40:43], v10, s[26:27] offset:2048 sc1
    global_load_dwordx4 v[44:47], v4, s[28:29] offset:2048 sc1
    global_load_dwordx4 v[48:51], v5, s[28:29] offset:2048 sc1
    s_waitcnt vmcnt(36)
    v_mfma_f32_16x16x32_bf16 a[0:3], v[88:91], v[116:119], a[0:3]
    v_mfma_f32_16x16x32_bf16 a[4:7], v[88:91], v[120:123], a[4:7]
    v_mfma_f32_16x16x32_bf16 a[8:11], v[92:95], v[116:119], a[8:11]
    v_mfma_f32_16x16x32_bf16 a[12:15], v[92:95], v[120:123], a[12:15]
    v_mfma_f32_16x16x32_bf16 a[16:19], v[96:99], v[116:119], a[16:19]
    v_mfma_f32_16x16x32_bf16 a[20:23], v[96:99], v[120:123], a[20:23]
    v_mfma_f32_16x16x32_bf16 a[24:27], v[100:103], v[116:119], a[24:27]
    v_mfma_f32_16x16x32_bf16 a[28:31], v[100:103], v[120:123], a[28:31]
    v_mfma_f32_16x16x32_bf16 a[32:35], v[104:107], v[116:119], a[32:35]
    v_mfma_f32_16x16x32_bf16 a[36:39], v[104:107], v[120:123], a[36:39]
    v_mfma_f32_16x16x32_bf16 a[40:43], v[108:111], v[116:119], a[40:43]
    v_mfma_f32_16x16x32_bf16 a[44:47], v[108:111], v[120:123], a[44:47]
    v_mfma_f32_16x16x32_bf16 a[48:51], v[112:115], v[116:119], a[48:51]
    v_mfma_f32_16x16x32_bf16 a[52:55], v[112:115], v[120:123], a[52:55]
    global_load_dwordx4 v[52:55], v4, s[26:27] offset:3072 sc1
    global_load_dwordx4 v[56:59], v5, s[26:27] offset:3072 sc1
    global_load_dwordx4 v[60:63], v6, s[26:27] offset:3072 sc1
    global_load_dwordx4 v[64:67], v7, s[26:27] offset:3072 sc1
    global_load_dwordx4 v[68:71], v8, s[26:27] offset:3072 sc1
    global_load_dwordx4 v[72:75], v9, s[26:27] offset:3072 sc1
    global_load_dwordx4 v[76:79], v10, s[26:27] offset:3072 sc1
    global_load_dwordx4 v[80:83], v4, s[28:29] offset:3072 sc1
    global_load_dwordx4 v[84:87], v5, s[28:29] offset:3072 sc1
    s_add_u32 s26, s26, 0x1000
    s_addc_u32 s27, s27, 0
    s_add_u32 s28, s28, 0x1000
    s_addc_u32 s29, s29, 0
    s_waitcnt vmcnt(36)
    v_mfma_f32_16x16x32_bf16 a[0:3], v[124:127], v[152:155], a[0:3]
    v_mfma_f32_16x16x32_bf16 a[4:7], v[124:127], v[156:159], a[4:7]
    v_mfma_f32_16x16x32_bf16 a[8:11], v[128:131], v[152:155], a[8:11]
    v_mfma_f32_16x16x32_bf16 a[12:15], v[128:131], v[156:159], a[12:15]
    v_mfma_f32_16x16x32_bf16 a[16:19], v[132:135], v[152:155], a[16:19]
    v_mfma_f32_16x16x32_bf16 a[20:23], v[132:135], v[156:159], a[20:23]
    v_mfma_f32_16x16x32_bf16 a[24:27], v[136:139], v[152:155], a[24:27]
    v_mfma_f32_16x16x32_bf16 a[28:31], v[136:139], v[156:159], a[28:31]
    v_mfma_f32_16x16x32_bf16 a[32:35], v[140:143], v[152:155], a[32:35]
    v_mfma_f32_16x16x32_bf16 a[36:39], v[140:143], v[156:159], a[36:39]
    v_mfma_f32_16x16x32_bf16 a[40:43], v[144:147], v[152:155], a[40:43]
    v_mfma_f32_16x16x32_bf16 a[44:47], v[144:147], v[156:159], a[44:47]
    v_mfma_f32_16x16x32_bf16 a[48:51], v[148:151], v[152:155], a[48:51]
    v_mfma_f32_16x16x32_bf16 a[52:55], v[148:151], v[156:159], a[52:55]
    global_load_dwordx4 v[88:91], v4, s[26:27] offset:0 sc1
    global_load_dwordx4 v[92:95], v5, s[26:27] offset:0 sc1
    global_load_dwordx4 v[96:99], v6, s[26:27] offset:0 sc1
    global_load_dwordx4 v[100:103], v7, s[26:27] offset:0 sc1
    global_load_dwordx4 v[104:107], v8, s[26:27] offset:0 sc1
    global_load_dwordx4 v[108:111], v9, s[26:27] offset:0 sc1
    global_load_dwordx4 v[112:115], v10, s[26:27] offset:0 sc1
    global_load_dwordx4 v[116:119], v4, s[28:29] offset:0 sc1
    global_load_dwordx4 v[120:123], v5, s[28:29] offset:0 sc1
    s_waitcnt vmcnt(36)
    v_mfma_f32_16x16x32_bf16 a[0:3], v[160:163], v[188:191], a[0:3]
    v_mfma_f32_16x16x32_bf16 a[4:7], v[160:163], v[192:195], a[4:7]
    v_mfma_f32_16x16x32_bf16 a[8:11], v[164:167], v[188:191], a[8:11]
    v_mfma_f32_16x16x32_bf16 a[12:15], v[164:167], v[192:195], a[12:15]
    v_mfma_f32_16x16x32_bf16 a[16:19], v[168:171], v[188:191], a[16:19]
    v_mfma_f32_16x16x32_bf16 a[20:23], v[168:171], v[192:195], a[20:23]
    v_mfma_f32_16x16x32_bf16 a[24:27], v[172:175], v[188:191], a[24:27]
    v_mfma_f32_16x16x32_bf16 a[28:31], v[172:175], v[192:195], a[28:31]
    v_mfma_f32_16x16x32_bf16 a[32:35], v[176:179], v[188:191], a[32:35]
    v_mfma_f32_16x16x32_bf16 a[36:39], v[176:179], v[192:195], a[36:39]
    v_mfma_f32_16x16x32_bf16 a[40:43], v[180:183], v[188:191], a[40:43]
    v_mfma_f32_16x16x32_bf16 a[44:47], v[180:183], v[192:195], a[44:47]
    v_mfma_f32_16x16x32_bf16 a[48:51], v[184:187], v[188:191], a[48:51]
    v_mfma_f32_16x16x32_bf16 a[52:55], v[184:187], v[192:195], a[52:55]
    global_load_dwordx4 v[124:127], v4, s[26:27] offset:1024 sc1
    global_load_dwordx4 v[128:131], v5, s[26:27] offset:1024 sc1
    global_load_dwordx4 v[132:135], v6, s[26:27] offset:1024 sc1
    global_load_dwordx4 v[136:139], v7, s[26:27] offset:1024 sc1
    global_load_dwordx4 v[140:143], v8, s[26:27] offset:1024 sc1
    global_load_dwordx4 v[144:147], v9, s[26:27] offset:1024 sc1
    global_load_dwordx4 v[148:151], v10, s[26:27] offset:1024 sc1
    global_load_dwordx4 v[152:155], v4, s[28:29] offset:1024 sc1
    global_load_dwordx4 v[156:159], v5, s[28:29] offset:1024 sc1
    s_waitcnt vmcnt(36)
    v_mfma_f32_16x16x32_bf16 a[0:3], v[196:199], v[224:227], a[0:3]
    v_mfma_f32_16x16x32_bf16 a[4:7], v[196:199], v[228:231], a[4:7]
    v_mfma_f32_16x16x32_bf16 a[8:11], v[200:203], v[224:227], a[8:11]
    v_mfma_f32_16x16x32_bf16 a[12:15], v[200:203], v[228:231], a[12:15]
    v_mfma_f32_16x16x32_bf16 a[16:19], v[204:207], v[224:227], a[16:19]
    v_mfma_f32_16x16x32_bf16 a[20:23], v[204:207], v[228:231], a[20:23]
    v_mfma_f32_16x16x32_bf16 a[24:27], v[208:211], v[224:227], a[24:27]
    v_mfma_f32_16x16x32_bf16 a[28:31], v[208:211], v[228:231], a[28:31]
    v_mfma_f32_16x16x32_bf16 a[32:35], v[212:215], v[224:227], a[32:35]
    v_mfma_f32_16x16x32_bf16 a[36:39], v[212:215], v[228:231], a[36:39]
    v_mfma_f32_16x16x32_bf16 a[40:43], v[216:219], v[224:227], a[40:43]
    v_mfma_f32_16x16x32_bf16 a[44:47], v[216:219], v[228:231], a[44:47]
    v_mfma_f32_16x16x32_bf16 a[48:51], v[220:223], v[224:227], a[48:51]
    v_mfma_f32_16x16x32_bf16 a[52:55], v[220:223], v[228:231], a[52:55]
    global_load_dwordx4 v[160:163], v4, s[26:27] offset:2048 sc1
    global_load_dwordx4 v[164:167], v5, s[26:27] offset:2048 sc1
    global_load_dwordx4 v[168:171], v6, s[26:27] offset:2048 sc1
    global_load_dwordx4 v[172:175], v7, s[26:27] offset:2048 sc1
    global_load_dwordx4 v[176:179], v8, s[26:27] offset:2048 sc1
    global_load_dwordx4 v[180:183], v9, s[26:27] offset:2048 sc1
    global_load_dwordx4 v[184:187], v10, s[26:27] offset:2048 sc1
    global_load_dwordx4 v[188:191], v4, s[28:29] offset:2048 sc1
    global_load_dwordx4 v[192:195], v5, s[28:29] offset:2048 sc1
    s_waitcnt vmcnt(36)
    v_mfma_f32_16x16x32_bf16 a[0:3], v[16:19], v[44:47], a[0:3]
    v_mfma_f32_16x16x32_bf16 a[4:7], v[16:19], v[48:51], a[4:7]
    v_mfma_f32_16x16x32_bf16 a[8:11], v[20:23], v[44:47], a[8:11]
    v_mfma_f32_16x16x32_bf16 a[12:15], v[20:23], v[48:51], a[12:15]
    v_mfma_f32_16x16x32_bf16 a[16:19], v[24:27], v[44:47], a[16:19]
    v_mfma_f32_16x16x32_bf16 a[20:23], v[24:27], v[48:51], a[20:23]
    v_mfma_f32_16x16x32_bf16 a[24:27], v[28:31], v[44:47], a[24:27]
    v_mfma_f32_16x16x32_bf16 a[28:31], v[28:31], v[48:51], a[28:31]
    v_mfma_f32_16x16x32_bf16 a[32:35], v[32:35], v[44:47], a[32:35]
    v_mfma_f32_16x16x32_bf16 a[36:39], v[32:35], v[48:51], a[36:39]
    v_mfma_f32_16x16x32_bf16 a[40:43], v[36:39], v[44:47], a[40:43]
    v_mfma_f32_16x16x32_bf16 a[44:47], v[36:39], v[48:51], a[44:47]
    v_mfma_f32_16x16x32_bf16 a[48:51], v[40:43], v[44:47], a[48:51]
    v_mfma_f32_16x16x32_bf16 a[52:55], v[40:43], v[48:51], a[52:55]
    global_load_dwordx4 v[196:199], v4, s[26:27] offset:3072 sc1
    global_load_dwordx4 v[200:203], v5, s[26:27] offset:3072 sc1
    global_load_dwordx4 v[204:207], v6, s[26:27] offset:3072 sc1
    global_load_dwordx4 v[208:211], v7, s[26:27] offset:3072 sc1
    global_load_dwordx4 v[212:215], v8, s[26:27] offset:3072 sc1
    global_load_dwordx4 v[216:219], v9, s[26:27] offset:3072 sc1
    global_load_dwordx4 v[220:223], v10, s[26:27] offset:3072 sc1
    global_load_dwordx4 v[224:227], v4, s[28:29] offset:3072 sc1
    global_load_dwordx4 v[228:231], v5, s[28:29] offset:3072 sc1
    s_add_u32 s26, s26, 0x1000
    s_addc_u32 s27, s27, 0
    s_add_u32 s28, s28, 0x1000
    s_addc_u32 s29, s29, 0
    s_waitcnt vmcnt(36)
    v_mfma_f32_16x16x32_bf16 a[0:3], v[52:55], v[80:83], a[0:3]
    v_mfma_f32_16x16x32_bf16 a[4:7], v[52:55], v[84:87], a[4:7]
    v_mfma_f32_16x16x32_bf16 a[8:11], v[56:59], v[80:83], a[8:11]
    v_mfma_f32_16x16x32_bf16 a[12:15], v[56:59], v[84:87], a[12:15]
    v_mfma_f32_16x16x32_bf16 a[16:19], v[60:63], v[80:83], a[16:19]
    v_mfma_f32_16x16x32_bf16 a[20:23], v[60:63], v[84:87], a[20:23]
    v_mfma_f32_16x16x32_bf16 a[24:27], v[64:67], v[80:83], a[24:27]
    v_mfma_f32_16x16x32_bf16 a[28:31], v[64:67], v[84:87], a[28:31]
    v_mfma_f32_16x16x32_bf16 a[32:35], v[68:71], v[80:83], a[32:35]
    v_mfma_f32_16x16x32_bf16 a[36:39], v[68:71], v[84:87], a[36:39]
    v_mfma_f32_16x16x32_bf16 a[40:43], v[72:75], v[80:83], a[40:43]
    v_mfma_f32_16x16x32_bf16 a[44:47], v[72:75], v[84:87], a[44:47]
    v_mfma_f32_16x16x32_bf16 a[48:51], v[76:79], v[80:83], a[48:51]
    v_mfma_f32_16x16x32_bf16 a[52:55], v[76:79], v[84:87], a[52:55]
    global_load_dwordx4 v[16:19], v4, s[26:27] offset:0 sc1
    global_load_dwordx4 v[20:23], v5, s[26:27] offset:0 sc1
    global_load_dwordx4 v[24:27], v6, s[26:27] offset:0 sc1
    global_load_dwordx4 v[28:31], v7, s[26:27] offset:0 sc1
    global_load_dwordx4 v[32:35], v8, s[26:27] offset:0 sc1
    global_load_dwordx4 v[36:39], v9, s[26:27] offset:0 sc1
    global_load_dwordx4 v[40:43], v10, s[26:27] offset:0 sc1
    global_load_dwordx4 v[44:47], v4, s[28:29] offset:0 sc1
    global_load_dwordx4 v[48:51], v5, s[28:29] offset:0 sc1
    s_waitcnt vmcnt(36)
    v_mfma_f32_16x16x32_bf16 a[0:3], v[88:91], v[116:119], a[0:3]
    v_mfma_f32_16x16x32_bf16 a[4:7], v[88:91], v[120:123], a[4:7]
    v_mfma_f32_16x16x32_bf16 a[8:11], v[92:95], v[116:119], a[8:11]
    v_mfma_f32_16x16x32_bf16 a[12:15], v[92:95], v[120:123], a[12:15]
    v_mfma_f32_16x16x32_bf16 a[16:19], v[96:99], v[116:119], a[16:19]
    v_mfma_f32_16x16x32_bf16 a[20:23], v[96:99], v[120:123], a[20:23]
    v_mfma_f32_16x16x32_bf16 a[24:27], v[100:103], v[116:119], a[24:27]
    v_mfma_f32_16x16x32_bf16 a[28:31], v[100:103], v[120:123], a[28:31]
    v_mfma_f32_16x16x32_bf16 a[32:35], v[104:107], v[116:119], a[32:35]
    v_mfma_f32_16x16x32_bf16 a[36:39], v[104:107], v[120:123], a[36:39]
    v_mfma_f32_16x16x32_bf16 a[40:43], v[108:111], v[116:119], a[40:43]
    v_mfma_f32_16x16x32_bf16 a[44:47], v[108:111], v[120:123], a[44:47]
    v_mfma_f32_16x16x32_bf16 a[48:51], v[112:115], v[116:119], a[48:51]
    v_mfma_f32_16x16x32_bf16 a[52:55], v[112:115], v[120:123], a[52:55]
    global_load_dwordx4 v[52:55], v4, s[26:27] offset:1024 sc1
    global_load_dwordx4 v[56:59], v5, s[26:27] offset:1024 sc1
    global_load_dwordx4 v[60:63], v6, s[26:27] offset:1024 sc1
    global_load_dwordx4 v[64:67], v7, s[26:27] offset:1024 sc1
    global_load_dwordx4 v[68:71], v8, s[26:27] offset:1024 sc1
    global_load_dwordx4 v[72:75], v9, s[26:27] offset:1024 sc1
    global_load_dwordx4 v[76:79], v10, s[26:27] offset:1024 sc1
    global_load_dwordx4 v[80:83], v4, s[28:29] offset:1024 sc1
    global_load_dwordx4 v[84:87], v5, s[28:29] offset:1024 sc1
    s_waitcnt vmcnt(36)
    v_mfma_f32_16x16x32_bf16 a[0:3], v[124:127], v[152:155], a[0:3]
    v_mfma_f32_16x16x32_bf16 a[4:7], v[124:127], v[156:159], a[4:7]
    v_mfma_f32_16x16x32_bf16 a[8:11], v[128:131], v[152:155], a[8:11]
    v_mfma_f32_16x16x32_bf16 a[12:15], v[128:131], v[156:159], a[12:15]
    v_mfma_f32_16x16x32_bf16 a[16:19], v[132:135], v[152:155], a[16:19]
    v_mfma_f32_16x16x32_bf16 a[20:23], v[132:135], v[156:159], a[20:23]
    v_mfma_f32_16x16x32_bf16 a[24:27], v[136:139], v[152:155], a[24:27]
    v_mfma_f32_16x16x32_bf16 a[28:31], v[136:139], v[156:159], a[28:31]
    v_mfma_f32_16x16x32_bf16 a[32:35], v[140:143], v[152:155], a[32:35]
    v_mfma_f32_16x16x32_bf16 a[36:39], v[140:143], v[156:159], a[36:39]
    v_mfma_f32_16x16x32_bf16 a[40:43], v[144:147], v[152:155], a[40:43]
    v_mfma_f32_16x16x32_bf16 a[44:47], v[144:147], v[156:159], a[44:47]
    v_mfma_f32_16x16x32_bf16 a[48:51], v[148:151], v[152:155], a[48:51]
    v_mfma_f32_16x16x32_bf16 a[52:55], v[148:151], v[156:159], a[52:55]
    global_load_dwordx4 v[88:91], v4, s[26:27] offset:2048 sc1
    global_load_dwordx4 v[92:95], v5, s[26:27] offset:2048 sc1
    global_load_dwordx4 v[96:99], v6, s[26:27] offset:2048 sc1
    global_load_dwordx4 v[100:103], v7, s[26:27] offset:2048 sc1
    global_load_dwordx4 v[104:107], v8, s[26:27] offset:2048 sc1
    global_load_dwordx4 v[108:111], v9, s[26:27] offset:2048 sc1
    global_load_dwordx4 v[112:115], v10, s[26:27] offset:2048 sc1
    global_load_dwordx4 v[116:119], v4, s[28:29] offset:2048 sc1
    global_load_dwordx4 v[120:123], v5, s[28:29] offset:2048 sc1
    s_waitcnt vmcnt(36)
    v_mfma_f32_16x16x32_bf16 a[0:3], v[160:163], v[188:191], a[0:3]
    v_mfma_f32_16x16x32_bf16 a[4:7], v[160:163], v[192:195], a[4:7]
    v_mfma_f32_16x16x32_bf16 a[8:11], v[164:167], v[188:191], a[8:11]
    v_mfma_f32_16x16x32_bf16 a[12:15], v[164:167], v[192:195], a[12:15]
    v_mfma_f32_16x16x32_bf16 a[16:19], v[168:171], v[188:191], a[16:19]
    v_mfma_f32_16x16x32_bf16 a[20:23], v[168:171], v[192:195], a[20:23]
    v_mfma_f32_16x16x32_bf16 a[24:27], v[172:175], v[188:191], a[24:27]
    v_mfma_f32_16x16x32_bf16 a[28:31], v[172:175], v[192:195], a[28:31]
    v_mfma_f32_16x16x32_bf16 a[32:35], v[176:179], v[188:191], a[32:35]
    v_mfma_f32_16x16x32_bf16 a[36:39], v[176:179], v[192:195], a[36:39]
    v_mfma_f32_16x16x32_bf16 a[40:43], v[180:183], v[188:191], a[40:43]
    v_mfma_f32_16x16x32_bf16 a[44:47], v[180:183], v[192:195], a[44:47]
    v_mfma_f32_16x16x32_bf16 a[48:51], v[184:187], v[188:191], a[48:51]
    v_mfma_f32_16x16x32_bf16 a[52:55], v[184:187], v[192:195], a[52:55]
    global_load_dwordx4 v[124:127], v4, s[26:27] offset:3072 sc1
    global_load_dwordx4 v[128:131], v5, s[26:27] offset:3072 sc1
    global_load_dwordx4 v[132:135], v6, s[26:27] offset:3072 sc1
    global_load_dwordx4 v[136:139], v7, s[26:27] offset:3072 sc1
    global_load_dwordx4 v[140:143], v8, s[26:27] offset:3072 sc1
    global_load_dwordx4 v[144:147], v9, s[26:27] offset:3072 sc1
    global_load_dwordx4 v[148:151], v10, s[26:27] offset:3072 sc1
    global_load_dwordx4 v[152:155], v4, s[28:29] offset:3072 sc1
    global_load_dwordx4 v[156:159], v5, s[28:29] offset:3072 sc1
    s_add_u32 s26, s26, 0x1000
    s_addc_u32 s27, s27, 0
    s_add_u32 s28, s28, 0x1000
    s_addc_u32 s29, s29, 0
    s_waitcnt vmcnt(36)
    v_mfma_f32_16x16x32_bf16 a[0:3], v[196:199], v[224:227], a[0:3]
    v_mfma_f32_16x16x32_bf16 a[4:7], v[196:199], v[228:231], a[4:7]
    v_mfma_f32_16x16x32_bf16 a[8:11], v[200:203], v[224:227], a[8:11]
    v_mfma_f32_16x16x32_bf16 a[12:15], v[200:203], v[228:231], a[12:15]
    v_mfma_f32_16x16x32_bf16 a[16:19], v[204:207], v[224:227], a[16:19]
    v_mfma_f32_16x16x32_bf16 a[20:23], v[204:207], v[228:231], a[20:23]
    v_mfma_f32_16x16x32_bf16 a[24:27], v[208:211], v[224:227], a[24:27]
    v_mfma_f32_16x16x32_bf16 a[28:31], v[208:211], v[228:231], a[28:31]
    v_mfma_f32_16x16x32_bf16 a[32:35], v[212:215], v[224:227], a[32:35]
    v_mfma_f32_16x16x32_bf16 a[36:39], v[212:215], v[228:231], a[36:39]
    v_mfma_f32_16x16x32_bf16 a[40:43], v[216:219], v[224:227], a[40:43]
    v_mfma_f32_16x16x32_bf16 a[44:47], v[216:219], v[228:231], a[44:47]
    v_mfma_f32_16x16x32_bf16 a[48:51], v[220:223], v[224:227], a[48:51]
    v_mfma_f32_16x16x32_bf16 a[52:55], v[220:223], v[228:231], a[52:55]
    global_load_dwordx4 v[160:163], v4, s[26:27] offset:0 sc1
    global_load_dwordx4 v[164:167], v5, s[26:27] offset:0 sc1
    global_load_dwordx4 v[168:171], v6, s[26:27] offset:0 sc1
    global_load_dwordx4 v[172:175], v7, s[26:27] offset:0 sc1
    global_load_dwordx4 v[176:179], v8, s[26:27] offset:0 sc1
    global_load_dwordx4 v[180:183], v9, s[26:27] offset:0 sc1
    global_load_dwordx4 v[184:187], v10, s[26:27] offset:0 sc1
    global_load_dwordx4 v[188:191], v4, s[28:29] offset:0 sc1
    global_load_dwordx4 v[192:195], v5, s[28:29] offset:0 sc1
    s_waitcnt vmcnt(36)
    v_mfma_f32_16x16x32_bf16 a[0:3], v[16:19], v[44:47], a[0:3]
    v_mfma_f32_16x16x32_bf16 a[4:7], v[16:19], v[48:51], a[4:7]
    v_mfma_f32_16x16x32_bf16 a[8:11], v[20:23], v[44:47], a[8:11]
    v_mfma_f32_16x16x32_bf16 a[12:15], v[20:23], v[48:51], a[12:15]
    v_mfma_f32_16x16x32_bf16 a[16:19], v[24:27], v[44:47], a[16:19]
    v_mfma_f32_16x16x32_bf16 a[20:23], v[24:27], v[48:51], a[20:23]
    v_mfma_f32_16x16x32_bf16 a[24:27], v[28:31], v[44:47], a[24:27]
    v_mfma_f32_16x16x32_bf16 a[28:31], v[28:31], v[48:51], a[28:31]
    v_mfma_f32_16x16x32_bf16 a[32:35], v[32:35], v[44:47], a[32:35]
    v_mfma_f32_16x16x32_bf16 a[36:39], v[32:35], v[48:51], a[36:39]
    v_mfma_f32_16x16x32_bf16 a[40:43], v[36:39], v[44:47], a[40:43]
    v_mfma_f32_16x16x32_bf16 a[44:47], v[36:39], v[48:51], a[44:47]
    v_mfma_f32_16x16x32_bf16 a[48:51], v[40:43], v[44:47], a[48:51]
    v_mfma_f32_16x16x32_bf16 a[52:55], v[40:43], v[48:51], a[52:55]
    global_load_dwordx4 v[196:199], v4, s[26:27] offset:1024 sc1
    global_load_dwordx4 v[200:203], v5, s[26:27] offset:1024 sc1
    global_load_dwordx4 v[204:207], v6, s[26:27] offset:1024 sc1
    global_load_dwordx4 v[208:211], v7, s[26:27] offset:1024 sc1
    global_load_dwordx4 v[212:215], v8, s[26:27] offset:1024 sc1
    global_load_dwordx4 v[216:219], v9, s[26:27] offset:1024 sc1
    global_load_dwordx4 v[220:223], v10, s[26:27] offset:1024 sc1
    global_load_dwordx4 v[224:227], v4, s[28:29] offset:1024 sc1
    global_load_dwordx4 v[228:231], v5, s[28:29] offset:1024 sc1
    s_waitcnt vmcnt(36)
    v_mfma_f32_16x16x32_bf16 a[0:3], v[52:55], v[80:83], a[0:3]
    v_mfma_f32_16x16x32_bf16 a[4:7], v[52:55], v[84:87], a[4:7]
    v_mfma_f32_16x16x32_bf16 a[8:11], v[56:59], v[80:83], a[8:11]
    v_mfma_f32_16x16x32_bf16 a[12:15], v[56:59], v[84:87], a[12:15]
    v_mfma_f32_16x16x32_bf16 a[16:19], v[60:63], v[80:83], a[16:19]
    v_mfma_f32_16x16x32_bf16 a[20:23], v[60:63], v[84:87], a[20:23]
    v_mfma_f32_16x16x32_bf16 a[24:27], v[64:67], v[80:83], a[24:27]
    v_mfma_f32_16x16x32_bf16 a[28:31], v[64:67], v[84:87], a[28:31]
    v_mfma_f32_16x16x32_bf16 a[32:35], v[68:71], v[80:83], a[32:35]
    v_mfma_f32_16x16x32_bf16 a[36:39], v[68:71], v[84:87], a[36:39]
    v_mfma_f32_16x16x32_bf16 a[40:43], v[72:75], v[80:83], a[40:43]
    v_mfma_f32_16x16x32_bf16 a[44:47], v[72:75], v[84:87], a[44:47]
    v_mfma_f32_16x16x32_bf16 a[48:51], v[76:79], v[80:83], a[48:51]
    v_mfma_f32_16x16x32_bf16 a[52:55], v[76:79], v[84:87], a[52:55]
    global_load_dwordx4 v[16:19], v4, s[26:27] offset:2048 sc1
    global_load_dwordx4 v[20:23], v5, s[26:27] offset:2048 sc1
    global_load_dwordx4 v[24:27], v6, s[26:27] offset:2048 sc1
    global_load_dwordx4 v[28:31], v7, s[26:27] offset:2048 sc1
    global_load_dwordx4 v[32:35], v8, s[26:27] offset:2048 sc1
    global_load_dwordx4 v[36:39], v9, s[26:27] offset:2048 sc1
    global_load_dwordx4 v[40:43], v10, s[26:27] offset:2048 sc1
    global_load_dwordx4 v[44:47], v4, s[28:29] offset:2048 sc1
    global_load_dwordx4 v[48:51], v5, s[28:29] offset:2048 sc1
    s_waitcnt vmcnt(36)
    v_mfma_f32_16x16x32_bf16 a[0:3], v[88:91], v[116:119], a[0:3]
    v_mfma_f32_16x16x32_bf16 a[4:7], v[88:91], v[120:123], a[4:7]
    v_mfma_f32_16x16x32_bf16 a[8:11], v[92:95], v[116:119], a[8:11]
    v_mfma_f32_16x16x32_bf16 a[12:15], v[92:95], v[120:123], a[12:15]
    v_mfma_f32_16x16x32_bf16 a[16:19], v[96:99], v[116:119], a[16:19]
    v_mfma_f32_16x16x32_bf16 a[20:23], v[96:99], v[120:123], a[20:23]
    v_mfma_f32_16x16x32_bf16 a[24:27], v[100:103], v[116:119], a[24:27]
    v_mfma_f32_16x16x32_bf16 a[28:31], v[100:103], v[120:123], a[28:31]
    v_mfma_f32_16x16x32_bf16 a[32:35], v[104:107], v[116:119], a[32:35]
    v_mfma_f32_16x16x32_bf16 a[36:39], v[104:107], v[120:123], a[36:39]
    v_mfma_f32_16x16x32_bf16 a[40:43], v[108:111], v[116:119], a[40:43]
    v_mfma_f32_16x16x32_bf16 a[44:47], v[108:111], v[120:123], a[44:47]
    v_mfma_f32_16x16x32_bf16 a[48:51], v[112:115], v[116:119], a[48:51]
    v_mfma_f32_16x16x32_bf16 a[52:55], v[112:115], v[120:123], a[52:55]
    global_load_dwordx4 v[52:55], v4, s[26:27] offset:3072 sc1
    global_load_dwordx4 v[56:59], v5, s[26:27] offset:3072 sc1
    global_load_dwordx4 v[60:63], v6, s[26:27] offset:3072 sc1
    global_load_dwordx4 v[64:67], v7, s[26:27] offset:3072 sc1
    global_load_dwordx4 v[68:71], v8, s[26:27] offset:3072 sc1
    global_load_dwordx4 v[72:75], v9, s[26:27] offset:3072 sc1
    global_load_dwordx4 v[76:79], v10, s[26:27] offset:3072 sc1
    global_load_dwordx4 v[80:83], v4, s[28:29] offset:3072 sc1
    global_load_dwordx4 v[84:87], v5, s[28:29] offset:3072 sc1
    s_add_u32 s26, s26, 0x1000
    s_addc_u32 s27, s27, 0
    s_add_u32 s28, s28, 0x1000
    s_addc_u32 s29, s29, 0
    s_waitcnt vmcnt(36)
    v_mfma_f32_16x16x32_bf16 a[0:3], v[124:127], v[152:155], a[0:3]
    v_mfma_f32_16x16x32_bf16 a[4:7], v[124:127], v[156:159], a[4:7]
    v_mfma_f32_16x16x32_bf16 a[8:11], v[128:131], v[152:155], a[8:11]
    v_mfma_f32_16x16x32_bf16 a[12:15], v[128:131], v[156:159], a[12:15]
    v_mfma_f32_16x16x32_bf16 a[16:19], v[132:135], v[152:155], a[16:19]
    v_mfma_f32_16x16x32_bf16 a[20:23], v[132:135], v[156:159], a[20:23]
    v_mfma_f32_16x16x32_bf16 a[24:27], v[136:139], v[152:155], a[24:27]
    v_mfma_f32_16x16x32_bf16 a[28:31], v[136:139], v[156:159], a[28:31]
    v_mfma_f32_16x16x32_bf16 a[32:35], v[140:143], v[152:155], a[32:35]
    v_mfma_f32_16x16x32_bf16 a[36:39], v[140:143], v[156:159], a[36:39]
    v_mfma_f32_16x16x32_bf16 a[40:43], v[144:147], v[152:155], a[40:43]
    v_mfma_f32_16x16x32_bf16 a[44:47], v[144:147], v[156:159], a[44:47]
    v_mfma_f32_16x16x32_bf16 a[48:51], v[148:151], v[152:155], a[48:51]
    v_mfma_f32_16x16x32_bf16 a[52:55], v[148:151], v[156:159], a[52:55]
    global_load_dwordx4 v[88:91], v4, s[26:27] offset:0 sc1
    global_load_dwordx4 v[92:95], v5, s[26:27] offset:0 sc1
    global_load_dwordx4 v[96:99], v6, s[26:27] offset:0 sc1
    global_load_dwordx4 v[100:103], v7, s[26:27] offset:0 sc1
    global_load_dwordx4 v[104:107], v8, s[26:27] offset:0 sc1
    global_load_dwordx4 v[108:111], v9, s[26:27] offset:0 sc1
    global_load_dwordx4 v[112:115], v10, s[26:27] offset:0 sc1
    global_load_dwordx4 v[116:119], v4, s[28:29] offset:0 sc1
    global_load_dwordx4 v[120:123], v5, s[28:29] offset:0 sc1
    s_waitcnt vmcnt(36)
    v_mfma_f32_16x16x32_bf16 a[0:3], v[160:163], v[188:191], a[0:3]
    v_mfma_f32_16x16x32_bf16 a[4:7], v[160:163], v[192:195], a[4:7]
    v_mfma_f32_16x16x32_bf16 a[8:11], v[164:167], v[188:191], a[8:11]
    v_mfma_f32_16x16x32_bf16 a[12:15], v[164:167], v[192:195], a[12:15]
    v_mfma_f32_16x16x32_bf16 a[16:19], v[168:171], v[188:191], a[16:19]
    v_mfma_f32_16x16x32_bf16 a[20:23], v[168:171], v[192:195], a[20:23]
    v_mfma_f32_16x16x32_bf16 a[24:27], v[172:175], v[188:191], a[24:27]
    v_mfma_f32_16x16x32_bf16 a[28:31], v[172:175], v[192:195], a[28:31]
    v_mfma_f32_16x16x32_bf16 a[32:35], v[176:179], v[188:191], a[32:35]
    v_mfma_f32_16x16x32_bf16 a[36:39], v[176:179], v[192:195], a[36:39]
    v_mfma_f32_16x16x32_bf16 a[40:43], v[180:183], v[188:191], a[40:43]
    v_mfma_f32_16x16x32_bf16 a[44:47], v[180:183], v[192:195], a[44:47]
    v_mfma_f32_16x16x32_bf16 a[48:51], v[184:187], v[188:191], a[48:51]
    v_mfma_f32_16x16x32_bf16 a[52:55], v[184:187], v[192:195], a[52:55]
    global_load_dwordx4 v[124:127], v4, s[26:27] offset:1024 sc1
    global_load_dwordx4 v[128:131], v5, s[26:27] offset:1024 sc1
    global_load_dwordx4 v[132:135], v6, s[26:27] offset:1024 sc1
    global_load_dwordx4 v[136:139], v7, s[26:27] offset:1024 sc1
    global_load_dwordx4 v[140:143], v8, s[26:27] offset:1024 sc1
    global_load_dwordx4 v[144:147], v9, s[26:27] offset:1024 sc1
    global_load_dwordx4 v[148:151], v10, s[26:27] offset:1024 sc1
    global_load_dwordx4 v[152:155], v4, s[28:29] offset:1024 sc1
    global_load_dwordx4 v[156:159], v5, s[28:29] offset:1024 sc1
    s_waitcnt vmcnt(36)
    v_mfma_f32_16x16x32_bf16 a[0:3], v[196:199], v[224:227], a[0:3]
    v_mfma_f32_16x16x32_bf16 a[4:7], v[196:199], v[228:231], a[4:7]
    v_mfma_f32_16x16x32_bf16 a[8:11], v[200:203], v[224:227], a[8:11]
    v_mfma_f32_16x16x32_bf16 a[12:15], v[200:203], v[228:231], a[12:15]
    v_mfma_f32_16x16x32_bf16 a[16:19], v[204:207], v[224:227], a[16:19]
    v_mfma_f32_16x16x32_bf16 a[20:23], v[204:207], v[228:231], a[20:23]
    v_mfma_f32_16x16x32_bf16 a[24:27], v[208:211], v[224:227], a[24:27]
    v_mfma_f32_16x16x32_bf16 a[28:31], v[208:211], v[228:231], a[28:31]
    v_mfma_f32_16x16x32_bf16 a[32:35], v[212:215], v[224:227], a[32:35]
    v_mfma_f32_16x16x32_bf16 a[36:39], v[212:215], v[228:231], a[36:39]
    v_mfma_f32_16x16x32_bf16 a[40:43], v[216:219], v[224:227], a[40:43]
    v_mfma_f32_16x16x32_bf16 a[44:47], v[216:219], v[228:231], a[44:47]
    v_mfma_f32_16x16x32_bf16 a[48:51], v[220:223], v[224:227], a[48:51]
    v_mfma_f32_16x16x32_bf16 a[52:55], v[220:223], v[228:231], a[52:55]
    global_load_dwordx4 v[160:163], v4, s[26:27] offset:2048 sc1
    global_load_dwordx4 v[164:167], v5, s[26:27] offset:2048 sc1
    global_load_dwordx4 v[168:171], v6, s[26:27] offset:2048 sc1
    global_load_dwordx4 v[172:175], v7, s[26:27] offset:2048 sc1
    global_load_dwordx4 v[176:179], v8, s[26:27] offset:2048 sc1
    global_load_dwordx4 v[180:183], v9, s[26:27] offset:2048 sc1
    global_load_dwordx4 v[184:187], v10, s[26:27] offset:2048 sc1
    global_load_dwordx4 v[188:191], v4, s[28:29] offset:2048 sc1
    global_load_dwordx4 v[192:195], v5, s[28:29] offset:2048 sc1
    s_waitcnt vmcnt(36)
    v_mfma_f32_16x16x32_bf16 a[0:3], v[16:19], v[44:47], a[0:3]
    v_mfma_f32_16x16x32_bf16 a[4:7], v[16:19], v[48:51], a[4:7]
    v_mfma_f32_16x16x32_bf16 a[8:11], v[20:23], v[44:47], a[8:11]
    v_mfma_f32_16x16x32_bf16 a[12:15], v[20:23], v[48:51], a[12:15]
    v_mfma_f32_16x16x32_bf16 a[16:19], v[24:27], v[44:47], a[16:19]
    v_mfma_f32_16x16x32_bf16 a[20:23], v[24:27], v[48:51], a[20:23]
    v_mfma_f32_16x16x32_bf16 a[24:27], v[28:31], v[44:47], a[24:27]
    v_mfma_f32_16x16x32_bf16 a[28:31], v[28:31], v[48:51], a[28:31]
    v_mfma_f32_16x16x32_bf16 a[32:35], v[32:35], v[44:47], a[32:35]
    v_mfma_f32_16x16x32_bf16 a[36:39], v[32:35], v[48:51], a[36:39]
    v_mfma_f32_16x16x32_bf16 a[40:43], v[36:39], v[44:47], a[40:43]
    v_mfma_f32_16x16x32_bf16 a[44:47], v[36:39], v[48:51], a[44:47]
    v_mfma_f32_16x16x32_bf16 a[48:51], v[40:43], v[44:47], a[48:51]
    v_mfma_f32_16x16x32_bf16 a[52:55], v[40:43], v[48:51], a[52:55]
    global_load_dwordx4 v[196:199], v4, s[26:27] offset:3072 sc1
    global_load_dwordx4 v[200:203], v5, s[26:27] offset:3072 sc1
    global_load_dwordx4 v[204:207], v6, s[26:27] offset:3072 sc1
    global_load_dwordx4 v[208:211], v7, s[26:27] offset:3072 sc1
    global_load_dwordx4 v[212:215], v8, s[26:27] offset:3072 sc1
    global_load_dwordx4 v[216:219], v9, s[26:27] offset:3072 sc1
    global_load_dwordx4 v[220:223], v10, s[26:27] offset:3072 sc1
    global_load_dwordx4 v[224:227], v4, s[28:29] offset:3072 sc1
    global_load_dwordx4 v[228:231], v5, s[28:29] offset:3072 sc1
    s_add_u32 s26, s26, 0x1000
    s_addc_u32 s27, s27, 0
    s_add_u32 s28, s28, 0x1000
    s_addc_u32 s29, s29, 0
    s_waitcnt vmcnt(36)
    v_mfma_f32_16x16x32_bf16 a[0:3], v[52:55], v[80:83], a[0:3]
    v_mfma_f32_16x16x32_bf16 a[4:7], v[52:55], v[84:87], a[4:7]
    v_mfma_f32_16x16x32_bf16 a[8:11], v[56:59], v[80:83], a[8:11]
    v_mfma_f32_16x16x32_bf16 a[12:15], v[56:59], v[84:87], a[12:15]
    v_mfma_f32_16x16x32_bf16 a[16:19], v[60:63], v[80:83], a[16:19]
    v_mfma_f32_16x16x32_bf16 a[20:23], v[60:63], v[84:87], a[20:23]
    v_mfma_f32_16x16x32_bf16 a[24:27], v[64:67], v[80:83], a[24:27]
    v_mfma_f32_16x16x32_bf16 a[28:31], v[64:67], v[84:87], a[28:31]
    v_mfma_f32_16x16x32_bf16 a[32:35], v[68:71], v[80:83], a[32:35]
    v_mfma_f32_16x16x32_bf16 a[36:39], v[68:71], v[84:87], a[36:39]
    v_mfma_f32_16x16x32_bf16 a[40:43], v[72:75], v[80:83], a[40:43]
    v_mfma_f32_16x16x32_bf16 a[44:47], v[72:75], v[84:87], a[44:47]
    v_mfma_f32_16x16x32_bf16 a[48:51], v[76:79], v[80:83], a[48:51]
    v_mfma_f32_16x16x32_bf16 a[52:55], v[76:79], v[84:87], a[52:55]
    global_load_dwordx4 v[16:19], v4, s[26:27] offset:0 sc1
    global_load_dwordx4 v[20:23], v5, s[26:27] offset:0 sc1
    global_load_dwordx4 v[24:27], v6, s[26:27] offset:0 sc1
    global_load_dwordx4 v[28:31], v7, s[26:27] offset:0 sc1
    global_load_dwordx4 v[32:35], v8, s[26:27] offset:0 sc1
    global_load_dwordx4 v[36:39], v9, s[26:27] offset:0 sc1
    global_load_dwordx4 v[40:43], v10, s[26:27] offset:0 sc1
    global_load_dwordx4 v[44:47], v4, s[28:29] offset:0 sc1
    global_load_dwordx4 v[48:51], v5, s[28:29] offset:0 sc1
    s_waitcnt vmcnt(36)
    v_mfma_f32_16x16x32_bf16 a[0:3], v[88:91], v[116:119], a[0:3]
    v_mfma_f32_16x16x32_bf16 a[4:7], v[88:91], v[120:123], a[4:7]
    v_mfma_f32_16x16x32_bf16 a[8:11], v[92:95], v[116:119], a[8:11]
    v_mfma_f32_16x16x32_bf16 a[12:15], v[92:95], v[120:123], a[12:15]
    v_mfma_f32_16x16x32_bf16 a[16:19], v[96:99], v[116:119], a[16:19]
    v_mfma_f32_16x16x32_bf16 a[20:23], v[96:99], v[120:123], a[20:23]
    v_mfma_f32_16x16x32_bf16 a[24:27], v[100:103], v[116:119], a[24:27]
    v_mfma_f32_16x16x32_bf16 a[28:31], v[100:103], v[120:123], a[28:31]
    v_mfma_f32_16x16x32_bf16 a[32:35], v[104:107], v[116:119], a[32:35]
    v_mfma_f32_16x16x32_bf16 a[36:39], v[104:107], v[120:123], a[36:39]
    v_mfma_f32_16x16x32_bf16 a[40:43], v[108:111], v[116:119], a[40:43]
    v_mfma_f32_16x16x32_bf16 a[44:47], v[108:111], v[120:123], a[44:47]
    v_mfma_f32_16x16x32_bf16 a[48:51], v[112:115], v[116:119], a[48:51]
    v_mfma_f32_16x16x32_bf16 a[52:55], v[112:115], v[120:123], a[52:55]
    global_load_dwordx4 v[52:55], v4, s[26:27] offset:1024 sc1
    global_load_dwordx4 v[56:59], v5, s[26:27] offset:1024 sc1
    global_load_dwordx4 v[60:63], v6, s[26:27] offset:1024 sc1
    global_load_dwordx4 v[64:67], v7, s[26:27] offset:1024 sc1
    global_load_dwordx4 v[68:71], v8, s[26:27] offset:1024 sc1
    global_load_dwordx4 v[72:75], v9, s[26:27] offset:1024 sc1
    global_load_dwordx4 v[76:79], v10, s[26:27] offset:1024 sc1
    global_load_dwordx4 v[80:83], v4, s[28:29] offset:1024 sc1
    global_load_dwordx4 v[84:87], v5, s[28:29] offset:1024 sc1
    s_waitcnt vmcnt(36)
    v_mfma_f32_16x16x32_bf16 a[0:3], v[124:127], v[152:155], a[0:3]
    v_mfma_f32_16x16x32_bf16 a[4:7], v[124:127], v[156:159], a[4:7]
    v_mfma_f32_16x16x32_bf16 a[8:11], v[128:131], v[152:155], a[8:11]
    v_mfma_f32_16x16x32_bf16 a[12:15], v[128:131], v[156:159], a[12:15]
    v_mfma_f32_16x16x32_bf16 a[16:19], v[132:135], v[152:155], a[16:19]
    v_mfma_f32_16x16x32_bf16 a[20:23], v[132:135], v[156:159], a[20:23]
    v_mfma_f32_16x16x32_bf16 a[24:27], v[136:139], v[152:155], a[24:27]
    v_mfma_f32_16x16x32_bf16 a[28:31], v[136:139], v[156:159], a[28:31]
    v_mfma_f32_16x16x32_bf16 a[32:35], v[140:143], v[152:155], a[32:35]
    v_mfma_f32_16x16x32_bf16 a[36:39], v[140:143], v[156:159], a[36:39]
    v_mfma_f32_16x16x32_bf16 a[40:43], v[144:147], v[152:155], a[40:43]
    v_mfma_f32_16x16x32_bf16 a[44:47], v[144:147], v[156:159], a[44:47]
    v_mfma_f32_16x16x32_bf16 a[48:51], v[148:151], v[152:155], a[48:51]
    v_mfma_f32_16x16x32_bf16 a[52:55], v[148:151], v[156:159], a[52:55]
    global_load_dwordx4 v[88:91], v4, s[26:27] offset:2048 sc1
    global_load_dwordx4 v[92:95], v5, s[26:27] offset:2048 sc1
    global_load_dwordx4 v[96:99], v6, s[26:27] offset:2048 sc1
    global_load_dwordx4 v[100:103], v7, s[26:27] offset:2048 sc1
    global_load_dwordx4 v[104:107], v8, s[26:27] offset:2048 sc1
    global_load_dwordx4 v[108:111], v9, s[26:27] offset:2048 sc1
    global_load_dwordx4 v[112:115], v10, s[26:27] offset:2048 sc1
    global_load_dwordx4 v[116:119], v4, s[28:29] offset:2048 sc1
    global_load_dwordx4 v[120:123], v5, s[28:29] offset:2048 sc1
    s_waitcnt vmcnt(36)
    v_mfma_f32_16x16x32_bf16 a[0:3], v[160:163], v[188:191], a[0:3]
    v_mfma_f32_16x16x32_bf16 a[4:7], v[160:163], v[192:195], a[4:7]
    v_mfma_f32_16x16x32_bf16 a[8:11], v[164:167], v[188:191], a[8:11]
    v_mfma_f32_16x16x32_bf16 a[12:15], v[164:167], v[192:195], a[12:15]
    v_mfma_f32_16x16x32_bf16 a[16:19], v[168:171], v[188:191], a[16:19]
    v_mfma_f32_16x16x32_bf16 a[20:23], v[168:171], v[192:195], a[20:23]
    v_mfma_f32_16x16x32_bf16 a[24:27], v[172:175], v[188:191], a[24:27]
    v_mfma_f32_16x16x32_bf16 a[28:31], v[172:175], v[192:195], a[28:31]
    v_mfma_f32_16x16x32_bf16 a[32:35], v[176:179], v[188:191], a[32:35]
    v_mfma_f32_16x16x32_bf16 a[36:39], v[176:179], v[192:195], a[36:39]
    v_mfma_f32_16x16x32_bf16 a[40:43], v[180:183], v[188:191], a[40:43]
    v_mfma_f32_16x16x32_bf16 a[44:47], v[180:183], v[192:195], a[44:47]
    v_mfma_f32_16x16x32_bf16 a[48:51], v[184:187], v[188:191], a[48:51]
    v_mfma_f32_16x16x32_bf16 a[52:55], v[184:187], v[192:195], a[52:55]
    global_load_dwordx4 v[124:127], v4, s[26:27] offset:3072 sc1
    global_load_dwordx4 v[128:131], v5, s[26:27] offset:3072 sc1
    global_load_dwordx4 v[132:135], v6, s[26:27] offset:3072 sc1
    global_load_dwordx4 v[136:139], v7, s[26:27] offset:3072 sc1
    global_load_dwordx4 v[140:143], v8, s[26:27] offset:3072 sc1
    global_load_dwordx4 v[144:147], v9, s[26:27] offset:3072 sc1
    global_load_dwordx4 v[148:151], v10, s[26:27] offset:3072 sc1
    global_load_dwordx4 v[152:155], v4, s[28:29] offset:3072 sc1
    global_load_dwordx4 v[156:159], v5, s[28:29] offset:3072 sc1
    s_add_u32 s26, s26, 0x1000
    s_addc_u32 s27, s27, 0
    s_add_u32 s28, s28, 0x1000
    s_addc_u32 s29, s29, 0
    s_waitcnt vmcnt(36)
    v_mfma_f32_16x16x32_bf16 a[0:3], v[196:199], v[224:227], a[0:3]
    v_mfma_f32_16x16x32_bf16 a[4:7], v[196:199], v[228:231], a[4:7]
    v_mfma_f32_16x16x32_bf16 a[8:11], v[200:203], v[224:227], a[8:11]
    v_mfma_f32_16x16x32_bf16 a[12:15], v[200:203], v[228:231], a[12:15]
    v_mfma_f32_16x16x32_bf16 a[16:19], v[204:207], v[224:227], a[16:19]
    v_mfma_f32_16x16x32_bf16 a[20:23], v[204:207], v[228:231], a[20:23]
    v_mfma_f32_16x16x32_bf16 a[24:27], v[208:211], v[224:227], a[24:27]
    v_mfma_f32_16x16x32_bf16 a[28:31], v[208:211], v[228:231], a[28:31]
    v_mfma_f32_16x16x32_bf16 a[32:35], v[212:215], v[224:227], a[32:35]
    v_mfma_f32_16x16x32_bf16 a[36:39], v[212:215], v[228:231], a[36:39]
    v_mfma_f32_16x16x32_bf16 a[40:43], v[216:219], v[224:227], a[40:43]
    v_mfma_f32_16x16x32_bf16 a[44:47], v[216:219], v[228:231], a[44:47]
    v_mfma_f32_16x16x32_bf16 a[48:51], v[220:223], v[224:227], a[48:51]
    v_mfma_f32_16x16x32_bf16 a[52:55], v[220:223], v[228:231], a[52:55]
    global_load_dwordx4 v[160:163], v4, s[26:27] offset:0 sc1
    global_load_dwordx4 v[164:167], v5, s[26:27] offset:0 sc1
    global_load_dwordx4 v[168:171], v6, s[26:27] offset:0 sc1
    global_load_dwordx4 v[172:175], v7, s[26:27] offset:0 sc1
    global_load_dwordx4 v[176:179], v8, s[26:27] offset:0 sc1
    global_load_dwordx4 v[180:183], v9, s[26:27] offset:0 sc1
    global_load_dwordx4 v[184:187], v10, s[26:27] offset:0 sc1
    global_load_dwordx4 v[188:191], v4, s[28:29] offset:0 sc1
    global_load_dwordx4 v[192:195], v5, s[28:29] offset:0 sc1
    s_waitcnt vmcnt(36)
    v_mfma_f32_16x16x32_bf16 a[0:3], v[16:19], v[44:47], a[0:3]
    v_mfma_f32_16x16x32_bf16 a[4:7], v[16:19], v[48:51], a[4:7]
    v_mfma_f32_16x16x32_bf16 a[8:11], v[20:23], v[44:47], a[8:11]
    v_mfma_f32_16x16x32_bf16 a[12:15], v[20:23], v[48:51], a[12:15]
    v_mfma_f32_16x16x32_bf16 a[16:19], v[24:27], v[44:47], a[16:19]
    v_mfma_f32_16x16x32_bf16 a[20:23], v[24:27], v[48:51], a[20:23]
    v_mfma_f32_16x16x32_bf16 a[24:27], v[28:31], v[44:47], a[24:27]
    v_mfma_f32_16x16x32_bf16 a[28:31], v[28:31], v[48:51], a[28:31]
    v_mfma_f32_16x16x32_bf16 a[32:35], v[32:35], v[44:47], a[32:35]
    v_mfma_f32_16x16x32_bf16 a[36:39], v[32:35], v[48:51], a[36:39]
    v_mfma_f32_16x16x32_bf16 a[40:43], v[36:39], v[44:47], a[40:43]
    v_mfma_f32_16x16x32_bf16 a[44:47], v[36:39], v[48:51], a[44:47]
    v_mfma_f32_16x16x32_bf16 a[48:51], v[40:43], v[44:47], a[48:51]
    v_mfma_f32_16x16x32_bf16 a[52:55], v[40:43], v[48:51], a[52:55]
    global_load_dwordx4 v[196:199], v4, s[26:27] offset:1024 sc1
    global_load_dwordx4 v[200:203], v5, s[26:27] offset:1024 sc1
    global_load_dwordx4 v[204:207], v6, s[26:27] offset:1024 sc1
    global_load_dwordx4 v[208:211], v7, s[26:27] offset:1024 sc1
    global_load_dwordx4 v[212:215], v8, s[26:27] offset:1024 sc1
    global_load_dwordx4 v[216:219], v9, s[26:27] offset:1024 sc1
    global_load_dwordx4 v[220:223], v10, s[26:27] offset:1024 sc1
    global_load_dwordx4 v[224:227], v4, s[28:29] offset:1024 sc1
    global_load_dwordx4 v[228:231], v5, s[28:29] offset:1024 sc1
    s_waitcnt vmcnt(36)
    v_mfma_f32_16x16x32_bf16 a[0:3], v[52:55], v[80:83], a[0:3]
    v_mfma_f32_16x16x32_bf16 a[4:7], v[52:55], v[84:87], a[4:7]
    v_mfma_f32_16x16x32_bf16 a[8:11], v[56:59], v[80:83], a[8:11]
    v_mfma_f32_16x16x32_bf16 a[12:15], v[56:59], v[84:87], a[12:15]
    v_mfma_f32_16x16x32_bf16 a[16:19], v[60:63], v[80:83], a[16:19]
    v_mfma_f32_16x16x32_bf16 a[20:23], v[60:63], v[84:87], a[20:23]
    v_mfma_f32_16x16x32_bf16 a[24:27], v[64:67], v[80:83], a[24:27]
    v_mfma_f32_16x16x32_bf16 a[28:31], v[64:67], v[84:87], a[28:31]
    v_mfma_f32_16x16x32_bf16 a[32:35], v[68:71], v[80:83], a[32:35]
    v_mfma_f32_16x16x32_bf16 a[36:39], v[68:71], v[84:87], a[36:39]
    v_mfma_f32_16x16x32_bf16 a[40:43], v[72:75], v[80:83], a[40:43]
    v_mfma_f32_16x16x32_bf16 a[44:47], v[72:75], v[84:87], a[44:47]
    v_mfma_f32_16x16x32_bf16 a[48:51], v[76:79], v[80:83], a[48:51]
    v_mfma_f32_16x16x32_bf16 a[52:55], v[76:79], v[84:87], a[52:55]
    global_load_dwordx4 v[16:19], v4, s[26:27] offset:2048 sc1
    global_load_dwordx4 v[20:23], v5, s[26:27] offset:2048 sc1
    global_load_dwordx4 v[24:27], v6, s[26:27] offset:2048 sc1
    global_load_dwordx4 v[28:31], v7, s[26:27] offset:2048 sc1
    global_load_dwordx4 v[32:35], v8, s[26:27] offset:2048 sc1
    global_load_dwordx4 v[36:39], v9, s[26:27] offset:2048 sc1
    global_load_dwordx4 v[40:43], v10, s[26:27] offset:2048 sc1
    global_load_dwordx4 v[44:47], v4, s[28:29] offset:2048 sc1
    global_load_dwordx4 v[48:51], v5, s[28:29] offset:2048 sc1
    s_waitcnt vmcnt(36)
    v_mfma_f32_16x16x32_bf16 a[0:3], v[88:91], v[116:119], a[0:3]
    v_mfma_f32_16x16x32_bf16 a[4:7], v[88:91], v[120:123], a[4:7]
    v_mfma_f32_16x16x32_bf16 a[8:11], v[92:95], v[116:119], a[8:11]
    v_mfma_f32_16x16x32_bf16 a[12:15], v[92:95], v[120:123], a[12:15]
    v_mfma_f32_16x16x32_bf16 a[16:19], v[96:99], v[116:119], a[16:19]
    v_mfma_f32_16x16x32_bf16 a[20:23], v[96:99], v[120:123], a[20:23]
    v_mfma_f32_16x16x32_bf16 a[24:27], v[100:103], v[116:119], a[24:27]
    v_mfma_f32_16x16x32_bf16 a[28:31], v[100:103], v[120:123], a[28:31]
    v_mfma_f32_16x16x32_bf16 a[32:35], v[104:107], v[116:119], a[32:35]
    v_mfma_f32_16x16x32_bf16 a[36:39], v[104:107], v[120:123], a[36:39]
    v_mfma_f32_16x16x32_bf16 a[40:43], v[108:111], v[116:119], a[40:43]
    v_mfma_f32_16x16x32_bf16 a[44:47], v[108:111], v[120:123], a[44:47]
    v_mfma_f32_16x16x32_bf16 a[48:51], v[112:115], v[116:119], a[48:51]
    v_mfma_f32_16x16x32_bf16 a[52:55], v[112:115], v[120:123], a[52:55]
    global_load_dwordx4 v[52:55], v4, s[26:27] offset:3072 sc1
    global_load_dwordx4 v[56:59], v5, s[26:27] offset:3072 sc1
    global_load_dwordx4 v[60:63], v6, s[26:27] offset:3072 sc1
    global_load_dwordx4 v[64:67], v7, s[26:27] offset:3072 sc1
    global_load_dwordx4 v[68:71], v8, s[26:27] offset:3072 sc1
    global_load_dwordx4 v[72:75], v9, s[26:27] offset:3072 sc1
    global_load_dwordx4 v[76:79], v10, s[26:27] offset:3072 sc1
    global_load_dwordx4 v[80:83], v4, s[28:29] offset:3072 sc1
    global_load_dwordx4 v[84:87], v5, s[28:29] offset:3072 sc1
    s_add_u32 s26, s26, 0x1000
    s_addc_u32 s27, s27, 0
    s_add_u32 s28, s28, 0x1000
    s_addc_u32 s29, s29, 0
    s_waitcnt vmcnt(36)
    v_mfma_f32_16x16x32_bf16 a[0:3], v[124:127], v[152:155], a[0:3]
    v_mfma_f32_16x16x32_bf16 a[4:7], v[124:127], v[156:159], a[4:7]
    v_mfma_f32_16x16x32_bf16 a[8:11], v[128:131], v[152:155], a[8:11]
    v_mfma_f32_16x16x32_bf16 a[12:15], v[128:131], v[156:159], a[12:15]
    v_mfma_f32_16x16x32_bf16 a[16:19], v[132:135], v[152:155], a[16:19]
    v_mfma_f32_16x16x32_bf16 a[20:23], v[132:135], v[156:159], a[20:23]
    v_mfma_f32_16x16x32_bf16 a[24:27], v[136:139], v[152:155], a[24:27]
    v_mfma_f32_16x16x32_bf16 a[28:31], v[136:139], v[156:159], a[28:31]
    v_mfma_f32_16x16x32_bf16 a[32:35], v[140:143], v[152:155], a[32:35]
    v_mfma_f32_16x16x32_bf16 a[36:39], v[140:143], v[156:159], a[36:39]
    v_mfma_f32_16x16x32_bf16 a[40:43], v[144:147], v[152:155], a[40:43]
    v_mfma_f32_16x16x32_bf16 a[44:47], v[144:147], v[156:159], a[44:47]
    v_mfma_f32_16x16x32_bf16 a[48:51], v[148:151], v[152:155], a[48:51]
    v_mfma_f32_16x16x32_bf16 a[52:55], v[148:151], v[156:159], a[52:55]
    s_waitcnt vmcnt(27)
    v_mfma_f32_16x16x32_bf16 a[0:3], v[160:163], v[188:191], a[0:3]
    v_mfma_f32_16x16x32_bf16 a[4:7], v[160:163], v[192:195], a[4:7]
    v_mfma_f32_16x16x32_bf16 a[8:11], v[164:167], v[188:191], a[8:11]
    v_mfma_f32_16x16x32_bf16 a[12:15], v[164:167], v[192:195], a[12:15]
    v_mfma_f32_16x16x32_bf16 a[16:19], v[168:171], v[188:191], a[16:19]
    v_mfma_f32_16x16x32_bf16 a[20:23], v[168:171], v[192:195], a[20:23]
    v_mfma_f32_16x16x32_bf16 a[24:27], v[172:175], v[188:191], a[24:27]
    v_mfma_f32_16x16x32_bf16 a[28:31], v[172:175], v[192:195], a[28:31]
    v_mfma_f32_16x16x32_bf16 a[32:35], v[176:179], v[188:191], a[32:35]
    v_mfma_f32_16x16x32_bf16 a[36:39], v[176:179], v[192:195], a[36:39]
    v_mfma_f32_16x16x32_bf16 a[40:43], v[180:183], v[188:191], a[40:43]
    v_mfma_f32_16x16x32_bf16 a[44:47], v[180:183], v[192:195], a[44:47]
    v_mfma_f32_16x16x32_bf16 a[48:51], v[184:187], v[188:191], a[48:51]
    v_mfma_f32_16x16x32_bf16 a[52:55], v[184:187], v[192:195], a[52:55]
    s_waitcnt vmcnt(18)
    v_mfma_f32_16x16x32_bf16 a[0:3], v[196:199], v[224:227], a[0:3]
    v_mfma_f32_16x16x32_bf16 a[4:7], v[196:199], v[228:231], a[4:7]
    v_mfma_f32_16x16x32_bf16 a[8:11], v[200:203], v[224:227], a[8:11]
    v_mfma_f32_16x16x32_bf16 a[12:15], v[200:203], v[228:231], a[12:15]
    v_mfma_f32_16x16x32_bf16 a[16:19], v[204:207], v[224:227], a[16:19]
    v_mfma_f32_16x16x32_bf16 a[20:23], v[204:207], v[228:231], a[20:23]
    v_mfma_f32_16x16x32_bf16 a[24:27], v[208:211], v[224:227], a[24:27]
    v_mfma_f32_16x16x32_bf16 a[28:31], v[208:211], v[228:231], a[28:31]
    v_mfma_f32_16x16x32_bf16 a[32:35], v[212:215], v[224:227], a[32:35]
    v_mfma_f32_16x16x32_bf16 a[36:39], v[212:215], v[228:231], a[36:39]
    v_mfma_f32_16x16x32_bf16 a[40:43], v[216:219], v[224:227], a[40:43]
    v_mfma_f32_16x16x32_bf16 a[44:47], v[216:219], v[228:231], a[44:47]
    v_mfma_f32_16x16x32_bf16 a[48:51], v[220:223], v[224:227], a[48:51]
    v_mfma_f32_16x16x32_bf16 a[52:55], v[220:223], v[228:231], a[52:55]
    s_waitcnt vmcnt(9)
    v_mfma_f32_16x16x32_bf16 a[0:3], v[16:19], v[44:47], a[0:3]
    v_mfma_f32_16x16x32_bf16 a[4:7], v[16:19], v[48:51], a[4:7]
    v_mfma_f32_16x16x32_bf16 a[8:11], v[20:23], v[44:47], a[8:11]
    v_mfma_f32_16x16x32_bf16 a[12:15], v[20:23], v[48:51], a[12:15]
    v_mfma_f32_16x16x32_bf16 a[16:19], v[24:27], v[44:47], a[16:19]
    v_mfma_f32_16x16x32_bf16 a[20:23], v[24:27], v[48:51], a[20:23]
    v_mfma_f32_16x16x32_bf16 a[24:27], v[28:31], v[44:47], a[24:27]
    v_mfma_f32_16x16x32_bf16 a[28:31], v[28:31], v[48:51], a[28:31]
    v_mfma_f32_16x16x32_bf16 a[32:35], v[32:35], v[44:47], a[32:35]
    v_mfma_f32_16x16x32_bf16 a[36:39], v[32:35], v[48:51], a[36:39]
    v_mfma_f32_16x16x32_bf16 a[40:43], v[36:39], v[44:47], a[40:43]
    v_mfma_f32_16x16x32_bf16 a[44:47], v[36:39], v[48:51], a[44:47]
    v_mfma_f32_16x16x32_bf16 a[48:51], v[40:43], v[44:47], a[48:51]
    v_mfma_f32_16x16x32_bf16 a[52:55], v[40:43], v[48:51], a[52:55]
    s_waitcnt vmcnt(0)
    v_mfma_f32_16x16x32_bf16 a[0:3], v[52:55], v[80:83], a[0:3]
    v_mfma_f32_16x16x32_bf16 a[4:7], v[52:55], v[84:87], a[4:7]
    v_mfma_f32_16x16x32_bf16 a[8:11], v[56:59], v[80:83], a[8:11]
    v_mfma_f32_16x16x32_bf16 a[12:15], v[56:59], v[84:87], a[12:15]
    v_mfma_f32_16x16x32_bf16 a[16:19], v[60:63], v[80:83], a[16:19]
    v_mfma_f32_16x16x32_bf16 a[20:23], v[60:63], v[84:87], a[20:23]
    v_mfma_f32_16x16x32_bf16 a[24:27], v[64:67], v[80:83], a[24:27]
    v_mfma_f32_16x16x32_bf16 a[28:31], v[64:67], v[84:87], a[28:31]
    v_mfma_f32_16x16x32_bf16 a[32:35], v[68:71], v[80:83], a[32:35]
    v_mfma_f32_16x16x32_bf16 a[36:39], v[68:71], v[84:87], a[36:39]
    v_mfma_f32_16x16x32_bf16 a[40:43], v[72:75], v[80:83], a[40:43]
    v_mfma_f32_16x16x32_bf16 a[44:47], v[72:75], v[84:87], a[44:47]
    v_mfma_f32_16x16x32_bf16 a[48:51], v[76:79], v[80:83], a[48:51]
    v_mfma_f32_16x16x32_bf16 a[52:55], v[76:79], v[84:87], a[52:55]
    s_mul_i32 s25, s23, 224
    s_add_u32 s25, s25, 115712
    v_and_b32 v3, 15, v1
    v_mul_u32_u24 v3, 912, v3
    v_lshrrev_b32 v4, 4, v1
    v_lshl_add_u32 v3, v4, 3, v3
    v_add_u32 v3, s25, v3
    s_mov_b32 s38, 0x3fb8aa3b
    s_nop 4
    v_accvgpr_read_b32 v16, a0
    v_accvgpr_read_b32 v17, a1
    v_accvgpr_read_b32 v18, a2
    v_accvgpr_read_b32 v19, a3
    v_cvt_pk_bf16_f32 v20, v16, v17
    v_cvt_pk_bf16_f32 v21, v18, v19
    v_lshlrev_b32 v16, 16, v20
    v_and_b32 v17, 0xffff0000, v20
    v_lshlrev_b32 v18, 16, v21
    v_and_b32 v19, 0xffff0000, v21
    v_mul_f32 v20, s38, v16
    v_mul_f32 v21, s38, v17
    v_mul_f32 v22, s38, v18
    v_mul_f32 v23, s38, v19
    v_exp_f32 v20, -v20
    v_exp_f32 v21, -v21
    v_exp_f32 v22, -v22
    v_exp_f32 v23, -v23
    s_nop 0
    v_add_f32 v20, 1.0, v20
    v_add_f32 v21, 1.0, v21
    v_add_f32 v22, 1.0, v22
    v_add_f32 v23, 1.0, v23
    v_rcp_f32 v20, v20
    v_rcp_f32 v21, v21
    v_rcp_f32 v22, v22
    v_rcp_f32 v23, v23
    s_nop 0
    v_mul_f32 v16, v16, v20
    v_mul_f32 v17, v17, v21
    v_mul_f32 v18, v18, v22
    v_mul_f32 v19, v19, v23
    v_cvt_pk_bf16_f32 v24, v16, v17
    v_cvt_pk_bf16_f32 v25, v18, v19
    ds_write_b64 v3, v[24:25] offset:0
    v_accvgpr_read_b32 v28, a4
    v_accvgpr_read_b32 v29, a5
    v_accvgpr_read_b32 v30, a6
    v_accvgpr_read_b32 v31, a7
    v_cvt_pk_bf16_f32 v32, v28, v29
    v_cvt_pk_bf16_f32 v33, v30, v31
    v_lshlrev_b32 v28, 16, v32
    v_and_b32 v29, 0xffff0000, v32
    v_lshlrev_b32 v30, 16, v33
    v_and_b32 v31, 0xffff0000, v33
    v_mul_f32 v32, s38, v28
    v_mul_f32 v33, s38, v29
    v_mul_f32 v34, s38, v30
    v_mul_f32 v35, s38, v31
    v_exp_f32 v32, -v32
    v_exp_f32 v33, -v33
    v_exp_f32 v34, -v34
    v_exp_f32 v35, -v35
    s_nop 0
    v_add_f32 v32, 1.0, v32
    v_add_f32 v33, 1.0, v33
    v_add_f32 v34, 1.0, v34
    v_add_f32 v35, 1.0, v35
    v_rcp_f32 v32, v32
    v_rcp_f32 v33, v33
    v_rcp_f32 v34, v34
    v_rcp_f32 v35, v35
    s_nop 0
    v_mul_f32 v28, v28, v32
    v_mul_f32 v29, v29, v33
    v_mul_f32 v30, v30, v34
    v_mul_f32 v31, v31, v35
    v_cvt_pk_bf16_f32 v36, v28, v29
    v_cvt_pk_bf16_f32 v37, v30, v31
    ds_write_b64 v3, v[36:37] offset:14592
    v_accvgpr_read_b32 v40, a8
    v_accvgpr_read_b32 v41, a9
    v_accvgpr_read_b32 v42, a10
    v_accvgpr_read_b32 v43, a11
    v_cvt_pk_bf16_f32 v44, v40, v41
    v_cvt_pk_bf16_f32 v45, v42, v43
    v_lshlrev_b32 v40, 16, v44
    v_and_b32 v41, 0xffff0000, v44
    v_lshlrev_b32 v42, 16, v45
    v_and_b32 v43, 0xffff0000, v45
    v_mul_f32 v44, s38, v40
    v_mul_f32 v45, s38, v41
    v_mul_f32 v46, s38, v42
    v_mul_f32 v47, s38, v43
    v_exp_f32 v44, -v44
    v_exp_f32 v45, -v45
    v_exp_f32 v46, -v46
    v_exp_f32 v47, -v47
    s_nop 0
    v_add_f32 v44, 1.0, v44
    v_add_f32 v45, 1.0, v45
    v_add_f32 v46, 1.0, v46
    v_add_f32 v47, 1.0, v47
    v_rcp_f32 v44, v44
    v_rcp_f32 v45, v45
    v_rcp_f32 v46, v46
    v_rcp_f32 v47, v47
    s_nop 0
    v_mul_f32 v40, v40, v44
    v_mul_f32 v41, v41, v45
    v_mul_f32 v42, v42, v46
    v_mul_f32 v43, v43, v47
    v_cvt_pk_bf16_f32 v48, v40, v41
    v_cvt_pk_bf16_f32 v49, v42, v43
    ds_write_b64 v3, v[48:49] offset:32
    v_accvgpr_read_b32 v52, a12
    v_accvgpr_read_b32 v53, a13
    v_accvgpr_read_b32 v54, a14
    v_accvgpr_read_b32 v55, a15
    v_cvt_pk_bf16_f32 v56, v52, v53
    v_cvt_pk_bf16_f32 v57, v54, v55
    v_lshlrev_b32 v52, 16, v56
    v_and_b32 v53, 0xffff0000, v56
    v_lshlrev_b32 v54, 16, v57
    v_and_b32 v55, 0xffff0000, v57
    v_mul_f32 v56, s38, v52
    v_mul_f32 v57, s38, v53
    v_mul_f32 v58, s38, v54
    v_mul_f32 v59, s38, v55
    v_exp_f32 v56, -v56
    v_exp_f32 v57, -v57
    v_exp_f32 v58, -v58
    v_exp_f32 v59, -v59
    s_nop 0
    v_add_f32 v56, 1.0, v56
    v_add_f32 v57, 1.0, v57
    v_add_f32 v58, 1.0, v58
    v_add_f32 v59, 1.0, v59
    v_rcp_f32 v56, v56
    v_rcp_f32 v57, v57
    v_rcp_f32 v58, v58
    v_rcp_f32 v59, v59
    s_nop 0
    v_mul_f32 v52, v52, v56
    v_mul_f32 v53, v53, v57
    v_mul_f32 v54, v54, v58
    v_mul_f32 v55, v55, v59
    v_cvt_pk_bf16_f32 v60, v52, v53
    v_cvt_pk_bf16_f32 v61, v54, v55
    ds_write_b64 v3, v[60:61] offset:14624
    v_accvgpr_read_b32 v16, a16
    v_accvgpr_read_b32 v17, a17
    v_accvgpr_read_b32 v18, a18
    v_accvgpr_read_b32 v19, a19
    v_cvt_pk_bf16_f32 v20, v16, v17
    v_cvt_pk_bf16_f32 v21, v18, v19
    v_lshlrev_b32 v16, 16, v20
    v_and_b32 v17, 0xffff0000, v20
    v_lshlrev_b32 v18, 16, v21
    v_and_b32 v19, 0xffff0000, v21
    v_mul_f32 v20, s38, v16
    v_mul_f32 v21, s38, v17
    v_mul_f32 v22, s38, v18
    v_mul_f32 v23, s38, v19
    v_exp_f32 v20, -v20
    v_exp_f32 v21, -v21
    v_exp_f32 v22, -v22
    v_exp_f32 v23, -v23
    s_nop 0
    v_add_f32 v20, 1.0, v20
    v_add_f32 v21, 1.0, v21
    v_add_f32 v22, 1.0, v22
    v_add_f32 v23, 1.0, v23
    v_rcp_f32 v20, v20
    v_rcp_f32 v21, v21
    v_rcp_f32 v22, v22
    v_rcp_f32 v23, v23
    s_nop 0
    v_mul_f32 v16, v16, v20
    v_mul_f32 v17, v17, v21
    v_mul_f32 v18, v18, v22
    v_mul_f32 v19, v19, v23
    v_cvt_pk_bf16_f32 v24, v16, v17
    v_cvt_pk_bf16_f32 v25, v18, v19
    ds_write_b64 v3, v[24:25] offset:64
    v_accvgpr_read_b32 v28, a20
    v_accvgpr_read_b32 v29, a21
    v_accvgpr_read_b32 v30, a22
    v_accvgpr_read_b32 v31, a23
    v_cvt_pk_bf16_f32 v32, v28, v29
    v_cvt_pk_bf16_f32 v33, v30, v31
    v_lshlrev_b32 v28, 16, v32
    v_and_b32 v29, 0xffff0000, v32
    v_lshlrev_b32 v30, 16, v33
    v_and_b32 v31, 0xffff0000, v33
    v_mul_f32 v32, s38, v28
    v_mul_f32 v33, s38, v29
    v_mul_f32 v34, s38, v30
    v_mul_f32 v35, s38, v31
    v_exp_f32 v32, -v32
    v_exp_f32 v33, -v33
    v_exp_f32 v34, -v34
    v_exp_f32 v35, -v35
    s_nop 0
    v_add_f32 v32, 1.0, v32
    v_add_f32 v33, 1.0, v33
    v_add_f32 v34, 1.0, v34
    v_add_f32 v35, 1.0, v35
    v_rcp_f32 v32, v32
    v_rcp_f32 v33, v33
    v_rcp_f32 v34, v34
    v_rcp_f32 v35, v35
    s_nop 0
    v_mul_f32 v28, v28, v32
    v_mul_f32 v29, v29, v33
    v_mul_f32 v30, v30, v34
    v_mul_f32 v31, v31, v35
    v_cvt_pk_bf16_f32 v36, v28, v29
    v_cvt_pk_bf16_f32 v37, v30, v31
    ds_write_b64 v3, v[36:37] offset:14656
    v_accvgpr_read_b32 v40, a24
    v_accvgpr_read_b32 v41, a25
    v_accvgpr_read_b32 v42, a26
    v_accvgpr_read_b32 v43, a27
    v_cvt_pk_bf16_f32 v44, v40, v41
    v_cvt_pk_bf16_f32 v45, v42, v43
    v_lshlrev_b32 v40, 16, v44
    v_and_b32 v41, 0xffff0000, v44
    v_lshlrev_b32 v42, 16, v45
    v_and_b32 v43, 0xffff0000, v45
    v_mul_f32 v44, s38, v40
    v_mul_f32 v45, s38, v41
    v_mul_f32 v46, s38, v42
    v_mul_f32 v47, s38, v43
    v_exp_f32 v44, -v44
    v_exp_f32 v45, -v45
    v_exp_f32 v46, -v46
    v_exp_f32 v47, -v47
    s_nop 0
    v_add_f32 v44, 1.0, v44
    v_add_f32 v45, 1.0, v45
    v_add_f32 v46, 1.0, v46
    v_add_f32 v47, 1.0, v47
    v_rcp_f32 v44, v44
    v_rcp_f32 v45, v45
    v_rcp_f32 v46, v46
    v_rcp_f32 v47, v47
    s_nop 0
    v_mul_f32 v40, v40, v44
    v_mul_f32 v41, v41, v45
    v_mul_f32 v42, v42, v46
    v_mul_f32 v43, v43, v47
    v_cvt_pk_bf16_f32 v48, v40, v41
    v_cvt_pk_bf16_f32 v49, v42, v43
    ds_write_b64 v3, v[48:49] offset:96
    v_accvgpr_read_b32 v52, a28
    v_accvgpr_read_b32 v53, a29
    v_accvgpr_read_b32 v54, a30
    v_accvgpr_read_b32 v55, a31
    v_cvt_pk_bf16_f32 v56, v52, v53
    v_cvt_pk_bf16_f32 v57, v54, v55
    v_lshlrev_b32 v52, 16, v56
    v_and_b32 v53, 0xffff0000, v56
    v_lshlrev_b32 v54, 16, v57
    v_and_b32 v55, 0xffff0000, v57
    v_mul_f32 v56, s38, v52
    v_mul_f32 v57, s38, v53
    v_mul_f32 v58, s38, v54
    v_mul_f32 v59, s38, v55
    v_exp_f32 v56, -v56
    v_exp_f32 v57, -v57
    v_exp_f32 v58, -v58
    v_exp_f32 v59, -v59
    s_nop 0
    v_add_f32 v56, 1.0, v56
    v_add_f32 v57, 1.0, v57
    v_add_f32 v58, 1.0, v58
    v_add_f32 v59, 1.0, v59
    v_rcp_f32 v56, v56
    v_rcp_f32 v57, v57
    v_rcp_f32 v58, v58
    v_rcp_f32 v59, v59
    s_nop 0
    v_mul_f32 v52, v52, v56
    v_mul_f32 v53, v53, v57
    v_mul_f32 v54, v54, v58
    v_mul_f32 v55, v55, v59
    v_cvt_pk_bf16_f32 v60, v52, v53
    v_cvt_pk_bf16_f32 v61, v54, v55
    ds_write_b64 v3, v[60:61] offset:14688
    v_accvgpr_read_b32 v16, a32
    v_accvgpr_read_b32 v17, a33
    v_accvgpr_read_b32 v18, a34
    v_accvgpr_read_b32 v19, a35
    v_cvt_pk_bf16_f32 v20, v16, v17
    v_cvt_pk_bf16_f32 v21, v18, v19
    v_lshlrev_b32 v16, 16, v20
    v_and_b32 v17, 0xffff0000, v20
    v_lshlrev_b32 v18, 16, v21
    v_and_b32 v19, 0xffff0000, v21
    v_mul_f32 v20, s38, v16
    v_mul_f32 v21, s38, v17
    v_mul_f32 v22, s38, v18
    v_mul_f32 v23, s38, v19
    v_exp_f32 v20, -v20
    v_exp_f32 v21, -v21
    v_exp_f32 v22, -v22
    v_exp_f32 v23, -v23
    s_nop 0
    v_add_f32 v20, 1.0, v20
    v_add_f32 v21, 1.0, v21
    v_add_f32 v22, 1.0, v22
    v_add_f32 v23, 1.0, v23
    v_rcp_f32 v20, v20
    v_rcp_f32 v21, v21
    v_rcp_f32 v22, v22
    v_rcp_f32 v23, v23
    s_nop 0
    v_mul_f32 v16, v16, v20
    v_mul_f32 v17, v17, v21
    v_mul_f32 v18, v18, v22
    v_mul_f32 v19, v19, v23
    v_cvt_pk_bf16_f32 v24, v16, v17
    v_cvt_pk_bf16_f32 v25, v18, v19
    ds_write_b64 v3, v[24:25] offset:128
    v_accvgpr_read_b32 v28, a36
    v_accvgpr_read_b32 v29, a37
    v_accvgpr_read_b32 v30, a38
    v_accvgpr_read_b32 v31, a39
    v_cvt_pk_bf16_f32 v32, v28, v29
    v_cvt_pk_bf16_f32 v33, v30, v31
    v_lshlrev_b32 v28, 16, v32
    v_and_b32 v29, 0xffff0000, v32
    v_lshlrev_b32 v30, 16, v33
    v_and_b32 v31, 0xffff0000, v33
    v_mul_f32 v32, s38, v28
    v_mul_f32 v33, s38, v29
    v_mul_f32 v34, s38, v30
    v_mul_f32 v35, s38, v31
    v_exp_f32 v32, -v32
    v_exp_f32 v33, -v33
    v_exp_f32 v34, -v34
    v_exp_f32 v35, -v35
    s_nop 0
    v_add_f32 v32, 1.0, v32
    v_add_f32 v33, 1.0, v33
    v_add_f32 v34, 1.0, v34
    v_add_f32 v35, 1.0, v35
    v_rcp_f32 v32, v32
    v_rcp_f32 v33, v33
    v_rcp_f32 v34, v34
    v_rcp_f32 v35, v35
    s_nop 0
    v_mul_f32 v28, v28, v32
    v_mul_f32 v29, v29, v33
    v_mul_f32 v30, v30, v34
    v_mul_f32 v31, v31, v35
    v_cvt_pk_bf16_f32 v36, v28, v29
    v_cvt_pk_bf16_f32 v37, v30, v31
    ds_write_b64 v3, v[36:37] offset:14720
    v_accvgpr_read_b32 v40, a40
    v_accvgpr_read_b32 v41, a41
    v_accvgpr_read_b32 v42, a42
    v_accvgpr_read_b32 v43, a43
    v_cvt_pk_bf16_f32 v44, v40, v41
    v_cvt_pk_bf16_f32 v45, v42, v43
    v_lshlrev_b32 v40, 16, v44
    v_and_b32 v41, 0xffff0000, v44
    v_lshlrev_b32 v42, 16, v45
    v_and_b32 v43, 0xffff0000, v45
    v_mul_f32 v44, s38, v40
    v_mul_f32 v45, s38, v41
    v_mul_f32 v46, s38, v42
    v_mul_f32 v47, s38, v43
    v_exp_f32 v44, -v44
    v_exp_f32 v45, -v45
    v_exp_f32 v46, -v46
    v_exp_f32 v47, -v47
    s_nop 0
    v_add_f32 v44, 1.0, v44
    v_add_f32 v45, 1.0, v45
    v_add_f32 v46, 1.0, v46
    v_add_f32 v47, 1.0, v47
    v_rcp_f32 v44, v44
    v_rcp_f32 v45, v45
    v_rcp_f32 v46, v46
    v_rcp_f32 v47, v47
    s_nop 0
    v_mul_f32 v40, v40, v44
    v_mul_f32 v41, v41, v45
    v_mul_f32 v42, v42, v46
    v_mul_f32 v43, v43, v47
    v_cvt_pk_bf16_f32 v48, v40, v41
    v_cvt_pk_bf16_f32 v49, v42, v43
    ds_write_b64 v3, v[48:49] offset:160
    v_accvgpr_read_b32 v52, a44
    v_accvgpr_read_b32 v53, a45
    v_accvgpr_read_b32 v54, a46
    v_accvgpr_read_b32 v55, a47
    v_cvt_pk_bf16_f32 v56, v52, v53
    v_cvt_pk_bf16_f32 v57, v54, v55
    v_lshlrev_b32 v52, 16, v56
    v_and_b32 v53, 0xffff0000, v56
    v_lshlrev_b32 v54, 16, v57
    v_and_b32 v55, 0xffff0000, v57
    v_mul_f32 v56, s38, v52
    v_mul_f32 v57, s38, v53
    v_mul_f32 v58, s38, v54
    v_mul_f32 v59, s38, v55
    v_exp_f32 v56, -v56
    v_exp_f32 v57, -v57
    v_exp_f32 v58, -v58
    v_exp_f32 v59, -v59
    s_nop 0
    v_add_f32 v56, 1.0, v56
    v_add_f32 v57, 1.0, v57
    v_add_f32 v58, 1.0, v58
    v_add_f32 v59, 1.0, v59
    v_rcp_f32 v56, v56
    v_rcp_f32 v57, v57
    v_rcp_f32 v58, v58
    v_rcp_f32 v59, v59
    s_nop 0
    v_mul_f32 v52, v52, v56
    v_mul_f32 v53, v53, v57
    v_mul_f32 v54, v54, v58
    v_mul_f32 v55, v55, v59
    v_cvt_pk_bf16_f32 v60, v52, v53
    v_cvt_pk_bf16_f32 v61, v54, v55
    ds_write_b64 v3, v[60:61] offset:14752
    v_accvgpr_read_b32 v16, a48
    v_accvgpr_read_b32 v17, a49
    v_accvgpr_read_b32 v18, a50
    v_accvgpr_read_b32 v19, a51
    v_cvt_pk_bf16_f32 v20, v16, v17
    v_cvt_pk_bf16_f32 v21, v18, v19
    v_lshlrev_b32 v16, 16, v20
    v_and_b32 v17, 0xffff0000, v20
    v_lshlrev_b32 v18, 16, v21
    v_and_b32 v19, 0xffff0000, v21
    v_mul_f32 v20, s38, v16
    v_mul_f32 v21, s38, v17
    v_mul_f32 v22, s38, v18
    v_mul_f32 v23, s38, v19
    v_exp_f32 v20, -v20
    v_exp_f32 v21, -v21
    v_exp_f32 v22, -v22
    v_exp_f32 v23, -v23
    s_nop 0
    v_add_f32 v20, 1.0, v20
    v_add_f32 v21, 1.0, v21
    v_add_f32 v22, 1.0, v22
    v_add_f32 v23, 1.0, v23
    v_rcp_f32 v20, v20
    v_rcp_f32 v21, v21
    v_rcp_f32 v22, v22
    v_rcp_f32 v23, v23
    s_nop 0
    v_mul_f32 v16, v16, v20
    v_mul_f32 v17, v17, v21
    v_mul_f32 v18, v18, v22
    v_mul_f32 v19, v19, v23
    v_cvt_pk_bf16_f32 v24, v16, v17
    v_cvt_pk_bf16_f32 v25, v18, v19
    ds_write_b64 v3, v[24:25] offset:192
    v_accvgpr_read_b32 v28, a52
    v_accvgpr_read_b32 v29, a53
    v_accvgpr_read_b32 v30, a54
    v_accvgpr_read_b32 v31, a55
    v_cvt_pk_bf16_f32 v32, v28, v29
    v_cvt_pk_bf16_f32 v33, v30, v31
    v_lshlrev_b32 v28, 16, v32
    v_and_b32 v29, 0xffff0000, v32
    v_lshlrev_b32 v30, 16, v33
    v_and_b32 v31, 0xffff0000, v33
    v_mul_f32 v32, s38, v28
    v_mul_f32 v33, s38, v29
    v_mul_f32 v34, s38, v30
    v_mul_f32 v35, s38, v31
    v_exp_f32 v32, -v32
    v_exp_f32 v33, -v33
    v_exp_f32 v34, -v34
    v_exp_f32 v35, -v35
    s_nop 0
    v_add_f32 v32, 1.0, v32
    v_add_f32 v33, 1.0, v33
    v_add_f32 v34, 1.0, v34
    v_add_f32 v35, 1.0, v35
    v_rcp_f32 v32, v32
    v_rcp_f32 v33, v33
    v_rcp_f32 v34, v34
    v_rcp_f32 v35, v35
    s_nop 0
    v_mul_f32 v28, v28, v32
    v_mul_f32 v29, v29, v33
    v_mul_f32 v30, v30, v34
    v_mul_f32 v31, v31, v35
    v_cvt_pk_bf16_f32 v36, v28, v29
    v_cvt_pk_bf16_f32 v37, v30, v31
    ds_write_b64 v3, v[36:37] offset:14784
    s_waitcnt lgkmcnt(0)
    s_barrier
    s_mul_i32 s25, s72, 28672
    s_add_u32 s25, s25, 0x1e00000
    s_add_u32 s26, s4, s25
    s_addc_u32 s27, s5, 0
    v_add_u32 v16, 0, v0
    v_mul_u32_u24 v17, 18725, v16
    v_lshrrev_b32 v17, 20, v17
    v_lshlrev_b32 v16, 4, v16
    v_lshl_add_u32 v17, v17, 4, v16
    v_add_u32 v17, 115712, v17
    ds_read_b128 v[20:23], v17
    v_add_u32 v24, 256, v0
    v_mul_u32_u24 v25, 18725, v24
    v_lshrrev_b32 v25, 20, v25
    v_lshlrev_b32 v24, 4, v24
    v_lshl_add_u32 v25, v25, 4, v24
    v_add_u32 v25, 115712, v25
    ds_read_b128 v[28:31], v25
    v_add_u32 v32, 512, v0
    v_mul_u32_u24 v33, 18725, v32
    v_lshrrev_b32 v33, 20, v33
    v_lshlrev_b32 v32, 4, v32
    v_lshl_add_u32 v33, v33, 4, v32
    v_add_u32 v33, 115712, v33
    ds_read_b128 v[36:39], v33
    v_add_u32 v40, 768, v0
    v_mul_u32_u24 v41, 18725, v40
    v_lshrrev_b32 v41, 20, v41
    v_lshlrev_b32 v40, 4, v40
    v_lshl_add_u32 v41, v41, 4, v40
    v_add_u32 v41, 115712, v41
    ds_read_b128 v[44:47], v41
    v_add_u32 v48, 1024, v0
    v_mul_u32_u24 v49, 18725, v48
    v_lshrrev_b32 v49, 20, v49
    v_lshlrev_b32 v48, 4, v48
    v_lshl_add_u32 v49, v49, 4, v48
    v_add_u32 v49, 115712, v49
    ds_read_b128 v[52:55], v49
    v_add_u32 v56, 1280, v0
    v_mul_u32_u24 v57, 18725, v56
    v_lshrrev_b32 v57, 20, v57
    v_lshlrev_b32 v56, 4, v56
    v_lshl_add_u32 v57, v57, 4, v56
    v_add_u32 v57, 115712, v57
    ds_read_b128 v[60:63], v57
    v_add_u32 v64, 1536, v0
    v_mul_u32_u24 v65, 18725, v64
    v_lshrrev_b32 v65, 20, v65
    v_lshlrev_b32 v64, 4, v64
    v_lshl_add_u32 v65, v65, 4, v64
    v_add_u32 v65, 115712, v65
    ds_read_b128 v[68:71], v65
    s_waitcnt lgkmcnt(0)
    global_store_dwordx4 v16, v[20:23], s[26:27] sc1
    global_store_dwordx4 v24, v[28:31], s[26:27] sc1
    global_store_dwordx4 v32, v[36:39], s[26:27] sc1
    global_store_dwordx4 v40, v[44:47], s[26:27] sc1
    global_store_dwordx4 v48, v[52:55], s[26:27] sc1
    global_store_dwordx4 v56, v[60:63], s[26:27] sc1
    global_store_dwordx4 v64, v[68:71], s[26:27] sc1
    s_waitcnt vmcnt(0)
    s_barrier
    s_cmp_lg_u32 s23, 0
    s_cbranch_scc1 Lsig_115
    s_lshl_b32 s25, s72, 2
    s_add_u32 s25, s25, 0x7900c00
    s_add_u32 s76, s4, s25
    s_addc_u32 s77, s5, 0
    s_mov_b64 exec, 1
    v_mov_b32 v22, 0
    v_mov_b32 v23, 1
    global_atomic_add v22, v23, s[76:77]
    s_mov_b64 exec, -1
Lsig_115:
    s_add_u32 s71, s72, 118
Lxa_111:
    s_waitcnt vmcnt(0)
    s_cmp_lg_u32 s23, 0
    s_cbranch_scc1 Lwo_116
    s_add_u32 s76, s4, 0x7900400
    s_addc_u32 s77, s5, 0
    v_mbcnt_lo_u32_b32 v8, -1, 0
    v_mbcnt_hi_u32_b32 v8, -1, v8
    v_lshlrev_b32 v8, 7, v8
    s_mov_b32 s78, 1048576
    s_mov_b32 exec_lo, 0xff
    s_mov_b32 exec_hi, 0x0
Lwf_117:
    global_load_dword v9, v8, s[76:77] sc1
    s_sub_u32 s78, s78, 1
    s_cmp_eq_u32 s78, 0
    s_cbranch_scc1 Lexit_1
    s_waitcnt vmcnt(0)
    v_cmp_ne_u32 vcc, 28, v9
    s_cbranch_vccz Lwfd_118
    s_sleep 8
    s_branch Lwf_117
Lwfd_118:
    s_mov_b64 exec, -1
Lwo_116:
    s_barrier
Lxl_119:
    s_lshr_b32 s75, s71, 2
    s_bfe_u32 s73, s71, 0x10001
    s_and_b32 s74, s71, 1
    v_and_b32 v1, 63, v0
    v_lshlrev_b32 v2, 4, v1
    v_lshlrev_b32 v3, 4, v1
    v_add_u32 v3, 4096, v3
    v_lshlrev_b32 v4, 4, v1
    v_add_u32 v4, 8192, v4
    v_lshlrev_b32 v5, 4, v1
    v_add_u32 v5, 12288, v5
    s_mul_i32 s25, s75, 28672
    s_add_u32 s26, s4, s25
    s_addc_u32 s27, s5, 0
    global_load_dwordx4 v[16:19], v2, s[26:27] offset:0 sc1
    global_load_dwordx4 v[20:23], v2, s[26:27] offset:1024 sc1
    global_load_dwordx4 v[24:27], v2, s[26:27] offset:2048 sc1
    global_load_dwordx4 v[28:31], v2, s[26:27] offset:3072 sc1
    global_load_dwordx4 v[32:35], v3, s[26:27] offset:0 sc1
    global_load_dwordx4 v[36:39], v3, s[26:27] offset:1024 sc1
    global_load_dwordx4 v[40:43], v3, s[26:27] offset:2048 sc1
    global_load_dwordx4 v[44:47], v3, s[26:27] offset:3072 sc1
    global_load_dwordx4 v[48:51], v4, s[26:27] offset:0 sc1
    global_load_dwordx4 v[52:55], v4, s[26:27] offset:1024 sc1
    global_load_dwordx4 v[56:59], v4, s[26:27] offset:2048 sc1
    global_load_dwordx4 v[60:63], v4, s[26:27] offset:3072 sc1
    global_load_dwordx4 v[64:67], v5, s[26:27] offset:0 sc1
    global_load_dwordx4 v[68:71], v5, s[26:27] offset:1024 sc1
    s_add_u32 s26, s26, 0x3800
    s_addc_u32 s27, s27, 0
    global_load_dwordx4 v[72:75], v2, s[26:27] offset:0 sc1
    global_load_dwordx4 v[76:79], v2, s[26:27] offset:1024 sc1
    global_load_dwordx4 v[80:83], v2, s[26:27] offset:2048 sc1
    global_load_dwordx4 v[84:87], v2, s[26:27] offset:3072 sc1
    global_load_dwordx4 v[88:91], v3, s[26:27] offset:0 sc1
    global_load_dwordx4 v[92:95], v3, s[26:27] offset:1024 sc1
    global_load_dwordx4 v[96:99], v3, s[26:27] offset:2048 sc1
    global_load_dwordx4 v[100:103], v3, s[26:27] offset:3072 sc1
    global_load_dwordx4 v[104:107], v4, s[26:27] offset:0 sc1
    global_load_dwordx4 v[108:111], v4, s[26:27] offset:1024 sc1
    global_load_dwordx4 v[112:115], v4, s[26:27] offset:2048 sc1
    global_load_dwordx4 v[116:119], v4, s[26:27] offset:3072 sc1
    global_load_dwordx4 v[120:123], v5, s[26:27] offset:0 sc1
    global_load_dwordx4 v[124:127], v5, s[26:27] offset:1024 sc1
    s_lshl_b32 s25, s75, 1
    s_add_u32 s25, s25, s73
    s_mul_i32 s40, s25, 14336
    s_mul_i32 s25, s25, 229376
    s_mul_i32 s26, s23, 57344
    s_add_u32 s25, s25, s26
    s_add_u32 s25, s25, 0x2000000
    s_add_u32 s28, s4, s25
    s_addc_u32 s29, s5, 0
    global_load_dwordx4 a[0:3], v2, s[28:29] offset:0 sc1
    global_load_dwordx4 a[4:7], v2, s[28:29] offset:1024 sc1
    global_load_dwordx4 a[8:11], v2, s[28:29] offset:2048 sc1
    global_load_dwordx4 a[12:15], v2, s[28:29] offset:3072 sc1
    global_load_dwordx4 a[16:19], v3, s[28:29] offset:0 sc1
    global_load_dwordx4 a[20:23], v3, s[28:29] offset:1024 sc1
    global_load_dwordx4 a[24:27], v3, s[28:29] offset:2048 sc1
    global_load_dwordx4 a[28:31], v3, s[28:29] offset:3072 sc1
    global_load_dwordx4 a[32:35], v4, s[28:29] offset:0 sc1
    global_load_dwordx4 a[36:39], v4, s[28:29] offset:1024 sc1
    global_load_dwordx4 a[40:43], v4, s[28:29] offset:2048 sc1
    global_load_dwordx4 a[44:47], v4, s[28:29] offset:3072 sc1
    global_load_dwordx4 a[48:51], v5, s[28:29] offset:0 sc1
    global_load_dwordx4 a[52:55], v5, s[28:29] offset:1024 sc1
    s_add_u32 s28, s28, 0x3800
    s_addc_u32 s29, s29, 0
    global_load_dwordx4 a[56:59], v2, s[28:29] offset:0 sc1
    global_load_dwordx4 a[60:63], v2, s[28:29] offset:1024 sc1
    global_load_dwordx4 a[64:67], v2, s[28:29] offset:2048 sc1
    global_load_dwordx4 a[68:71], v2, s[28:29] offset:3072 sc1
    global_load_dwordx4 a[72:75], v3, s[28:29] offset:0 sc1
    global_load_dwordx4 a[76:79], v3, s[28:29] offset:1024 sc1
    global_load_dwordx4 a[80:83], v3, s[28:29] offset:2048 sc1
    global_load_dwordx4 a[84:87], v3, s[28:29] offset:3072 sc1
    global_load_dwordx4 a[88:91], v4, s[28:29] offset:0 sc1
    global_load_dwordx4 a[92:95], v4, s[28:29] offset:1024 sc1
    global_load_dwordx4 a[96:99], v4, s[28:29] offset:2048 sc1
    global_load_dwordx4 a[100:103], v4, s[28:29] offset:3072 sc1
    global_load_dwordx4 a[104:107], v5, s[28:29] offset:0 sc1
    global_load_dwordx4 a[108:111], v5, s[28:29] offset:1024 sc1
    s_add_u32 s28, s28, 0x3800
    s_addc_u32 s29, s29, 0
    global_load_dwordx4 a[112:115], v2, s[28:29] offset:0 sc1
    global_load_dwordx4 a[116:119], v2, s[28:29] offset:1024 sc1
    global_load_dwordx4 a[120:123], v2, s[28:29] offset:2048 sc1
    global_load_dwordx4 a[124:127], v2, s[28:29] offset:3072 sc1
    global_load_dwordx4 a[128:131], v3, s[28:29] offset:0 sc1
    global_load_dwordx4 a[132:135], v3, s[28:29] offset:1024 sc1
    global_load_dwordx4 a[136:139], v3, s[28:29] offset:2048 sc1
    global_load_dwordx4 a[140:143], v3, s[28:29] offset:3072 sc1
    global_load_dwordx4 a[144:147], v4, s[28:29] offset:0 sc1
    global_load_dwordx4 a[148:151], v4, s[28:29] offset:1024 sc1
    global_load_dwordx4 a[152:155], v4, s[28:29] offset:2048 sc1
    global_load_dwordx4 a[156:159], v4, s[28:29] offset:3072 sc1
    global_load_dwordx4 a[160:163], v5, s[28:29] offset:0 sc1
    global_load_dwordx4 a[164:167], v5, s[28:29] offset:1024 sc1
    s_add_u32 s28, s28, 0x3800
    s_addc_u32 s29, s29, 0
    global_load_dwordx4 a[168:171], v2, s[28:29] offset:0 sc1
    global_load_dwordx4 a[172:175], v2, s[28:29] offset:1024 sc1
    global_load_dwordx4 a[176:179], v2, s[28:29] offset:2048 sc1
    global_load_dwordx4 a[180:183], v2, s[28:29] offset:3072 sc1
    global_load_dwordx4 a[184:187], v3, s[28:29] offset:0 sc1
    global_load_dwordx4 a[188:191], v3, s[28:29] offset:1024 sc1
    global_load_dwordx4 a[192:195], v3, s[28:29] offset:2048 sc1
    global_load_dwordx4 a[196:199], v3, s[28:29] offset:3072 sc1
    global_load_dwordx4 a[200:203], v4, s[28:29] offset:0 sc1
    global_load_dwordx4 a[204:207], v4, s[28:29] offset:1024 sc1
    global_load_dwordx4 a[208:211], v4, s[28:29] offset:2048 sc1
    global_load_dwordx4 a[212:215], v4, s[28:29] offset:3072 sc1
    global_load_dwordx4 a[216:219], v5, s[28:29] offset:0 sc1
    global_load_dwordx4 a[220:223], v5, s[28:29] offset:1024 sc1
    s_add_u32 s28, s28, 0x3800
    s_addc_u32 s29, s29, 0
    v_and_b32 v8, 15, v1
    v_lshrrev_b32 v9, 4, v1
    v_lshlrev_b32 v9, 2, v9
    s_cmp_eq_u32 s73, 0
    v_add_u32 v10, 0, v9
    v_cmp_le_u32 s[64:65], v10, v8
    s_nop 3
    s_cselect_b64 s[46:47], s[64:65], -1
    s_cselect_b64 s[54:55], 0, s[64:65]
    v_add_u32 v10, 1, v9
    v_cmp_le_u32 s[64:65], v10, v8
    s_nop 3
    s_cselect_b64 s[48:49], s[64:65], -1
    s_cselect_b64 s[56:57], 0, s[64:65]
    v_add_u32 v10, 2, v9
    v_cmp_le_u32 s[64:65], v10, v8
    s_nop 3
    s_cselect_b64 s[50:51], s[64:65], -1
    s_cselect_b64 s[58:59], 0, s[64:65]
    v_add_u32 v10, 3, v9
    v_cmp_le_u32 s[64:65], v10, v8
    s_nop 3
    s_cselect_b64 s[52:53], s[64:65], -1
    s_cselect_b64 s[60:61], 0, s[64:65]
    s_mov_b32 s38, 0x3db8aa3b
    v_mov_b32 v11, 0xff800000
    s_waitcnt vmcnt(42)
    v_mfma_f32_16x16x32_bf16 v[128:131], v[16:19], a[0:3], 0
    v_mfma_f32_16x16x32_bf16 v[132:135], v[72:75], a[0:3], 0
    v_mfma_f32_16x16x32_bf16 v[128:131], v[20:23], a[4:7], v[128:131]
    v_mfma_f32_16x16x32_bf16 v[132:135], v[76:79], a[4:7], v[132:135]
    v_mfma_f32_16x16x32_bf16 v[128:131], v[24:27], a[8:11], v[128:131]
    v_mfma_f32_16x16x32_bf16 v[132:135], v[80:83], a[8:11], v[132:135]
    v_mfma_f32_16x16x32_bf16 v[128:131], v[28:31], a[12:15], v[128:131]
    v_mfma_f32_16x16x32_bf16 v[132:135], v[84:87], a[12:15], v[132:135]
    v_mfma_f32_16x16x32_bf16 v[128:131], v[32:35], a[16:19], v[128:131]
    v_mfma_f32_16x16x32_bf16 v[132:135], v[88:91], a[16:19], v[132:135]
    v_mfma_f32_16x16x32_bf16 v[128:131], v[36:39], a[20:23], v[128:131]
    v_mfma_f32_16x16x32_bf16 v[132:135], v[92:95], a[20:23], v[132:135]
    v_mfma_f32_16x16x32_bf16 v[128:131], v[40:43], a[24:27], v[128:131]
    v_mfma_f32_16x16x32_bf16 v[132:135], v[96:99], a[24:27], v[132:135]
    v_mfma_f32_16x16x32_bf16 v[128:131], v[44:47], a[28:31], v[128:131]
    v_mfma_f32_16x16x32_bf16 v[132:135], v[100:103], a[28:31], v[132:135]
    v_mfma_f32_16x16x32_bf16 v[128:131], v[48:51], a[32:35], v[128:131]
    v_mfma_f32_16x16x32_bf16 v[132:135], v[104:107], a[32:35], v[132:135]
    v_mfma_f32_16x16x32_bf16 v[128:131], v[52:55], a[36:39], v[128:131]
    v_mfma_f32_16x16x32_bf16 v[132:135], v[108:111], a[36:39], v[132:135]
    v_mfma_f32_16x16x32_bf16 v[128:131], v[56:59], a[40:43], v[128:131]
    v_mfma_f32_16x16x32_bf16 v[132:135], v[112:115], a[40:43], v[132:135]
    v_mfma_f32_16x16x32_bf16 v[128:131], v[60:63], a[44:47], v[128:131]
    v_mfma_f32_16x16x32_bf16 v[132:135], v[116:119], a[44:47], v[132:135]
    v_mfma_f32_16x16x32_bf16 v[128:131], v[64:67], a[48:51], v[128:131]
    v_mfma_f32_16x16x32_bf16 v[132:135], v[120:123], a[48:51], v[132:135]
    v_mfma_f32_16x16x32_bf16 v[128:131], v[68:71], a[52:55], v[128:131]
    v_mfma_f32_16x16x32_bf16 v[132:135], v[124:127], a[52:55], v[132:135]
    s_waitcnt vmcnt(28)
    v_mfma_f32_16x16x32_bf16 v[136:139], v[16:19], a[56:59], 0
    v_mfma_f32_16x16x32_bf16 v[140:143], v[72:75], a[56:59], 0
    v_mfma_f32_16x16x32_bf16 v[136:139], v[20:23], a[60:63], v[136:139]
    v_mfma_f32_16x16x32_bf16 v[140:143], v[76:79], a[60:63], v[140:143]
    v_mfma_f32_16x16x32_bf16 v[136:139], v[24:27], a[64:67], v[136:139]
    v_mfma_f32_16x16x32_bf16 v[140:143], v[80:83], a[64:67], v[140:143]
    v_mfma_f32_16x16x32_bf16 v[136:139], v[28:31], a[68:71], v[136:139]
    v_mfma_f32_16x16x32_bf16 v[140:143], v[84:87], a[68:71], v[140:143]
    v_mfma_f32_16x16x32_bf16 v[136:139], v[32:35], a[72:75], v[136:139]
    v_mfma_f32_16x16x32_bf16 v[140:143], v[88:91], a[72:75], v[140:143]
    v_mfma_f32_16x16x32_bf16 v[136:139], v[36:39], a[76:79], v[136:139]
    v_mfma_f32_16x16x32_bf16 v[140:143], v[92:95], a[76:79], v[140:143]
    v_mfma_f32_16x16x32_bf16 v[136:139], v[40:43], a[80:83], v[136:139]
    v_mfma_f32_16x16x32_bf16 v[140:143], v[96:99], a[80:83], v[140:143]
    v_mfma_f32_16x16x32_bf16 v[136:139], v[44:47], a[84:87], v[136:139]
    v_mfma_f32_16x16x32_bf16 v[140:143], v[100:103], a[84:87], v[140:143]
    v_mfma_f32_16x16x32_bf16 v[136:139], v[48:51], a[88:91], v[136:139]
    v_mfma_f32_16x16x32_bf16 v[140:143], v[104:107], a[88:91], v[140:143]
    v_mfma_f32_16x16x32_bf16 v[136:139], v[52:55], a[92:95], v[136:139]
    v_mfma_f32_16x16x32_bf16 v[140:143], v[108:111], a[92:95], v[140:143]
    v_mfma_f32_16x16x32_bf16 v[136:139], v[56:59], a[96:99], v[136:139]
    v_mfma_f32_16x16x32_bf16 v[140:143], v[112:115], a[96:99], v[140:143]
    v_mfma_f32_16x16x32_bf16 v[136:139], v[60:63], a[100:103], v[136:139]
    v_mfma_f32_16x16x32_bf16 v[140:143], v[116:119], a[100:103], v[140:143]
    v_mfma_f32_16x16x32_bf16 v[136:139], v[64:67], a[104:107], v[136:139]
    v_mfma_f32_16x16x32_bf16 v[140:143], v[120:123], a[104:107], v[140:143]
    v_mfma_f32_16x16x32_bf16 v[136:139], v[68:71], a[108:111], v[136:139]
    v_mfma_f32_16x16x32_bf16 v[140:143], v[124:127], a[108:111], v[140:143]
    s_waitcnt vmcnt(14)
    v_mfma_f32_16x16x32_bf16 v[144:147], v[16:19], a[112:115], 0
    v_mfma_f32_16x16x32_bf16 v[148:151], v[72:75], a[112:115], 0
    v_mfma_f32_16x16x32_bf16 v[144:147], v[20:23], a[116:119], v[144:147]
    v_mfma_f32_16x16x32_bf16 v[148:151], v[76:79], a[116:119], v[148:151]
    v_mfma_f32_16x16x32_bf16 v[144:147], v[24:27], a[120:123], v[144:147]
    v_mfma_f32_16x16x32_bf16 v[148:151], v[80:83], a[120:123], v[148:151]
    v_mfma_f32_16x16x32_bf16 v[144:147], v[28:31], a[124:127], v[144:147]
    v_mfma_f32_16x16x32_bf16 v[148:151], v[84:87], a[124:127], v[148:151]
    v_mfma_f32_16x16x32_bf16 v[144:147], v[32:35], a[128:131], v[144:147]
    v_mfma_f32_16x16x32_bf16 v[148:151], v[88:91], a[128:131], v[148:151]
    v_mfma_f32_16x16x32_bf16 v[144:147], v[36:39], a[132:135], v[144:147]
    v_mfma_f32_16x16x32_bf16 v[148:151], v[92:95], a[132:135], v[148:151]
    v_mfma_f32_16x16x32_bf16 v[144:147], v[40:43], a[136:139], v[144:147]
    v_mfma_f32_16x16x32_bf16 v[148:151], v[96:99], a[136:139], v[148:151]
    v_mfma_f32_16x16x32_bf16 v[144:147], v[44:47], a[140:143], v[144:147]
    v_mfma_f32_16x16x32_bf16 v[148:151], v[100:103], a[140:143], v[148:151]
    v_mfma_f32_16x16x32_bf16 v[144:147], v[48:51], a[144:147], v[144:147]
    v_mfma_f32_16x16x32_bf16 v[148:151], v[104:107], a[144:147], v[148:151]
    v_mfma_f32_16x16x32_bf16 v[144:147], v[52:55], a[148:151], v[144:147]
    v_mfma_f32_16x16x32_bf16 v[148:151], v[108:111], a[148:151], v[148:151]
    v_mfma_f32_16x16x32_bf16 v[144:147], v[56:59], a[152:155], v[144:147]
    v_mfma_f32_16x16x32_bf16 v[148:151], v[112:115], a[152:155], v[148:151]
    v_mfma_f32_16x16x32_bf16 v[144:147], v[60:63], a[156:159], v[144:147]
    v_mfma_f32_16x16x32_bf16 v[148:151], v[116:119], a[156:159], v[148:151]
    v_mfma_f32_16x16x32_bf16 v[144:147], v[64:67], a[160:163], v[144:147]
    v_mfma_f32_16x16x32_bf16 v[148:151], v[120:123], a[160:163], v[148:151]
    v_mfma_f32_16x16x32_bf16 v[144:147], v[68:71], a[164:167], v[144:147]
    v_mfma_f32_16x16x32_bf16 v[148:151], v[124:127], a[164:167], v[148:151]
    s_waitcnt vmcnt(0)
    v_mfma_f32_16x16x32_bf16 v[152:155], v[16:19], a[168:171], 0
    v_mfma_f32_16x16x32_bf16 v[156:159], v[72:75], a[168:171], 0
    v_mfma_f32_16x16x32_bf16 v[152:155], v[20:23], a[172:175], v[152:155]
    v_mfma_f32_16x16x32_bf16 v[156:159], v[76:79], a[172:175], v[156:159]
    v_mfma_f32_16x16x32_bf16 v[152:155], v[24:27], a[176:179], v[152:155]
    v_mfma_f32_16x16x32_bf16 v[156:159], v[80:83], a[176:179], v[156:159]
    v_mfma_f32_16x16x32_bf16 v[152:155], v[28:31], a[180:183], v[152:155]
    v_mfma_f32_16x16x32_bf16 v[156:159], v[84:87], a[180:183], v[156:159]
    v_mfma_f32_16x16x32_bf16 v[152:155], v[32:35], a[184:187], v[152:155]
    v_mfma_f32_16x16x32_bf16 v[156:159], v[88:91], a[184:187], v[156:159]
    v_mfma_f32_16x16x32_bf16 v[152:155], v[36:39], a[188:191], v[152:155]
    v_mfma_f32_16x16x32_bf16 v[156:159], v[92:95], a[188:191], v[156:159]
    v_mfma_f32_16x16x32_bf16 v[152:155], v[40:43], a[192:195], v[152:155]
    v_mfma_f32_16x16x32_bf16 v[156:159], v[96:99], a[192:195], v[156:159]
    v_mfma_f32_16x16x32_bf16 v[152:155], v[44:47], a[196:199], v[152:155]
    v_mfma_f32_16x16x32_bf16 v[156:159], v[100:103], a[196:199], v[156:159]
    v_mfma_f32_16x16x32_bf16 v[152:155], v[48:51], a[200:203], v[152:155]
    v_mfma_f32_16x16x32_bf16 v[156:159], v[104:107], a[200:203], v[156:159]
    v_mfma_f32_16x16x32_bf16 v[152:155], v[52:55], a[204:207], v[152:155]
    v_mfma_f32_16x16x32_bf16 v[156:159], v[108:111], a[204:207], v[156:159]
    v_mfma_f32_16x16x32_bf16 v[152:155], v[56:59], a[208:211], v[152:155]
    v_mfma_f32_16x16x32_bf16 v[156:159], v[112:115], a[208:211], v[156:159]
    v_mfma_f32_16x16x32_bf16 v[152:155], v[60:63], a[212:215], v[152:155]
    v_mfma_f32_16x16x32_bf16 v[156:159], v[116:119], a[212:215], v[156:159]
    v_mfma_f32_16x16x32_bf16 v[152:155], v[64:67], a[216:219], v[152:155]
    v_mfma_f32_16x16x32_bf16 v[156:159], v[120:123], a[216:219], v[156:159]
    v_mfma_f32_16x16x32_bf16 v[152:155], v[68:71], a[220:223], v[152:155]
    v_mfma_f32_16x16x32_bf16 v[156:159], v[124:127], a[220:223], v[156:159]
    s_mul_i32 s25, s75, 458752
    s_mul_i32 s26, s23, 114688
    s_add_u32 s25, s25, s26
    s_mul_i32 s26, s74, 14336
    s_add_u32 s25, s25, s26
    s_add_u32 s25, s25, 0x4000000
    s_add_u32 s30, s4, s25
    s_addc_u32 s31, s5, 0
    s_mov_b32 s26, s30
    s_mov_b32 s27, s31
    global_load_dwordx4 v[16:19], v2, s[26:27] offset:0 sc1
    global_load_dwordx4 v[20:23], v2, s[26:27] offset:1024 sc1
    global_load_dwordx4 v[24:27], v2, s[26:27] offset:2048 sc1
    global_load_dwordx4 v[28:31], v2, s[26:27] offset:3072 sc1
    global_load_dwordx4 v[32:35], v3, s[26:27] offset:0 sc1
    global_load_dwordx4 v[36:39], v3, s[26:27] offset:1024 sc1
    global_load_dwordx4 v[40:43], v3, s[26:27] offset:2048 sc1
    global_load_dwordx4 v[44:47], v3, s[26:27] offset:3072 sc1
    global_load_dwordx4 v[48:51], v4, s[26:27] offset:0 sc1
    global_load_dwordx4 v[52:55], v4, s[26:27] offset:1024 sc1
    global_load_dwordx4 v[56:59], v4, s[26:27] offset:2048 sc1
    global_load_dwordx4 v[60:63], v4, s[26:27] offset:3072 sc1
    global_load_dwordx4 v[64:67], v5, s[26:27] offset:0 sc1
    global_load_dwordx4 v[68:71], v5, s[26:27] offset:1024 sc1
    s_add_u32 s26, s26, 0x7000
    s_addc_u32 s27, s27, 0
    global_load_dwordx4 v[16:19], v2, s[26:27] offset:0 sc1
    global_load_dwordx4 v[20:23], v2, s[26:27] offset:1024 sc1
    global_load_dwordx4 v[24:27], v2, s[26:27] offset:2048 sc1
    global_load_dwordx4 v[28:31], v2, s[26:27] offset:3072 sc1
    global_load_dwordx4 v[32:35], v3, s[26:27] offset:0 sc1
    global_load_dwordx4 v[36:39], v3, s[26:27] offset:1024 sc1
    global_load_dwordx4 v[40:43], v3, s[26:27] offset:2048 sc1
    global_load_dwordx4 v[44:47], v3, s[26:27] offset:3072 sc1
    global_load_dwordx4 v[48:51], v4, s[26:27] offset:0 sc1
    global_load_dwordx4 v[52:55], v4, s[26:27] offset:1024 sc1
    global_load_dwordx4 v[56:59], v4, s[26:27] offset:2048 sc1
    global_load_dwordx4 v[60:63], v4, s[26:27] offset:3072 sc1
    global_load_dwordx4 v[64:67], v5, s[26:27] offset:0 sc1
    global_load_dwordx4 v[68:71], v5, s[26:27] offset:1024 sc1
    s_add_u32 s26, s26, 0x7000
    s_addc_u32 s27, s27, 0
    global_load_dwordx4 v[16:19], v2, s[26:27] offset:0 sc1
    global_load_dwordx4 v[20:23], v2, s[26:27] offset:1024 sc1
    global_load_dwordx4 v[24:27], v2, s[26:27] offset:2048 sc1
    global_load_dwordx4 v[28:31], v2, s[26:27] offset:3072 sc1
    global_load_dwordx4 v[32:35], v3, s[26:27] offset:0 sc1
    global_load_dwordx4 v[36:39], v3, s[26:27] offset:1024 sc1
    global_load_dwordx4 v[40:43], v3, s[26:27] offset:2048 sc1
    global_load_dwordx4 v[44:47], v3, s[26:27] offset:3072 sc1
    global_load_dwordx4 v[48:51], v4, s[26:27] offset:0 sc1
    global_load_dwordx4 v[52:55], v4, s[26:27] offset:1024 sc1
    global_load_dwordx4 v[56:59], v4, s[26:27] offset:2048 sc1
    global_load_dwordx4 v[60:63], v4, s[26:27] offset:3072 sc1
    global_load_dwordx4 v[64:67], v5, s[26:27] offset:0 sc1
    global_load_dwordx4 v[68:71], v5, s[26:27] offset:1024 sc1
    s_add_u32 s26, s26, 0x7000
    s_addc_u32 s27, s27, 0
    global_load_dwordx4 v[16:19], v2, s[26:27] offset:0 sc1
    global_load_dwordx4 v[20:23], v2, s[26:27] offset:1024 sc1
    global_load_dwordx4 v[24:27], v2, s[26:27] offset:2048 sc1
    global_load_dwordx4 v[28:31], v2, s[26:27] offset:3072 sc1
    global_load_dwordx4 v[32:35], v3, s[26:27] offset:0 sc1
    global_load_dwordx4 v[36:39], v3, s[26:27] offset:1024 sc1
    global_load_dwordx4 v[40:43], v3, s[26:27] offset:2048 sc1
    global_load_dwordx4 v[44:47], v3, s[26:27] offset:3072 sc1
    global_load_dwordx4 v[48:51], v4, s[26:27] offset:0 sc1
    global_load_dwordx4 v[52:55], v4, s[26:27] offset:1024 sc1
    global_load_dwordx4 v[56:59], v4, s[26:27] offset:2048 sc1
    global_load_dwordx4 v[60:63], v4, s[26:27] offset:3072 sc1
    global_load_dwordx4 v[64:67], v5, s[26:27] offset:0 sc1
    global_load_dwordx4 v[68:71], v5, s[26:27] offset:1024 sc1
    s_add_u32 s26, s26, 0x7000
    s_addc_u32 s27, s27, 0
    s_nop 7
    v_cndmask_b32 v128, v11, v128, s[46:47]
    v_cndmask_b32 v129, v11, v129, s[48:49]
    v_cndmask_b32 v130, v11, v130, s[50:51]
    v_cndmask_b32 v131, v11, v131, s[52:53]
    v_cndmask_b32 v132, v11, v132, s[54:55]
    v_cndmask_b32 v133, v11, v133, s[56:57]
    v_cndmask_b32 v134, v11, v134, s[58:59]
    v_cndmask_b32 v135, v11, v135, s[60:61]
    v_cndmask_b32 v136, v11, v136, s[46:47]
    v_cndmask_b32 v137, v11, v137, s[48:49]
    v_cndmask_b32 v138, v11, v138, s[50:51]
    v_cndmask_b32 v139, v11, v139, s[52:53]
    v_cndmask_b32 v140, v11, v140, s[54:55]
    v_cndmask_b32 v141, v11, v141, s[56:57]
    v_cndmask_b32 v142, v11, v142, s[58:59]
    v_cndmask_b32 v143, v11, v143, s[60:61]
    v_cndmask_b32 v144, v11, v144, s[46:47]
    v_cndmask_b32 v145, v11, v145, s[48:49]
    v_cndmask_b32 v146, v11, v146, s[50:51]
    v_cndmask_b32 v147, v11, v147, s[52:53]
    v_cndmask_b32 v148, v11, v148, s[54:55]
    v_cndmask_b32 v149, v11, v149, s[56:57]
    v_cndmask_b32 v150, v11, v150, s[58:59]
    v_cndmask_b32 v151, v11, v151, s[60:61]
    v_cndmask_b32 v152, v11, v152, s[46:47]
    v_cndmask_b32 v153, v11, v153, s[48:49]
    v_cndmask_b32 v154, v11, v154, s[50:51]
    v_cndmask_b32 v155, v11, v155, s[52:53]
    v_cndmask_b32 v156, v11, v156, s[54:55]
    v_cndmask_b32 v157, v11, v157, s[56:57]
    v_cndmask_b32 v158, v11, v158, s[58:59]
    v_cndmask_b32 v159, v11, v159, s[60:61]
    v_add_u32 v6, 0, v0
    v_min_u32 v6, 447, v6
    v_mul_u32_u24 v7, 2341, v6
    v_lshrrev_b32 v7, 16, v7
    v_mul_u32_u24 v10, 28, v7
    v_sub_u32 v6, v6, v10
    v_mul_u32_u24 v10, 912, v7
    v_lshl_add_u32 v216, v6, 5, v10
    v_mul_u32_u24 v10, 896, v7
    v_lshl_add_u32 v218, v6, 4, v10
    v_add_u32 v6, 256, v0
    v_min_u32 v6, 447, v6
    v_mul_u32_u24 v7, 2341, v6
    v_lshrrev_b32 v7, 16, v7
    v_mul_u32_u24 v10, 28, v7
    v_sub_u32 v6, v6, v10
    v_mul_u32_u24 v10, 912, v7
    v_lshl_add_u32 v217, v6, 5, v10
    v_mul_u32_u24 v10, 896, v7
    v_lshl_add_u32 v219, v6, 4, v10
    s_mul_i32 s25, s74, 448
    s_add_u32 s40, s40, s25
    s_waitcnt vmcnt(0)
    s_cmp_lg_u32 s23, 0
    s_cbranch_scc1 Lwo_120
    s_lshl_b32 s25, s75, 2
    s_add_u32 s25, s25, 0x7900c00
    s_add_u32 s76, s4, s25
    s_addc_u32 s77, s5, 0
    v_mbcnt_lo_u32_b32 v8, -1, 0
    v_mbcnt_hi_u32_b32 v8, -1, v8
    v_lshlrev_b32 v8, 2, v8
    s_mov_b32 s78, 1048576
    s_mov_b32 exec_lo, 0x1
    s_mov_b32 exec_hi, 0x0
Lwf_121:
    global_load_dword v9, v8, s[76:77] sc1
    s_sub_u32 s78, s78, 1
    s_cmp_eq_u32 s78, 0
    s_cbranch_scc1 Lexit_1
    s_waitcnt vmcnt(0)
    v_cmp_ne_u32 vcc, 1, v9
    s_cbranch_vccz Lwfd_122
    s_sleep 16
    s_branch Lwf_121
Lwfd_122:
    s_mov_b64 exec, -1
Lwo_120:
    s_barrier
    s_add_u32 s26, s44, s40
    s_addc_u32 s27, s45, 0
    s_add_u32 s25, s40, 0x1e00000
    s_add_u32 s28, s4, s25
    s_addc_u32 s29, s5, 0
    global_load_dwordx4 v[200:203], v218, s[26:27]
    global_load_dwordx4 v[208:211], v218, s[28:29] sc1
    global_load_dwordx4 v[204:207], v219, s[26:27]
    global_load_dwordx4 v[212:215], v219, s[28:29] sc1
    v_lshrrev_b32 v6, 4, v1
    v_lshlrev_b32 v6, 7, v6
    v_and_b32 v7, 5, v1
    v_bfe_u32 v10, v1, 3, 1
    v_lshl_add_u32 v7, v10, 1, v7
    v_lshl_add_u32 v6, v7, 4, v6
    v_add_u32 v7, 4096, v6
    s_lshl_b32 s25, s75, 13
    s_add_u32 s25, s25, 0x6300000
    s_add_u32 s26, s4, s25
    s_addc_u32 s27, s5, 0
    s_mov_b32 s78, 1048576
    s_max_u32 s25, s75, 1
    s_lshl_b32 s25, s25, 13
    s_add_u32 s25, s25, 0x62fe000
    s_add_u32 s28, s4, s25
    s_addc_u32 s29, s5, 0
    s_cmp_lg_u32 s23, 0
    s_cbranch_scc1 Lxq1_127
Lxq0_126:
    global_load_dword v10, v7, s[28:29] offset:2560 sc1
    s_sub_u32 s78, s78, 1
    s_cmp_eq_u32 s78, 0
    s_cbranch_scc1 Lexit_1
    s_waitcnt vmcnt(0)
    v_cmp_eq_u32 vcc, -1, v10
    s_cbranch_vccz Lxq1_127
    s_sleep 8
    s_branch Lxq0_126
Lxq1_127:
    s_barrier
    s_branch Lxp_124
Lxq_123:
    s_sub_u32 s78, s78, 1
    s_cmp_eq_u32 s78, 0
    s_cbranch_scc1 Lexit_1
Lxp_124:
    global_load_dwordx4 v[16:19], v6, s[26:27] offset:0 sc1
    global_load_dwordx4 v[20:23], v6, s[26:27] offset:512 sc1
    global_load_dwordx4 v[24:27], v6, s[26:27] offset:1024 sc1
    global_load_dwordx4 v[28:31], v6, s[26:27] offset:1536 sc1
    global_load_dwordx4 v[32:35], v6, s[26:27] offset:2048 sc1
    global_load_dwordx4 v[36:39], v6, s[26:27] offset:2560 sc1
    global_load_dwordx4 v[40:43], v6, s[26:27] offset:3072 sc1
    global_load_dwordx4 v[44:47], v6, s[26:27] offset:3584 sc1
    global_load_dwordx4 v[48:51], v7, s[26:27] offset:0 sc1
    global_load_dwordx4 v[52:55], v7, s[26:27] offset:512 sc1
    global_load_dwordx4 v[56:59], v7, s[26:27] offset:1024 sc1
    global_load_dwordx4 v[60:63], v7, s[26:27] offset:1536 sc1
    global_load_dwordx4 v[64:67], v7, s[26:27] offset:2048 sc1
    global_load_dwordx4 v[68:71], v7, s[26:27] offset:2560 sc1
    s_waitcnt vmcnt(0)
    v_max3_u32 v10, v16, v17, v18
    v_max3_u32 v10, v10, v19, v20
    v_max3_u32 v10, v10, v21, v22
    v_max3_u32 v10, v10, v23, v24
    v_max3_u32 v10, v10, v25, v26
    v_max3_u32 v10, v10, v27, v28
    v_max3_u32 v10, v10, v29, v30
    v_max3_u32 v10, v10, v31, v32
    v_max3_u32 v10, v10, v33, v34
    v_max3_u32 v10, v10, v35, v36
    v_max3_u32 v10, v10, v37, v38
    v_max3_u32 v10, v10, v39, v40
    v_max3_u32 v10, v10, v41, v42
    v_max3_u32 v10, v10, v43, v44
    v_max3_u32 v10, v10, v45, v46
    v_max3_u32 v10, v10, v47, v48
    v_max3_u32 v10, v10, v49, v50
    v_max3_u32 v10, v10, v51, v52
    v_max3_u32 v10, v10, v53, v54
    v_max3_u32 v10, v10, v55, v56
    v_max3_u32 v10, v10, v57, v58
    v_max3_u32 v10, v10, v59, v60
    v_max3_u32 v10, v10, v61, v62
    v_max3_u32 v10, v10, v63, v64
    v_max3_u32 v10, v10, v65, v66
    v_max3_u32 v10, v10, v67, v68
    v_max3_u32 v10, v10, v69, v70
    v_max_u32 v10, v10, v71
    v_cmp_eq_u32 vcc, -1, v10
    s_cbranch_vccnz Lxq_123
    v_add_u32 v12, 0, v2
    v_add_u32 v13, 28672, v2
    v_add_u32 v14, 57344, v2
    v_add_u32 v15, 86016, v2
    global_load_dwordx4 v[80:83], v12, s[30:31] offset:0 sc1
    global_load_dwordx4 v[84:87], v13, s[30:31] offset:0 sc1
    global_load_dwordx4 v[88:91], v14, s[30:31] offset:0 sc1
    global_load_dwordx4 v[92:95], v15, s[30:31] offset:0 sc1
    global_load_dwordx4 v[96:99], v12, s[30:31] offset:1024 sc1
    global_load_dwordx4 v[100:103], v13, s[30:31] offset:1024 sc1
    global_load_dwordx4 v[104:107], v14, s[30:31] offset:1024 sc1
    global_load_dwordx4 v[108:111], v15, s[30:31] offset:1024 sc1
    global_load_dwordx4 v[112:115], v12, s[30:31] offset:2048 sc1
    global_load_dwordx4 v[116:119], v13, s[30:31] offset:2048 sc1
    global_load_dwordx4 v[120:123], v14, s[30:31] offset:2048 sc1
    global_load_dwordx4 v[124:127], v15, s[30:31] offset:2048 sc1
    v_mfma_f32_16x16x32_bf16 v[160:163], v[16:19], a[0:3], 0
    v_mfma_f32_16x16x32_bf16 v[164:167], v[16:19], a[56:59], 0
    v_mfma_f32_16x16x32_bf16 v[168:171], v[16:19], a[112:115], 0
    v_mfma_f32_16x16x32_bf16 v[172:175], v[16:19], a[168:171], 0
    v_mfma_f32_16x16x32_bf16 v[160:163], v[20:23], a[4:7], v[160:163]
    v_mfma_f32_16x16x32_bf16 v[164:167], v[20:23], a[60:63], v[164:167]
    v_mfma_f32_16x16x32_bf16 v[168:171], v[20:23], a[116:119], v[168:171]
    v_mfma_f32_16x16x32_bf16 v[172:175], v[20:23], a[172:175], v[172:175]
    v_mfma_f32_16x16x32_bf16 v[160:163], v[24:27], a[8:11], v[160:163]
    v_mfma_f32_16x16x32_bf16 v[164:167], v[24:27], a[64:67], v[164:167]
    v_mfma_f32_16x16x32_bf16 v[168:171], v[24:27], a[120:123], v[168:171]
    v_mfma_f32_16x16x32_bf16 v[172:175], v[24:27], a[176:179], v[172:175]
    v_mfma_f32_16x16x32_bf16 v[160:163], v[28:31], a[12:15], v[160:163]
    v_mfma_f32_16x16x32_bf16 v[164:167], v[28:31], a[68:71], v[164:167]
    v_mfma_f32_16x16x32_bf16 v[168:171], v[28:31], a[124:127], v[168:171]
    v_mfma_f32_16x16x32_bf16 v[172:175], v[28:31], a[180:183], v[172:175]
    v_mfma_f32_16x16x32_bf16 v[160:163], v[32:35], a[16:19], v[160:163]
    v_mfma_f32_16x16x32_bf16 v[164:167], v[32:35], a[72:75], v[164:167]
    v_mfma_f32_16x16x32_bf16 v[168:171], v[32:35], a[128:131], v[168:171]
    v_mfma_f32_16x16x32_bf16 v[172:175], v[32:35], a[184:187], v[172:175]
    v_mfma_f32_16x16x32_bf16 v[160:163], v[36:39], a[20:23], v[160:163]
    v_mfma_f32_16x16x32_bf16 v[164:167], v[36:39], a[76:79], v[164:167]
    v_mfma_f32_16x16x32_bf16 v[168:171], v[36:39], a[132:135], v[168:171]
    v_mfma_f32_16x16x32_bf16 v[172:175], v[36:39], a[188:191], v[172:175]
    v_mfma_f32_16x16x32_bf16 v[160:163], v[40:43], a[24:27], v[160:163]
    v_mfma_f32_16x16x32_bf16 v[164:167], v[40:43], a[80:83], v[164:167]
    v_mfma_f32_16x16x32_bf16 v[168:171], v[40:43], a[136:139], v[168:171]
    v_mfma_f32_16x16x32_bf16 v[172:175], v[40:43], a[192:195], v[172:175]
    v_mfma_f32_16x16x32_bf16 v[160:163], v[44:47], a[28:31], v[160:163]
    v_mfma_f32_16x16x32_bf16 v[164:167], v[44:47], a[84:87], v[164:167]
    v_mfma_f32_16x16x32_bf16 v[168:171], v[44:47], a[140:143], v[168:171]
    v_mfma_f32_16x16x32_bf16 v[172:175], v[44:47], a[196:199], v[172:175]
    v_mfma_f32_16x16x32_bf16 v[160:163], v[48:51], a[32:35], v[160:163]
    v_mfma_f32_16x16x32_bf16 v[164:167], v[48:51], a[88:91], v[164:167]
    v_mfma_f32_16x16x32_bf16 v[168:171], v[48:51], a[144:147], v[168:171]
    v_mfma_f32_16x16x32_bf16 v[172:175], v[48:51], a[200:203], v[172:175]
    v_mfma_f32_16x16x32_bf16 v[160:163], v[52:55], a[36:39], v[160:163]
    v_mfma_f32_16x16x32_bf16 v[164:167], v[52:55], a[92:95], v[164:167]
    v_mfma_f32_16x16x32_bf16 v[168:171], v[52:55], a[148:151], v[168:171]
    v_mfma_f32_16x16x32_bf16 v[172:175], v[52:55], a[204:207], v[172:175]
    v_mfma_f32_16x16x32_bf16 v[160:163], v[56:59], a[40:43], v[160:163]
    v_mfma_f32_16x16x32_bf16 v[164:167], v[56:59], a[96:99], v[164:167]
    v_mfma_f32_16x16x32_bf16 v[168:171], v[56:59], a[152:155], v[168:171]
    v_mfma_f32_16x16x32_bf16 v[172:175], v[56:59], a[208:211], v[172:175]
    v_mfma_f32_16x16x32_bf16 v[160:163], v[60:63], a[44:47], v[160:163]
    v_mfma_f32_16x16x32_bf16 v[164:167], v[60:63], a[100:103], v[164:167]
    v_mfma_f32_16x16x32_bf16 v[168:171], v[60:63], a[156:159], v[168:171]
    v_mfma_f32_16x16x32_bf16 v[172:175], v[60:63], a[212:215], v[172:175]
    v_mfma_f32_16x16x32_bf16 v[160:163], v[64:67], a[48:51], v[160:163]
    v_mfma_f32_16x16x32_bf16 v[164:167], v[64:67], a[104:107], v[164:167]
    v_mfma_f32_16x16x32_bf16 v[168:171], v[64:67], a[160:163], v[168:171]
    v_mfma_f32_16x16x32_bf16 v[172:175], v[64:67], a[216:219], v[172:175]
    v_mfma_f32_16x16x32_bf16 v[160:163], v[68:71], a[52:55], v[160:163]
    v_mfma_f32_16x16x32_bf16 v[164:167], v[68:71], a[108:111], v[164:167]
    v_mfma_f32_16x16x32_bf16 v[168:171], v[68:71], a[164:167], v[168:171]
    v_mfma_f32_16x16x32_bf16 v[172:175], v[68:71], a[220:223], v[172:175]
    global_load_dwordx4 v[16:19], v12, s[30:31] offset:3072 sc1
    global_load_dwordx4 v[20:23], v13, s[30:31] offset:3072 sc1
    global_load_dwordx4 v[24:27], v14, s[30:31] offset:3072 sc1
    global_load_dwordx4 v[28:31], v15, s[30:31] offset:3072 sc1
    s_add_u32 s30, s30, 0x1000
    s_addc_u32 s31, s31, 0
    global_load_dwordx4 v[32:35], v12, s[30:31] offset:0 sc1
    global_load_dwordx4 v[36:39], v13, s[30:31] offset:0 sc1
    global_load_dwordx4 v[40:43], v14, s[30:31] offset:0 sc1
    global_load_dwordx4 v[44:47], v15, s[30:31] offset:0 sc1
    global_load_dwordx4 v[48:51], v12, s[30:31] offset:1024 sc1
    global_load_dwordx4 v[52:55], v13, s[30:31] offset:1024 sc1
    global_load_dwordx4 v[56:59], v14, s[30:31] offset:1024 sc1
    global_load_dwordx4 v[60:63], v15, s[30:31] offset:1024 sc1
    global_load_dwordx4 v[64:67], v12, s[30:31] offset:2048 sc1
    global_load_dwordx4 v[68:71], v13, s[30:31] offset:2048 sc1
    global_load_dwordx4 v[72:75], v14, s[30:31] offset:2048 sc1
    global_load_dwordx4 v[76:79], v15, s[30:31] offset:2048 sc1
    global_load_dwordx4 a[64:67], v12, s[30:31] offset:3072 sc1
    global_load_dwordx4 a[68:71], v13, s[30:31] offset:3072 sc1
    global_load_dwordx4 a[72:75], v14, s[30:31] offset:3072 sc1
    global_load_dwordx4 a[76:79], v15, s[30:31] offset:3072 sc1
    s_add_u32 s30, s30, 0x1000
    s_addc_u32 s31, s31, 0
    global_load_dwordx4 a[80:83], v12, s[30:31] offset:0 sc1
    global_load_dwordx4 a[84:87], v13, s[30:31] offset:0 sc1
    global_load_dwordx4 a[88:91], v14, s[30:31] offset:0 sc1
    global_load_dwordx4 a[92:95], v15, s[30:31] offset:0 sc1
    global_load_dwordx4 a[96:99], v12, s[30:31] offset:1024 sc1
    global_load_dwordx4 a[100:103], v13, s[30:31] offset:1024 sc1
    global_load_dwordx4 a[104:107], v14, s[30:31] offset:1024 sc1
    global_load_dwordx4 a[108:111], v15, s[30:31] offset:1024 sc1
    global_load_dwordx4 a[112:115], v12, s[30:31] offset:2048 sc1
    global_load_dwordx4 a[116:119], v13, s[30:31] offset:2048 sc1
    global_load_dwordx4 a[120:123], v14, s[30:31] offset:2048 sc1
    global_load_dwordx4 a[124:127], v15, s[30:31] offset:2048 sc1
    global_load_dwordx4 a[128:131], v12, s[30:31] offset:3072 sc1
    global_load_dwordx4 a[132:135], v13, s[30:31] offset:3072 sc1
    global_load_dwordx4 a[136:139], v14, s[30:31] offset:3072 sc1
    global_load_dwordx4 a[140:143], v15, s[30:31] offset:3072 sc1
    s_add_u32 s30, s30, 0x1000
    s_addc_u32 s31, s31, 0
    global_load_dwordx4 a[144:147], v12, s[30:31] offset:0 sc1
    global_load_dwordx4 a[148:151], v13, s[30:31] offset:0 sc1
    global_load_dwordx4 a[152:155], v14, s[30:31] offset:0 sc1
    global_load_dwordx4 a[156:159], v15, s[30:31] offset:0 sc1
    global_load_dwordx4 a[160:163], v12, s[30:31] offset:1024 sc1
    global_load_dwordx4 a[164:167], v13, s[30:31] offset:1024 sc1
    global_load_dwordx4 a[168:171], v14, s[30:31] offset:1024 sc1
    global_load_dwordx4 a[172:175], v15, s[30:31] offset:1024 sc1
    s_nop 3
    v_max3_f32 v232, v128, v129, v130
    v_max3_f32 v234, v136, v137, v138
    v_max3_f32 v236, v144, v145, v146
    v_max3_f32 v238, v152, v153, v154
    v_max3_f32 v232, v232, v131, v132
    v_max3_f32 v234, v234, v139, v140
    v_max3_f32 v236, v236, v147, v148
    v_max3_f32 v238, v238, v155, v156
    v_max3_f32 v232, v232, v133, v134
    v_max3_f32 v234, v234, v141, v142
    v_max3_f32 v236, v236, v149, v150
    v_max3_f32 v238, v238, v157, v158
    v_max3_f32 v232, v232, v135, v160
    v_max3_f32 v234, v234, v143, v164
    v_max3_f32 v236, v236, v151, v168
    v_max3_f32 v238, v238, v159, v172
    v_max3_f32 v232, v232, v161, v162
    v_max3_f32 v234, v234, v165, v166
    v_max3_f32 v236, v236, v169, v170
    v_max3_f32 v238, v238, v173, v174
    v_max_f32 v232, v232, v163
    v_max_f32 v234, v234, v167
    v_max_f32 v236, v236, v171
    v_max_f32 v238, v238, v175
    v_mov_b32 v233, v232
    v_mov_b32 v235, v234
    v_mov_b32 v237, v236
    v_mov_b32 v239, v238
    s_nop 1
    v_permlane16_swap_b32 v232, v233
    v_permlane16_swap_b32 v234, v235
    v_permlane16_swap_b32 v236, v237
    v_permlane16_swap_b32 v238, v239
    v_max_f32 v232, v232, v233
    v_max_f32 v234, v234, v235
    v_max_f32 v236, v236, v237
    v_max_f32 v238, v238, v239
    v_mov_b32 v233, v232
    v_mov_b32 v235, v234
    v_mov_b32 v237, v236
    v_mov_b32 v239, v238
    s_nop 1
    v_permlane32_swap_b32 v232, v233
    v_permlane32_swap_b32 v234, v235
    v_permlane32_swap_b32 v236, v237
    v_permlane32_swap_b32 v238, v239
    v_max_f32 v232, v232, v233
    v_max_f32 v234, v234, v235
    v_max_f32 v236, v236, v237
    v_max_f32 v238, v238, v239
    v_sub_f32 v128, v128, v232
    v_sub_f32 v129, v129, v232
    v_sub_f32 v130, v130, v232
    v_sub_f32 v131, v131, v232
    v_sub_f32 v132, v132, v232
    v_sub_f32 v133, v133, v232
    v_sub_f32 v134, v134, v232
    v_sub_f32 v135, v135, v232
    v_sub_f32 v160, v160, v232
    v_sub_f32 v161, v161, v232
    v_sub_f32 v162, v162, v232
    v_sub_f32 v163, v163, v232
    v_sub_f32 v136, v136, v234
    v_sub_f32 v137, v137, v234
    v_sub_f32 v138, v138, v234
    v_sub_f32 v139, v139, v234
    v_sub_f32 v140, v140, v234
    v_sub_f32 v141, v141, v234
    v_sub_f32 v142, v142, v234
    v_sub_f32 v143, v143, v234
    v_sub_f32 v164, v164, v234
    v_sub_f32 v165, v165, v234
    v_sub_f32 v166, v166, v234
    v_sub_f32 v167, v167, v234
    v_sub_f32 v144, v144, v236
    v_sub_f32 v145, v145, v236
    v_sub_f32 v146, v146, v236
    v_sub_f32 v147, v147, v236
    v_sub_f32 v148, v148, v236
    v_sub_f32 v149, v149, v236
    v_sub_f32 v150, v150, v236
    v_sub_f32 v151, v151, v236
    v_sub_f32 v168, v168, v236
    v_sub_f32 v169, v169, v236
    v_sub_f32 v170, v170, v236
    v_sub_f32 v171, v171, v236
    v_sub_f32 v152, v152, v238
    v_sub_f32 v153, v153, v238
    v_sub_f32 v154, v154, v238
    v_sub_f32 v155, v155, v238
    v_sub_f32 v156, v156, v238
    v_sub_f32 v157, v157, v238
    v_sub_f32 v158, v158, v238
    v_sub_f32 v159, v159, v238
    v_sub_f32 v172, v172, v238
    v_sub_f32 v173, v173, v238
    v_sub_f32 v174, v174, v238
    v_sub_f32 v175, v175, v238
    v_mul_f32 v128, s38, v128
    v_mul_f32 v129, s38, v129
    v_mul_f32 v130, s38, v130
    v_mul_f32 v131, s38, v131
    v_mul_f32 v132, s38, v132
    v_mul_f32 v133, s38, v133
    v_mul_f32 v134, s38, v134
    v_mul_f32 v135, s38, v135
    v_mul_f32 v160, s38, v160
    v_mul_f32 v161, s38, v161
    v_mul_f32 v162, s38, v162
    v_mul_f32 v163, s38, v163
    v_mul_f32 v136, s38, v136
    v_mul_f32 v137, s38, v137
    v_mul_f32 v138, s38, v138
    v_mul_f32 v139, s38, v139
    v_mul_f32 v140, s38, v140
    v_mul_f32 v141, s38, v141
    v_mul_f32 v142, s38, v142
    v_mul_f32 v143, s38, v143
    v_mul_f32 v164, s38, v164
    v_mul_f32 v165, s38, v165
    v_mul_f32 v166, s38, v166
    v_mul_f32 v167, s38, v167
    v_mul_f32 v144, s38, v144
    v_mul_f32 v145, s38, v145
    v_mul_f32 v146, s38, v146
    v_mul_f32 v147, s38, v147
    v_mul_f32 v148, s38, v148
    v_mul_f32 v149, s38, v149
    v_mul_f32 v150, s38, v150
    v_mul_f32 v151, s38, v151
    v_mul_f32 v168, s38, v168
    v_mul_f32 v169, s38, v169
    v_mul_f32 v170, s38, v170
    v_mul_f32 v171, s38, v171
    v_mul_f32 v152, s38, v152
    v_mul_f32 v153, s38, v153
    v_mul_f32 v154, s38, v154
    v_mul_f32 v155, s38, v155
    v_mul_f32 v156, s38, v156
    v_mul_f32 v157, s38, v157
    v_mul_f32 v158, s38, v158
    v_mul_f32 v159, s38, v159
    v_mul_f32 v172, s38, v172
    v_mul_f32 v173, s38, v173
    v_mul_f32 v174, s38, v174
    v_mul_f32 v175, s38, v175
    v_exp_f32 v128, v128
    v_exp_f32 v129, v129
    v_exp_f32 v130, v130
    v_exp_f32 v131, v131
    v_exp_f32 v132, v132
    v_exp_f32 v133, v133
    v_exp_f32 v134, v134
    v_exp_f32 v135, v135
    v_exp_f32 v160, v160
    v_exp_f32 v161, v161
    v_exp_f32 v162, v162
    v_exp_f32 v163, v163
    v_exp_f32 v136, v136
    v_exp_f32 v137, v137
    v_exp_f32 v138, v138
    v_exp_f32 v139, v139
    v_exp_f32 v140, v140
    v_exp_f32 v141, v141
    v_exp_f32 v142, v142
    v_exp_f32 v143, v143
    v_exp_f32 v164, v164
    v_exp_f32 v165, v165
    v_exp_f32 v166, v166
    v_exp_f32 v167, v167
    v_exp_f32 v144, v144
    v_exp_f32 v145, v145
    v_exp_f32 v146, v146
    v_exp_f32 v147, v147
    v_exp_f32 v148, v148
    v_exp_f32 v149, v149
    v_exp_f32 v150, v150
    v_exp_f32 v151, v151
    v_exp_f32 v168, v168
    v_exp_f32 v169, v169
    v_exp_f32 v170, v170
    v_exp_f32 v171, v171
    v_exp_f32 v152, v152
    v_exp_f32 v153, v153
    v_exp_f32 v154, v154
    v_exp_f32 v155, v155
    v_exp_f32 v156, v156
    v_exp_f32 v157, v157
    v_exp_f32 v158, v158
    v_exp_f32 v159, v159
    v_exp_f32 v172, v172
    v_exp_f32 v173, v173
    v_exp_f32 v174, v174
    v_exp_f32 v175, v175
    s_nop 0
    v_add_f32 v232, v160, v161
    v_add_f32 v233, v162, v163
    v_add_f32 v234, v164, v165
    v_add_f32 v235, v166, v167
    v_add_f32 v236, v168, v169
    v_add_f32 v237, v170, v171
    v_add_f32 v238, v172, v173
    v_add_f32 v239, v174, v175
    v_add_f32 v232, v232, v233
    v_add_f32 v234, v234, v235
    v_add_f32 v236, v236, v237
    v_add_f32 v238, v238, v239
    v_mul_f32 v232, 0.5, v232
    v_mul_f32 v234, 0.5, v234
    v_mul_f32 v236, 0.5, v236
    v_mul_f32 v238, 0.5, v238
    v_add_f32 v232, v232, v128
    v_add_f32 v234, v234, v136
    v_add_f32 v236, v236, v144
    v_add_f32 v238, v238, v152
    v_add_f32 v232, v232, v129
    v_add_f32 v234, v234, v137
    v_add_f32 v236, v236, v145
    v_add_f32 v238, v238, v153
    v_add_f32 v232, v232, v130
    v_add_f32 v234, v234, v138
    v_add_f32 v236, v236, v146
    v_add_f32 v238, v238, v154
    v_add_f32 v232, v232, v131
    v_add_f32 v234, v234, v139
    v_add_f32 v236, v236, v147
    v_add_f32 v238, v238, v155
    v_add_f32 v232, v232, v132
    v_add_f32 v234, v234, v140
    v_add_f32 v236, v236, v148
    v_add_f32 v238, v238, v156
    v_add_f32 v232, v232, v133
    v_add_f32 v234, v234, v141
    v_add_f32 v236, v236, v149
    v_add_f32 v238, v238, v157
    v_add_f32 v232, v232, v134
    v_add_f32 v234, v234, v142
    v_add_f32 v236, v236, v150
    v_add_f32 v238, v238, v158
    v_add_f32 v232, v232, v135
    v_add_f32 v234, v234, v143
    v_add_f32 v236, v236, v151
    v_add_f32 v238, v238, v159
    v_mov_b32 v233, v232
    v_mov_b32 v235, v234
    v_mov_b32 v237, v236
    v_mov_b32 v239, v238
    s_nop 1
    v_permlane16_swap_b32 v232, v233
    v_permlane16_swap_b32 v234, v235
    v_permlane16_swap_b32 v236, v237
    v_permlane16_swap_b32 v238, v239
    v_add_f32 v232, v232, v233
    v_add_f32 v234, v234, v235
    v_add_f32 v236, v236, v237
    v_add_f32 v238, v238, v239
    v_mov_b32 v233, v232
    v_mov_b32 v235, v234
    v_mov_b32 v237, v236
    v_mov_b32 v239, v238
    s_nop 1
    v_permlane32_swap_b32 v232, v233
    v_permlane32_swap_b32 v234, v235
    v_permlane32_swap_b32 v236, v237
    v_permlane32_swap_b32 v238, v239
    v_add_f32 v232, v232, v233
    v_add_f32 v234, v234, v235
    v_add_f32 v236, v236, v237
    v_add_f32 v238, v238, v239
    v_rcp_f32 v232, v232
    v_rcp_f32 v234, v234
    v_rcp_f32 v236, v236
    v_rcp_f32 v238, v238
    s_nop 0
    v_mul_f32 v128, v128, v232
    v_mul_f32 v129, v129, v232
    v_mul_f32 v130, v130, v232
    v_mul_f32 v131, v131, v232
    v_mul_f32 v132, v132, v232
    v_mul_f32 v133, v133, v232
    v_mul_f32 v134, v134, v232
    v_mul_f32 v135, v135, v232
    v_mul_f32 v160, v160, v232
    v_mul_f32 v161, v161, v232
    v_mul_f32 v162, v162, v232
    v_mul_f32 v163, v163, v232
    v_mul_f32 v136, v136, v234
    v_mul_f32 v137, v137, v234
    v_mul_f32 v138, v138, v234
    v_mul_f32 v139, v139, v234
    v_mul_f32 v140, v140, v234
    v_mul_f32 v141, v141, v234
    v_mul_f32 v142, v142, v234
    v_mul_f32 v143, v143, v234
    v_mul_f32 v164, v164, v234
    v_mul_f32 v165, v165, v234
    v_mul_f32 v166, v166, v234
    v_mul_f32 v167, v167, v234
    v_mul_f32 v144, v144, v236
    v_mul_f32 v145, v145, v236
    v_mul_f32 v146, v146, v236
    v_mul_f32 v147, v147, v236
    v_mul_f32 v148, v148, v236
    v_mul_f32 v149, v149, v236
    v_mul_f32 v150, v150, v236
    v_mul_f32 v151, v151, v236
    v_mul_f32 v168, v168, v236
    v_mul_f32 v169, v169, v236
    v_mul_f32 v170, v170, v236
    v_mul_f32 v171, v171, v236
    v_mul_f32 v152, v152, v238
    v_mul_f32 v153, v153, v238
    v_mul_f32 v154, v154, v238
    v_mul_f32 v155, v155, v238
    v_mul_f32 v156, v156, v238
    v_mul_f32 v157, v157, v238
    v_mul_f32 v158, v158, v238
    v_mul_f32 v159, v159, v238
    v_mul_f32 v172, v172, v238
    v_mul_f32 v173, v173, v238
    v_mul_f32 v174, v174, v238
    v_mul_f32 v175, v175, v238
    v_cvt_pk_bf16_f32 v176, v128, v129
    v_cvt_pk_bf16_f32 v177, v130, v131
    v_cvt_pk_bf16_f32 v178, v132, v133
    v_cvt_pk_bf16_f32 v179, v134, v135
    v_cvt_pk_bf16_f32 v192, v160, v161
    v_cvt_pk_bf16_f32 v180, v136, v137
    v_cvt_pk_bf16_f32 v181, v138, v139
    v_cvt_pk_bf16_f32 v182, v140, v141
    v_cvt_pk_bf16_f32 v183, v142, v143
    v_cvt_pk_bf16_f32 v193, v164, v165
    v_cvt_pk_bf16_f32 v184, v144, v145
    v_cvt_pk_bf16_f32 v185, v146, v147
    v_cvt_pk_bf16_f32 v186, v148, v149
    v_cvt_pk_bf16_f32 v187, v150, v151
    v_cvt_pk_bf16_f32 v194, v168, v169
    v_cvt_pk_bf16_f32 v188, v152, v153
    v_cvt_pk_bf16_f32 v189, v154, v155
    v_cvt_pk_bf16_f32 v190, v156, v157
    v_cvt_pk_bf16_f32 v191, v158, v159
    v_cvt_pk_bf16_f32 v195, v172, v173
    s_nop 1
    s_waitcnt vmcnt(0)
    s_cmp_lg_u32 s23, 0
    s_cbranch_scc1 Lwo_128
    s_lshl_b32 s25, s75, 8
    s_add_u32 s25, s25, 0x7901200
    s_add_u32 s76, s4, s25
    s_addc_u32 s77, s5, 0
    v_mbcnt_lo_u32_b32 v8, -1, 0
    v_mbcnt_hi_u32_b32 v8, -1, v8
    v_lshlrev_b32 v8, 2, v8
    s_mov_b32 s78, 1048576
    s_mov_b32 exec_lo, 0xffffffff
    s_mov_b32 exec_hi, 0xffffff
Lwf_129:
    global_load_dword v9, v8, s[76:77] sc1
    s_sub_u32 s78, s78, 1
    s_cmp_eq_u32 s78, 0
    s_cbranch_scc1 Lexit_1
    s_waitcnt vmcnt(0)
    v_cmp_ne_u32 vcc, 1, v9
    s_cbranch_vccz Lwfd_130
    s_sleep 2
    s_branch Lwf_129
Lwfd_130:
    s_mov_b64 exec, -1
Lwo_128:
    s_barrier
    s_mul_i32 s25, s75, 114688
    s_lshl_b32 s26, s23, 10
    s_add_u32 s25, s25, s26
    s_mul_i32 s26, s74, 57344
    s_add_u32 s25, s25, s26
    s_add_u32 s25, s25, 0x6400000
    s_add_u32 s28, s4, s25
    s_addc_u32 s29, s5, 0
    global_load_dwordx4 a[176:179], v2, s[28:29] sc1
    s_add_u32 s28, s28, 0x1000
    s_addc_u32 s29, s29, 0
    global_load_dwordx4 a[180:183], v2, s[28:29] sc1
    s_add_u32 s28, s28, 0x1000
    s_addc_u32 s29, s29, 0
    global_load_dwordx4 a[184:187], v2, s[28:29] sc1
    s_add_u32 s28, s28, 0x1000
    s_addc_u32 s29, s29, 0
    global_load_dwordx4 a[188:191], v2, s[28:29] sc1
    s_add_u32 s28, s28, 0x1000
    s_addc_u32 s29, s29, 0
    global_load_dwordx4 a[192:195], v2, s[28:29] sc1
    s_add_u32 s28, s28, 0x1000
    s_addc_u32 s29, s29, 0
    global_load_dwordx4 a[196:199], v2, s[28:29] sc1
    s_add_u32 s28, s28, 0x1000
    s_addc_u32 s29, s29, 0
    global_load_dwordx4 a[200:203], v2, s[28:29] sc1
    s_add_u32 s28, s28, 0x1000
    s_addc_u32 s29, s29, 0
    global_load_dwordx4 a[204:207], v2, s[28:29] sc1
    s_add_u32 s28, s28, 0x1000
    s_addc_u32 s29, s29, 0
    global_load_dwordx4 a[208:211], v2, s[28:29] sc1
    s_add_u32 s28, s28, 0x1000
    s_addc_u32 s29, s29, 0
    global_load_dwordx4 a[212:215], v2, s[28:29] sc1
    s_add_u32 s28, s28, 0x1000
    s_addc_u32 s29, s29, 0
    global_load_dwordx4 a[216:219], v2, s[28:29] sc1
    s_add_u32 s28, s28, 0x1000
    s_addc_u32 s29, s29, 0
    global_load_dwordx4 a[220:223], v2, s[28:29] sc1
    s_add_u32 s28, s28, 0x1000
    s_addc_u32 s29, s29, 0
    global_load_dwordx4 a[224:227], v2, s[28:29] sc1
    s_add_u32 s28, s28, 0x1000
    s_addc_u32 s29, s29, 0
    global_load_dwordx4 a[228:231], v2, s[28:29] sc1
    s_add_u32 s28, s28, 0x1000
    s_addc_u32 s29, s29, 0
    v_mfma_f32_16x16x32_bf16 a[0:3], v[80:83], v[176:179], 0
    v_mfma_f32_16x16x32_bf16 a[0:3], v[84:87], v[180:183], a[0:3]
    v_mfma_f32_16x16x32_bf16 a[0:3], v[88:91], v[184:187], a[0:3]
    v_mfma_f32_16x16x32_bf16 a[0:3], v[92:95], v[188:191], a[0:3]
    v_mfma_f32_16x16x32_bf16 a[4:7], v[96:99], v[176:179], 0
    v_mfma_f32_16x16x32_bf16 a[4:7], v[100:103], v[180:183], a[4:7]
    v_mfma_f32_16x16x32_bf16 a[4:7], v[104:107], v[184:187], a[4:7]
    v_mfma_f32_16x16x32_bf16 a[4:7], v[108:111], v[188:191], a[4:7]
    v_mfma_f32_16x16x32_bf16 a[8:11], v[112:115], v[176:179], 0
    v_mfma_f32_16x16x32_bf16 a[8:11], v[116:119], v[180:183], a[8:11]
    v_mfma_f32_16x16x32_bf16 a[8:11], v[120:123], v[184:187], a[8:11]
    v_mfma_f32_16x16x32_bf16 a[8:11], v[124:127], v[188:191], a[8:11]
    v_mfma_f32_16x16x32_bf16 a[12:15], v[16:19], v[176:179], 0
    v_mfma_f32_16x16x32_bf16 a[12:15], v[20:23], v[180:183], a[12:15]
    v_mfma_f32_16x16x32_bf16 a[12:15], v[24:27], v[184:187], a[12:15]
    v_mfma_f32_16x16x32_bf16 a[12:15], v[28:31], v[188:191], a[12:15]
    v_mfma_f32_16x16x32_bf16 a[16:19], v[32:35], v[176:179], 0
    v_mfma_f32_16x16x32_bf16 a[16:19], v[36:39], v[180:183], a[16:19]
    v_mfma_f32_16x16x32_bf16 a[16:19], v[40:43], v[184:187], a[16:19]
    v_mfma_f32_16x16x32_bf16 a[16:19], v[44:47], v[188:191], a[16:19]
    v_mfma_f32_16x16x32_bf16 a[20:23], v[48:51], v[176:179], 0
    v_mfma_f32_16x16x32_bf16 a[20:23], v[52:55], v[180:183], a[20:23]
    v_mfma_f32_16x16x32_bf16 a[20:23], v[56:59], v[184:187], a[20:23]
    v_mfma_f32_16x16x32_bf16 a[20:23], v[60:63], v[188:191], a[20:23]
    v_mfma_f32_16x16x32_bf16 a[24:27], v[64:67], v[176:179], 0
    v_mfma_f32_16x16x32_bf16 a[24:27], v[68:71], v[180:183], a[24:27]
    v_mfma_f32_16x16x32_bf16 a[24:27], v[72:75], v[184:187], a[24:27]
    v_mfma_f32_16x16x32_bf16 a[24:27], v[76:79], v[188:191], a[24:27]
    v_mfma_f32_16x16x32_bf16 a[28:31], a[64:67], v[176:179], 0
    v_mfma_f32_16x16x32_bf16 a[28:31], a[68:71], v[180:183], a[28:31]
    v_mfma_f32_16x16x32_bf16 a[28:31], a[72:75], v[184:187], a[28:31]
    v_mfma_f32_16x16x32_bf16 a[28:31], a[76:79], v[188:191], a[28:31]
    v_mfma_f32_16x16x32_bf16 a[32:35], a[80:83], v[176:179], 0
    v_mfma_f32_16x16x32_bf16 a[32:35], a[84:87], v[180:183], a[32:35]
    v_mfma_f32_16x16x32_bf16 a[32:35], a[88:91], v[184:187], a[32:35]
    v_mfma_f32_16x16x32_bf16 a[32:35], a[92:95], v[188:191], a[32:35]
    v_mfma_f32_16x16x32_bf16 a[36:39], a[96:99], v[176:179], 0
    v_mfma_f32_16x16x32_bf16 a[36:39], a[100:103], v[180:183], a[36:39]
    v_mfma_f32_16x16x32_bf16 a[36:39], a[104:107], v[184:187], a[36:39]
    v_mfma_f32_16x16x32_bf16 a[36:39], a[108:111], v[188:191], a[36:39]
    v_mfma_f32_16x16x32_bf16 a[40:43], a[112:115], v[176:179], 0
    v_mfma_f32_16x16x32_bf16 a[40:43], a[116:119], v[180:183], a[40:43]
    v_mfma_f32_16x16x32_bf16 a[40:43], a[120:123], v[184:187], a[40:43]
    v_mfma_f32_16x16x32_bf16 a[40:43], a[124:127], v[188:191], a[40:43]
    v_mfma_f32_16x16x32_bf16 a[44:47], a[128:131], v[176:179], 0
    v_mfma_f32_16x16x32_bf16 a[44:47], a[132:135], v[180:183], a[44:47]
    v_mfma_f32_16x16x32_bf16 a[44:47], a[136:139], v[184:187], a[44:47]
    v_mfma_f32_16x16x32_bf16 a[44:47], a[140:143], v[188:191], a[44:47]
    v_mfma_f32_16x16x32_bf16 a[48:51], a[144:147], v[176:179], 0
    v_mfma_f32_16x16x32_bf16 a[48:51], a[148:151], v[180:183], a[48:51]
    v_mfma_f32_16x16x32_bf16 a[48:51], a[152:155], v[184:187], a[48:51]
    v_mfma_f32_16x16x32_bf16 a[48:51], a[156:159], v[188:191], a[48:51]
    v_mfma_f32_16x16x32_bf16 a[52:55], a[160:163], v[176:179], 0
    v_mfma_f32_16x16x32_bf16 a[52:55], a[164:167], v[180:183], a[52:55]
    v_mfma_f32_16x16x32_bf16 a[52:55], a[168:171], v[184:187], a[52:55]
    v_mfma_f32_16x16x32_bf16 a[52:55], a[172:175], v[188:191], a[52:55]
    s_mul_i32 s25, s23, 14592
    v_and_b32 v3, 15, v1
    v_mul_u32_u24 v3, 912, v3
    v_lshrrev_b32 v4, 4, v1
    v_lshl_add_u32 v3, v4, 4, v3
    v_add_u32 v3, s25, v3
    s_add_u32 s28, s62, s40
    s_addc_u32 s29, s63, 0
    s_waitcnt vmcnt(13)
    v_mfma_f32_16x16x32_bf16 a[0:3], a[176:179], v[192:195], a[0:3]
    s_waitcnt vmcnt(12)
    v_mfma_f32_16x16x32_bf16 a[4:7], a[180:183], v[192:195], a[4:7]
    s_waitcnt vmcnt(11)
    v_mfma_f32_16x16x32_bf16 a[8:11], a[184:187], v[192:195], a[8:11]
    s_waitcnt vmcnt(10)
    v_mfma_f32_16x16x32_bf16 a[12:15], a[188:191], v[192:195], a[12:15]
    ds_write_b128 v3, a[0:3] offset:0
    s_waitcnt vmcnt(9)
    v_mfma_f32_16x16x32_bf16 a[16:19], a[192:195], v[192:195], a[16:19]
    ds_write_b128 v3, a[4:7] offset:64
    s_waitcnt vmcnt(8)
    v_mfma_f32_16x16x32_bf16 a[20:23], a[196:199], v[192:195], a[20:23]
    ds_write_b128 v3, a[8:11] offset:128
    s_waitcnt vmcnt(7)
    v_mfma_f32_16x16x32_bf16 a[24:27], a[200:203], v[192:195], a[24:27]
    ds_write_b128 v3, a[12:15] offset:192
    s_waitcnt vmcnt(6)
    v_mfma_f32_16x16x32_bf16 a[28:31], a[204:207], v[192:195], a[28:31]
    ds_write_b128 v3, a[16:19] offset:256
    s_waitcnt vmcnt(5)
    v_mfma_f32_16x16x32_bf16 a[32:35], a[208:211], v[192:195], a[32:35]
    ds_write_b128 v3, a[20:23] offset:320
    s_waitcnt vmcnt(4)
    v_mfma_f32_16x16x32_bf16 a[36:39], a[212:215], v[192:195], a[36:39]
    ds_write_b128 v3, a[24:27] offset:384
    s_waitcnt vmcnt(3)
    v_mfma_f32_16x16x32_bf16 a[40:43], a[216:219], v[192:195], a[40:43]
    ds_write_b128 v3, a[28:31] offset:448
    s_waitcnt vmcnt(2)
    v_mfma_f32_16x16x32_bf16 a[44:47], a[220:223], v[192:195], a[44:47]
    ds_write_b128 v3, a[32:35] offset:512
    s_waitcnt vmcnt(1)
    v_mfma_f32_16x16x32_bf16 a[48:51], a[224:227], v[192:195], a[48:51]
    ds_write_b128 v3, a[36:39] offset:576
    s_waitcnt vmcnt(0)
    v_mfma_f32_16x16x32_bf16 a[52:55], a[228:231], v[192:195], a[52:55]
    ds_write_b128 v3, a[40:43] offset:640
    s_nop 7
    ds_write_b128 v3, a[44:47] offset:704
    ds_write_b128 v3, a[48:51] offset:768
    ds_write_b128 v3, a[52:55] offset:832
    s_waitcnt lgkmcnt(0)
    s_barrier
    ds_read_b128 v[16:19], v216 offset:0
    ds_read_b128 v[20:23], v216 offset:16
    ds_read_b128 v[24:27], v216 offset:14592
    ds_read_b128 v[28:31], v216 offset:14608
    ds_read_b128 v[32:35], v216 offset:29184
    ds_read_b128 v[36:39], v216 offset:29200
    ds_read_b128 v[40:43], v216 offset:43776
    ds_read_b128 v[44:47], v216 offset:43792
    ds_read_b128 v[56:59], v217 offset:0
    ds_read_b128 v[60:63], v217 offset:16
    ds_read_b128 v[64:67], v217 offset:14592
    ds_read_b128 v[68:71], v217 offset:14608
    ds_read_b128 v[72:75], v217 offset:29184
    ds_read_b128 v[76:79], v217 offset:29200
    ds_read_b128 v[80:83], v217 offset:43776
    ds_read_b128 v[84:87], v217 offset:43792
    s_waitcnt lgkmcnt(8)
    v_pk_add_f32 v[16:17], v[16:17], v[24:25]
    v_pk_add_f32 v[32:33], v[32:33], v[40:41]
    v_pk_add_f32 v[16:17], v[16:17], v[32:33]
    v_pk_add_f32 v[18:19], v[18:19], v[26:27]
    v_pk_add_f32 v[34:35], v[34:35], v[42:43]
    v_pk_add_f32 v[18:19], v[18:19], v[34:35]
    v_pk_add_f32 v[20:21], v[20:21], v[28:29]
    v_pk_add_f32 v[36:37], v[36:37], v[44:45]
    v_pk_add_f32 v[20:21], v[20:21], v[36:37]
    v_pk_add_f32 v[22:23], v[22:23], v[30:31]
    v_pk_add_f32 v[38:39], v[38:39], v[46:47]
    v_pk_add_f32 v[22:23], v[22:23], v[38:39]
    v_cvt_pk_bf16_f32 v24, v16, v17
    v_lshlrev_b32 v16, 16, v24
    v_and_b32 v17, 0xffff0000, v24
    v_lshlrev_b32 v24, 16, v208
    v_and_b32 v25, 0xffff0000, v208
    v_mul_f32 v16, v16, v24
    v_mul_f32 v17, v17, v25
    v_cvt_pk_bf16_f32 v24, v16, v17
    v_lshlrev_b32 v16, 16, v24
    v_and_b32 v17, 0xffff0000, v24
    v_lshlrev_b32 v24, 16, v200
    v_and_b32 v25, 0xffff0000, v200
    v_add_f32 v16, v16, v24
    v_add_f32 v17, v17, v25
    v_cvt_pk_bf16_f32 v52, v16, v17
    v_cvt_pk_bf16_f32 v24, v18, v19
    v_lshlrev_b32 v18, 16, v24
    v_and_b32 v19, 0xffff0000, v24
    v_lshlrev_b32 v24, 16, v209
    v_and_b32 v25, 0xffff0000, v209
    v_mul_f32 v18, v18, v24
    v_mul_f32 v19, v19, v25
    v_cvt_pk_bf16_f32 v24, v18, v19
    v_lshlrev_b32 v18, 16, v24
    v_and_b32 v19, 0xffff0000, v24
    v_lshlrev_b32 v24, 16, v201
    v_and_b32 v25, 0xffff0000, v201
    v_add_f32 v18, v18, v24
    v_add_f32 v19, v19, v25
    v_cvt_pk_bf16_f32 v53, v18, v19
    v_cvt_pk_bf16_f32 v24, v20, v21
    v_lshlrev_b32 v20, 16, v24
    v_and_b32 v21, 0xffff0000, v24
    v_lshlrev_b32 v24, 16, v210
    v_and_b32 v25, 0xffff0000, v210
    v_mul_f32 v20, v20, v24
    v_mul_f32 v21, v21, v25
    v_cvt_pk_bf16_f32 v24, v20, v21
    v_lshlrev_b32 v20, 16, v24
    v_and_b32 v21, 0xffff0000, v24
    v_lshlrev_b32 v24, 16, v202
    v_and_b32 v25, 0xffff0000, v202
    v_add_f32 v20, v20, v24
    v_add_f32 v21, v21, v25
    v_cvt_pk_bf16_f32 v54, v20, v21
    v_cvt_pk_bf16_f32 v24, v22, v23
    v_lshlrev_b32 v22, 16, v24
    v_and_b32 v23, 0xffff0000, v24
    v_lshlrev_b32 v24, 16, v211
    v_and_b32 v25, 0xffff0000, v211
    v_mul_f32 v22, v22, v24
    v_mul_f32 v23, v23, v25
    v_cvt_pk_bf16_f32 v24, v22, v23
    v_lshlrev_b32 v22, 16, v24
    v_and_b32 v23, 0xffff0000, v24
    v_lshlrev_b32 v24, 16, v203
    v_and_b32 v25, 0xffff0000, v203
    v_add_f32 v22, v22, v24
    v_add_f32 v23, v23, v25
    v_cvt_pk_bf16_f32 v55, v22, v23
    global_store_dwordx4 v218, v[52:55], s[28:29]
    s_waitcnt lgkmcnt(0)
    v_pk_add_f32 v[56:57], v[56:57], v[64:65]
    v_pk_add_f32 v[72:73], v[72:73], v[80:81]
    v_pk_add_f32 v[56:57], v[56:57], v[72:73]
    v_pk_add_f32 v[58:59], v[58:59], v[66:67]
    v_pk_add_f32 v[74:75], v[74:75], v[82:83]
    v_pk_add_f32 v[58:59], v[58:59], v[74:75]
    v_pk_add_f32 v[60:61], v[60:61], v[68:69]
    v_pk_add_f32 v[76:77], v[76:77], v[84:85]
    v_pk_add_f32 v[60:61], v[60:61], v[76:77]
    v_pk_add_f32 v[62:63], v[62:63], v[70:71]
    v_pk_add_f32 v[78:79], v[78:79], v[86:87]
    v_pk_add_f32 v[62:63], v[62:63], v[78:79]
    v_cvt_pk_bf16_f32 v64, v56, v57
    v_lshlrev_b32 v56, 16, v64
    v_and_b32 v57, 0xffff0000, v64
    v_lshlrev_b32 v64, 16, v212
    v_and_b32 v65, 0xffff0000, v212
    v_mul_f32 v56, v56, v64
    v_mul_f32 v57, v57, v65
    v_cvt_pk_bf16_f32 v64, v56, v57
    v_lshlrev_b32 v56, 16, v64
    v_and_b32 v57, 0xffff0000, v64
    v_lshlrev_b32 v64, 16, v204
    v_and_b32 v65, 0xffff0000, v204
    v_add_f32 v56, v56, v64
    v_add_f32 v57, v57, v65
    v_cvt_pk_bf16_f32 v92, v56, v57
    v_cvt_pk_bf16_f32 v64, v58, v59
    v_lshlrev_b32 v58, 16, v64
    v_and_b32 v59, 0xffff0000, v64
    v_lshlrev_b32 v64, 16, v213
    v_and_b32 v65, 0xffff0000, v213
    v_mul_f32 v58, v58, v64
    v_mul_f32 v59, v59, v65
    v_cvt_pk_bf16_f32 v64, v58, v59
    v_lshlrev_b32 v58, 16, v64
    v_and_b32 v59, 0xffff0000, v64
    v_lshlrev_b32 v64, 16, v205
    v_and_b32 v65, 0xffff0000, v205
    v_add_f32 v58, v58, v64
    v_add_f32 v59, v59, v65
    v_cvt_pk_bf16_f32 v93, v58, v59
    v_cvt_pk_bf16_f32 v64, v60, v61
    v_lshlrev_b32 v60, 16, v64
    v_and_b32 v61, 0xffff0000, v64
    v_lshlrev_b32 v64, 16, v214
    v_and_b32 v65, 0xffff0000, v214
    v_mul_f32 v60, v60, v64
    v_mul_f32 v61, v61, v65
    v_cvt_pk_bf16_f32 v64, v60, v61
    v_lshlrev_b32 v60, 16, v64
    v_and_b32 v61, 0xffff0000, v64
    v_lshlrev_b32 v64, 16, v206
    v_and_b32 v65, 0xffff0000, v206
    v_add_f32 v60, v60, v64
    v_add_f32 v61, v61, v65
    v_cvt_pk_bf16_f32 v94, v60, v61
    v_cvt_pk_bf16_f32 v64, v62, v63
    v_lshlrev_b32 v62, 16, v64
    v_and_b32 v63, 0xffff0000, v64
    v_lshlrev_b32 v64, 16, v215
    v_and_b32 v65, 0xffff0000, v215
    v_mul_f32 v62, v62, v64
    v_mul_f32 v63, v63, v65
    v_cvt_pk_bf16_f32 v64, v62, v63
    v_lshlrev_b32 v62, 16, v64
    v_and_b32 v63, 0xffff0000, v64
    v_lshlrev_b32 v64, 16, v207
    v_and_b32 v65, 0xffff0000, v207
    v_add_f32 v62, v62, v64
    v_add_f32 v63, v63, v65
    v_cvt_pk_bf16_f32 v95, v62, v63
    global_store_dwordx4 v219, v[92:95], s[28:29]
    s_barrier
    s_add_u32 s71, s71, 182
    s_cmp_lt_u32 s71, 256
    s_cbranch_scc1 Lxl_119
    s_sub_u32 s72, s71, 182
    s_add_u32 s72, s72, 1000
Lexit_1:
    s_endpgm
.section .rodata,"a"
.p2align 6
.amdhsa_kernel recurrent_scan__memory_aug_recurrent_mem_tr__glu_gated_swiglu__prompt_kernel
  .amdhsa_next_free_vgpr 512
  .amdhsa_next_free_sgpr 102
  .amdhsa_accum_offset 256
  .amdhsa_group_segment_fixed_size 0
  .amdhsa_kernarg_size 112
  .amdhsa_user_sgpr_count 2
  .amdhsa_user_sgpr_kernarg_segment_ptr 1
  .amdhsa_system_sgpr_workgroup_id_x 1
  .amdhsa_float_denorm_mode_32 3
.end_amdhsa_kernel
```
